```python
import torch

def _softmax(x, axis=-1):
    return torch.softmax(x, dim=axis)
def _gelu(x):
    return torch.nn.functional.gelu(x, approximate="tanh")
def _silu(x):
    return torch.nn.functional.silu(x)
def _sigmoid(x):
    return torch.sigmoid(x)
def _layernorm(x, axis=-1, eps=1e-5):
    m = x.mean(dim=axis, keepdim=True)
    v = x.var(dim=axis, keepdim=True, unbiased=False)
    return (x - m) / torch.sqrt(v + eps)
def _scatter_add(tgt, idx, src, axis=0):
    return tgt.clone().index_add_(axis, idx, src)
def _segment_sum(src, seg, n):
    out = torch.zeros((n,) + src.shape[1:], dtype=src.dtype)
    return out.index_add_(0, seg, src)
def _pad(x, pw):
    flat = tuple(v for pair in reversed(pw) for v in pair)
    return torch.nn.functional.pad(x, flat)

kernel_name = 'interleave_layers__linear_kernel_hedgehog__glu_gated_geglu__prompt'

def setup_inputs():

    _w = (lambda a: (lambda t: t.to(torch.bfloat16) if t.is_floating_point() else t)(torch.as_tensor(a)))
    def _A_setup():
        B, S, D, H = 1, 2048, 512, 32
        Dh = D // H
        return {
            "x": _w((lambda *s: torch.randn(*s, dtype=torch.bfloat16) * 0.05)(B, S, D)),
            "wqkv": _w((lambda *s: torch.randn(*s, dtype=torch.bfloat16) * 0.4)(D, 3 * D)),
            "w_phi": _w((lambda *s: torch.randn(*s, dtype=torch.bfloat16) * 0.4)(H, Dh, Dh) * (Dh ** -0.5)),
            "wo": _w((lambda *s: torch.randn(*s, dtype=torch.bfloat16) * 0.05)(D, D)),
        }
    _A_in = _A_setup()

    def _B_setup():
        B, S, Dm, Df = 1, 2048, 512, 1792
        return {
            "x": _w((lambda *s: torch.randn(*s, dtype=torch.bfloat16) * 0.05)(B, S, Dm)),
            "w_gate": _w((lambda *s: torch.randn(*s, dtype=torch.bfloat16) * 1.6)(Dm, Df) * (Dm ** -0.5)),
            "w_up": _w((lambda *s: torch.randn(*s, dtype=torch.bfloat16) * 1.6)(Dm, Df) * (Dm ** -0.5)),
            "w_down": _w((lambda *s: torch.randn(*s, dtype=torch.bfloat16) * 1.6)(Df, Dm) * (Df ** -0.5)),
        }
    _B_in = _B_setup()

    return {
        "A_x": _A_in["x"],
        "A_wqkv": _A_in["wqkv"],
        "A_w_phi": _A_in["w_phi"],
        "A_wo": _A_in["wo"],
        "B_x": _B_in["x"],
        "B_w_gate": _B_in["w_gate"],
        "B_w_up": _B_in["w_up"],
        "B_w_down": _B_in["w_down"],
    }

def reference(A_x, A_wqkv, A_w_phi, A_wo, B_x, B_w_gate, B_w_up, B_w_down):
    def _A_ref(x, wqkv, w_phi, wo):
        B, S, D = x.shape
        H = 32; Dh = D // H
        qkv = (lambda x, *d: x.permute(*d))((x @ wqkv).reshape(B, S, 3, H, Dh), 2, 0, 3, 1, 4)
        q, k, v = qkv[0], qkv[1], qkv[2]
        pq = torch.einsum("bhsd,hdf->bhsf", q, w_phi)
        pk = torch.einsum("bhsd,hdf->bhsf", k, w_phi)
        phi_q = torch.concatenate([_softmax(pq, axis=-1), _softmax(-pq, axis=-1)], axis=-1)
        phi_k = torch.concatenate([_softmax(pk, axis=-1), _softmax(-pk, axis=-1)], axis=-1)
        kv = torch.einsum("bhsf,bhsd->bhfd", phi_k, v)
        z  = torch.einsum("bhsf->bhf", phi_k)
        num = torch.einsum("bhqf,bhfd->bhqd", phi_q, kv)
        den = torch.einsum("bhqf,bhf->bhq", phi_q, z)[..., None] + 1e-6
        o = num / den
        return (lambda x, *d: x.permute(*d))(o, 0, 2, 1, 3).reshape(B, S, D) @ wo

    def _B_ref(x, w_gate, w_up, w_down):
        g = torch.einsum("bsd,df->bsf", x, w_gate)
        u = torch.einsum("bsd,df->bsf", x, w_up)
        h = _gelu(g) * u
        return torch.einsum("bsf,fd->bsd", h, w_down)

    x = A_x
    x = x + _A_ref(_layernorm(x, axis=-1), A_wqkv, A_w_phi, A_wo)
    x = x + _B_ref(_layernorm(x, axis=-1), B_w_gate, B_w_up, B_w_down)
    x = x + _A_ref(_layernorm(x, axis=-1), A_wqkv, A_w_phi, A_wo)
    x = x + _B_ref(_layernorm(x, axis=-1), B_w_gate, B_w_up, B_w_down)
    return x
```

```asm
; @launch grid=(256,1,1) block=(256,1,1) lds=163840
.amdgcn_target "amdgcn-amd-amdhsa--gfx950"
.text
.globl interleave_layers__linear_kernel_hedgehog__glu_gated_geglu__prompt_kernel
.p2align 8
.type interleave_layers__linear_kernel_hedgehog__glu_gated_geglu__prompt_kernel,@function
interleave_layers__linear_kernel_hedgehog__glu_gated_geglu__prompt_kernel:
s_cmp_ge_u32 s2, 256
s_cbranch_scc1 L_done
s_load_dwordx16 s[52:67], s[0:1], 0
s_load_dwordx2 s[8:9], s[0:1], 64
s_load_dwordx2 s[90:91], s[0:1], 72
s_load_dwordx2 s[4:5], s[0:1], 80
s_getpc_b64 s[26:27]
s_lshr_b32 s28, s2, 3
s_lshl_b32 s28, s28, 4
v_add_u32 v40, s28, v0
v_lshlrev_b32 v40, 7, v40
v_min_u32 v40, L_code_end-interleave_layers__linear_kernel_hedgehog__glu_gated_geglu__prompt_kernel-256, v40
v_cmp_gt_u32 vcc, 16, v0
s_nop 0
s_and_saveexec_b64 s[24:25], vcc
s_cbranch_execz L_nowarm
global_load_dword v5, v40, s[26:27]
L_nowarm:
s_mov_b64 exec, -1
v_lshrrev_b32 v1, 6, v0
v_and_b32 v0, 63, v0
v_readfirstlane_b32 s3, v1
v_lshlrev_b32 v1, 4, v0
v_and_b32 v44, 7, v0
v_lshrrev_b32 v45, 3, v0
s_and_b32 s16, s2, 15
s_lshr_b32 s17, s2, 4
s_lshl_b32 s21, s3, 13
s_lshl_b32 s75, s3, 15
s_mov_b32 s6, 40894464
s_mov_b32 s7, 0x20000
s_mov_b32 s50, 2097152
s_mov_b32 s51, 0x20000
s_mov_b32 s95, 0x20000
s_mov_b32 s99, 0x20000
s_lshr_b32 s69, s2, 3
s_and_b32 s71, s2, 7
s_lshl_b32 s26, s71, 2
s_add_u32 s72, s26, s3
s_cmp_lt_u32 s2, 192
s_cselect_b32 s68, 3, 1
s_cselect_b32 s27, 0, 24
s_lshl_b32 s94, s68, 19
s_lshl_b32 s68, s68, 10
s_sub_u32 s69, s69, s27
s_lshl_b32 s26, s72, 4
s_mul_i32 s26, s26, s68
s_lshl_b32 s27, s69, 7
s_add_u32 s26, s26, s27
s_lshl_b32 s27, s68, 3
s_add_u32 s27, s27, s26
v_mul_lo_u32 v47, v45, s68
v_lshl_add_u32 v47, v44, 4, v47
s_lshl_b32 s70, s16, 17
s_add_u32 s70, s70, s75
s_lshr_b32 s75, s75, 1
s_add_u32 s75, s75, 32768
s_lshl_b32 s28, s17, 10
s_mov_b32 s98, 16384
s_mov_b32 m0, s21
s_cmp_lt_u32 s2, 192
s_waitcnt lgkmcnt(0)
s_cselect_b32 s92, s54, s58
s_cselect_b32 s93, s55, s59
s_mov_b32 s48, s52
s_mov_b32 s49, s53
s_mov_b32 s96, s56
s_mov_b32 s97, s57
buffer_load_dwordx4 v47, s[92:95], s26 offen lds
s_add_u32 m0, s21, 1024
s_nop 0
buffer_load_dwordx4 v47, s[92:95], s27 offen lds
buffer_load_dwordx4 v[112:115], v1, s[96:99], s28 offen
s_or_b32 s26, s2, s3
s_cbranch_scc1 L_notag_1
s_memrealtime s[100:101]
s_waitcnt lgkmcnt(0)
s_or_b32 s100, s100, 1
s_and_b32 s101, s101, 0x7fffff
s_or_b32 s101, s101, 0x800000
v_mov_b32 v40, s100
v_mov_b32 v41, s101
v_mov_b32 v42, 0
s_mov_b64 exec, 1
global_store_dwordx2 v42, v[40:41], s[90:91] sc1
s_mov_b64 exec, -1
L_notag_1:
s_lshl_b32 s68, s17, 11
v_lshrrev_b32 v48, 5, v0
v_and_b32 v46, 31, v0
v_xor_b32 v46, v46, v48
v_lshlrev_b32 v46, 4, v46
v_lshl_add_u32 v46, v48, 10, v46
s_add_u32 s52, s70, 512
s_add_u32 s26, s68, 0
s_add_u32 m0, s75, 65536
s_and_b32 s26, s26, 0x7fff
v_xor_b32 v49, 0, v46
s_add_u32 s26, s26, s52
buffer_load_dwordx4 v49, s[48:51], s26 offen lds
s_add_u32 s26, s68, 0
s_add_u32 m0, s75, 0
s_and_b32 s26, s26, 0x7fff
v_xor_b32 v48, 0, v46
s_add_u32 s26, s26, s70
buffer_load_dwordx4 v48, s[48:51], s26 offen lds
s_getreg_b32 s13, hwreg(HW_REG_XCC_ID, 0, 4)
s_mov_b32 s22, 1065369472
s_mov_b32 s24, -1
s_mov_b32 s25, 0
s_mov_b32 s29, 200000
s_lshl_b32 s26, s17, 2
s_add_u32 s26, s26, s3
s_lshl_b32 s86, s26, 13
s_lshl_b32 s31, s26, 10
v_lshrrev_b32 v52, 5, v0
v_bfe_u32 v53, v0, 2, 2
v_lshl_add_u32 v52, v52, 3, v53
v_lshlrev_b32 v56, 5, v52
v_lshlrev_b32 v52, 7, v52
v_and_b32 v53, 1, v0
v_lshl_add_u32 v52, v53, 4, v52
v_bfe_u32 v53, v0, 1, 1
v_lshl_add_u32 v52, v53, 3, v52
v_lshl_add_u32 v56, v53, 3, v56
v_bfe_u32 v53, v0, 4, 1
v_lshl_add_u32 v56, v53, 4, v56
v_add_u32 v56, s21, v56
v_add_u32 v52, s21, v52
v_lshl_add_u32 v57, v53, 5, v52
v_lshl_add_u32 v58, v53, 11, v52
v_mov_b32 v72, -1
v_mov_b32 v73, -1
v_mov_b32 v74, -1
v_mov_b32 v75, -1
v_mov_b32 v76, 0
v_and_b32 v77, 31, v0
v_lshlrev_b32 v77, 4, v77
v_lshrrev_b32 v78, 5, v0
v_mul_u32_u24 v78, 655360, v78
v_add_u32 v77, v77, v78
v_lshlrev_b32 v78, 2, v0
v_mov_b32 v42, 0
s_lshr_b32 s26, s69, 3
s_add_u32 s26, s26, 2
s_cmp_ge_u32 s26, 3
s_cselect_b32 s27, 3, 0
s_sub_u32 s26, s26, s27
s_and_b32 s27, s69, 7
s_mul_i32 s27, s27, 20
s_add_u32 s26, s26, s27
s_lshl_b32 s12, s26, 15
s_add_u32 s14, s12, 327680
s_lshl_b32 s26, s72, 10
s_add_u32 s15, s12, s26
s_add_u32 s23, s14, s26
s_lshl_b32 s26, s69, 16
s_lshr_b32 s27, s72, 1
s_lshl_b32 s27, s27, 12
s_add_u32 s26, s26, s27
s_and_b32 s27, s72, 1
s_lshl_b32 s27, s27, 9
s_add_u32 s26, s26, s27
s_add_u32 s26, s26, 5242880
s_add_u32 s27, s26, 2048
s_cmp_lt_u32 s2, 192
s_cselect_b64 vcc, -1, 0
s_cselect_b32 s15, s15, s26
s_cselect_b32 s23, s23, s27
s_cselect_b32 s36, 0, 40894464
s_lshl_b32 s37, s71, 7
s_add_u32 s37, s37, 9961472
s_add_u32 s36, s36, s37
s_lshl_b32 s26, s16, 9
s_add_u32 s26, s26, s86
s_add_u32 s26, s26, 8388608
s_lshl_b32 s27, s16, 6
s_add_u32 s27, s27, s31
s_add_u32 s27, s27, 8912896
s_lshl_b32 s28, s2, 8
s_add_u32 s28, s28, 7733248
s_cmp_eq_u32 s3, 0
s_cselect_b32 s28, s28, 40894464
buffer_store_dwordx4 v[72:75], v77, s[4:7], s26 offen sc1
s_mov_b32 exec_lo, 0xf
s_mov_b32 exec_hi, 0xf
buffer_store_dwordx4 v[72:75], v77, s[4:7], s27 offen sc1
s_mov_b64 exec, -1
buffer_store_dword v76, v78, s[4:7], s28 offen sc1
v_bfe_u32 v53, v0, 4, 1
v_lshlrev_b32 v39, 10, v53
v_lshrrev_b32 v53, 5, v0
v_lshl_add_u32 v39, v53, 8, v39
v_and_b32 v53, 15, v0
v_lshl_add_u32 v39, v53, 4, v39
v_cndmask_b32 v38, v39, v1, vcc
v_and_b32 v54, 0xffffff80, v52
v_and_b32 v53, 3, v0
v_lshl_add_u32 v54, v53, 4, v54
v_bfe_u32 v53, v0, 4, 1
v_lshl_add_u32 v54, v53, 3, v54
v_cndmask_b32 v55, v54, v57, vcc
v_mov_b32 v57, v54
s_waitcnt vmcnt(5)
ds_read_b64_tr_b16 v[64:65], v55 offset:0
ds_read_b64_tr_b16 v[66:67], v55 offset:512
ds_read_b64_tr_b16 v[68:69], v55 offset:64
ds_read_b64_tr_b16 v[70:71], v55 offset:576
global_load_dwordx2 v[40:41], v42, s[90:91] sc1
s_add_u32 s26, s68, 2048
s_add_u32 m0, s75, 1024
s_and_b32 s26, s26, 0x7fff
v_xor_b32 v49, 32, v46
s_add_u32 s26, s26, s70
buffer_load_dwordx4 v49, s[48:51], s26 offen lds
s_waitcnt lgkmcnt(2)
buffer_store_dwordx4 v[64:67], v38, s[4:7], s15 offen sc1
s_waitcnt lgkmcnt(0)
buffer_store_dwordx4 v[68:71], v38, s[4:7], s23 offen sc1
v_add_u32 v43, s21, v1
ds_write_b128 v43, v[112:115] offset:1024
ds_read_b64_tr_b16 v[14:15], v56 offset:1024
ds_read_b64_tr_b16 v[16:17], v56 offset:1152
ds_read_b64_tr_b16 v[18:19], v56 offset:1536
ds_read_b64_tr_b16 v[20:21], v56 offset:1664
v_dot2_f32_bf16 v80, v64, s22, 0
v_dot2_f32_bf16 v81, v68, s22, 0
v_dot2_f32_bf16 v80, v65, s22, v80
v_dot2_f32_bf16 v81, v69, s22, v81
v_dot2_f32_bf16 v80, v66, s22, v80
v_dot2_f32_bf16 v81, v70, s22, v81
v_dot2_f32_bf16 v80, v67, s22, v80
v_dot2_f32_bf16 v81, v71, s22, v81
s_nop 2
v_permlane32_swap_b32 v80, v81
v_add_f32 v80, v80, v81
v_lshlrev_b32 v104, 2, v0
v_add_u32 v105, s21, v104
ds_write_b32 v105, v80 offset:0
s_and_b32 s27, s3, 0
v_lshl_add_u32 v104, s27, 8, v104
s_cmp_eq_u32 s3, 0
s_cselect_b32 s27, s12, s12
s_cselect_b32 s28, s14, s14
s_lshr_b32 s27, s27, 5
s_lshr_b32 s28, s28, 5
v_mov_b32 v52, s27
v_mov_b32 v53, s28
v_and_b32 v105, 31, v0
v_cndmask_b32 v52, v53, v52, s[24:25]
v_lshl_add_u32 v105, v105, 2, v52
s_cmp_lt_u32 s3, 1
s_cselect_b32 s56, s36, 40894464
s_waitcnt lgkmcnt(0)
s_barrier
ds_read_b32 v106, v104 offset:0
ds_read_b32 v107, v104 offset:8192
ds_read_b32 v108, v104 offset:16384
ds_read_b32 v109, v104 offset:24576
s_add_u32 s26, s68, 4096
s_add_u32 m0, s75, 2048
s_and_b32 s26, s26, 0x7fff
v_xor_b32 v48, 64, v46
s_add_u32 s26, s26, s70
buffer_load_dwordx4 v48, s[48:51], s26 offen lds
s_waitcnt lgkmcnt(0)
v_add_f32 v106, v106, v107
v_add_f32 v108, v108, v109
v_add_f32 v106, v106, v108
buffer_store_dword v106, v105, s[4:7], s56 offen sc1
s_cmp_lt_u32 s2, 224
s_cselect_b32 s94, 1835008, 0
s_cselect_b32 s53, 0, 40894464
s_mov_b32 s98, s94
s_mov_b32 s92, s62
s_mov_b32 s93, s63
s_mov_b32 s96, s64
s_mov_b32 s97, s65
s_mul_i32 s58, s72, 57344
s_lshr_b32 s63, s2, 3
s_lshl_b32 s28, s63, 7
s_add_u32 s58, s58, s28
s_add_u32 s59, s58, 28672
v_mul_u32_u24 v59, 3584, v45
v_lshl_add_u32 v59, v44, 4, v59
s_add_u32 m0, s21, 4096
s_nop 0
buffer_load_dwordx4 v59, s[92:95], s58 offen lds
s_add_u32 m0, s21, 5120
s_nop 0
buffer_load_dwordx4 v59, s[92:95], s59 offen lds
s_add_u32 m0, s21, 6144
s_nop 0
buffer_load_dwordx4 v59, s[96:99], s58 offen lds
s_add_u32 m0, s21, 7168
s_nop 0
buffer_load_dwordx4 v59, s[96:99], s59 offen lds
s_mov_b32 s92, s66
s_mov_b32 s93, s67
s_mov_b32 s94, 1835008
s_lshr_b32 s27, s2, 3
s_lshl_b32 s27, s27, 2
s_add_u32 s27, s27, s3
s_and_b32 s28, s2, 7
s_mul_i32 s57, s28, 229376
s_mul_i32 s58, s27, 9363
s_lshr_b32 s58, s58, 16
s_and_b32 s59, s58, 1
s_lshl_b32 s59, s59, 9
s_add_u32 s57, s57, s59
s_add_u32 s58, s58, 1
s_lshr_b32 s58, s58, 1
s_mul_i32 s58, s58, 7
s_sub_u32 s58, s27, s58
s_lshl_b32 s58, s58, 12
s_add_u32 s57, s57, s58
s_add_u32 s57, s57, s53
s_add_u32 s57, s57, 5767168
s_lshl_b32 s27, s27, 14
s_lshl_b32 s28, s28, 7
s_add_u32 s27, s27, s28
s_add_u32 s28, s27, 7168
v_lshlrev_b32 v59, 10, v45
v_lshl_add_u32 v59, v44, 4, v59
s_add_u32 m0, s21, 2048
s_nop 0
buffer_load_dwordx4 v59, s[92:95], s27 offen lds
buffer_load_dwordx4 v59, s[92:95], s28 offen offset:1024 lds
s_add_u32 s26, s68, 6144
s_add_u32 m0, s75, 3072
s_and_b32 s26, s26, 0x7fff
v_xor_b32 v49, 96, v46
s_add_u32 s26, s26, s70
buffer_load_dwordx4 v49, s[48:51], s26 offen lds
s_lshl_b32 s63, s63, 2
s_lshl_b32 s72, s72, 10
s_add_u32 s72, s72, s53
s_add_u32 s26, s68, 8192
s_add_u32 m0, s75, 4096
s_and_b32 s26, s26, 0x7fff
v_xor_b32 v48, 128, v46
s_add_u32 s26, s26, s70
buffer_load_dwordx4 v48, s[48:51], s26 offen lds
s_add_u32 s65, s37, s53
v_add_u32 v2, 65536, v1
v_add_u32 v3, 131072, v1
v_bfe_u32 v54, v0, 2, 1
v_mul_u32_u24 v54, 0x8000, v54
v_lshl_or_b32 v54, v54, 16, v54
v_xor_b32 v14, v54, v14
v_xor_b32 v15, v54, v15
v_xor_b32 v16, v54, v16
v_xor_b32 v17, v54, v17
v_xor_b32 v18, v54, v18
v_xor_b32 v19, v54, v19
v_xor_b32 v20, v54, v20
v_xor_b32 v21, v54, v21
s_waitcnt vmcnt(8)
v_min_u32 v43, v40, v41
v_cmp_eq_u32 vcc, 0, v43
s_nop 0
s_cbranch_vccnz L_tag_2
L_tagok_3:
v_readfirstlane_b32 s73, v40
v_readfirstlane_b32 s74, v41
s_lshl_b32 s26, s13, 24
s_or_b32 s74, s74, s26
s_barrier
s_cmp_lg_u32 s3, 3
s_cbranch_scc1 L_nosig_4
v_mov_b32 v60, s73
v_mov_b32 v61, s74
v_mov_b32 v62, s73
v_mov_b32 v63, s74
s_lshl_b32 s26, s2, 7
s_add_u32 s26, s26, 10485760
s_mov_b64 exec, 0xff
buffer_store_dwordx4 v[60:63], v1, s[4:7], s26 offen sc1
s_mov_b64 exec, -1
L_nosig_4:
s_add_u32 s26, s68, 10240
s_add_u32 m0, s75, 5120
s_and_b32 s26, s26, 0x7fff
v_xor_b32 v49, 160, v46
s_add_u32 s26, s26, s70
buffer_load_dwordx4 v49, s[48:51], s26 offen lds
s_add_u32 s26, s68, 12288
s_add_u32 m0, s75, 6144
s_and_b32 s26, s26, 0x7fff
v_xor_b32 v48, 192, v46
s_add_u32 s26, s26, s70
buffer_load_dwordx4 v48, s[48:51], s26 offen lds
s_add_u32 s26, s68, 14336
s_add_u32 m0, s75, 7168
s_and_b32 s26, s26, 0x7fff
v_xor_b32 v49, 224, v46
s_add_u32 s26, s26, s70
buffer_load_dwordx4 v49, s[48:51], s26 offen lds
s_add_u32 s26, s68, 16384
s_add_u32 m0, s75, 8192
s_and_b32 s26, s26, 0x7fff
v_xor_b32 v48, 0, v46
s_add_u32 s26, s26, s70
buffer_load_dwordx4 v48, s[48:51], s26 offen lds
v_mov_b32 v4, 1
s_mov_b32 s10, 2097152
s_mov_b32 s11, 0x20000
s_and_b32 s18, s17, 1
s_lshr_b32 s19, s17, 1
s_mul_i32 s20, s17, 327680
s_add_u32 s20, s20, s21
s_add_u32 s62, s63, 0
s_mul_i32 s28, s62, 9363
s_lshr_b32 s28, s28, 16
s_mul_i32 s28, s28, 3
s_add_u32 s62, s62, s28
s_add_u32 s62, s62, 3
s_lshl_b32 s60, s62, 15
s_add_u32 s62, s63, 1
s_mul_i32 s28, s62, 9363
s_lshr_b32 s28, s28, 16
s_mul_i32 s28, s28, 3
s_add_u32 s62, s62, s28
s_add_u32 s62, s62, 3
s_lshl_b32 s61, s62, 15
s_add_u32 s62, s63, 2
s_mul_i32 s28, s62, 9363
s_lshr_b32 s28, s28, 16
s_mul_i32 s28, s28, 3
s_add_u32 s62, s62, s28
s_add_u32 s62, s62, 3
s_lshl_b32 s54, s62, 15
s_add_u32 s62, s63, 3
s_mul_i32 s28, s62, 9363
s_lshr_b32 s28, s28, 16
s_mul_i32 s28, s28, 3
s_add_u32 s62, s62, s28
s_add_u32 s62, s62, 3
s_lshl_b32 s55, s62, 15
v_mov_b32 v33, 0
v_mov_b32 v34, 0
v_mov_b32 v35, 0
v_mov_b32 v36, 0
v_mov_b32 v25, 0
v_mov_b32 v26, 0
v_mov_b32 v27, 0
s_lshl_b32 s15, s16, 2
s_lshl_b32 s23, s18, 1
s_add_u32 s23, s23, s15
s_add_u32 s15, s15, s3
s_lshl_b32 s80, s15, 15
s_lshl_b32 s81, s15, 11
s_lshl_b32 s64, s17, 11
s_add_u32 s38, s80, s64
s_mul_i32 s32, s15, 114688
s_mul_i32 s64, s19, 14336
s_add_u32 s32, s32, s64
s_lshl_b32 s64, s18, 9
s_add_u32 s32, s32, s64
s_lshl_b32 s88, s23, 15
s_add_u32 s39, s88, s21
s_lshl_b32 s64, s19, 12
s_add_u32 s82, s88, s64
s_lshl_b32 s64, s19, 7
s_add_u32 s88, s88, s64
s_lshl_b32 s83, s23, 11
s_lshl_b32 s64, s19, 8
s_add_u32 s83, s83, s64
s_mul_i32 s87, s23, 114688
s_mul_i32 s64, s3, 28672
s_add_u32 s87, s87, s64
s_lshl_b32 s15, s19, 2
s_add_u32 s15, s15, s3
s_lshl_b32 s85, s15, 14
s_add_u32 s85, s85, 5242880
s_mul_i32 s35, s15, 57344
s_add_u32 s35, s35, 5767168
s_lshl_b32 s14, s16, 8
s_add_u32 s14, s14, 7733248
s_lshl_b32 s64, s18, 5
s_add_u32 s76, s64, s15
s_lshl_b32 s76, s76, 2
s_add_u32 s76, s76, s14
s_lshl_b32 s79, s3, 3
s_add_u32 s79, s79, s64
s_lshl_b32 s79, s79, 2
s_add_u32 s79, s79, s14
s_lshr_b32 s64, s3, 1
s_lshl_b32 s64, s64, 7
s_add_u32 s77, s64, s14
s_lshl_b32 s78, s17, 3
s_add_u32 s78, s78, s77
s_and_b32 s64, s3, 1
s_lshl_b32 s64, s64, 2
s_add_u32 s78, s78, s64
s_add_u32 s76, s76, 4096
s_add_u32 s77, s77, 4096
s_mul_i32 s84, s17, 327680
s_lshr_b32 s64, s16, 3
s_lshl_b32 s64, s64, 14
s_add_u32 s84, s84, s64
s_lshl_b32 s64, s3, 12
s_add_u32 s84, s84, s64
s_lshl_b32 s28, s17, 1
v_subrev_u32 v50, s28, v0
v_and_b32 v50, 31, v50
v_lshlrev_b32 v51, 9, v50
v_add_u32 v51, s75, v51
v_and_b32 v50, 15, v50
v_lshrrev_b32 v54, 5, v0
v_xor_b32 v50, v50, v54
v_lshl_add_u32 v51, v50, 4, v51
v_lshlrev_b32 v54, 10, v44
v_lshl_add_u32 v54, v45, 4, v54
s_lshl_b32 s36, s3, 7
s_lshl_b32 s28, s19, 3
s_add_u32 s36, s36, s28
s_lshl_b32 s28, s17, 4
s_mov_b32 s15, 1
s_mov_b32 s23, 64
s_cmp_eq_u32 s3, 2
s_cselect_b32 s36, s28, s36
s_cselect_b32 s23, 8, s23
s_cmp_eq_u32 s3, 3
s_cselect_b32 s36, s16, s36
s_cselect_b32 s23, 0x80, s23
s_cselect_b32 s15, 16, s15
v_mul_u32_u24 v50, s15, v44
v_and_b32 v55, 1, v45
v_mad_u32_u24 v50, v55, s23, v50
v_lshlrev_b32 v50, 7, v50
s_lshl_b32 s36, s36, 7
s_add_u32 s36, s36, 10485760
s_lshl_b32 s14, s16, 7
s_add_u32 s14, s14, 10485760
s_add_u32 s26, s68, 18432
s_add_u32 m0, s75, 9216
s_and_b32 s26, s26, 0x7fff
v_xor_b32 v49, 32, v46
s_add_u32 s26, s26, s70
buffer_load_dwordx4 v49, s[48:51], s26 offen lds
s_add_u32 s26, s68, 20480
s_add_u32 m0, s75, 10240
s_and_b32 s26, s26, 0x7fff
v_xor_b32 v48, 64, v46
s_add_u32 s26, s26, s70
buffer_load_dwordx4 v48, s[48:51], s26 offen lds
s_add_u32 s26, s68, 22528
s_add_u32 m0, s75, 11264
s_and_b32 s26, s26, 0x7fff
v_xor_b32 v49, 96, v46
s_add_u32 s26, s26, s70
buffer_load_dwordx4 v49, s[48:51], s26 offen lds
s_add_u32 s26, s68, 24576
s_add_u32 m0, s75, 12288
s_and_b32 s26, s26, 0x7fff
v_xor_b32 v48, 128, v46
s_add_u32 s26, s26, s70
buffer_load_dwordx4 v48, s[48:51], s26 offen lds
s_add_u32 s26, s68, 26624
s_add_u32 m0, s75, 13312
s_and_b32 s26, s26, 0x7fff
v_xor_b32 v49, 160, v46
s_add_u32 s26, s26, s70
buffer_load_dwordx4 v49, s[48:51], s26 offen lds
s_add_u32 s26, s68, 28672
s_add_u32 m0, s75, 14336
s_and_b32 s26, s26, 0x7fff
v_xor_b32 v48, 192, v46
s_add_u32 s26, s26, s70
buffer_load_dwordx4 v48, s[48:51], s26 offen lds
s_add_u32 s26, s68, 30720
s_add_u32 m0, s75, 15360
s_and_b32 s26, s26, 0x7fff
v_xor_b32 v49, 224, v46
s_add_u32 s26, s26, s70
buffer_load_dwordx4 v49, s[48:51], s26 offen lds
s_add_u32 s26, s68, 2048
s_add_u32 m0, s75, 66560
s_and_b32 s26, s26, 0x7fff
v_xor_b32 v48, 32, v46
s_add_u32 s26, s26, s52
buffer_load_dwordx4 v48, s[48:51], s26 offen lds
s_add_u32 s26, s68, 4096
s_add_u32 m0, s75, 67584
s_and_b32 s26, s26, 0x7fff
v_xor_b32 v49, 64, v46
s_add_u32 s26, s26, s52
buffer_load_dwordx4 v49, s[48:51], s26 offen lds
s_add_u32 s26, s68, 6144
s_add_u32 m0, s75, 68608
s_and_b32 s26, s26, 0x7fff
v_xor_b32 v48, 96, v46
s_add_u32 s26, s26, s52
buffer_load_dwordx4 v48, s[48:51], s26 offen lds
s_add_u32 s26, s68, 8192
s_add_u32 m0, s75, 69632
s_and_b32 s26, s26, 0x7fff
v_xor_b32 v49, 128, v46
s_add_u32 s26, s26, s52
buffer_load_dwordx4 v49, s[48:51], s26 offen lds
s_waitcnt vmcnt(4)
v_xor_b32 v52, 0, v51
ds_read_b128 v[128:131], v52 offset:0
ds_read_b128 v[160:163], v52 offset:256
v_xor_b32 v53, 32, v51
ds_read_b128 v[132:135], v53 offset:0
ds_read_b128 v[164:167], v53 offset:256
s_add_u32 s26, s68, 10240
s_add_u32 m0, s75, 70656
s_and_b32 s26, s26, 0x7fff
v_xor_b32 v48, 160, v46
s_add_u32 s26, s26, s52
buffer_load_dwordx4 v48, s[48:51], s26 offen lds
v_xor_b32 v52, 64, v51
ds_read_b128 v[136:139], v52 offset:0
ds_read_b128 v[168:171], v52 offset:256
v_xor_b32 v53, 96, v51
ds_read_b128 v[140:143], v53 offset:0
ds_read_b128 v[172:175], v53 offset:256
s_add_u32 s26, s68, 12288
s_add_u32 m0, s75, 71680
s_and_b32 s26, s26, 0x7fff
v_xor_b32 v49, 192, v46
s_add_u32 s26, s26, s52
buffer_load_dwordx4 v49, s[48:51], s26 offen lds
v_xor_b32 v52, 128, v51
ds_read_b128 v[144:147], v52 offset:0
ds_read_b128 v[176:179], v52 offset:256
v_xor_b32 v53, 160, v51
ds_read_b128 v[148:151], v53 offset:0
ds_read_b128 v[180:183], v53 offset:256
s_add_u32 s26, s68, 14336
s_add_u32 m0, s75, 72704
s_and_b32 s26, s26, 0x7fff
v_xor_b32 v48, 224, v46
s_add_u32 s26, s26, s52
buffer_load_dwordx4 v48, s[48:51], s26 offen lds
v_xor_b32 v52, 192, v51
ds_read_b128 v[152:155], v52 offset:0
ds_read_b128 v[184:187], v52 offset:256
v_xor_b32 v53, 224, v51
ds_read_b128 v[156:159], v53 offset:0
ds_read_b128 v[188:191], v53 offset:256
v_mov_b32 v40, v39
v_mov_b32 v112, v57
v_mov_b32 v113, v58
ds_read_b64_tr_b16 v[96:97], v113 offset:4096
ds_read_b64_tr_b16 v[98:99], v113 offset:4608
ds_read_b64_tr_b16 v[100:101], v113 offset:4128
ds_read_b64_tr_b16 v[102:103], v113 offset:4640
ds_read_b64_tr_b16 v[104:105], v113 offset:4160
ds_read_b64_tr_b16 v[106:107], v113 offset:4672
ds_read_b64_tr_b16 v[108:109], v113 offset:4192
ds_read_b64_tr_b16 v[110:111], v113 offset:4704
ds_read_b64_tr_b16 a[0:1], v112 offset:2048
ds_read_b64_tr_b16 a[2:3], v112 offset:2560
ds_read_b64_tr_b16 a[4:5], v112 offset:2112
ds_read_b64_tr_b16 a[6:7], v112 offset:2624
s_add_u32 s26, s68, 16384
s_add_u32 m0, s75, 73728
s_and_b32 s26, s26, 0x7fff
v_xor_b32 v49, 0, v46
s_add_u32 s26, s26, s52
buffer_load_dwordx4 v49, s[48:51], s26 offen lds
s_waitcnt lgkmcnt(0)
v_dot2_f32_bf16 v64, v96, s22, 0
v_dot2_f32_bf16 v65, v100, s22, 0
v_dot2_f32_bf16 v66, v104, s22, 0
v_dot2_f32_bf16 v67, v108, s22, 0
v_dot2_f32_bf16 v64, v97, s22, v64
v_dot2_f32_bf16 v65, v101, s22, v65
v_dot2_f32_bf16 v66, v105, s22, v66
v_dot2_f32_bf16 v67, v109, s22, v67
v_dot2_f32_bf16 v64, v98, s22, v64
v_dot2_f32_bf16 v65, v102, s22, v65
v_dot2_f32_bf16 v66, v106, s22, v66
v_dot2_f32_bf16 v67, v110, s22, v67
v_dot2_f32_bf16 v64, v99, s22, v64
v_dot2_f32_bf16 v65, v103, s22, v65
v_dot2_f32_bf16 v66, v107, s22, v66
v_dot2_f32_bf16 v67, v111, s22, v67
s_nop 0
v_permlane32_swap_b32 v64, v65
s_nop 0
v_permlane32_swap_b32 v66, v67
v_add_f32 v64, v64, v65
v_add_f32 v66, v66, v67
v_lshlrev_b32 v56, 2, v0
v_add_u32 v57, s21, v56
ds_write_b32 v57, v64 offset:256
ds_write_b32 v57, v66 offset:512
s_and_b32 s27, s3, 1
v_lshl_add_u32 v56, s27, 8, v56
s_cmp_eq_u32 s3, 0
s_cselect_b32 s27, s60, s54
s_cselect_b32 s28, s61, s55
s_lshr_b32 s27, s27, 5
s_lshr_b32 s28, s28, 5
v_mov_b32 v52, s27
v_mov_b32 v53, s28
v_and_b32 v57, 31, v0
v_cndmask_b32 v52, v53, v52, s[24:25]
v_lshl_add_u32 v57, v57, 2, v52
s_cmp_lt_u32 s3, 2
s_cselect_b32 s56, s65, 40894464
s_waitcnt lgkmcnt(0)
s_add_u32 s26, s68, 18432
s_add_u32 m0, s75, 74752
s_and_b32 s26, s26, 0x7fff
v_xor_b32 v48, 32, v46
s_add_u32 s26, s26, s52
buffer_load_dwordx4 v48, s[48:51], s26 offen lds
v_dot2_f32_bf16 v42, v128, s22, 0
v_dot2_f32_bf16 v43, v128, v128, 0
v_dot2_f32_bf16 v44, v129, s22, 0
v_dot2_f32_bf16 v45, v129, v129, 0
v_dot2_f32_bf16 v42, v130, s22, v42
v_dot2_f32_bf16 v43, v130, v130, v43
v_dot2_f32_bf16 v44, v131, s22, v44
v_dot2_f32_bf16 v45, v131, v131, v45
v_dot2_f32_bf16 v42, v132, s22, v42
v_dot2_f32_bf16 v43, v132, v132, v43
buffer_load_dwordx2 v[60:61], v50, s[4:7], s36 offen sc1
s_add_u32 s26, s68, 20480
s_add_u32 m0, s75, 75776
s_and_b32 s26, s26, 0x7fff
v_xor_b32 v49, 64, v46
s_add_u32 s26, s26, s52
buffer_load_dwordx4 v49, s[48:51], s26 offen lds
v_dot2_f32_bf16 v44, v133, s22, v44
v_dot2_f32_bf16 v45, v133, v133, v45
v_dot2_f32_bf16 v42, v134, s22, v42
v_dot2_f32_bf16 v43, v134, v134, v43
v_dot2_f32_bf16 v44, v135, s22, v44
v_dot2_f32_bf16 v45, v135, v135, v45
v_dot2_f32_bf16 v42, v136, s22, v42
v_dot2_f32_bf16 v43, v136, v136, v43
v_dot2_f32_bf16 v44, v137, s22, v44
v_dot2_f32_bf16 v45, v137, v137, v45
s_add_u32 s60, s60, s72
buffer_store_dwordx4 v[96:99], v1, s[4:7], s60 offen sc1
s_add_u32 s26, s68, 22528
s_add_u32 m0, s75, 76800
s_and_b32 s26, s26, 0x7fff
v_xor_b32 v48, 96, v46
s_add_u32 s26, s26, s52
buffer_load_dwordx4 v48, s[48:51], s26 offen lds
v_dot2_f32_bf16 v42, v138, s22, v42
v_dot2_f32_bf16 v43, v138, v138, v43
v_dot2_f32_bf16 v44, v139, s22, v44
v_dot2_f32_bf16 v45, v139, v139, v45
v_dot2_f32_bf16 v42, v140, s22, v42
v_dot2_f32_bf16 v43, v140, v140, v43
v_dot2_f32_bf16 v44, v141, s22, v44
v_dot2_f32_bf16 v45, v141, v141, v45
v_dot2_f32_bf16 v42, v142, s22, v42
v_dot2_f32_bf16 v43, v142, v142, v43
s_add_u32 s61, s61, s72
buffer_store_dwordx4 v[100:103], v1, s[4:7], s61 offen sc1
s_add_u32 s26, s68, 24576
s_add_u32 m0, s75, 77824
s_and_b32 s26, s26, 0x7fff
v_xor_b32 v49, 128, v46
s_add_u32 s26, s26, s52
buffer_load_dwordx4 v49, s[48:51], s26 offen lds
v_dot2_f32_bf16 v44, v143, s22, v44
v_dot2_f32_bf16 v45, v143, v143, v45
v_dot2_f32_bf16 v42, v144, s22, v42
v_dot2_f32_bf16 v43, v144, v144, v43
v_dot2_f32_bf16 v44, v145, s22, v44
v_dot2_f32_bf16 v45, v145, v145, v45
v_dot2_f32_bf16 v42, v146, s22, v42
v_dot2_f32_bf16 v43, v146, v146, v43
v_dot2_f32_bf16 v44, v147, s22, v44
v_dot2_f32_bf16 v45, v147, v147, v45
s_add_u32 s54, s54, s72
buffer_store_dwordx4 v[104:107], v1, s[4:7], s54 offen sc1
s_add_u32 s26, s68, 26624
s_add_u32 m0, s75, 78848
s_and_b32 s26, s26, 0x7fff
v_xor_b32 v48, 160, v46
s_add_u32 s26, s26, s52
buffer_load_dwordx4 v48, s[48:51], s26 offen lds
v_dot2_f32_bf16 v42, v148, s22, v42
v_dot2_f32_bf16 v43, v148, v148, v43
v_dot2_f32_bf16 v44, v149, s22, v44
v_dot2_f32_bf16 v45, v149, v149, v45
v_dot2_f32_bf16 v42, v150, s22, v42
v_dot2_f32_bf16 v43, v150, v150, v43
v_dot2_f32_bf16 v44, v151, s22, v44
v_dot2_f32_bf16 v45, v151, v151, v45
v_dot2_f32_bf16 v42, v152, s22, v42
v_dot2_f32_bf16 v43, v152, v152, v43
s_add_u32 s55, s55, s72
buffer_store_dwordx4 v[108:111], v1, s[4:7], s55 offen sc1
s_add_u32 s26, s68, 28672
s_add_u32 m0, s75, 79872
s_and_b32 s26, s26, 0x7fff
v_xor_b32 v49, 192, v46
s_add_u32 s26, s26, s52
buffer_load_dwordx4 v49, s[48:51], s26 offen lds
v_dot2_f32_bf16 v44, v153, s22, v44
v_dot2_f32_bf16 v45, v153, v153, v45
v_dot2_f32_bf16 v42, v154, s22, v42
v_dot2_f32_bf16 v43, v154, v154, v43
v_dot2_f32_bf16 v44, v155, s22, v44
v_dot2_f32_bf16 v45, v155, v155, v45
v_dot2_f32_bf16 v42, v156, s22, v42
v_dot2_f32_bf16 v43, v156, v156, v43
v_dot2_f32_bf16 v44, v157, s22, v44
v_dot2_f32_bf16 v45, v157, v157, v45
buffer_store_dwordx4 a[0:3], v40, s[4:7], s57 offen offset:0 sc1
s_add_u32 s26, s68, 30720
s_add_u32 m0, s75, 80896
s_and_b32 s26, s26, 0x7fff
v_xor_b32 v48, 224, v46
s_add_u32 s26, s26, s52
buffer_load_dwordx4 v48, s[48:51], s26 offen lds
v_dot2_f32_bf16 v42, v158, s22, v42
v_dot2_f32_bf16 v43, v158, v158, v43
v_dot2_f32_bf16 v44, v159, s22, v44
v_dot2_f32_bf16 v45, v159, v159, v45
v_dot2_f32_bf16 v42, v160, s22, v42
v_dot2_f32_bf16 v43, v160, v160, v43
v_dot2_f32_bf16 v44, v161, s22, v44
v_dot2_f32_bf16 v45, v161, v161, v45
v_dot2_f32_bf16 v42, v162, s22, v42
v_dot2_f32_bf16 v43, v162, v162, v43
buffer_store_dwordx4 a[4:7], v40, s[4:7], s57 offen offset:2048 sc1
v_lshrrev_b32 v114, 5, v0
v_lshlrev_b32 v114, 9, v114
v_and_b32 v55, 31, v0
v_lshl_add_u32 v114, v55, 2, v114
v_and_b32 v115, 15, v0
v_lshlrev_b32 v115, 11, v115
s_lshr_b32 s68, s21, 1
s_sub_u32 s69, s20, s68
s_mul_i32 s26, s17, 10240
s_add_u32 s26, s26, 9961472
v_dot2_f32_bf16 v44, v163, s22, v44
v_dot2_f32_bf16 v45, v163, v163, v45
v_dot2_f32_bf16 v42, v164, s22, v42
v_dot2_f32_bf16 v43, v164, v164, v43
v_dot2_f32_bf16 v44, v165, s22, v44
v_dot2_f32_bf16 v45, v165, v165, v45
v_dot2_f32_bf16 v42, v166, s22, v42
v_dot2_f32_bf16 v43, v166, v166, v43
v_dot2_f32_bf16 v44, v167, s22, v44
v_dot2_f32_bf16 v45, v167, v167, v45
v_dot2_f32_bf16 v42, v168, s22, v42
v_dot2_f32_bf16 v43, v168, v168, v43
v_dot2_f32_bf16 v44, v169, s22, v44
v_dot2_f32_bf16 v45, v169, v169, v45
v_dot2_f32_bf16 v42, v170, s22, v42
v_dot2_f32_bf16 v43, v170, v170, v43
v_dot2_f32_bf16 v44, v171, s22, v44
v_dot2_f32_bf16 v45, v171, v171, v45
v_dot2_f32_bf16 v42, v172, s22, v42
v_dot2_f32_bf16 v43, v172, v172, v43
v_dot2_f32_bf16 v44, v173, s22, v44
v_dot2_f32_bf16 v45, v173, v173, v45
v_dot2_f32_bf16 v42, v174, s22, v42
v_dot2_f32_bf16 v43, v174, v174, v43
v_dot2_f32_bf16 v44, v175, s22, v44
v_dot2_f32_bf16 v45, v175, v175, v45
v_dot2_f32_bf16 v42, v176, s22, v42
v_dot2_f32_bf16 v43, v176, v176, v43
v_dot2_f32_bf16 v44, v177, s22, v44
v_dot2_f32_bf16 v45, v177, v177, v45
v_dot2_f32_bf16 v42, v178, s22, v42
v_dot2_f32_bf16 v43, v178, v178, v43
v_dot2_f32_bf16 v44, v179, s22, v44
v_dot2_f32_bf16 v45, v179, v179, v45
v_dot2_f32_bf16 v42, v180, s22, v42
v_dot2_f32_bf16 v43, v180, v180, v43
v_dot2_f32_bf16 v44, v181, s22, v44
v_dot2_f32_bf16 v45, v181, v181, v45
v_dot2_f32_bf16 v42, v182, s22, v42
v_dot2_f32_bf16 v43, v182, v182, v43
v_dot2_f32_bf16 v44, v183, s22, v44
v_dot2_f32_bf16 v45, v183, v183, v45
v_dot2_f32_bf16 v42, v184, s22, v42
v_dot2_f32_bf16 v43, v184, v184, v43
v_dot2_f32_bf16 v44, v185, s22, v44
v_dot2_f32_bf16 v45, v185, v185, v45
v_dot2_f32_bf16 v42, v186, s22, v42
v_dot2_f32_bf16 v43, v186, v186, v43
v_dot2_f32_bf16 v44, v187, s22, v44
v_dot2_f32_bf16 v45, v187, v187, v45
v_dot2_f32_bf16 v42, v188, s22, v42
v_dot2_f32_bf16 v43, v188, v188, v43
v_dot2_f32_bf16 v44, v189, s22, v44
v_dot2_f32_bf16 v45, v189, v189, v45
v_dot2_f32_bf16 v42, v190, s22, v42
v_dot2_f32_bf16 v43, v190, v190, v43
v_dot2_f32_bf16 v44, v191, s22, v44
v_dot2_f32_bf16 v45, v191, v191, v45
s_waitcnt vmcnt(12)
v_xor_b32 v60, s73, v60
v_xor_b32 v61, s74, v61
v_and_b32 v61, 0xffffff, v61
v_or_b32 v60, v60, v61
v_cmp_ne_u32 vcc, 0, v60
s_nop 0
s_cbranch_vccnz L_spoll_5
L_spolled_6:
s_barrier
L_synced:
s_add_u32 m0, s68, 32768
s_add_u32 s30, s69, 0
buffer_load_dwordx4 v1, s[4:7], s30 offen offset:0 lds
s_waitcnt vmcnt(2)
v_add_u32 v51, 65536, v51
v_xor_b32 v52, 0, v51
ds_read_b128 v[192:195], v52 offset:0
ds_read_b128 v[224:227], v52 offset:256
buffer_load_dwordx4 v1, s[4:7], s30 offen offset:1024 lds
v_xor_b32 v53, 32, v51
ds_read_b128 v[196:199], v53 offset:0
ds_read_b128 v[228:231], v53 offset:256
buffer_load_dwordx4 v1, s[4:7], s30 offen offset:2048 lds
v_xor_b32 v52, 64, v51
ds_read_b128 v[200:203], v52 offset:0
ds_read_b128 v[232:235], v52 offset:256
buffer_load_dwordx4 v1, s[4:7], s30 offen offset:3072 lds
v_xor_b32 v53, 96, v51
ds_read_b128 v[204:207], v53 offset:0
ds_read_b128 v[236:239], v53 offset:256
s_add_u32 m0, s68, 65536
s_add_u32 s30, s69, 32768
buffer_load_dwordx4 v1, s[4:7], s30 offen offset:0 lds
v_xor_b32 v52, 128, v51
ds_read_b128 v[208:211], v52 offset:0
ds_read_b128 v[240:243], v52 offset:256
buffer_load_dwordx4 v1, s[4:7], s30 offen offset:1024 lds
v_xor_b32 v53, 160, v51
ds_read_b128 v[212:215], v53 offset:0
ds_read_b128 v[244:247], v53 offset:256
buffer_load_dwordx4 v1, s[4:7], s30 offen offset:2048 lds
v_xor_b32 v52, 192, v51
ds_read_b128 v[216:219], v52 offset:0
ds_read_b128 v[248:251], v52 offset:256
buffer_load_dwordx4 v1, s[4:7], s30 offen offset:3072 lds
v_xor_b32 v53, 224, v51
ds_read_b128 v[220:223], v53 offset:0
ds_read_b128 v[252:255], v53 offset:256
ds_read_b32 v58, v56 offset:256
ds_read_b32 v59, v56 offset:8448
ds_read_b32 v60, v56 offset:16640
ds_read_b32 v61, v56 offset:24832
s_waitcnt lgkmcnt(0)
v_add_f32 v58, v58, v59
v_add_f32 v60, v60, v61
v_add_f32 v58, v58, v60
buffer_store_dword v58, v57, s[4:7], s56 offen sc1
v_mov_b32 v40, v39
s_mov_b32 s70, s26
s_mov_b32 s71, s14
s_getpc_b64 s[92:93]
L_pc:
s_mov_b32 s94, L_code_end-L_pc+0
s_lshr_b32 s13, s2, 3
s_lshl_b32 s13, s13, 2
s_add_u32 s13, s13, s3
s_lshl_b32 s13, s13, 7
v_dot2_f32_bf16 v42, v192, s22, v42
v_dot2_f32_bf16 v43, v192, v192, v43
v_dot2_f32_bf16 v44, v193, s22, v44
v_dot2_f32_bf16 v45, v193, v193, v45
v_dot2_f32_bf16 v42, v194, s22, v42
v_dot2_f32_bf16 v43, v194, v194, v43
v_dot2_f32_bf16 v44, v195, s22, v44
v_dot2_f32_bf16 v45, v195, v195, v45
v_dot2_f32_bf16 v42, v196, s22, v42
v_dot2_f32_bf16 v43, v196, v196, v43
v_dot2_f32_bf16 v44, v197, s22, v44
v_dot2_f32_bf16 v45, v197, v197, v45
v_dot2_f32_bf16 v42, v198, s22, v42
v_dot2_f32_bf16 v43, v198, v198, v43
v_dot2_f32_bf16 v44, v199, s22, v44
v_dot2_f32_bf16 v45, v199, v199, v45
v_dot2_f32_bf16 v42, v200, s22, v42
v_dot2_f32_bf16 v43, v200, v200, v43
v_dot2_f32_bf16 v44, v201, s22, v44
v_dot2_f32_bf16 v45, v201, v201, v45
v_dot2_f32_bf16 v42, v202, s22, v42
v_dot2_f32_bf16 v43, v202, v202, v43
v_dot2_f32_bf16 v44, v203, s22, v44
v_dot2_f32_bf16 v45, v203, v203, v45
v_dot2_f32_bf16 v42, v204, s22, v42
v_dot2_f32_bf16 v43, v204, v204, v43
v_dot2_f32_bf16 v44, v205, s22, v44
v_dot2_f32_bf16 v45, v205, v205, v45
v_dot2_f32_bf16 v42, v206, s22, v42
v_dot2_f32_bf16 v43, v206, v206, v43
v_dot2_f32_bf16 v44, v207, s22, v44
v_dot2_f32_bf16 v45, v207, v207, v45
v_dot2_f32_bf16 v42, v208, s22, v42
v_dot2_f32_bf16 v43, v208, v208, v43
v_dot2_f32_bf16 v44, v209, s22, v44
v_dot2_f32_bf16 v45, v209, v209, v45
v_dot2_f32_bf16 v42, v210, s22, v42
v_dot2_f32_bf16 v43, v210, v210, v43
v_dot2_f32_bf16 v44, v211, s22, v44
v_dot2_f32_bf16 v45, v211, v211, v45
v_dot2_f32_bf16 v42, v212, s22, v42
v_dot2_f32_bf16 v43, v212, v212, v43
v_dot2_f32_bf16 v44, v213, s22, v44
v_dot2_f32_bf16 v45, v213, v213, v45
v_dot2_f32_bf16 v42, v214, s22, v42
v_dot2_f32_bf16 v43, v214, v214, v43
v_dot2_f32_bf16 v44, v215, s22, v44
v_dot2_f32_bf16 v45, v215, v215, v45
v_dot2_f32_bf16 v42, v216, s22, v42
v_dot2_f32_bf16 v43, v216, v216, v43
v_dot2_f32_bf16 v44, v217, s22, v44
v_dot2_f32_bf16 v45, v217, v217, v45
v_dot2_f32_bf16 v42, v218, s22, v42
v_dot2_f32_bf16 v43, v218, v218, v43
v_dot2_f32_bf16 v44, v219, s22, v44
v_dot2_f32_bf16 v45, v219, v219, v45
v_dot2_f32_bf16 v42, v220, s22, v42
v_dot2_f32_bf16 v43, v220, v220, v43
v_dot2_f32_bf16 v44, v221, s22, v44
v_dot2_f32_bf16 v45, v221, v221, v45
v_dot2_f32_bf16 v42, v222, s22, v42
v_dot2_f32_bf16 v43, v222, v222, v43
v_dot2_f32_bf16 v44, v223, s22, v44
v_dot2_f32_bf16 v45, v223, v223, v45
v_dot2_f32_bf16 v42, v224, s22, v42
v_dot2_f32_bf16 v43, v224, v224, v43
v_dot2_f32_bf16 v44, v225, s22, v44
v_dot2_f32_bf16 v45, v225, v225, v45
v_dot2_f32_bf16 v42, v226, s22, v42
v_dot2_f32_bf16 v43, v226, v226, v43
v_dot2_f32_bf16 v44, v227, s22, v44
v_dot2_f32_bf16 v45, v227, v227, v45
v_dot2_f32_bf16 v42, v228, s22, v42
v_dot2_f32_bf16 v43, v228, v228, v43
v_dot2_f32_bf16 v44, v229, s22, v44
v_dot2_f32_bf16 v45, v229, v229, v45
v_dot2_f32_bf16 v42, v230, s22, v42
v_dot2_f32_bf16 v43, v230, v230, v43
v_dot2_f32_bf16 v44, v231, s22, v44
v_dot2_f32_bf16 v45, v231, v231, v45
v_dot2_f32_bf16 v42, v232, s22, v42
v_dot2_f32_bf16 v43, v232, v232, v43
v_dot2_f32_bf16 v44, v233, s22, v44
v_dot2_f32_bf16 v45, v233, v233, v45
v_dot2_f32_bf16 v42, v234, s22, v42
v_dot2_f32_bf16 v43, v234, v234, v43
v_dot2_f32_bf16 v44, v235, s22, v44
v_dot2_f32_bf16 v45, v235, v235, v45
v_dot2_f32_bf16 v42, v236, s22, v42
v_dot2_f32_bf16 v43, v236, v236, v43
v_dot2_f32_bf16 v44, v237, s22, v44
v_dot2_f32_bf16 v45, v237, v237, v45
v_dot2_f32_bf16 v42, v238, s22, v42
v_dot2_f32_bf16 v43, v238, v238, v43
v_dot2_f32_bf16 v44, v239, s22, v44
v_dot2_f32_bf16 v45, v239, v239, v45
v_dot2_f32_bf16 v42, v240, s22, v42
v_dot2_f32_bf16 v43, v240, v240, v43
v_dot2_f32_bf16 v44, v241, s22, v44
v_dot2_f32_bf16 v45, v241, v241, v45
s_add_u32 m0, s68, 49152
s_add_u32 s30, s69, 16384
buffer_load_dwordx4 v1, s[4:7], s30 offen offset:0 lds
v_dot2_f32_bf16 v42, v242, s22, v42
v_dot2_f32_bf16 v43, v242, v242, v43
v_dot2_f32_bf16 v44, v243, s22, v44
v_dot2_f32_bf16 v45, v243, v243, v45
v_dot2_f32_bf16 v42, v244, s22, v42
v_dot2_f32_bf16 v43, v244, v244, v43
v_dot2_f32_bf16 v44, v245, s22, v44
v_dot2_f32_bf16 v45, v245, v245, v45
v_dot2_f32_bf16 v42, v246, s22, v42
v_dot2_f32_bf16 v43, v246, v246, v43
v_dot2_f32_bf16 v44, v247, s22, v44
v_dot2_f32_bf16 v45, v247, v247, v45
v_dot2_f32_bf16 v42, v248, s22, v42
v_dot2_f32_bf16 v43, v248, v248, v43
v_dot2_f32_bf16 v44, v249, s22, v44
v_dot2_f32_bf16 v45, v249, v249, v45
v_dot2_f32_bf16 v42, v250, s22, v42
v_dot2_f32_bf16 v43, v250, v250, v43
v_dot2_f32_bf16 v44, v251, s22, v44
v_dot2_f32_bf16 v45, v251, v251, v45
v_dot2_f32_bf16 v42, v252, s22, v42
v_dot2_f32_bf16 v43, v252, v252, v43
v_dot2_f32_bf16 v44, v253, s22, v44
v_dot2_f32_bf16 v45, v253, v253, v45
v_dot2_f32_bf16 v42, v254, s22, v42
v_dot2_f32_bf16 v43, v254, v254, v43
v_dot2_f32_bf16 v44, v255, s22, v44
v_dot2_f32_bf16 v45, v255, v255, v45
s_waitcnt vmcnt(2)
s_waitcnt vmcnt(1)
s_barrier
s_cmp_lg_u32 s3, 3
s_cbranch_scc1 L_nosig_7
v_mov_b32 v100, s73
v_mov_b32 v101, s74
v_mov_b32 v102, s73
v_mov_b32 v103, s74
s_lshl_b32 s52, s2, 7
s_add_u32 s52, s52, 10518528
s_mov_b64 exec, 0xff
buffer_store_dwordx4 v[100:103], v1, s[4:7], s52 offen sc1
s_mov_b64 exec, -1
L_nosig_7:
ds_read_b128 a[224:227], v1 offset:32768
ds_read_b128 a[228:231], v2 offset:0
ds_read_b128 a[232:235], v1 offset:33792
ds_read_b128 a[236:239], v2 offset:1024
ds_read_b128 a[240:243], v1 offset:34816
ds_read_b128 a[244:247], v2 offset:2048
ds_read_b128 a[248:251], v1 offset:35840
s_waitcnt lgkmcnt(5)
v_mfma_f32_32x32x16_bf16 v[64:79], a[224:227], v[128:131], 0
buffer_load_dwordx4 v1, s[4:7], s30 offen offset:1024 lds
ds_read_b128 a[252:255], v2 offset:3072
v_mfma_f32_32x32x16_bf16 v[80:95], a[228:231], v[128:131], 0
buffer_load_dwordx4 v1, s[4:7], s30 offen offset:2048 lds
ds_read_b128 a[224:227], v1 offset:36864
s_waitcnt lgkmcnt(5)
v_mfma_f32_32x32x16_bf16 v[64:79], a[232:235], v[132:135], v[64:79]
buffer_load_dwordx4 v1, s[4:7], s30 offen offset:3072 lds
ds_read_b128 a[228:231], v2 offset:4096
v_mfma_f32_32x32x16_bf16 v[80:95], a[236:239], v[132:135], v[80:95]
s_add_u32 m0, s68, 81920
s_add_u32 s30, s69, 49152
buffer_load_dwordx4 v1, s[4:7], s30 offen offset:0 lds
ds_read_b128 a[232:235], v1 offset:37888
s_waitcnt lgkmcnt(5)
v_mfma_f32_32x32x16_bf16 v[64:79], a[240:243], v[136:139], v[64:79]
buffer_load_dwordx4 v1, s[4:7], s30 offen offset:1024 lds
ds_read_b128 a[236:239], v2 offset:5120
v_mfma_f32_32x32x16_bf16 v[80:95], a[244:247], v[136:139], v[80:95]
buffer_load_dwordx4 v1, s[4:7], s30 offen offset:2048 lds
ds_read_b128 a[240:243], v1 offset:38912
s_waitcnt lgkmcnt(5)
v_mfma_f32_32x32x16_bf16 v[64:79], a[248:251], v[140:143], v[64:79]
buffer_load_dwordx4 v1, s[4:7], s30 offen offset:3072 lds
ds_read_b128 a[244:247], v2 offset:6144
v_mfma_f32_32x32x16_bf16 v[80:95], a[252:255], v[140:143], v[80:95]
buffer_load_dword v46, v115, s[4:7], s71 offen offset:4 sc1
ds_read_b128 a[248:251], v1 offset:39936
s_waitcnt lgkmcnt(5)
v_mfma_f32_32x32x16_bf16 v[64:79], a[224:227], v[144:147], v[64:79]
buffer_load_dword v116, v114, s[4:7], s70 offen offset:0 sc1
ds_read_b128 a[252:255], v2 offset:7168
v_mfma_f32_32x32x16_bf16 v[80:95], a[228:231], v[144:147], v[80:95]
buffer_load_dword v117, v114, s[4:7], s70 offen offset:128 sc1
ds_read_b128 a[224:227], v1 offset:40960
s_waitcnt lgkmcnt(5)
v_mfma_f32_32x32x16_bf16 v[64:79], a[232:235], v[148:151], v[64:79]
buffer_load_dword v118, v114, s[4:7], s70 offen offset:256 sc1
ds_read_b128 a[228:231], v2 offset:8192
v_mfma_f32_32x32x16_bf16 v[80:95], a[236:239], v[148:151], v[80:95]
buffer_load_dword v119, v114, s[4:7], s70 offen offset:384 sc1
ds_read_b128 a[232:235], v1 offset:41984
s_waitcnt lgkmcnt(5)
v_mfma_f32_32x32x16_bf16 v[64:79], a[240:243], v[152:155], v[64:79]
buffer_load_dword v120, v114, s[4:7], s70 offen offset:1024 sc1
ds_read_b128 a[236:239], v2 offset:9216
v_mfma_f32_32x32x16_bf16 v[80:95], a[244:247], v[152:155], v[80:95]
buffer_load_dword v121, v114, s[4:7], s70 offen offset:1152 sc1
ds_read_b128 a[240:243], v1 offset:43008
s_waitcnt lgkmcnt(5)
v_mfma_f32_32x32x16_bf16 v[64:79], a[248:251], v[156:159], v[64:79]
buffer_load_dword v122, v114, s[4:7], s70 offen offset:1280 sc1
ds_read_b128 a[244:247], v2 offset:10240
v_mfma_f32_32x32x16_bf16 v[80:95], a[252:255], v[156:159], v[80:95]
buffer_load_dword v123, v114, s[4:7], s70 offen offset:1408 sc1
ds_read_b128 a[248:251], v1 offset:44032
s_waitcnt lgkmcnt(5)
v_mfma_f32_32x32x16_bf16 v[64:79], a[224:227], v[160:163], v[64:79]
buffer_load_dword v124, v114, s[4:7], s70 offen offset:2048 sc1
ds_read_b128 a[252:255], v2 offset:11264
v_mfma_f32_32x32x16_bf16 v[80:95], a[228:231], v[160:163], v[80:95]
buffer_load_dword v125, v114, s[4:7], s70 offen offset:2176 sc1
ds_read_b128 a[224:227], v1 offset:45056
s_waitcnt lgkmcnt(5)
v_mfma_f32_32x32x16_bf16 v[64:79], a[232:235], v[164:167], v[64:79]
buffer_load_dword v126, v114, s[4:7], s70 offen offset:2304 sc1
ds_read_b128 a[228:231], v2 offset:12288
v_mfma_f32_32x32x16_bf16 v[80:95], a[236:239], v[164:167], v[80:95]
buffer_load_dword v127, v114, s[4:7], s70 offen offset:2432 sc1
ds_read_b128 a[232:235], v1 offset:46080
s_waitcnt lgkmcnt(5)
v_mfma_f32_32x32x16_bf16 v[64:79], a[240:243], v[168:171], v[64:79]
s_add_u32 s53, s88, s21
buffer_load_dwordx4 v[6:9], v54, s[48:51], s53 offen
ds_read_b128 a[236:239], v2 offset:13312
v_mfma_f32_32x32x16_bf16 v[80:95], a[244:247], v[168:171], v[80:95]
s_add_u32 s53, s53, 32768
buffer_load_dwordx4 v[10:13], v54, s[48:51], s53 offen
ds_read_b128 a[240:243], v1 offset:47104
s_waitcnt lgkmcnt(5)
v_mfma_f32_32x32x16_bf16 v[64:79], a[248:251], v[172:175], v[64:79]
s_add_u32 m0, s21, 98304
s_add_u32 s30, s20, 65536
buffer_load_dwordx4 v1, s[4:7], s30 offen offset:0  lds
ds_read_b128 a[244:247], v2 offset:14336
v_mfma_f32_32x32x16_bf16 v[80:95], a[252:255], v[172:175], v[80:95]
buffer_load_dwordx4 v1, s[4:7], s30 offen offset:1024  lds
ds_read_b128 a[248:251], v1 offset:48128
v_add_f32 v42, v42, v44
v_add_f32 v43, v43, v45
s_waitcnt vmcnt(17)
s_barrier
s_mul_i32 s69, s17, 7
s_and_b32 s69, s69, 0xfc
s_lshl_b32 s69, s69, 1
v_and_b32 v97, 31, v0
v_min_u32 v96, 23, v97
v_add_u32 v96, s69, v96
v_min_u32 v97, 6, v97
s_mul_i32 s69, s3, 7
v_add_u32 v97, s69, v97
v_lshlrev_b32 v97, 3, v97
v_add_u32 v97, s19, v97
v_cndmask_b32 v96, v97, v96, s[24:25]
v_lshlrev_b32 v96, 7, v96
s_mov_b32 s68, 10518528
s_waitcnt lgkmcnt(5)
v_mfma_f32_32x32x16_bf16 v[64:79], a[224:227], v[176:179], v[64:79]
buffer_load_dwordx4 v1, s[4:7], s30 offen offset:2048  lds
ds_read_b128 a[252:255], v2 offset:15360
v_mfma_f32_32x32x16_bf16 v[80:95], a[228:231], v[176:179], v[80:95]
buffer_load_dwordx4 v1, s[4:7], s30 offen offset:3072  lds
ds_read_b128 a[224:227], v1 offset:49152
buffer_load_dwordx2 v[98:99], v96, s[4:7], s68 offen sc1
s_waitcnt lgkmcnt(5)
v_mfma_f32_32x32x16_bf16 v[64:79], a[232:235], v[180:183], v[64:79]
s_add_u32 m0, s21, 102400
s_add_u32 s30, s20, 69632
buffer_load_dwordx4 v1, s[4:7], s30 offen offset:0  lds
ds_read_b128 a[228:231], v2 offset:16384
v_permlane32_swap_b32 v42, v43
v_add_f32 v42, v42, v43
v_mfma_f32_32x32x16_bf16 v[80:95], a[236:239], v[180:183], v[80:95]
buffer_load_dwordx4 v1, s[4:7], s30 offen offset:1024  lds
ds_read_b128 a[232:235], v1 offset:50176
v_mov_b32 v43, v42
s_nop 1
v_permlane32_swap_b32 v42, v43
v_mul_f32 v42, 0xbb000000, v42
v_mul_f32 v43, 0x3b000000, v43
s_waitcnt lgkmcnt(5)
v_mfma_f32_32x32x16_bf16 v[64:79], a[240:243], v[184:187], v[64:79]
buffer_load_dwordx4 v1, s[4:7], s30 offen offset:2048  lds
ds_read_b128 a[236:239], v2 offset:17408
v_cvt_pk_bf16_f32 v44, v42, v42
v_fma_f32 v43, -v42, v42, v43
v_and_b32 v45, 0xffff0000, v44
v_max_f32 v43, 0, v43
v_mfma_f32_32x32x16_bf16 v[80:95], a[244:247], v[184:187], v[80:95]
buffer_load_dwordx4 v1, s[4:7], s30 offen offset:3072  lds
ds_read_b128 a[240:243], v1 offset:51200
v_sub_f32 v45, v42, v45
v_add_f32 v50, 0x3727c5ac, v43
v_cvt_pk_bf16_f32 v45, v45, v45
v_rsq_f32 v39, v50
s_waitcnt lgkmcnt(5)
v_mfma_f32_32x32x16_bf16 v[64:79], a[248:251], v[188:191], v[64:79]
s_add_u32 s62, s38, 20971520
buffer_store_dwordx4 v[14:17], v1, s[4:7], s62 offen offset:0 sc1
ds_read_b128 a[244:247], v2 offset:18432
v_cndmask_b32 v32, v45, v44, s[24:25]
v_mov_b32 v37, v32
v_mul_f32 v38, 0x3fb8aa3b, v39
v_mfma_f32_32x32x16_bf16 v[80:95], a[252:255], v[188:191], v[80:95]
buffer_store_dwordx4 v[14:17], v1, s[4:7], s62 offen offset:1024 sc1
ds_read_b128 a[248:251], v1 offset:52224
v_and_b32 v51, 31, v0
v_lshl_add_u32 v51, s3, 5, v51
v_lshlrev_b32 v51, 4, v51
v_lshrrev_b32 v52, 5, v0
s_waitcnt lgkmcnt(5)
v_mfma_f32_32x32x16_bf16 v[64:79], a[224:227], v[192:195], v[64:79]
ds_read_b128 a[252:255], v2 offset:19456
v_mul_u32_u24 v52, 2112, v52
v_add_u32 v57, v51, v52
v_add_u32 v56, v57, v52
v_lshrrev_b32 v51, 4, v0
v_bfe_u32 v52, v0, 2, 2
v_mfma_f32_32x32x16_bf16 v[80:95], a[228:231], v[192:195], v[80:95]
ds_read_b128 a[224:227], v1 offset:53248
v_lshl_add_u32 v51, v51, 3, v52
v_lshlrev_b32 v51, 4, v51
v_and_b32 v52, 1, v0
v_lshl_add_u32 v51, v52, 3, v51
v_bfe_u32 v52, v0, 1, 1
s_waitcnt lgkmcnt(5)
v_mfma_f32_32x32x16_bf16 v[64:79], a[232:235], v[196:199], v[64:79]
ds_read_b128 a[228:231], v2 offset:20480
v_mul_u32_u24 v52, 2112, v52
v_add_u32 v51, v51, v52
s_and_b32 s26, s3, 1
s_lshr_b32 s28, s3, 1
s_mul_i32 s36, s26, 4224
v_mfma_f32_32x32x16_bf16 v[80:95], a[236:239], v[196:199], v[80:95]
ds_read_b128 a[232:235], v1 offset:54272
s_mul_i32 s37, s28, 4224
v_add_u32 v59, s36, v51
s_add_u32 s37, s37, s36
v_add_u32 v58, s37, v59
s_lshl_b32 s26, s26, 11
s_waitcnt vmcnt(6)
v_xor_b32 v98, s73, v98
v_xor_b32 v99, s74, v99
v_and_b32 v99, 0xffffff, v99
v_or_b32 v98, v98, v99
v_cmp_ne_u32 vcc, 0, v98
s_nop 0
s_cbranch_vccnz L_spoll_8
L_spolled_9:
s_waitcnt lgkmcnt(5)
v_mfma_f32_32x32x16_bf16 v[64:79], a[240:243], v[200:203], v[64:79]
s_add_u32 m0, s21, 131072
s_add_u32 s30, s20, 98304
buffer_load_dwordx4 v1, s[4:7], s30 offen offset:0  lds
ds_read_b128 a[236:239], v2 offset:21504
s_lshl_b32 s28, s28, 9
s_add_u32 s26, s26, s28
v_mfma_f32_32x32x16_bf16 v[80:95], a[244:247], v[200:203], v[80:95]
buffer_load_dwordx4 v1, s[4:7], s30 offen offset:1024  lds
ds_read_b128 a[240:243], v1 offset:55296
v_and_b32 v51, 15, v0
v_lshlrev_b32 v51, 4, v51
v_bfe_u32 v52, v0, 4, 1
v_lshl_add_u32 v51, v52, 3, v51
s_waitcnt lgkmcnt(5)
v_mfma_f32_32x32x16_bf16 v[64:79], a[248:251], v[204:207], v[64:79]
buffer_load_dwordx4 v1, s[4:7], s30 offen offset:2048  lds
ds_read_b128 a[244:247], v2 offset:22528
v_lshrrev_b32 v52, 5, v0
v_lshl_add_u32 v51, v52, 10, v51
v_add_u32 v61, s26, v51
v_and_b32 v51, 1, v0
v_mfma_f32_32x32x16_bf16 v[80:95], a[252:255], v[204:207], v[80:95]
buffer_load_dwordx4 v1, s[4:7], s30 offen offset:3072  lds
ds_read_b128 a[248:251], v1 offset:56320
v_lshl_add_u32 v51, v51, 1, v52
v_bfe_u32 v52, v0, 1, 1
v_lshl_add_u32 v51, v52, 3, v51
v_bfe_u32 v52, v0, 2, 1
s_waitcnt lgkmcnt(5)
v_mfma_f32_32x32x16_bf16 v[64:79], a[224:227], v[208:211], v[64:79]
s_add_u32 m0, s21, 135168
s_add_u32 s30, s20, 102400
buffer_load_dwordx4 v1, s[4:7], s30 offen offset:0  lds
ds_read_b128 a[252:255], v2 offset:23552
v_lshl_add_u32 v51, v52, 2, v51
v_lshlrev_b32 v51, 4, v51
v_mfma_f32_32x32x16_bf16 v[80:95], a[228:231], v[208:211], v[80:95]
buffer_load_dwordx4 v1, s[4:7], s30 offen offset:1024  lds
ds_read_b128 a[224:227], v1 offset:57344
v_bfe_u32 v52, v0, 3, 1
v_lshl_add_u32 v51, v52, 3, v51
v_bfe_u32 v52, v0, 4, 1
v_lshl_add_u32 v51, v52, 10, v51
s_waitcnt lgkmcnt(5)
v_mfma_f32_32x32x16_bf16 v[64:79], a[232:235], v[212:215], v[64:79]
buffer_load_dwordx4 v1, s[4:7], s30 offen offset:2048  lds
ds_read_b128 a[228:231], v2 offset:24576
v_add_u32 v60, s26, v51
v_and_b32 v62, 0x30, v0
v_lshlrev_b32 v63, 3, v0
s_add_u32 s36, s86, 8388608
v_mfma_f32_32x32x16_bf16 v[80:95], a[236:239], v[212:215], v[80:95]
buffer_load_dwordx4 v1, s[4:7], s30 offen offset:3072  lds
ds_read_b128 a[232:235], v1 offset:58368
s_add_u32 s37, s31, 8912896
s_lshl_b32 s26, s16, 9
s_add_u32 s26, s26, s36
s_lshl_b32 s28, s16, 6
s_waitcnt lgkmcnt(5)
v_mfma_f32_32x32x16_bf16 v[64:79], a[240:243], v[216:219], v[64:79]
ds_read_b128 a[236:239], v2 offset:25600
s_add_u32 s28, s28, s37
v_cmp_ne_u32 vcc, s74, v46
s_nop 0
s_or_b32 s33, vcc_lo, vcc_hi
v_add_f32 v116, v116, v118
v_add_f32 v117, v117, v119
v_mfma_f32_32x32x16_bf16 v[80:95], a[244:247], v[216:219], v[80:95]
ds_read_b128 a[240:243], v1 offset:59392
v_add_f32 v120, v120, v122
v_add_f32 v121, v121, v123
v_add_f32 v124, v124, v126
v_add_f32 v125, v125, v127
v_add_f32 v116, v116, v117
s_waitcnt lgkmcnt(5)
v_mfma_f32_32x32x16_bf16 v[64:79], a[248:251], v[220:223], v[64:79]
ds_read_b128 a[244:247], v2 offset:26624
v_add_f32 v120, v120, v121
v_add_f32 v124, v124, v125
v_mov_b32 v117, v116
v_mov_b32 v121, v120
v_mov_b32 v125, v124
v_mfma_f32_32x32x16_bf16 v[80:95], a[252:255], v[220:223], v[80:95]
ds_read_b128 a[248:251], v1 offset:60416
v_permlane32_swap_b32 v116, v117
v_permlane32_swap_b32 v120, v121
v_permlane32_swap_b32 v124, v125
v_add_f32 v116, v116, v117
v_add_f32 v120, v120, v121
s_waitcnt lgkmcnt(5)
v_mfma_f32_32x32x16_bf16 v[64:79], a[224:227], v[224:227], v[64:79]
ds_read_b128 a[252:255], v2 offset:27648
v_add_f32 v124, v124, v125
v_cvt_pk_bf16_f32 v117, v116, v116
v_and_b32 v117, 0xffff0000, v117
v_sub_f32 v47, v116, v117
v_cvt_pk_bf16_f32 v22, v117, v47
v_mfma_f32_32x32x16_bf16 v[80:95], a[228:231], v[224:227], v[80:95]
ds_read_b128 a[224:227], v1 offset:61440
v_cvt_pk_bf16_f32 v121, v120, v120
v_and_b32 v121, 0xffff0000, v121
v_sub_f32 v47, v120, v121
v_cvt_pk_bf16_f32 v23, v121, v47
v_cvt_pk_bf16_f32 v125, v124, v124
s_waitcnt lgkmcnt(5)
v_mfma_f32_32x32x16_bf16 v[64:79], a[232:235], v[228:231], v[64:79]
ds_read_b128 a[228:231], v2 offset:28672
v_and_b32 v125, 0xffff0000, v125
v_sub_f32 v47, v124, v125
v_cvt_pk_bf16_f32 v24, v125, v47
v_mfma_f32_32x32x16_bf16 v[80:95], a[236:239], v[228:231], v[80:95]
ds_read_b128 a[232:235], v1 offset:62464
v_mfma_f32_32x32x16_bf16 v[64:79], v[22:25], v[32:35], v[64:79]
v_mfma_f32_32x32x16_bf16 v[80:95], v[20:23], v[34:37], v[80:95]
s_waitcnt lgkmcnt(5)
v_mfma_f32_32x32x16_bf16 v[64:79], a[240:243], v[232:235], v[64:79]
ds_read_b128 a[236:239], v2 offset:29696
v_mov_b32 v44, s22
v_mov_b32 v45, s22
v_mov_b32 v46, s22
v_mov_b32 v47, s22
v_mfma_f32_32x32x16_bf16 v[80:95], a[244:247], v[232:235], v[80:95]
ds_read_b128 a[240:243], v1 offset:63488
s_waitcnt lgkmcnt(5)
v_mfma_f32_32x32x16_bf16 v[64:79], a[248:251], v[236:239], v[64:79]
ds_read_b128 a[244:247], v2 offset:30720
v_mfma_f32_32x32x16_bf16 v[80:95], a[252:255], v[236:239], v[80:95]
ds_read_b128 a[248:251], v1 offset:64512
s_waitcnt lgkmcnt(5)
v_mfma_f32_32x32x16_bf16 v[64:79], a[224:227], v[240:243], v[64:79]
ds_read_b128 a[252:255], v2 offset:31744
v_mfma_f32_32x32x16_bf16 v[80:95], a[228:231], v[240:243], v[80:95]
s_waitcnt lgkmcnt(4)
v_mfma_f32_32x32x16_bf16 v[64:79], a[232:235], v[244:247], v[64:79]
v_mfma_f32_32x32x16_bf16 v[80:95], a[236:239], v[244:247], v[80:95]
s_waitcnt lgkmcnt(2)
v_mfma_f32_32x32x16_bf16 v[64:79], a[240:243], v[248:251], v[64:79]
v_mfma_f32_32x32x16_bf16 v[80:95], a[244:247], v[248:251], v[80:95]
s_waitcnt lgkmcnt(0)
v_mfma_f32_32x32x16_bf16 v[64:79], a[248:251], v[252:255], v[64:79]
v_mfma_f32_32x32x16_bf16 v[80:95], a[252:255], v[252:255], v[80:95]
s_barrier
L_here_10:
s_add_u32 s99, s13, L_here_10-L_pc+2048
buffer_load_dword v5, off, s[92:95], s99
buffer_load_dword v5, off, s[4:7], s77 sc1
buffer_load_dword v5, off, s[4:7], s79 sc1
s_nop 5
v_cvt_pk_bf16_f32 v48, v64, v65
v_cvt_pk_bf16_f32 v49, v66, v67
v_cvt_pk_bf16_f32 v50, v68, v69
v_cvt_pk_bf16_f32 v51, v70, v71
v_cvt_pk_bf16_f32 v52, v72, v73
v_cvt_pk_bf16_f32 v53, v74, v75
v_cvt_pk_bf16_f32 v54, v76, v77
v_cvt_pk_bf16_f32 v55, v78, v79
v_mfma_f32_32x32x16_bf16 v[96:111], v[14:17], v[48:51], 0
s_nop 0
v_mfma_f32_32x32x16_bf16 v[112:127], v[18:21], v[52:55], 0
v_mul_f32 v80, v39, v80
v_mul_f32 v81, v39, v81
v_mul_f32 v82, v39, v82
v_mul_f32 v83, v39, v83
v_mul_f32 v84, v39, v84
s_add_u32 s62, s38, 12582912
buffer_store_dwordx4 v[14:17], v1, s[4:7], s62 offen offset:0 sc1
v_mul_f32 v85, v39, v85
v_mul_f32 v86, v39, v86
v_mul_f32 v87, v39, v87
v_mul_f32 v88, v39, v88
v_mul_f32 v89, v39, v89
v_mul_f32 v90, v39, v90
v_mul_f32 v91, v39, v91
v_mul_f32 v92, v39, v92
v_mul_f32 v93, v39, v93
v_mul_f32 v94, v39, v94
v_mul_f32 v95, v39, v95
v_cvt_pk_bf16_f32 v80, v80, v81
v_cvt_pk_bf16_f32 v81, v82, v83
v_cvt_pk_bf16_f32 v82, v84, v85
v_cvt_pk_bf16_f32 v83, v86, v87
v_cvt_pk_bf16_f32 v84, v88, v89
v_cvt_pk_bf16_f32 v85, v90, v91
v_cvt_pk_bf16_f32 v86, v92, v93
v_cvt_pk_bf16_f32 v87, v94, v95
ds_write_b128 v57, v[80:83] offset:16896
ds_write_b128 v57, v[84:87] offset:21120
v_max3_f32 v40, v96, v97, v98
buffer_store_dwordx4 v[14:17], v1, s[4:7], s62 offen offset:1024 sc1
v_max3_f32 v42, v112, v113, v114
v_max3_f32 v40, v40, v99, v100
v_max3_f32 v42, v42, v115, v116
v_max3_f32 v40, v40, v101, v102
v_max3_f32 v42, v42, v117, v118
v_max3_f32 v40, v40, v103, v104
v_max3_f32 v42, v42, v119, v120
v_max3_f32 v40, v40, v105, v106
v_max3_f32 v42, v42, v121, v122
v_max3_f32 v40, v40, v107, v108
v_max3_f32 v42, v42, v123, v124
v_max3_f32 v40, v40, v109, v110
v_max3_f32 v42, v42, v125, v126
v_max_f32 v40, v40, v111
v_max_f32 v42, v42, v127
v_mul_f32 v40, -v40, v38
v_mul_f32 v42, -v42, v38
v_pk_fma_f32 v[96:97], v[96:97], v[38:39], v[40:41] op_sel_hi:[1,0,0]
v_pk_fma_f32 v[112:113], v[112:113], v[38:39], v[42:43] op_sel_hi:[1,0,0]
v_pk_fma_f32 v[98:99], v[98:99], v[38:39], v[40:41] op_sel_hi:[1,0,0]
v_pk_fma_f32 v[114:115], v[114:115], v[38:39], v[42:43] op_sel_hi:[1,0,0]
v_pk_fma_f32 v[100:101], v[100:101], v[38:39], v[40:41] op_sel_hi:[1,0,0]
s_lshr_b32 s62, s38, 4
s_add_u32 s62, s62, 7864320
s_mov_b64 exec, 0xff
buffer_store_dwordx4 v[14:17], v1, s[4:7], s62 offen sc1
s_mov_b64 exec, -1
v_pk_fma_f32 v[116:117], v[116:117], v[38:39], v[42:43] op_sel_hi:[1,0,0]
v_pk_fma_f32 v[102:103], v[102:103], v[38:39], v[40:41] op_sel_hi:[1,0,0]
v_pk_fma_f32 v[118:119], v[118:119], v[38:39], v[42:43] op_sel_hi:[1,0,0]
v_pk_fma_f32 v[104:105], v[104:105], v[38:39], v[40:41] op_sel_hi:[1,0,0]
v_pk_fma_f32 v[120:121], v[120:121], v[38:39], v[42:43] op_sel_hi:[1,0,0]
v_pk_fma_f32 v[106:107], v[106:107], v[38:39], v[40:41] op_sel_hi:[1,0,0]
v_pk_fma_f32 v[122:123], v[122:123], v[38:39], v[42:43] op_sel_hi:[1,0,0]
v_pk_fma_f32 v[108:109], v[108:109], v[38:39], v[40:41] op_sel_hi:[1,0,0]
v_pk_fma_f32 v[124:125], v[124:125], v[38:39], v[42:43] op_sel_hi:[1,0,0]
v_pk_fma_f32 v[110:111], v[110:111], v[38:39], v[40:41] op_sel_hi:[1,0,0]
v_pk_fma_f32 v[126:127], v[126:127], v[38:39], v[42:43] op_sel_hi:[1,0,0]
v_exp_f32 v96, v96
v_exp_f32 v112, v112
v_exp_f32 v97, v97
v_exp_f32 v113, v113
s_lshr_b32 s96, s16, 3
s_lshl_b32 s96, s96, 1
s_add_u32 s96, s96, s18
s_lshl_b32 s96, s96, 12
s_add_u32 s97, s96, s85
buffer_load_dword v5, v1, s[4:7], s97 offen offset:0
v_exp_f32 v98, v98
v_exp_f32 v114, v114
v_exp_f32 v99, v99
v_exp_f32 v115, v115
v_exp_f32 v100, v100
v_exp_f32 v116, v116
v_exp_f32 v101, v101
v_exp_f32 v117, v117
v_exp_f32 v102, v102
buffer_load_dword v5, v1, s[4:7], s97 offen offset:1024
v_exp_f32 v118, v118
v_exp_f32 v103, v103
v_exp_f32 v119, v119
v_exp_f32 v104, v104
v_exp_f32 v120, v120
v_exp_f32 v105, v105
v_exp_f32 v121, v121
v_exp_f32 v106, v106
v_exp_f32 v122, v122
v_exp_f32 v107, v107
v_exp_f32 v123, v123
buffer_load_dword v5, v1, s[4:7], s97 offen offset:2048
v_exp_f32 v108, v108
v_exp_f32 v124, v124
v_exp_f32 v109, v109
v_exp_f32 v125, v125
v_exp_f32 v110, v110
v_exp_f32 v126, v126
v_exp_f32 v111, v111
v_exp_f32 v127, v127
v_pk_add_f32 v[40:41], v[96:97], v[98:99]
v_pk_add_f32 v[42:43], v[112:113], v[114:115]
v_pk_add_f32 v[40:41], v[40:41], v[100:101]
v_pk_add_f32 v[42:43], v[42:43], v[116:117]
v_pk_add_f32 v[40:41], v[40:41], v[102:103]
v_pk_add_f32 v[42:43], v[42:43], v[118:119]
buffer_load_dword v5, v1, s[4:7], s97 offen offset:3072
v_pk_add_f32 v[40:41], v[40:41], v[104:105]
v_pk_add_f32 v[42:43], v[42:43], v[120:121]
v_pk_add_f32 v[40:41], v[40:41], v[106:107]
v_pk_add_f32 v[42:43], v[42:43], v[122:123]
v_pk_add_f32 v[40:41], v[40:41], v[108:109]
v_pk_add_f32 v[42:43], v[42:43], v[124:125]
v_pk_add_f32 v[40:41], v[40:41], v[110:111]
v_pk_add_f32 v[42:43], v[42:43], v[126:127]
v_add_f32 v40, v40, v41
v_add_f32 v42, v42, v43
v_rcp_f32 v40, v40
v_rcp_f32 v42, v42
v_pk_mul_f32 v[96:97], v[96:97], v[40:41] op_sel_hi:[1,0]
v_pk_mul_f32 v[98:99], v[98:99], v[40:41] op_sel_hi:[1,0]
v_pk_mul_f32 v[100:101], v[100:101], v[40:41] op_sel_hi:[1,0]
v_pk_mul_f32 v[102:103], v[102:103], v[40:41] op_sel_hi:[1,0]
v_pk_mul_f32 v[104:105], v[104:105], v[40:41] op_sel_hi:[1,0]
v_pk_mul_f32 v[106:107], v[106:107], v[40:41] op_sel_hi:[1,0]
v_pk_mul_f32 v[108:109], v[108:109], v[40:41] op_sel_hi:[1,0]
v_pk_mul_f32 v[110:111], v[110:111], v[40:41] op_sel_hi:[1,0]
s_add_u32 m0, s21, 32768
s_add_u32 s30, s20, 163840
buffer_load_dwordx4 v1, s[4:7], s30 offen offset:0  lds
v_cvt_pk_bf16_f32 v64, v96, v97
v_cvt_pk_bf16_f32 v65, v98, v99
v_cvt_pk_bf16_f32 v66, v100, v101
v_cvt_pk_bf16_f32 v67, v102, v103
ds_write_b128 v56, v[64:67] offset:0
v_cvt_pk_bf16_f32 v68, v104, v105
v_cvt_pk_bf16_f32 v69, v106, v107
v_cvt_pk_bf16_f32 v70, v108, v109
v_cvt_pk_bf16_f32 v71, v110, v111
ds_write_b128 v56, v[68:71] offset:2112
v_pk_mul_f32 v[112:113], v[112:113], v[42:43] op_sel_hi:[1,0]
v_pk_mul_f32 v[114:115], v[114:115], v[42:43] op_sel_hi:[1,0]
v_pk_mul_f32 v[116:117], v[116:117], v[42:43] op_sel_hi:[1,0]
v_pk_mul_f32 v[118:119], v[118:119], v[42:43] op_sel_hi:[1,0]
v_pk_mul_f32 v[120:121], v[120:121], v[42:43] op_sel_hi:[1,0]
v_pk_mul_f32 v[122:123], v[122:123], v[42:43] op_sel_hi:[1,0]
v_pk_mul_f32 v[124:125], v[124:125], v[42:43] op_sel_hi:[1,0]
v_pk_mul_f32 v[126:127], v[126:127], v[42:43] op_sel_hi:[1,0]
v_cvt_pk_bf16_f32 v72, v112, v113
v_cvt_pk_bf16_f32 v73, v114, v115
buffer_load_dwordx4 v1, s[4:7], s30 offen offset:1024  lds
v_cvt_pk_bf16_f32 v74, v116, v117
v_cvt_pk_bf16_f32 v75, v118, v119
ds_write_b128 v56, v[72:75] offset:8448
v_cvt_pk_bf16_f32 v76, v120, v121
v_cvt_pk_bf16_f32 v77, v122, v123
v_cvt_pk_bf16_f32 v78, v124, v125
v_cvt_pk_bf16_f32 v79, v126, v127
ds_write_b128 v56, v[76:79] offset:10560
s_waitcnt vmcnt(22) lgkmcnt(0)
s_barrier
ds_read_b64_tr_b16 v[64:65], v58 offset:0
ds_read_b64_tr_b16 v[66:67], v58 offset:64
ds_read_b64_tr_b16 v[80:81], v59 offset:16896
ds_read_b64_tr_b16 v[82:83], v59 offset:16960
ds_read_b64_tr_b16 v[68:69], v58 offset:512
ds_read_b64_tr_b16 v[70:71], v58 offset:576
ds_read_b64_tr_b16 v[84:85], v59 offset:17408
ds_read_b64_tr_b16 v[86:87], v59 offset:17472
ds_read_b64_tr_b16 v[72:73], v58 offset:1024
ds_read_b64_tr_b16 v[74:75], v58 offset:1088
ds_read_b64_tr_b16 v[88:89], v59 offset:17920
ds_read_b64_tr_b16 v[90:91], v59 offset:17984
ds_read_b64_tr_b16 v[76:77], v58 offset:1536
ds_read_b64_tr_b16 v[78:79], v58 offset:1600
ds_read_b64_tr_b16 v[92:93], v59 offset:18432
ds_read_b64_tr_b16 v[94:95], v59 offset:18496
s_waitcnt lgkmcnt(12)
v_mfma_f32_16x16x32_bf16 v[96:99], v[64:67], v[80:83], 0
v_mfma_f32_16x16x32_bf16 v[100:103], v[64:67], v[44:47], 0
s_waitcnt lgkmcnt(8)
v_mfma_f32_16x16x32_bf16 v[96:99], v[68:71], v[84:87], v[96:99]
v_mfma_f32_16x16x32_bf16 v[100:103], v[68:71], v[44:47], v[100:103]
s_waitcnt lgkmcnt(4)
v_mfma_f32_16x16x32_bf16 v[96:99], v[72:75], v[88:91], v[96:99]
v_mfma_f32_16x16x32_bf16 v[100:103], v[72:75], v[44:47], v[100:103]
s_waitcnt lgkmcnt(0)
v_mfma_f32_16x16x32_bf16 v[96:99], v[76:79], v[92:95], v[96:99]
v_mfma_f32_16x16x32_bf16 v[100:103], v[76:79], v[44:47], v[100:103]
ds_read_b128 a[224:227], v2 offset:32768
ds_read_b128 a[228:231], v2 offset:33792
ds_read_b128 a[232:235], v2 offset:34816
ds_read_b128 a[236:239], v2 offset:35840
ds_read_b128 a[240:243], v2 offset:36864
ds_read_b128 a[244:247], v2 offset:37888
ds_read_b128 a[248:251], v2 offset:38912
v_cvt_pk_bf16_f32 v96, v96, v97
v_cvt_pk_bf16_f32 v97, v98, v99
buffer_store_dwordx2 v[96:97], v63, s[4:7], s26 offen sc1
s_mov_b32 exec_lo, 0x00010001
s_mov_b32 exec_hi, 0x00010001
buffer_store_dwordx4 v[100:103], v62, s[4:7], s28 offen sc1
s_mov_b64 exec, -1
v_mfma_f32_32x32x16_bf16 v[112:127], v[24:27], v[32:35], 0
s_waitcnt lgkmcnt(3)
v_mfma_f32_32x32x16_bf16 v[112:127], a[224:227], v[128:131], v[112:127]
ds_read_b128 a[252:255], v2 offset:39936
buffer_load_dwordx4 v1, s[4:7], s30 offen offset:2048  lds
v_mfma_f32_32x32x16_bf16 v[112:127], a[228:231], v[132:135], v[112:127]
ds_read_b128 a[224:227], v2 offset:40960
v_mfma_f32_32x32x16_bf16 v[112:127], a[232:235], v[136:139], v[112:127]
ds_read_b128 a[228:231], v2 offset:41984
v_and_b32 v51, 15, v0
v_lshl_add_u32 v62, v51, 6, v62
v_and_b32 v51, 31, v0
v_and_b32 v52, 1, v0
v_mfma_f32_32x32x16_bf16 v[112:127], a[236:239], v[140:143], v[112:127]
ds_read_b128 a[232:235], v2 offset:43008
buffer_load_dwordx4 v1, s[4:7], s30 offen offset:3072  lds
v_lshlrev_b32 v52, 4, v52
v_mov_b32 v53, 0x3f80
v_lshlrev_b32 v52, v52, v53
s_waitcnt lgkmcnt(3)
v_mfma_f32_32x32x16_bf16 v[112:127], a[240:243], v[144:147], v[112:127]
ds_read_b128 a[236:239], v2 offset:44032
v_lshrrev_b32 v51, 1, v51
s_add_u32 s28, s38, 20971520
v_bfe_u32 v54, v0, 4, 1
v_lshlrev_b32 v63, 10, v54
v_mfma_f32_32x32x16_bf16 v[112:127], a[244:247], v[148:151], v[112:127]
ds_read_b128 a[240:243], v2 offset:45056
v_lshrrev_b32 v54, 5, v0
v_lshl_add_u32 v63, v54, 8, v63
v_and_b32 v54, 15, v0
v_lshl_add_u32 v63, v54, 4, v63
v_mfma_f32_32x32x16_bf16 v[112:127], a[248:251], v[152:155], v[112:127]
ds_read_b128 a[244:247], v2 offset:46080
s_add_u32 m0, s21, 36864
s_add_u32 s30, s20, 167936
buffer_load_dwordx4 v1, s[4:7], s30 offen offset:0  lds
v_cmp_eq_u32 vcc, 0, v51
v_mfma_f32_32x32x16_bf16 v[112:127], a[252:255], v[156:159], v[112:127]
ds_read_b128 a[248:251], v2 offset:47104
s_nop 1
v_cndmask_b32 v44, 0, v52, vcc
v_cmp_eq_u32 vcc, 1, v51
s_nop 1
s_waitcnt lgkmcnt(3)
v_mfma_f32_32x32x16_bf16 v[112:127], a[224:227], v[160:163], v[112:127]
ds_read_b128 a[252:255], v2 offset:48128
v_cndmask_b32 v45, 0, v52, vcc
v_cmp_eq_u32 vcc, 2, v51
s_nop 1
v_cndmask_b32 v46, 0, v52, vcc
v_mfma_f32_32x32x16_bf16 v[112:127], a[228:231], v[164:167], v[112:127]
ds_read_b128 a[224:227], v2 offset:49152
buffer_load_dwordx4 v1, s[4:7], s30 offen offset:1024  lds
v_cmp_eq_u32 vcc, 3, v51
s_nop 1
v_cndmask_b32 v47, 0, v52, vcc
v_mfma_f32_32x32x16_bf16 v[112:127], a[232:235], v[168:171], v[112:127]
ds_read_b128 a[228:231], v2 offset:50176
v_lshrrev_b32 v65, 5, v0
v_lshlrev_b32 v65, 9, v65
v_and_b32 v68, 31, v0
v_lshl_add_u32 v65, v68, 2, v65
v_mfma_f32_32x32x16_bf16 v[112:127], a[236:239], v[172:175], v[112:127]
ds_read_b128 a[232:235], v2 offset:51200
s_mul_i32 s26, s17, 10240
s_lshl_b32 s15, s3, 10
s_add_u32 s26, s26, s15
s_add_u32 s26, s26, 9964544
s_waitcnt lgkmcnt(3)
v_mfma_f32_32x32x16_bf16 v[112:127], a[240:243], v[176:179], v[112:127]
ds_read_b128 a[236:239], v2 offset:52224
buffer_load_dwordx4 v1, s[4:7], s30 offen offset:2048  lds
s_add_u32 s15, s26, 4096
v_lshlrev_b32 v57, 2, v0
v_lshl_add_u32 v56, s3, 8, v57
v_mfma_f32_32x32x16_bf16 v[112:127], a[244:247], v[180:183], v[112:127]
ds_read_b128 a[240:243], v2 offset:53248
v_mfma_f32_32x32x16_bf16 v[112:127], a[248:251], v[184:187], v[112:127]
ds_read_b128 a[244:247], v2 offset:54272
buffer_load_dword v104, v65, s[4:7], s26 offen offset:0 sc1
buffer_load_dword v105, v65, s[4:7], s26 offen offset:128 sc1
buffer_load_dword v106, v65, s[4:7], s26 offen offset:256 sc1
buffer_load_dword v107, v65, s[4:7], s26 offen offset:384 sc1
buffer_load_dword v108, v65, s[4:7], s15 offen offset:0 sc1
buffer_load_dword v109, v65, s[4:7], s15 offen offset:128 sc1
buffer_load_dword v110, v65, s[4:7], s15 offen offset:256 sc1
buffer_load_dword v111, v65, s[4:7], s15 offen offset:384 sc1
s_waitcnt vmcnt(35)
s_mov_b32 exec_lo, 0x1010101
s_mov_b32 exec_hi, 0x1010101
buffer_load_dword v5, v1, s[4:7], s28 offen offset:0 sc1
buffer_load_dword v5, v1, s[4:7], s28 offen offset:1024 sc1
s_mov_b64 exec, -1
buffer_load_dwordx4 v1, s[4:7], s30 offen offset:3072  lds
v_mfma_f32_32x32x16_bf16 v[112:127], a[252:255], v[188:191], v[112:127]
ds_read_b128 a[248:251], v2 offset:55296
s_waitcnt lgkmcnt(3)
v_mfma_f32_32x32x16_bf16 v[112:127], a[224:227], v[192:195], v[112:127]
ds_read_b128 a[252:255], v2 offset:56320
s_add_u32 s27, s85, 0
buffer_load_dwordx4 v[128:131], v1, s[4:7], s27 offen offset:0
v_mfma_f32_32x32x16_bf16 v[112:127], a[228:231], v[196:199], v[112:127]
ds_read_b128 a[224:227], v2 offset:57344
v_mfma_f32_32x32x16_bf16 v[112:127], a[232:235], v[200:203], v[112:127]
ds_read_b128 a[228:231], v2 offset:58368
buffer_load_dwordx4 v[132:135], v1, s[4:7], s27 offen offset:1024
v_mfma_f32_32x32x16_bf16 v[112:127], a[236:239], v[204:207], v[112:127]
ds_read_b128 a[232:235], v2 offset:59392
s_waitcnt lgkmcnt(3)
v_mfma_f32_32x32x16_bf16 v[112:127], a[240:243], v[208:211], v[112:127]
ds_read_b128 a[236:239], v2 offset:60416
buffer_load_dwordx4 v[136:139], v1, s[4:7], s27 offen offset:2048
v_mfma_f32_32x32x16_bf16 v[112:127], a[244:247], v[212:215], v[112:127]
ds_read_b128 a[240:243], v2 offset:61440
v_mfma_f32_32x32x16_bf16 v[112:127], a[248:251], v[216:219], v[112:127]
ds_read_b128 a[244:247], v2 offset:62464
buffer_load_dwordx4 v[140:143], v1, s[4:7], s27 offen offset:3072
v_mfma_f32_32x32x16_bf16 v[112:127], a[252:255], v[220:223], v[112:127]
ds_read_b128 a[248:251], v2 offset:63488
s_waitcnt lgkmcnt(3)
v_mfma_f32_32x32x16_bf16 v[112:127], a[224:227], v[224:227], v[112:127]
ds_read_b128 a[252:255], v2 offset:64512
s_add_u32 s27, s85, 4096
buffer_load_dwordx4 v[144:147], v1, s[4:7], s27 offen offset:0
v_mfma_f32_32x32x16_bf16 v[112:127], a[228:231], v[228:231], v[112:127]
v_mfma_f32_32x32x16_bf16 v[112:127], a[232:235], v[232:235], v[112:127]
buffer_load_dwordx4 v[148:151], v1, s[4:7], s27 offen offset:1024
v_mfma_f32_32x32x16_bf16 v[112:127], a[236:239], v[236:239], v[112:127]
s_waitcnt lgkmcnt(0)
v_mfma_f32_32x32x16_bf16 v[112:127], a[240:243], v[240:243], v[112:127]
buffer_load_dwordx4 v[152:155], v1, s[4:7], s27 offen offset:2048
v_mfma_f32_32x32x16_bf16 v[112:127], a[244:247], v[244:247], v[112:127]
v_mfma_f32_32x32x16_bf16 v[112:127], a[248:251], v[248:251], v[112:127]
buffer_load_dwordx4 v[156:159], v1, s[4:7], s27 offen offset:3072
v_mfma_f32_32x32x16_bf16 v[112:127], a[252:255], v[252:255], v[112:127]
s_nop 11
v_cvt_pk_bf16_f32 v48, v112, v113
v_cvt_pk_bf16_f32 v49, v114, v115
v_cvt_pk_bf16_f32 v50, v116, v117
v_cvt_pk_bf16_f32 v51, v118, v119
v_cvt_pk_bf16_f32 v52, v120, v121
v_cvt_pk_bf16_f32 v53, v122, v123
v_cvt_pk_bf16_f32 v54, v124, v125
v_cvt_pk_bf16_f32 v55, v126, v127
v_mfma_f32_32x32x16_bf16 v[64:79], v[14:17], v[48:51], 0
s_nop 0
v_mfma_f32_32x32x16_bf16 v[80:95], v[18:21], v[52:55], 0
s_waitcnt vmcnt(11)
v_add_f32 v104, v104, v106
v_add_f32 v105, v105, v107
v_add_f32 v108, v108, v110
v_add_f32 v109, v109, v111
v_add_f32 v104, v104, v105
buffer_load_dwordx4 v[224:227], v62, s[4:7], s37 offen sc1
v_add_f32 v108, v108, v109
v_mov_b32 v105, v104
v_mov_b32 v109, v108
s_nop 0
v_permlane32_swap_b32 v104, v105
v_permlane32_swap_b32 v108, v109
v_add_f32 v104, v104, v105
v_add_f32 v108, v108, v109
v_cvt_pk_bf16_f32 v105, v104, v104
v_and_b32 v105, 0xffff0000, v105
v_sub_f32 v96, v104, v105
v_cvt_pk_bf16_f32 v25, v105, v96
v_cvt_pk_bf16_f32 v109, v108, v108
v_and_b32 v109, 0xffff0000, v109
v_sub_f32 v96, v108, v109
v_cvt_pk_bf16_f32 v26, v109, v96
s_add_u32 s23, s36, 0
buffer_load_dwordx4 v[192:195], v1, s[4:7], s23 offen offset:0 sc1
ds_write_b32 v56, v25 offset:29440
ds_write_b32 v56, v26 offset:30464
v_max3_f32 v40, v64, v65, v66
v_max3_f32 v42, v80, v81, v82
v_max3_f32 v40, v40, v67, v68
v_max3_f32 v42, v42, v83, v84
v_max3_f32 v40, v40, v69, v70
v_max3_f32 v42, v42, v85, v86
v_max3_f32 v40, v40, v71, v72
v_max3_f32 v42, v42, v87, v88
v_max3_f32 v40, v40, v73, v74
v_max3_f32 v42, v42, v89, v90
v_max3_f32 v40, v40, v75, v76
v_max3_f32 v42, v42, v91, v92
buffer_load_dwordx4 v[196:199], v1, s[4:7], s23 offen offset:1024 sc1
v_max3_f32 v40, v40, v77, v78
v_max3_f32 v42, v42, v93, v94
v_max_f32 v40, v40, v79
v_max_f32 v42, v42, v95
v_mul_f32 v40, -v40, v38
v_mul_f32 v42, -v42, v38
v_pk_fma_f32 v[64:65], v[64:65], v[38:39], v[40:41] op_sel_hi:[1,0,0]
v_pk_fma_f32 v[80:81], v[80:81], v[38:39], v[42:43] op_sel_hi:[1,0,0]
v_pk_fma_f32 v[66:67], v[66:67], v[38:39], v[40:41] op_sel_hi:[1,0,0]
v_pk_fma_f32 v[82:83], v[82:83], v[38:39], v[42:43] op_sel_hi:[1,0,0]
v_pk_fma_f32 v[68:69], v[68:69], v[38:39], v[40:41] op_sel_hi:[1,0,0]
v_pk_fma_f32 v[84:85], v[84:85], v[38:39], v[42:43] op_sel_hi:[1,0,0]
v_pk_fma_f32 v[70:71], v[70:71], v[38:39], v[40:41] op_sel_hi:[1,0,0]
v_pk_fma_f32 v[86:87], v[86:87], v[38:39], v[42:43] op_sel_hi:[1,0,0]
v_pk_fma_f32 v[72:73], v[72:73], v[38:39], v[40:41] op_sel_hi:[1,0,0]
buffer_load_dwordx4 v[200:203], v1, s[4:7], s23 offen offset:2048 sc1
v_pk_fma_f32 v[88:89], v[88:89], v[38:39], v[42:43] op_sel_hi:[1,0,0]
v_pk_fma_f32 v[74:75], v[74:75], v[38:39], v[40:41] op_sel_hi:[1,0,0]
v_pk_fma_f32 v[90:91], v[90:91], v[38:39], v[42:43] op_sel_hi:[1,0,0]
v_pk_fma_f32 v[76:77], v[76:77], v[38:39], v[40:41] op_sel_hi:[1,0,0]
v_pk_fma_f32 v[92:93], v[92:93], v[38:39], v[42:43] op_sel_hi:[1,0,0]
v_pk_fma_f32 v[78:79], v[78:79], v[38:39], v[40:41] op_sel_hi:[1,0,0]
v_pk_fma_f32 v[94:95], v[94:95], v[38:39], v[42:43] op_sel_hi:[1,0,0]
v_exp_f32 v64, v64
v_exp_f32 v80, v80
v_exp_f32 v65, v65
v_exp_f32 v81, v81
buffer_load_dwordx4 v[204:207], v1, s[4:7], s23 offen offset:3072 sc1
v_exp_f32 v66, v66
v_exp_f32 v82, v82
v_exp_f32 v67, v67
v_exp_f32 v83, v83
v_exp_f32 v68, v68
v_exp_f32 v84, v84
v_exp_f32 v69, v69
v_exp_f32 v85, v85
s_add_u32 s23, s36, 4096
buffer_load_dwordx4 v[208:211], v1, s[4:7], s23 offen offset:0 sc1
v_exp_f32 v70, v70
v_exp_f32 v86, v86
v_exp_f32 v71, v71
v_exp_f32 v87, v87
v_exp_f32 v72, v72
v_exp_f32 v88, v88
v_exp_f32 v73, v73
buffer_load_dwordx4 v[212:215], v1, s[4:7], s23 offen offset:1024 sc1
v_exp_f32 v89, v89
v_exp_f32 v74, v74
v_exp_f32 v90, v90
v_exp_f32 v75, v75
v_exp_f32 v91, v91
v_exp_f32 v76, v76
v_exp_f32 v92, v92
v_exp_f32 v77, v77
buffer_load_dwordx4 v[216:219], v1, s[4:7], s23 offen offset:2048 sc1
v_exp_f32 v93, v93
v_exp_f32 v78, v78
v_exp_f32 v94, v94
v_exp_f32 v79, v79
v_exp_f32 v95, v95
v_pk_add_f32 v[40:41], v[64:65], v[66:67]
v_pk_add_f32 v[42:43], v[80:81], v[82:83]
v_pk_add_f32 v[40:41], v[40:41], v[68:69]
v_pk_add_f32 v[42:43], v[42:43], v[84:85]
v_pk_add_f32 v[40:41], v[40:41], v[70:71]
buffer_load_dwordx4 v[220:223], v1, s[4:7], s23 offen offset:3072 sc1
v_pk_add_f32 v[42:43], v[42:43], v[86:87]
v_pk_add_f32 v[40:41], v[40:41], v[72:73]
v_pk_add_f32 v[42:43], v[42:43], v[88:89]
v_pk_add_f32 v[40:41], v[40:41], v[74:75]
v_pk_add_f32 v[42:43], v[42:43], v[90:91]
v_pk_add_f32 v[40:41], v[40:41], v[76:77]
v_pk_add_f32 v[42:43], v[42:43], v[92:93]
v_pk_add_f32 v[40:41], v[40:41], v[78:79]
v_pk_add_f32 v[42:43], v[42:43], v[94:95]
v_add_f32 v40, v40, v41
v_add_f32 v42, v42, v43
v_rcp_f32 v40, v40
v_rcp_f32 v42, v42
s_add_u32 s27, s85, 8192
buffer_load_dwordx4 v[160:163], v1, s[4:7], s27 offen offset:0
v_pk_mul_f32 v[64:65], v[64:65], v[40:41] op_sel_hi:[1,0]
v_pk_mul_f32 v[66:67], v[66:67], v[40:41] op_sel_hi:[1,0]
v_pk_mul_f32 v[68:69], v[68:69], v[40:41] op_sel_hi:[1,0]
v_pk_mul_f32 v[70:71], v[70:71], v[40:41] op_sel_hi:[1,0]
v_pk_mul_f32 v[72:73], v[72:73], v[40:41] op_sel_hi:[1,0]
v_pk_mul_f32 v[74:75], v[74:75], v[40:41] op_sel_hi:[1,0]
v_pk_mul_f32 v[76:77], v[76:77], v[40:41] op_sel_hi:[1,0]
v_pk_mul_f32 v[78:79], v[78:79], v[40:41] op_sel_hi:[1,0]
v_cvt_pk_bf16_f32 v96, v64, v65
v_cvt_pk_bf16_f32 v97, v66, v67
v_cvt_pk_bf16_f32 v98, v68, v69
v_cvt_pk_bf16_f32 v99, v70, v71
v_cvt_pk_bf16_f32 v100, v72, v73
v_cvt_pk_bf16_f32 v101, v74, v75
buffer_load_dwordx4 v[164:167], v1, s[4:7], s27 offen offset:1024
v_cvt_pk_bf16_f32 v102, v76, v77
v_cvt_pk_bf16_f32 v103, v78, v79
v_pk_mul_f32 v[80:81], v[80:81], v[42:43] op_sel_hi:[1,0]
v_pk_mul_f32 v[82:83], v[82:83], v[42:43] op_sel_hi:[1,0]
v_pk_mul_f32 v[84:85], v[84:85], v[42:43] op_sel_hi:[1,0]
v_pk_mul_f32 v[86:87], v[86:87], v[42:43] op_sel_hi:[1,0]
v_pk_mul_f32 v[88:89], v[88:89], v[42:43] op_sel_hi:[1,0]
v_pk_mul_f32 v[90:91], v[90:91], v[42:43] op_sel_hi:[1,0]
v_pk_mul_f32 v[92:93], v[92:93], v[42:43] op_sel_hi:[1,0]
v_pk_mul_f32 v[94:95], v[94:95], v[42:43] op_sel_hi:[1,0]
v_cvt_pk_bf16_f32 v104, v80, v81
v_cvt_pk_bf16_f32 v105, v82, v83
v_cvt_pk_bf16_f32 v106, v84, v85
v_cvt_pk_bf16_f32 v107, v86, v87
v_cvt_pk_bf16_f32 v108, v88, v89
buffer_load_dwordx4 v[168:171], v1, s[4:7], s27 offen offset:2048
v_cvt_pk_bf16_f32 v109, v90, v91
v_cvt_pk_bf16_f32 v110, v92, v93
v_cvt_pk_bf16_f32 v111, v94, v95
s_waitcnt vmcnt(11)
s_waitcnt vmcnt(10)
v_mfma_f32_32x32x16_bf16 v[112:127], v[44:47], v[192:195], 0
v_add_f32_dpp v224, v224, v224 row_ror:8 row_mask:0xf bank_mask:0xf
v_add_f32_dpp v225, v225, v225 row_ror:8 row_mask:0xf bank_mask:0xf
v_add_f32_dpp v226, v226, v226 row_ror:8 row_mask:0xf bank_mask:0xf
v_add_f32_dpp v227, v227, v227 row_ror:8 row_mask:0xf bank_mask:0xf
s_waitcnt vmcnt(9)
v_mfma_f32_32x32x16_bf16 v[112:127], v[44:47], v[196:199], v[112:127]
buffer_load_dwordx4 v[172:175], v1, s[4:7], s27 offen offset:3072
v_add_f32_dpp v224, v224, v224 row_ror:4 row_mask:0xf bank_mask:0xf
v_add_f32_dpp v225, v225, v225 row_ror:4 row_mask:0xf bank_mask:0xf
v_add_f32_dpp v226, v226, v226 row_ror:4 row_mask:0xf bank_mask:0xf
v_add_f32_dpp v227, v227, v227 row_ror:4 row_mask:0xf bank_mask:0xf
s_waitcnt vmcnt(9)
v_mfma_f32_32x32x16_bf16 v[112:127], v[44:47], v[200:203], v[112:127]
v_add_f32_dpp v224, v224, v224 row_ror:2 row_mask:0xf bank_mask:0xf
v_add_f32_dpp v225, v225, v225 row_ror:2 row_mask:0xf bank_mask:0xf
v_add_f32_dpp v226, v226, v226 row_ror:2 row_mask:0xf bank_mask:0xf
v_add_f32_dpp v227, v227, v227 row_ror:2 row_mask:0xf bank_mask:0xf
s_waitcnt vmcnt(8)
v_mfma_f32_32x32x16_bf16 v[112:127], v[44:47], v[204:207], v[112:127]
s_add_u32 s27, s85, 12288
buffer_load_dwordx4 v[176:179], v1, s[4:7], s27 offen offset:0
v_add_f32_dpp v224, v224, v224 row_ror:1 row_mask:0xf bank_mask:0xf
v_add_f32_dpp v225, v225, v225 row_ror:1 row_mask:0xf bank_mask:0xf
v_add_f32_dpp v226, v226, v226 row_ror:1 row_mask:0xf bank_mask:0xf
v_add_f32_dpp v227, v227, v227 row_ror:1 row_mask:0xf bank_mask:0xf
s_waitcnt vmcnt(8)
v_mfma_f32_32x32x16_bf16 v[112:127], v[44:47], v[208:211], v[112:127]
v_add_f32 v52, v224, v225
v_add_f32 v53, v226, v227
v_cvt_pk_bf16_f32 v54, v224, v225
v_cvt_pk_bf16_f32 v55, v226, v227
s_waitcnt vmcnt(7)
v_mfma_f32_32x32x16_bf16 v[112:127], v[44:47], v[212:215], v[112:127]
buffer_load_dwordx4 v[180:183], v1, s[4:7], s27 offen offset:1024
v_add_f32 v52, v52, v53
s_waitcnt vmcnt(7)
v_mfma_f32_32x32x16_bf16 v[112:127], v[44:47], v[216:219], v[112:127]
s_waitcnt vmcnt(6)
v_mfma_f32_32x32x16_bf16 v[112:127], v[44:47], v[220:223], v[112:127]
buffer_load_dwordx4 v[184:187], v1, s[4:7], s27 offen offset:2048
s_nop 10
v_cmp_u_f32 vcc, v112, v52
v_cvt_pk_bf16_f32 v50, v112, v113
s_cbranch_vccnz L_kvagain_12
L_kvok_11:
v_cvt_pk_bf16_f32 v51, v114, v115
ds_write_b64 v61, v[54:55] offset:25600
ds_write_b64 v60, v[50:51] offset:25344
s_waitcnt lgkmcnt(0)
s_barrier
s_cmp_lg_u32 s33, 0
s_cbranch_scc1 L_slow_tail
ds_read_b128 a[224:227], v1 offset:25344
ds_read_b128 a[232:235], v1 offset:27392
ds_read_b128 a[228:231], v1 offset:26368
ds_read_b128 a[236:239], v1 offset:28416
ds_read_b32 v25, v57 offset:29440
ds_read_b32 v26, v57 offset:29696
ds_read_b32 v27, v57 offset:29952
ds_read_b32 v28, v57 offset:30208
ds_read_b32 v29, v57 offset:30464
ds_read_b32 v30, v57 offset:30720
ds_read_b32 v31, v57 offset:30976
buffer_load_dwordx4 v[188:191], v1, s[4:7], s27 offen offset:3072
s_waitcnt lgkmcnt(9)
v_mfma_f32_32x32x16_bf16 v[64:79], a[224:227], v[96:99], 0
v_mfma_f32_32x32x16_bf16 v[80:95], a[232:235], v[104:107], 0
s_waitcnt lgkmcnt(7)
v_mfma_f32_32x32x16_bf16 v[64:79], a[228:231], v[100:103], v[64:79]
v_mfma_f32_32x32x16_bf16 v[80:95], a[236:239], v[108:111], v[80:95]
v_and_b32 v59, 7, v0
v_lshl_add_u32 v59, s3, 3, v59
v_bfe_u32 v61, v0, 4, 1
v_and_b32 v56, 15, v0
v_lshlrev_b32 v60, 3, v61
v_xor_b32 v56, v56, v60
v_lshlrev_b32 v56, 4, v56
v_lshrrev_b32 v60, 4, v0
v_lshl_add_u32 v56, v60, 9, v56
v_lshl_add_u32 v56, s3, 12, v56
s_nop 0
v_add_f32 v72, 0x358637bd, v72
v_rcp_f32 v72, v72
v_add_f32 v88, 0x358637bd, v88
v_rcp_f32 v88, v88
v_pk_mul_f32 v[64:65], v[64:65], v[72:73] op_sel_hi:[1,0]
v_pk_mul_f32 v[66:67], v[66:67], v[72:73] op_sel_hi:[1,0]
v_pk_mul_f32 v[68:69], v[68:69], v[72:73] op_sel_hi:[1,0]
v_pk_mul_f32 v[70:71], v[70:71], v[72:73] op_sel_hi:[1,0]
v_cvt_pk_bf16_f32 v76, v64, v65
v_cvt_pk_bf16_f32 v77, v66, v67
v_cvt_pk_bf16_f32 v78, v68, v69
v_cvt_pk_bf16_f32 v79, v70, v71
buffer_store_dwordx4 v[76:79], v63, s[4:7], s28 offen offset:0
v_pk_mul_f32 v[80:81], v[80:81], v[88:89] op_sel_hi:[1,0]
v_pk_mul_f32 v[82:83], v[82:83], v[88:89] op_sel_hi:[1,0]
v_pk_mul_f32 v[84:85], v[84:85], v[88:89] op_sel_hi:[1,0]
v_pk_mul_f32 v[86:87], v[86:87], v[88:89] op_sel_hi:[1,0]
v_cvt_pk_bf16_f32 v92, v80, v81
v_cvt_pk_bf16_f32 v93, v82, v83
v_cvt_pk_bf16_f32 v94, v84, v85
v_cvt_pk_bf16_f32 v95, v86, v87
buffer_store_dwordx4 v[92:95], v63, s[4:7], s28 offen offset:512
s_waitcnt lgkmcnt(0)
v_bfe_u32 v61, v0, 3, 1
v_lshlrev_b32 v57, 3, v61
v_xor_b32 v57, v57, v59
v_lshlrev_b32 v57, 4, v57
v_lshl_add_u32 v57, v61, 9, v57
v_lshl_add_u32 v57, v60, 12, v57
v_lshlrev_b32 v58, 4, v59
v_lshl_add_u32 v58, v61, 9, v58
v_lshl_add_u32 v58, v60, 10, v58
v_lshrrev_b32 v60, 5, v0
v_lshlrev_b32 v59, 3, v59
v_lshl_add_u32 v59, v60, 2, v59
v_and_b32 v62, 7, v0
v_lshlrev_b32 v62, 2, v62
s_add_u32 s36, s82, 12582912
s_add_u32 s37, s83, 7864320
v_permlane16_swap_b32 v6, v8
v_permlane16_swap_b32 v7, v9
v_permlane16_swap_b32 v10, v12
v_permlane16_swap_b32 v11, v13
s_add_u32 s15, s36, 32768
v_lshlrev_b32 v40, 16, v6
v_and_b32 v41, 0xffff0000, v6
v_lshlrev_b32 v42, 16, v7
v_and_b32 v43, 0xffff0000, v7
v_lshlrev_b32 v44, 16, v8
v_and_b32 v45, 0xffff0000, v8
v_lshlrev_b32 v46, 16, v9
v_and_b32 v47, 0xffff0000, v9
v_lshlrev_b32 v48, 16, v10
v_and_b32 v49, 0xffff0000, v10
v_lshlrev_b32 v50, 16, v11
v_and_b32 v51, 0xffff0000, v11
v_lshlrev_b32 v52, 16, v12
v_and_b32 v53, 0xffff0000, v12
v_lshlrev_b32 v54, 16, v13
v_and_b32 v55, 0xffff0000, v13
v_mov_b32 v4, 1
s_waitcnt vmcnt(0)
s_mov_b64 exec, 1
buffer_store_dword v4, off, s[4:7], s78
s_mov_b64 exec, -1
v_and_b32 v38, 1, v0
v_lshlrev_b32 v38, 4, v38
v_mov_b32 v39, 0x3f80
v_lshlrev_b32 v38, v38, v39
v_bfe_u32 v39, v0, 1, 3
v_cmp_eq_u32 s[96:97], 0, v39
v_cmp_eq_u32 s[26:27], 1, v39
s_nop 0
v_cndmask_b32 v60, 0, v38, s[96:97]
v_cndmask_b32 v61, 0, v38, s[26:27]
v_cmp_eq_u32 s[96:97], 2, v39
v_cmp_eq_u32 s[26:27], 3, v39
v_accvgpr_write_b32 a240, v60
v_accvgpr_write_b32 a241, v61
v_cndmask_b32 v60, 0, v38, s[96:97]
v_cndmask_b32 v61, 0, v38, s[26:27]
v_cmp_eq_u32 s[96:97], 4, v39
v_cmp_eq_u32 s[26:27], 5, v39
v_accvgpr_write_b32 a242, v60
v_accvgpr_write_b32 a243, v61
v_cndmask_b32 v60, 0, v38, s[96:97]
v_cndmask_b32 v61, 0, v38, s[26:27]
v_cmp_eq_u32 s[96:97], 6, v39
v_cmp_eq_u32 s[26:27], 7, v39
v_accvgpr_write_b32 a244, v60
v_accvgpr_write_b32 a245, v61
v_cndmask_b32 v60, 0, v38, s[96:97]
v_cndmask_b32 v61, 0, v38, s[26:27]
v_accvgpr_write_b32 a246, v60
v_accvgpr_write_b32 a247, v61
L_spin_15:
buffer_load_dword v63, v62, s[4:7], s79 offen sc1
s_sub_u32 s29, s29, 1
s_waitcnt vmcnt(0)
v_cmp_gt_u32 vcc, 1, v63
s_cbranch_scc1 L_spinout_17
s_cbranch_vccnz L_spin_15
L_spun_16:
s_add_u32 s23, s39, 20971520
buffer_load_dwordx4 v[192:195], v1, s[4:7], s23 offen offset:0 sc1
buffer_load_dwordx4 v[196:199], v1, s[4:7], s23 offen offset:2048 sc1
s_add_u32 s23, s39, 20975616
buffer_load_dwordx4 v[200:203], v1, s[4:7], s23 offen offset:0 sc1
buffer_load_dwordx4 v[204:207], v1, s[4:7], s23 offen offset:2048 sc1
s_add_u32 s23, s39, 20972544
buffer_load_dwordx4 v[208:211], v1, s[4:7], s23 offen offset:0 sc1
buffer_load_dwordx4 v[212:215], v1, s[4:7], s23 offen offset:2048 sc1
s_add_u32 s23, s39, 20976640
buffer_load_dwordx4 v[216:219], v1, s[4:7], s23 offen offset:0 sc1
buffer_load_dwordx4 v[220:223], v1, s[4:7], s23 offen offset:2048 sc1
s_add_u32 s23, s39, 21004288
buffer_load_dwordx4 v[224:227], v1, s[4:7], s23 offen offset:0 sc1
buffer_load_dwordx4 v[228:231], v1, s[4:7], s23 offen offset:2048 sc1
s_waitcnt vmcnt(9)
v_mfma_f32_16x16x32_bf16 v[64:67], v[128:131], v[192:195], 0
s_add_u32 s23, s39, 21008384
buffer_load_dwordx4 v[232:235], v1, s[4:7], s23 offen offset:0 sc1
v_mfma_f32_16x16x32_bf16 v[68:71], v[132:135], v[192:195], 0
v_mfma_f32_16x16x32_bf16 v[72:75], v[136:139], v[192:195], 0
v_mfma_f32_16x16x32_bf16 v[76:79], v[140:143], v[192:195], 0
s_waitcnt vmcnt(9)
v_mfma_f32_16x16x32_bf16 v[64:67], v[144:147], v[196:199], v[64:67]
buffer_load_dwordx4 v[236:239], v1, s[4:7], s23 offen offset:2048 sc1
v_mfma_f32_16x16x32_bf16 v[68:71], v[148:151], v[196:199], v[68:71]
v_mfma_f32_16x16x32_bf16 v[72:75], v[152:155], v[196:199], v[72:75]
v_mfma_f32_16x16x32_bf16 v[76:79], v[156:159], v[196:199], v[76:79]
s_waitcnt vmcnt(9)
v_mfma_f32_16x16x32_bf16 v[64:67], v[160:163], v[200:203], v[64:67]
s_add_u32 s23, s39, 21005312
buffer_load_dwordx4 v[240:243], v1, s[4:7], s23 offen offset:0 sc1
v_mfma_f32_16x16x32_bf16 v[68:71], v[164:167], v[200:203], v[68:71]
v_mfma_f32_16x16x32_bf16 v[72:75], v[168:171], v[200:203], v[72:75]
v_mfma_f32_16x16x32_bf16 v[76:79], v[172:175], v[200:203], v[76:79]
s_waitcnt vmcnt(9)
v_mfma_f32_16x16x32_bf16 v[64:67], v[176:179], v[204:207], v[64:67]
buffer_load_dwordx4 v[244:247], v1, s[4:7], s23 offen offset:2048 sc1
v_mfma_f32_16x16x32_bf16 v[68:71], v[180:183], v[204:207], v[68:71]
v_mfma_f32_16x16x32_bf16 v[72:75], v[184:187], v[204:207], v[72:75]
v_mfma_f32_16x16x32_bf16 v[76:79], v[188:191], v[204:207], v[76:79]
s_waitcnt vmcnt(9)
v_mfma_f32_16x16x32_bf16 v[80:83], v[128:131], v[208:211], 0
s_add_u32 s23, s39, 21009408
buffer_load_dwordx4 v[248:251], v1, s[4:7], s23 offen offset:0 sc1
v_mfma_f32_16x16x32_bf16 v[84:87], v[132:135], v[208:211], 0
v_mfma_f32_16x16x32_bf16 v[88:91], v[136:139], v[208:211], 0
v_mfma_f32_16x16x32_bf16 v[92:95], v[140:143], v[208:211], 0
s_waitcnt vmcnt(9)
v_mfma_f32_16x16x32_bf16 v[80:83], v[144:147], v[212:215], v[80:83]
buffer_load_dwordx4 v[252:255], v1, s[4:7], s23 offen offset:2048 sc1
v_mfma_f32_16x16x32_bf16 v[84:87], v[148:151], v[212:215], v[84:87]
v_cvt_pk_bf16_f32 v64, v64, v65
v_cvt_pk_bf16_f32 v65, v66, v67
v_cvt_pk_bf16_f32 v66, v68, v69
v_cvt_pk_bf16_f32 v67, v70, v71
ds_write_b128 v56, v[64:67] offset:0
v_mfma_f32_16x16x32_bf16 v[88:91], v[152:155], v[212:215], v[88:91]
v_mfma_f32_16x16x32_bf16 v[92:95], v[156:159], v[212:215], v[92:95]
s_waitcnt vmcnt(9)
v_mfma_f32_16x16x32_bf16 v[80:83], v[160:163], v[216:219], v[80:83]
s_mov_b32 exec_lo, 0x1010101
s_mov_b32 exec_hi, 0x1010101
buffer_load_dword v5, v58, s[4:7], s36 offen offset:0 sc1
buffer_load_dword v5, v58, s[4:7], s15 offen offset:0 sc1
s_mov_b64 exec, -1
v_mfma_f32_16x16x32_bf16 v[84:87], v[164:167], v[216:219], v[84:87]
v_mfma_f32_16x16x32_bf16 v[88:91], v[168:171], v[216:219], v[88:91]
v_mfma_f32_16x16x32_bf16 v[92:95], v[172:175], v[216:219], v[92:95]
v_cvt_pk_bf16_f32 v72, v72, v73
v_cvt_pk_bf16_f32 v73, v74, v75
v_cvt_pk_bf16_f32 v74, v76, v77
v_cvt_pk_bf16_f32 v75, v78, v79
ds_write_b128 v56, v[72:75] offset:2048
s_waitcnt vmcnt(10)
v_mfma_f32_16x16x32_bf16 v[80:83], v[176:179], v[220:223], v[80:83]
s_mov_b32 exec_lo, 0x1
s_mov_b32 exec_hi, 0x1
buffer_load_dword v5, v59, s[4:7], s37 offen offset:0 sc1
buffer_load_dword v5, v59, s[4:7], s37 offen offset:2048 sc1
s_mov_b64 exec, -1
v_mfma_f32_16x16x32_bf16 v[84:87], v[180:183], v[220:223], v[84:87]
v_mfma_f32_16x16x32_bf16 v[88:91], v[184:187], v[220:223], v[88:91]
v_mfma_f32_16x16x32_bf16 v[92:95], v[188:191], v[220:223], v[92:95]
s_waitcnt vmcnt(11)
v_mfma_f32_16x16x32_bf16 v[96:99], v[128:131], v[224:227], 0
s_add_u32 m0, s21, 98304
s_add_u32 s30, s20, 131072
buffer_load_dwordx4 v1, s[4:7], s30 offen offset:0  lds
v_mfma_f32_16x16x32_bf16 v[100:103], v[132:135], v[224:227], 0
v_mfma_f32_16x16x32_bf16 v[104:107], v[136:139], v[224:227], 0
v_mfma_f32_16x16x32_bf16 v[108:111], v[140:143], v[224:227], 0
v_cvt_pk_bf16_f32 v80, v80, v81
v_cvt_pk_bf16_f32 v81, v82, v83
v_cvt_pk_bf16_f32 v82, v84, v85
v_cvt_pk_bf16_f32 v83, v86, v87
ds_write_b128 v56, v[80:83] offset:256
s_waitcnt vmcnt(11)
v_mfma_f32_16x16x32_bf16 v[96:99], v[144:147], v[228:231], v[96:99]
buffer_load_dwordx4 v1, s[4:7], s30 offen offset:1024  lds
v_mfma_f32_16x16x32_bf16 v[100:103], v[148:151], v[228:231], v[100:103]
v_cvt_pk_bf16_f32 v88, v88, v89
v_cvt_pk_bf16_f32 v89, v90, v91
v_cvt_pk_bf16_f32 v90, v92, v93
v_cvt_pk_bf16_f32 v91, v94, v95
ds_write_b128 v56, v[88:91] offset:2304
v_mfma_f32_16x16x32_bf16 v[104:107], v[152:155], v[228:231], v[104:107]
v_mfma_f32_16x16x32_bf16 v[108:111], v[156:159], v[228:231], v[108:111]
s_waitcnt vmcnt(11)
v_mfma_f32_16x16x32_bf16 v[96:99], v[160:163], v[232:235], v[96:99]
buffer_load_dwordx4 v1, s[4:7], s30 offen offset:2048  lds
v_mfma_f32_16x16x32_bf16 v[100:103], v[164:167], v[232:235], v[100:103]
s_waitcnt lgkmcnt(0)
s_barrier
ds_read_b128 v[64:67], v57 offset:0
ds_read_b128 v[68:71], v57 offset:1024
ds_read_b128 v[72:75], v57 offset:2048
ds_read_b128 v[76:79], v57 offset:3072
v_mfma_f32_16x16x32_bf16 v[104:107], v[168:171], v[232:235], v[104:107]
v_mfma_f32_16x16x32_bf16 v[108:111], v[172:175], v[232:235], v[108:111]
s_waitcnt vmcnt(11)
v_mfma_f32_16x16x32_bf16 v[96:99], v[176:179], v[236:239], v[96:99]
buffer_load_dwordx4 v1, s[4:7], s30 offen offset:3072  lds
v_mfma_f32_16x16x32_bf16 v[100:103], v[180:183], v[236:239], v[100:103]
v_mfma_f32_16x16x32_bf16 v[104:107], v[184:187], v[236:239], v[104:107]
v_mfma_f32_16x16x32_bf16 v[108:111], v[188:191], v[236:239], v[108:111]
s_waitcnt vmcnt(11)
v_mfma_f32_16x16x32_bf16 v[112:115], v[128:131], v[240:243], 0
s_add_u32 m0, s21, 102400
s_add_u32 s30, s20, 135168
buffer_load_dwordx4 v1, s[4:7], s30 offen offset:0  lds
v_mfma_f32_16x16x32_bf16 v[116:119], v[132:135], v[240:243], 0
s_waitcnt lgkmcnt(3)
v_mfma_f32_16x16x32_bf16 v[40:43], a[240:243], v[64:67], v[40:43]
s_waitcnt lgkmcnt(2)
v_mfma_f32_16x16x32_bf16 v[44:47], a[240:243], v[68:71], v[44:47]
s_waitcnt lgkmcnt(1)
v_mfma_f32_16x16x32_bf16 v[40:43], a[244:247], v[72:75], v[40:43]
s_waitcnt lgkmcnt(0)
v_mfma_f32_16x16x32_bf16 v[44:47], a[244:247], v[76:79], v[44:47]
v_mfma_f32_16x16x32_bf16 v[120:123], v[136:139], v[240:243], 0
v_mfma_f32_16x16x32_bf16 v[124:127], v[140:143], v[240:243], 0
s_waitcnt vmcnt(11)
v_mfma_f32_16x16x32_bf16 v[112:115], v[144:147], v[244:247], v[112:115]
buffer_load_dwordx4 v1, s[4:7], s30 offen offset:1024  lds
v_mfma_f32_16x16x32_bf16 v[116:119], v[148:151], v[244:247], v[116:119]
v_cvt_pk_bf16_f32 v96, v96, v97
v_cvt_pk_bf16_f32 v97, v98, v99
v_cvt_pk_bf16_f32 v98, v100, v101
v_cvt_pk_bf16_f32 v99, v102, v103
ds_write_b128 v56, v[96:99] offset:16384
v_mfma_f32_16x16x32_bf16 v[120:123], v[152:155], v[244:247], v[120:123]
v_mfma_f32_16x16x32_bf16 v[124:127], v[156:159], v[244:247], v[124:127]
s_waitcnt vmcnt(11)
v_mfma_f32_16x16x32_bf16 v[112:115], v[160:163], v[248:251], v[112:115]
buffer_load_dwordx4 v1, s[4:7], s30 offen offset:2048  lds
v_mfma_f32_16x16x32_bf16 v[116:119], v[164:167], v[248:251], v[116:119]
v_cvt_pk_bf16_f32 v104, v104, v105
v_cvt_pk_bf16_f32 v105, v106, v107
v_cvt_pk_bf16_f32 v106, v108, v109
v_cvt_pk_bf16_f32 v107, v110, v111
ds_write_b128 v56, v[104:107] offset:18432
v_mfma_f32_16x16x32_bf16 v[120:123], v[168:171], v[248:251], v[120:123]
v_mfma_f32_16x16x32_bf16 v[124:127], v[172:175], v[248:251], v[124:127]
s_waitcnt vmcnt(11)
v_mfma_f32_16x16x32_bf16 v[112:115], v[176:179], v[252:255], v[112:115]
buffer_load_dwordx4 v1, s[4:7], s30 offen offset:3072  lds
v_mfma_f32_16x16x32_bf16 v[116:119], v[180:183], v[252:255], v[116:119]
v_cvt_pk_bf16_f32 v6, v40, v41
v_cvt_pk_bf16_f32 v7, v42, v43
v_cvt_pk_bf16_f32 v8, v44, v45
v_cvt_pk_bf16_f32 v9, v46, v47
s_nop 0
v_permlane16_swap_b32 v6, v8
v_permlane16_swap_b32 v7, v9
buffer_store_dwordx4 v[6:9], v58, s[4:7], s36 offen
v_mfma_f32_16x16x32_bf16 v[120:123], v[184:187], v[252:255], v[120:123]
v_mfma_f32_16x16x32_bf16 v[124:127], v[188:191], v[252:255], v[124:127]
v_cvt_pk_bf16_f32 v112, v112, v113
v_cvt_pk_bf16_f32 v113, v114, v115
v_cvt_pk_bf16_f32 v114, v116, v117
v_cvt_pk_bf16_f32 v115, v118, v119
ds_write_b128 v56, v[112:115] offset:16640
s_nop 1
v_cvt_pk_bf16_f32 v120, v120, v121
v_cvt_pk_bf16_f32 v121, v122, v123
v_cvt_pk_bf16_f32 v122, v124, v125
v_cvt_pk_bf16_f32 v123, v126, v127
ds_write_b128 v56, v[120:123] offset:18688
s_waitcnt lgkmcnt(0)
s_barrier
ds_read_b128 v[96:99], v57 offset:16384
ds_read_b128 v[100:103], v57 offset:17408
ds_read_b128 v[104:107], v57 offset:18432
ds_read_b128 v[108:111], v57 offset:19456
v_dot2_f32_bf16 v60, v6, s22, 0
v_dot2_f32_bf16 v61, v6, v6, 0
v_dot2_f32_bf16 v60, v7, s22, v60
v_dot2_f32_bf16 v61, v7, v7, v61
v_dot2_f32_bf16 v60, v8, s22, v60
v_dot2_f32_bf16 v61, v8, v8, v61
v_dot2_f32_bf16 v60, v9, s22, v60
v_dot2_f32_bf16 v61, v9, v9, v61
v_bfe_u32 v62, v0, 4, 1
v_lshl_add_u32 v62, v62, 11, v59
s_nop 0
v_permlane32_swap_b32 v60, v61
v_add_f32 v60, v60, v61
s_waitcnt lgkmcnt(3)
v_mfma_f32_16x16x32_bf16 v[48:51], a[240:243], v[96:99], v[48:51]
s_waitcnt lgkmcnt(2)
v_mfma_f32_16x16x32_bf16 v[52:55], a[240:243], v[100:103], v[52:55]
s_waitcnt lgkmcnt(1)
v_mfma_f32_16x16x32_bf16 v[48:51], a[244:247], v[104:107], v[48:51]
s_waitcnt lgkmcnt(0)
v_mfma_f32_16x16x32_bf16 v[52:55], a[244:247], v[108:111], v[52:55]
s_nop 5
v_cvt_pk_bf16_f32 v10, v48, v49
v_cvt_pk_bf16_f32 v11, v50, v51
v_cvt_pk_bf16_f32 v12, v52, v53
v_cvt_pk_bf16_f32 v13, v54, v55
v_dot2_f32_bf16 v38, v10, s22, 0
v_dot2_f32_bf16 v39, v10, v10, 0
v_dot2_f32_bf16 v38, v11, s22, v38
v_dot2_f32_bf16 v39, v11, v11, v39
v_dot2_f32_bf16 v38, v12, s22, v38
v_dot2_f32_bf16 v39, v12, v12, v39
v_dot2_f32_bf16 v38, v13, s22, v38
v_dot2_f32_bf16 v39, v13, v13, v39
v_permlane16_swap_b32 v10, v12
v_permlane16_swap_b32 v11, v13
buffer_store_dwordx4 v[10:13], v58, s[4:7], s15 offen
v_permlane32_swap_b32 v38, v39
v_add_f32 v38, v38, v39
s_nop 1
v_permlane16_swap_b32 v60, v38
v_add_f32 v60, v60, v38
s_nop 1
v_add_f32_dpp v60, v60, v60 row_ror:8 row_mask:0xf bank_mask:0xf
s_mov_b32 exec_lo, 0x00ff00ff
s_mov_b32 exec_hi, 0x00ff00ff
buffer_store_dword v60, v62, s[4:7], s37 offen
s_mov_b64 exec, -1
v_lshrrev_b32 v40, 5, v0
v_lshlrev_b32 v40, 10, v40
v_and_b32 v41, 31, v0
v_lshl_add_u32 v40, v41, 3, v40
s_add_u32 s23, s81, 7864320
s_add_u32 s15, s80, 12582912
v_and_b32 v62, 31, v0
v_lshlrev_b32 v62, 2, v62
v_mov_b32 v4, 2
s_waitcnt vmcnt(0)
s_mov_b64 exec, 1
buffer_store_dword v4, off, s[4:7], s76
s_mov_b64 exec, -1
s_barrier
buffer_load_dword v63, v62, s[4:7], s77 offen sc1
ds_read_b128 a[224:227], v3 offset:0
ds_read_b128 a[228:231], v2 offset:32768
ds_read_b128 a[232:235], v3 offset:1024
ds_read_b128 a[236:239], v2 offset:33792
ds_read_b128 a[240:243], v3 offset:2048
ds_read_b128 a[244:247], v2 offset:34816
ds_read_b128 a[248:251], v3 offset:3072
s_waitcnt vmcnt(0)
v_cmp_gt_u32 vcc, 2, v63
s_nop 0
s_cbranch_vccz L_spun_19
L_spin_18:
buffer_load_dword v63, v62, s[4:7], s77 offen sc1
s_sub_u32 s29, s29, 1
s_waitcnt vmcnt(0)
v_cmp_gt_u32 vcc, 2, v63
s_cbranch_scc1 L_spinout_20
s_cbranch_vccnz L_spin_18
L_spun_19:
s_add_u32 s27, s15, 0
buffer_load_dwordx4 v[128:131], v1, s[4:7], s27 offen offset:0 sc1
buffer_load_dwordx4 v[132:135], v1, s[4:7], s27 offen offset:1024 sc1
buffer_load_dwordx4 v[136:139], v1, s[4:7], s27 offen offset:2048 sc1
buffer_load_dwordx4 v[140:143], v1, s[4:7], s27 offen offset:3072 sc1
s_add_u32 s27, s15, 4096
buffer_load_dwordx4 v[144:147], v1, s[4:7], s27 offen offset:0 sc1
buffer_load_dwordx4 v[148:151], v1, s[4:7], s27 offen offset:1024 sc1
buffer_load_dwordx4 v[152:155], v1, s[4:7], s27 offen offset:2048 sc1
buffer_load_dwordx4 v[156:159], v1, s[4:7], s27 offen offset:3072 sc1
buffer_load_dwordx2 v[42:43], v40, s[4:7], s23 offen offset:0 sc1
buffer_load_dwordx2 v[44:45], v40, s[4:7], s23 offen offset:256 sc1
buffer_load_dwordx2 v[46:47], v40, s[4:7], s23 offen offset:512 sc1
buffer_load_dwordx2 v[48:49], v40, s[4:7], s23 offen offset:768 sc1
s_waitcnt vmcnt(11) lgkmcnt(5)
v_mfma_f32_32x32x16_bf16 v[64:79], a[224:227], v[128:131], 0
s_add_u32 s27, s15, 8192
buffer_load_dwordx4 v[160:163], v1, s[4:7], s27 offen offset:0 sc1
ds_read_b128 a[252:255], v2 offset:35840
v_mfma_f32_32x32x16_bf16 v[80:95], a[228:231], v[128:131], 0
ds_read_b128 a[224:227], v3 offset:4096
s_waitcnt vmcnt(11) lgkmcnt(5)
v_mfma_f32_32x32x16_bf16 v[64:79], a[232:235], v[132:135], v[64:79]
buffer_load_dwordx4 v[164:167], v1, s[4:7], s27 offen offset:1024 sc1
ds_read_b128 a[228:231], v2 offset:36864
v_mfma_f32_32x32x16_bf16 v[80:95], a[236:239], v[132:135], v[80:95]
ds_read_b128 a[232:235], v3 offset:5120
s_waitcnt vmcnt(11) lgkmcnt(5)
v_mfma_f32_32x32x16_bf16 v[64:79], a[240:243], v[136:139], v[64:79]
buffer_load_dwordx4 v[168:171], v1, s[4:7], s27 offen offset:2048 sc1
ds_read_b128 a[236:239], v2 offset:37888
v_mfma_f32_32x32x16_bf16 v[80:95], a[244:247], v[136:139], v[80:95]
ds_read_b128 a[240:243], v3 offset:6144
s_waitcnt vmcnt(11) lgkmcnt(5)
v_mfma_f32_32x32x16_bf16 v[64:79], a[248:251], v[140:143], v[64:79]
buffer_load_dwordx4 v[172:175], v1, s[4:7], s27 offen offset:3072 sc1
ds_read_b128 a[244:247], v2 offset:38912
v_mfma_f32_32x32x16_bf16 v[80:95], a[252:255], v[140:143], v[80:95]
ds_read_b128 a[248:251], v3 offset:7168
s_waitcnt vmcnt(11) lgkmcnt(5)
v_mfma_f32_32x32x16_bf16 v[64:79], a[224:227], v[144:147], v[64:79]
s_add_u32 s27, s15, 12288
buffer_load_dwordx4 v[176:179], v1, s[4:7], s27 offen offset:0 sc1
ds_read_b128 a[252:255], v2 offset:39936
v_mfma_f32_32x32x16_bf16 v[80:95], a[228:231], v[144:147], v[80:95]
ds_read_b128 a[224:227], v1 offset:32768
s_waitcnt vmcnt(11) lgkmcnt(5)
v_mfma_f32_32x32x16_bf16 v[64:79], a[232:235], v[148:151], v[64:79]
buffer_load_dwordx4 v[180:183], v1, s[4:7], s27 offen offset:1024 sc1
ds_read_b128 a[228:231], v3 offset:8192
v_mfma_f32_32x32x16_bf16 v[80:95], a[236:239], v[148:151], v[80:95]
ds_read_b128 a[232:235], v2 offset:40960
s_waitcnt vmcnt(11) lgkmcnt(5)
v_mfma_f32_32x32x16_bf16 v[64:79], a[240:243], v[152:155], v[64:79]
buffer_load_dwordx4 v[184:187], v1, s[4:7], s27 offen offset:2048 sc1
ds_read_b128 a[236:239], v3 offset:9216
v_mfma_f32_32x32x16_bf16 v[80:95], a[244:247], v[152:155], v[80:95]
ds_read_b128 a[240:243], v2 offset:41984
s_waitcnt vmcnt(11) lgkmcnt(4)
v_mfma_f32_32x32x16_bf16 v[64:79], a[248:251], v[156:159], v[64:79]
buffer_load_dwordx4 v[188:191], v1, s[4:7], s27 offen offset:3072 sc1
ds_read_b128 a[244:247], v3 offset:10240
v_mfma_f32_32x32x16_bf16 v[80:95], a[252:255], v[156:159], v[80:95]
ds_read_b128 a[248:251], v2 offset:43008
v_mfma_f32_32x32x16_bf16 v[96:111], a[224:227], v[128:131], 0
ds_read_b128 a[252:255], v3 offset:11264
s_waitcnt vmcnt(7) lgkmcnt(5)
v_mfma_f32_32x32x16_bf16 v[64:79], a[228:231], v[160:163], v[64:79]
s_add_u32 s27, s15, 16384
buffer_load_dwordx4 v[192:195], v1, s[4:7], s27 offen offset:0 sc1
ds_read_b128 a[224:227], v2 offset:44032
v_add_f32 v42, v42, v44
v_add_f32 v43, v43, v45
v_mfma_f32_32x32x16_bf16 v[80:95], a[232:235], v[160:163], v[80:95]
ds_read_b128 a[228:231], v3 offset:12288
v_add_f32 v46, v46, v48
v_add_f32 v47, v47, v49
v_add_f32 v42, v42, v46
v_add_f32 v43, v43, v47
s_waitcnt vmcnt(7) lgkmcnt(5)
v_mfma_f32_32x32x16_bf16 v[64:79], a[236:239], v[164:167], v[64:79]
buffer_load_dwordx4 v[196:199], v1, s[4:7], s27 offen offset:1024 sc1
ds_read_b128 a[232:235], v2 offset:45056
v_permlane32_swap_b32 v42, v43
v_add_f32 v42, v42, v43
v_mov_b32 v43, v42
v_mfma_f32_32x32x16_bf16 v[80:95], a[240:243], v[164:167], v[80:95]
ds_read_b128 a[236:239], v3 offset:13312
v_permlane32_swap_b32 v42, v43
v_mul_f32 v42, 0xbb000000, v42
v_mul_f32 v43, 0x3b000000, v43
v_cvt_pk_bf16_f32 v44, v42, v42
s_waitcnt vmcnt(7) lgkmcnt(5)
v_mfma_f32_32x32x16_bf16 v[64:79], a[244:247], v[168:171], v[64:79]
buffer_load_dwordx4 v[200:203], v1, s[4:7], s27 offen offset:2048 sc1
ds_read_b128 a[240:243], v2 offset:46080
v_fma_f32 v43, -v42, v42, v43
v_and_b32 v45, 0xffff0000, v44
v_max_f32 v43, 0, v43
v_mfma_f32_32x32x16_bf16 v[80:95], a[248:251], v[168:171], v[80:95]
ds_read_b128 a[244:247], v3 offset:14336
v_sub_f32 v45, v42, v45
v_add_f32 v50, 0x3727c5ac, v43
v_cvt_pk_bf16_f32 v45, v45, v45
v_rsq_f32 v51, v50
s_waitcnt vmcnt(7) lgkmcnt(5)
v_mfma_f32_32x32x16_bf16 v[64:79], a[252:255], v[172:175], v[64:79]
buffer_load_dwordx4 v[204:207], v1, s[4:7], s27 offen offset:3072 sc1
ds_read_b128 a[248:251], v2 offset:47104
v_cndmask_b32 v32, v45, v44, s[24:25]
v_mov_b32 v37, v32
v_mfma_f32_32x32x16_bf16 v[80:95], a[224:227], v[172:175], v[80:95]
ds_read_b128 a[252:255], v3 offset:15360
v_mfma_f32_32x32x16_bf16 v[64:79], v[22:25], v[34:37], v[64:79]
v_mfma_f32_32x32x16_bf16 v[80:95], v[26:29], v[32:35], v[80:95]
v_mfma_f32_32x32x16_bf16 v[96:111], v[24:27], v[34:37], v[96:111]
s_waitcnt vmcnt(7) lgkmcnt(5)
v_mfma_f32_32x32x16_bf16 v[64:79], a[228:231], v[176:179], v[64:79]
s_add_u32 s27, s15, 20480
buffer_load_dwordx4 v[208:211], v1, s[4:7], s27 offen offset:0 sc1
ds_read_b128 a[224:227], v2 offset:48128
v_mul_f32 v38, 0xc0135761, v51
v_mul_f32 v39, v51, v51
v_mfma_f32_32x32x16_bf16 v[80:95], a[232:235], v[176:179], v[80:95]
ds_read_b128 a[228:231], v1 offset:33792
v_mul_f32 v39, v39, v38
v_mul_f32 v39, 0x3d372713, v39
s_add_u32 s36, s32, 25165824
s_mul_i32 s28, s18, 1536
s_waitcnt vmcnt(7) lgkmcnt(5)
v_mfma_f32_32x32x16_bf16 v[64:79], a[236:239], v[180:183], v[64:79]
buffer_load_dwordx4 v[212:215], v1, s[4:7], s27 offen offset:1024 sc1
ds_read_b128 a[232:235], v3 offset:16384
s_sub_u32 s28, s38, s28
s_add_u32 s28, s28, 20971520
v_bfe_u32 v41, v0, 4, 1
v_mfma_f32_32x32x16_bf16 v[80:95], a[240:243], v[180:183], v[80:95]
ds_read_b128 a[236:239], v2 offset:49152
v_lshlrev_b32 v40, 10, v41
v_lshrrev_b32 v41, 5, v0
v_lshl_add_u32 v40, v41, 8, v40
v_and_b32 v41, 15, v0
s_waitcnt vmcnt(7) lgkmcnt(5)
v_mfma_f32_32x32x16_bf16 v[64:79], a[244:247], v[184:187], v[64:79]
buffer_load_dwordx4 v[216:219], v1, s[4:7], s27 offen offset:2048 sc1
ds_read_b128 a[240:243], v3 offset:17408
v_lshl_add_u32 v40, v41, 4, v40
v_mov_b32 v41, v58
v_and_b32 v62, 7, v0
v_mfma_f32_32x32x16_bf16 v[80:95], a[248:251], v[184:187], v[80:95]
ds_read_b128 a[244:247], v2 offset:50176
v_lshlrev_b32 v62, 2, v62
v_and_b32 v59, 7, v0
v_lshl_add_u32 v59, s3, 3, v59
v_bfe_u32 v61, v0, 4, 1
s_waitcnt vmcnt(7) lgkmcnt(4)
v_mfma_f32_32x32x16_bf16 v[64:79], a[252:255], v[188:191], v[64:79]
buffer_load_dwordx4 v[220:223], v1, s[4:7], s27 offen offset:3072 sc1
ds_read_b128 a[248:251], v3 offset:18432
v_and_b32 v56, 15, v0
v_lshlrev_b32 v60, 3, v61
v_xor_b32 v56, v56, v60
v_mfma_f32_32x32x16_bf16 v[80:95], a[224:227], v[188:191], v[80:95]
ds_read_b128 a[252:255], v2 offset:51200
v_lshlrev_b32 v56, 4, v56
v_lshrrev_b32 v60, 4, v0
v_lshl_add_u32 v56, v60, 9, v56
v_lshl_add_u32 v56, s3, 12, v56
v_mfma_f32_32x32x16_bf16 v[96:111], a[228:231], v[132:135], v[96:111]
ds_read_b128 a[224:227], v3 offset:19456
v_bfe_u32 v61, v0, 3, 1
v_lshlrev_b32 v57, 3, v61
v_xor_b32 v57, v57, v59
v_lshlrev_b32 v57, 4, v57
s_waitcnt vmcnt(7) lgkmcnt(5)
v_mfma_f32_32x32x16_bf16 v[64:79], a[232:235], v[192:195], v[64:79]
s_add_u32 s27, s15, 24576
buffer_load_dwordx4 v[224:227], v1, s[4:7], s27 offen offset:0 sc1
ds_read_b128 a[228:231], v2 offset:52224
v_lshl_add_u32 v57, v61, 9, v57
v_lshl_add_u32 v57, v60, 12, v57
v_mfma_f32_32x32x16_bf16 v[80:95], a[236:239], v[192:195], v[80:95]
ds_read_b128 a[232:235], v3 offset:20480
v_lshlrev_b32 v58, 4, v59
v_lshl_add_u32 v58, v61, 9, v58
v_lshl_add_u32 v58, v60, 10, v58
v_lshrrev_b32 v60, 5, v0
s_waitcnt vmcnt(7) lgkmcnt(5)
v_mfma_f32_32x32x16_bf16 v[64:79], a[240:243], v[196:199], v[64:79]
buffer_load_dwordx4 v[228:231], v1, s[4:7], s27 offen offset:1024 sc1
ds_read_b128 a[236:239], v2 offset:53248
v_lshlrev_b32 v59, 3, v59
v_lshl_add_u32 v59, v60, 2, v59
v_mfma_f32_32x32x16_bf16 v[80:95], a[244:247], v[196:199], v[80:95]
ds_read_b128 a[240:243], v3 offset:21504
s_waitcnt vmcnt(7) lgkmcnt(5)
v_mfma_f32_32x32x16_bf16 v[64:79], a[248:251], v[200:203], v[64:79]
buffer_load_dwordx4 v[232:235], v1, s[4:7], s27 offen offset:2048 sc1
ds_read_b128 a[244:247], v2 offset:54272
v_mfma_f32_32x32x16_bf16 v[80:95], a[252:255], v[200:203], v[80:95]
ds_read_b128 a[248:251], v3 offset:22528
s_waitcnt vmcnt(7) lgkmcnt(5)
v_mfma_f32_32x32x16_bf16 v[64:79], a[224:227], v[204:207], v[64:79]
buffer_load_dwordx4 v[236:239], v1, s[4:7], s27 offen offset:3072 sc1
ds_read_b128 a[252:255], v2 offset:55296
v_mfma_f32_32x32x16_bf16 v[80:95], a[228:231], v[204:207], v[80:95]
ds_read_b128 a[224:227], v3 offset:23552
s_waitcnt vmcnt(7) lgkmcnt(5)
v_mfma_f32_32x32x16_bf16 v[64:79], a[232:235], v[208:211], v[64:79]
s_add_u32 s27, s15, 28672
buffer_load_dwordx4 v[240:243], v1, s[4:7], s27 offen offset:0 sc1
ds_read_b128 a[228:231], v2 offset:56320
v_mfma_f32_32x32x16_bf16 v[80:95], a[236:239], v[208:211], v[80:95]
ds_read_b128 a[232:235], v1 offset:34816
s_waitcnt vmcnt(7) lgkmcnt(5)
v_mfma_f32_32x32x16_bf16 v[64:79], a[240:243], v[212:215], v[64:79]
buffer_load_dwordx4 v[244:247], v1, s[4:7], s27 offen offset:1024 sc1
ds_read_b128 a[236:239], v3 offset:24576
v_mfma_f32_32x32x16_bf16 v[80:95], a[244:247], v[212:215], v[80:95]
ds_read_b128 a[240:243], v2 offset:57344
s_waitcnt vmcnt(7) lgkmcnt(5)
v_mfma_f32_32x32x16_bf16 v[64:79], a[248:251], v[216:219], v[64:79]
buffer_load_dwordx4 v[248:251], v1, s[4:7], s27 offen offset:2048 sc1
ds_read_b128 a[244:247], v3 offset:25600
v_mfma_f32_32x32x16_bf16 v[80:95], a[252:255], v[216:219], v[80:95]
ds_read_b128 a[248:251], v2 offset:58368
s_waitcnt vmcnt(7) lgkmcnt(4)
v_mfma_f32_32x32x16_bf16 v[64:79], a[224:227], v[220:223], v[64:79]
buffer_load_dwordx4 v[252:255], v1, s[4:7], s27 offen offset:3072 sc1
ds_read_b128 a[252:255], v3 offset:26624
v_mfma_f32_32x32x16_bf16 v[80:95], a[228:231], v[220:223], v[80:95]
ds_read_b128 a[224:227], v2 offset:59392
v_mfma_f32_32x32x16_bf16 v[96:111], a[232:235], v[136:139], v[96:111]
ds_read_b128 a[228:231], v3 offset:27648
s_waitcnt vmcnt(7) lgkmcnt(5)
v_mfma_f32_32x32x16_bf16 v[64:79], a[236:239], v[224:227], v[64:79]
s_add_u32 m0, s21, 0
s_add_u32 s30, s20, 196608
buffer_load_dwordx4 v1, s[4:7], s30 offen offset:0  lds
ds_read_b128 a[232:235], v2 offset:60416
v_mfma_f32_32x32x16_bf16 v[80:95], a[240:243], v[224:227], v[80:95]
ds_read_b128 a[236:239], v3 offset:28672
s_waitcnt vmcnt(7) lgkmcnt(5)
v_mfma_f32_32x32x16_bf16 v[64:79], a[244:247], v[228:231], v[64:79]
buffer_load_dwordx4 v1, s[4:7], s30 offen offset:1024  lds
ds_read_b128 a[240:243], v2 offset:61440
v_mfma_f32_32x32x16_bf16 v[80:95], a[248:251], v[228:231], v[80:95]
ds_read_b128 a[244:247], v3 offset:29696
s_waitcnt vmcnt(7) lgkmcnt(5)
v_mfma_f32_32x32x16_bf16 v[64:79], a[252:255], v[232:235], v[64:79]
buffer_load_dwordx4 v1, s[4:7], s30 offen offset:2048  lds
ds_read_b128 a[248:251], v2 offset:62464
v_mfma_f32_32x32x16_bf16 v[80:95], a[224:227], v[232:235], v[80:95]
ds_read_b128 a[252:255], v3 offset:30720
s_waitcnt vmcnt(7) lgkmcnt(5)
v_mfma_f32_32x32x16_bf16 v[64:79], a[228:231], v[236:239], v[64:79]
buffer_load_dwordx4 v1, s[4:7], s30 offen offset:3072  lds
ds_read_b128 a[224:227], v2 offset:63488
v_mfma_f32_32x32x16_bf16 v[80:95], a[232:235], v[236:239], v[80:95]
ds_read_b128 a[228:231], v3 offset:31744
s_waitcnt vmcnt(7) lgkmcnt(5)
v_mfma_f32_32x32x16_bf16 v[64:79], a[236:239], v[240:243], v[64:79]
s_add_u32 m0, s21, 4096
s_add_u32 s30, s20, 200704
buffer_load_dwordx4 v1, s[4:7], s30 offen offset:0  lds
ds_read_b128 a[232:235], v2 offset:64512
v_mfma_f32_32x32x16_bf16 v[80:95], a[240:243], v[240:243], v[80:95]
ds_read_b128 a[236:239], v1 offset:35840
s_waitcnt vmcnt(7) lgkmcnt(5)
v_mfma_f32_32x32x16_bf16 v[64:79], a[244:247], v[244:247], v[64:79]
buffer_load_dwordx4 v1, s[4:7], s30 offen offset:1024  lds
ds_read_b128 a[240:243], v1 offset:36864
v_mfma_f32_32x32x16_bf16 v[80:95], a[248:251], v[244:247], v[80:95]
ds_read_b128 a[244:247], v1 offset:37888
s_waitcnt vmcnt(7) lgkmcnt(5)
v_mfma_f32_32x32x16_bf16 v[64:79], a[252:255], v[248:251], v[64:79]
buffer_load_dwordx4 v1, s[4:7], s30 offen offset:2048  lds
ds_read_b128 a[248:251], v1 offset:38912
v_mfma_f32_32x32x16_bf16 v[80:95], a[224:227], v[248:251], v[80:95]
ds_read_b128 a[252:255], v1 offset:39936
s_waitcnt vmcnt(7) lgkmcnt(4)
v_mfma_f32_32x32x16_bf16 v[64:79], a[228:231], v[252:255], v[64:79]
buffer_load_dwordx4 v1, s[4:7], s30 offen offset:3072  lds
ds_read_b128 a[224:227], v1 offset:40960
v_mfma_f32_32x32x16_bf16 v[80:95], a[232:235], v[252:255], v[80:95]
ds_read_b128 a[228:231], v1 offset:41984
v_mfma_f32_32x32x16_bf16 v[96:111], a[236:239], v[140:143], v[96:111]
ds_read_b128 a[232:235], v1 offset:43008
s_waitcnt lgkmcnt(3)
v_mfma_f32_32x32x16_bf16 v[96:111], a[240:243], v[144:147], v[96:111]
s_barrier
ds_read_b128 a[236:239], v1 offset:44032
s_add_u32 s34, s35, 0
buffer_load_dwordx4 a[0:3], v1, s[4:7], s34 offen offset:0
v_mfma_f32_32x32x16_bf16 v[96:111], a[244:247], v[148:151], v[96:111]
ds_read_b128 a[240:243], v1 offset:45056
L_here_21:
s_add_u32 s99, s13, L_here_21-L_pc+2048
buffer_load_dword v5, off, s[92:95], s99
v_mfma_f32_32x32x16_bf16 v[96:111], a[248:251], v[152:155], v[96:111]
ds_read_b128 a[244:247], v1 offset:46080
v_mul_f32 v52, v64, v64
v_mul_f32 v53, v65, v65
v_mul_f32 v54, v66, v66
v_mul_f32 v55, v67, v67
v_fma_f32 v52, v52, v39, v38
v_fma_f32 v53, v53, v39, v38
v_mfma_f32_32x32x16_bf16 v[96:111], a[252:255], v[156:159], v[96:111]
ds_read_b128 a[248:251], v1 offset:47104
buffer_load_dwordx4 a[4:7], v1, s[4:7], s34 offen offset:1024
v_fma_f32 v54, v54, v39, v38
v_fma_f32 v55, v55, v39, v38
v_mul_f32 v52, v52, v64
v_mul_f32 v53, v53, v65
v_mul_f32 v54, v54, v66
s_waitcnt lgkmcnt(3)
v_mfma_f32_32x32x16_bf16 v[96:111], a[224:227], v[160:163], v[96:111]
ds_read_b128 a[252:255], v1 offset:48128
v_mul_f32 v55, v55, v67
v_exp_f32 v52, v52
v_mul_f32 v64, v64, v72
v_mfma_f32_32x32x16_bf16 v[96:111], a[228:231], v[164:167], v[96:111]
ds_read_b128 a[224:227], v1 offset:49152
buffer_load_dword v5, off, s[4:7], s79 sc1
v_exp_f32 v53, v53
v_mul_f32 v65, v65, v73
v_exp_f32 v54, v54
v_mfma_f32_32x32x16_bf16 v[96:111], a[232:235], v[168:171], v[96:111]
ds_read_b128 a[228:231], v1 offset:50176
buffer_load_dwordx4 a[8:11], v1, s[4:7], s34 offen offset:2048
v_mul_f32 v66, v66, v74
v_exp_f32 v55, v55
v_mul_f32 v67, v67, v75
v_fma_f32 v52, v52, v50, v50
v_mfma_f32_32x32x16_bf16 v[96:111], a[236:239], v[172:175], v[96:111]
ds_read_b128 a[232:235], v1 offset:51200
v_fma_f32 v53, v53, v50, v50
v_fma_f32 v54, v54, v50, v50
v_fma_f32 v55, v55, v50, v50
v_rcp_f32 v52, v52
s_waitcnt lgkmcnt(3)
v_mfma_f32_32x32x16_bf16 v[96:111], a[240:243], v[176:179], v[96:111]
ds_read_b128 a[236:239], v1 offset:52224
buffer_load_dwordx4 a[12:15], v1, s[4:7], s34 offen offset:3072
v_rcp_f32 v53, v53
v_rcp_f32 v54, v54
v_mfma_f32_32x32x16_bf16 v[96:111], a[244:247], v[180:183], v[96:111]
ds_read_b128 a[240:243], v1 offset:53248
s_add_u32 m0, s21, 131072
s_add_u32 s30, s20, 229376
buffer_load_dwordx4 v1, s[4:7], s30 offen offset:0  lds
v_rcp_f32 v55, v55
v_mul_f32 v64, v64, v52
v_mfma_f32_32x32x16_bf16 v[96:111], a[248:251], v[184:187], v[96:111]
ds_read_b128 a[244:247], v1 offset:54272
v_mul_f32 v65, v65, v53
v_mul_f32 v66, v66, v54
v_mul_f32 v67, v67, v55
v_cvt_pk_bf16_f32 v42, v64, v65
v_cvt_pk_bf16_f32 v43, v66, v67
v_mul_f32 v52, v68, v68
v_mfma_f32_32x32x16_bf16 v[96:111], a[252:255], v[188:191], v[96:111]
ds_read_b128 a[248:251], v1 offset:55296
s_add_u32 s34, s35, 4096
buffer_load_dwordx4 a[16:19], v1, s[4:7], s34 offen offset:0
v_mul_f32 v53, v69, v69
v_mul_f32 v54, v70, v70
v_mul_f32 v55, v71, v71
v_fma_f32 v52, v52, v39, v38
s_waitcnt lgkmcnt(3)
v_mfma_f32_32x32x16_bf16 v[96:111], a[224:227], v[192:195], v[96:111]
ds_read_b128 a[252:255], v1 offset:56320
v_fma_f32 v53, v53, v39, v38
v_fma_f32 v54, v54, v39, v38
v_fma_f32 v55, v55, v39, v38
v_mul_f32 v52, v52, v68
v_mul_f32 v53, v53, v69
v_mfma_f32_32x32x16_bf16 v[96:111], a[228:231], v[196:199], v[96:111]
ds_read_b128 a[224:227], v1 offset:57344
buffer_load_dwordx4 v1, s[4:7], s30 offen offset:1024  lds
v_mul_f32 v54, v54, v70
v_mul_f32 v55, v55, v71
v_exp_f32 v52, v52
v_mul_f32 v68, v68, v76
v_mfma_f32_32x32x16_bf16 v[96:111], a[232:235], v[200:203], v[96:111]
ds_read_b128 a[228:231], v1 offset:58368
buffer_load_dwordx4 a[20:23], v1, s[4:7], s34 offen offset:1024
v_exp_f32 v53, v53
v_mul_f32 v69, v69, v77
v_exp_f32 v54, v54
v_mfma_f32_32x32x16_bf16 v[96:111], a[236:239], v[204:207], v[96:111]
ds_read_b128 a[232:235], v1 offset:59392
v_mul_f32 v70, v70, v78
v_exp_f32 v55, v55
v_mul_f32 v71, v71, v79
v_fma_f32 v52, v52, v50, v50
v_fma_f32 v53, v53, v50, v50
s_waitcnt lgkmcnt(3)
v_mfma_f32_32x32x16_bf16 v[96:111], a[240:243], v[208:211], v[96:111]
ds_read_b128 a[236:239], v1 offset:60416
buffer_load_dwordx4 a[24:27], v1, s[4:7], s34 offen offset:2048
v_fma_f32 v54, v54, v50, v50
v_fma_f32 v55, v55, v50, v50
v_rcp_f32 v52, v52
v_mfma_f32_32x32x16_bf16 v[96:111], a[244:247], v[212:215], v[96:111]
ds_read_b128 a[240:243], v1 offset:61440
buffer_load_dwordx4 v1, s[4:7], s30 offen offset:2048  lds
v_rcp_f32 v53, v53
v_rcp_f32 v54, v54
v_mfma_f32_32x32x16_bf16 v[96:111], a[248:251], v[216:219], v[96:111]
s_waitcnt vmcnt(12)
s_barrier
ds_read_b128 a[244:247], v1 offset:62464
buffer_load_dwordx4 a[28:31], v1, s[4:7], s34 offen offset:3072
v_rcp_f32 v55, v55
v_mul_f32 v68, v68, v52
v_mfma_f32_32x32x16_bf16 v[96:111], a[252:255], v[220:223], v[96:111]
ds_read_b128 a[248:251], v1 offset:63488
v_mul_f32 v69, v69, v53
v_mul_f32 v70, v70, v54
v_mul_f32 v71, v71, v55
v_cvt_pk_bf16_f32 v44, v68, v69
v_cvt_pk_bf16_f32 v45, v70, v71
s_add_u32 s37, s36, 0
buffer_store_dwordx4 v[42:45], v40, s[4:7], s37 offen sc1
s_waitcnt lgkmcnt(3)
v_mfma_f32_32x32x16_bf16 v[96:111], a[224:227], v[224:227], v[96:111]
ds_read_b128 a[252:255], v1 offset:64512
s_add_u32 s34, s35, 8192
buffer_load_dwordx4 a[32:35], v1, s[4:7], s34 offen offset:0
v_mul_f32 v52, v80, v80
v_mul_f32 v53, v81, v81
v_mul_f32 v54, v82, v82
v_mfma_f32_32x32x16_bf16 v[96:111], a[228:231], v[228:231], v[96:111]
ds_read_b128 a[224:227], v1 offset:0
buffer_load_dwordx4 v1, s[4:7], s30 offen offset:3072  lds
v_mul_f32 v55, v83, v83
v_fma_f32 v52, v52, v39, v38
v_fma_f32 v53, v53, v39, v38
v_fma_f32 v54, v54, v39, v38
v_fma_f32 v55, v55, v39, v38
v_mfma_f32_32x32x16_bf16 v[96:111], a[232:235], v[232:235], v[96:111]
ds_read_b128 a[228:231], v1 offset:1024
v_mul_f32 v52, v52, v80
v_mul_f32 v53, v53, v81
v_mul_f32 v54, v54, v82
v_mul_f32 v55, v55, v83
v_exp_f32 v52, v52
v_mfma_f32_32x32x16_bf16 v[96:111], a[236:239], v[236:239], v[96:111]
ds_read_b128 a[232:235], v1 offset:2048
buffer_load_dwordx4 a[36:39], v1, s[4:7], s34 offen offset:1024
v_mul_f32 v80, v80, v88
v_exp_f32 v53, v53
v_mul_f32 v81, v81, v89
s_waitcnt lgkmcnt(3)
v_mfma_f32_32x32x16_bf16 v[96:111], a[240:243], v[240:243], v[96:111]
ds_read_b128 a[236:239], v1 offset:3072
v_exp_f32 v54, v54
v_mul_f32 v82, v82, v90
v_exp_f32 v55, v55
v_mfma_f32_32x32x16_bf16 v[96:111], a[244:247], v[244:247], v[96:111]
ds_read_b128 a[240:243], v1 offset:4096
s_add_u32 m0, s21, 135168
s_add_u32 s30, s20, 233472
buffer_load_dwordx4 v1, s[4:7], s30 offen offset:0  lds
v_mul_f32 v83, v83, v91
v_fma_f32 v52, v52, v50, v50
v_fma_f32 v53, v53, v50, v50
v_mfma_f32_32x32x16_bf16 v[96:111], a[248:251], v[248:251], v[96:111]
ds_read_b128 a[244:247], v1 offset:5120
buffer_load_dwordx4 a[40:43], v1, s[4:7], s34 offen offset:2048
v_fma_f32 v54, v54, v50, v50
v_fma_f32 v55, v55, v50, v50
v_rcp_f32 v52, v52
v_mfma_f32_32x32x16_bf16 v[96:111], a[252:255], v[252:255], v[96:111]
ds_read_b128 a[248:251], v1 offset:6144
v_rcp_f32 v53, v53
v_rcp_f32 v54, v54
v_rcp_f32 v55, v55
v_mfma_f32_32x32x16_bf16 v[112:127], v[28:31], v[32:35], 0
s_waitcnt lgkmcnt(3)
v_mfma_f32_32x32x16_bf16 v[112:127], a[224:227], v[128:131], v[112:127]
ds_read_b128 a[252:255], v1 offset:7168
buffer_load_dwordx4 v1, s[4:7], s30 offen offset:1024  lds
v_mfma_f32_32x32x16_bf16 v[112:127], a[228:231], v[132:135], v[112:127]
ds_read_b128 a[224:227], v1 offset:8192
buffer_load_dwordx4 a[44:47], v1, s[4:7], s34 offen offset:3072
v_mfma_f32_32x32x16_bf16 v[112:127], a[232:235], v[136:139], v[112:127]
ds_read_b128 a[228:231], v1 offset:9216
v_mul_f32 v80, v80, v52
v_mul_f32 v81, v81, v53
v_mul_f32 v82, v82, v54
v_mul_f32 v83, v83, v55
v_cvt_pk_bf16_f32 v46, v80, v81
v_cvt_pk_bf16_f32 v47, v82, v83
v_mfma_f32_32x32x16_bf16 v[112:127], a[236:239], v[140:143], v[112:127]
ds_read_b128 a[232:235], v1 offset:10240
v_mul_f32 v52, v84, v84
v_mul_f32 v53, v85, v85
v_mul_f32 v54, v86, v86
v_mul_f32 v55, v87, v87
v_fma_f32 v52, v52, v39, v38
v_fma_f32 v53, v53, v39, v38
s_waitcnt lgkmcnt(3)
v_mfma_f32_32x32x16_bf16 v[112:127], a[240:243], v[144:147], v[112:127]
ds_read_b128 a[236:239], v1 offset:11264
buffer_load_dwordx4 v1, s[4:7], s30 offen offset:2048  lds
v_fma_f32 v54, v54, v39, v38
v_fma_f32 v55, v55, v39, v38
v_mul_f32 v52, v52, v84
v_mul_f32 v53, v53, v85
v_mfma_f32_32x32x16_bf16 v[112:127], a[244:247], v[148:151], v[112:127]
ds_read_b128 a[240:243], v1 offset:12288
s_add_u32 s34, s35, 12288
buffer_load_dwordx4 a[48:51], v1, s[4:7], s34 offen offset:0
v_mul_f32 v54, v54, v86
v_mul_f32 v55, v55, v87
v_exp_f32 v52, v52
v_mfma_f32_32x32x16_bf16 v[112:127], a[248:251], v[152:155], v[112:127]
ds_read_b128 a[244:247], v1 offset:13312
v_mul_f32 v84, v84, v92
v_exp_f32 v53, v53
v_mul_f32 v85, v85, v93
v_exp_f32 v54, v54
v_mfma_f32_32x32x16_bf16 v[112:127], a[252:255], v[156:159], v[112:127]
ds_read_b128 a[248:251], v1 offset:14336
buffer_load_dwordx4 a[52:55], v1, s[4:7], s34 offen offset:1024
v_mul_f32 v86, v86, v94
v_exp_f32 v55, v55
v_mul_f32 v87, v87, v95
v_fma_f32 v52, v52, v50, v50
s_waitcnt lgkmcnt(3)
v_mfma_f32_32x32x16_bf16 v[112:127], a[224:227], v[160:163], v[112:127]
ds_read_b128 a[252:255], v1 offset:15360
buffer_load_dwordx4 v1, s[4:7], s30 offen offset:3072  lds
v_fma_f32 v53, v53, v50, v50
v_fma_f32 v54, v54, v50, v50
v_fma_f32 v55, v55, v50, v50
v_mfma_f32_32x32x16_bf16 v[112:127], a[228:231], v[164:167], v[112:127]
ds_read_b128 a[224:227], v1 offset:16384
buffer_load_dwordx4 a[56:59], v1, s[4:7], s34 offen offset:2048
v_rcp_f32 v52, v52
v_rcp_f32 v53, v53
v_mfma_f32_32x32x16_bf16 v[112:127], a[232:235], v[168:171], v[112:127]
ds_read_b128 a[228:231], v1 offset:17408
v_rcp_f32 v54, v54
v_rcp_f32 v55, v55
v_mul_f32 v84, v84, v52
v_mul_f32 v85, v85, v53
v_mfma_f32_32x32x16_bf16 v[112:127], a[236:239], v[172:175], v[112:127]
ds_read_b128 a[232:235], v1 offset:18432
v_mul_f32 v86, v86, v54
v_mul_f32 v87, v87, v55
v_cvt_pk_bf16_f32 v48, v84, v85
v_cvt_pk_bf16_f32 v49, v86, v87
s_add_u32 s37, s36, 2048
buffer_store_dwordx4 v[46:49], v40, s[4:7], s37 offen sc1
v_mul_f32 v52, v96, v96
s_waitcnt lgkmcnt(3)
v_mfma_f32_32x32x16_bf16 v[112:127], a[240:243], v[176:179], v[112:127]
ds_read_b128 a[236:239], v1 offset:19456
s_add_u32 m0, s21, 98304
s_add_u32 s30, s20, 262144
buffer_load_dwordx4 v1, s[4:7], s30 offen offset:0  lds
v_mul_f32 v53, v97, v97
v_mul_f32 v54, v98, v98
v_mfma_f32_32x32x16_bf16 v[112:127], a[244:247], v[180:183], v[112:127]
ds_read_b128 a[240:243], v1 offset:20480
buffer_load_dwordx4 a[60:63], v1, s[4:7], s34 offen offset:3072
v_mul_f32 v55, v99, v99
v_fma_f32 v52, v52, v39, v38
v_fma_f32 v53, v53, v39, v38
v_fma_f32 v54, v54, v39, v38
v_fma_f32 v55, v55, v39, v38
v_mfma_f32_32x32x16_bf16 v[112:127], a[248:251], v[184:187], v[112:127]
ds_read_b128 a[244:247], v1 offset:21504
v_mul_f32 v52, v52, v96
v_mul_f32 v53, v53, v97
v_mul_f32 v54, v54, v98
v_mul_f32 v55, v55, v99
v_exp_f32 v52, v52
v_mfma_f32_32x32x16_bf16 v[112:127], a[252:255], v[188:191], v[112:127]
ds_read_b128 a[248:251], v1 offset:22528
s_add_u32 s34, s35, 28672
buffer_load_dwordx4 a[112:115], v1, s[4:7], s34 offen offset:0
v_mul_f32 v96, v96, v104
v_exp_f32 v53, v53
v_mul_f32 v97, v97, v105
s_waitcnt lgkmcnt(3)
v_mfma_f32_32x32x16_bf16 v[112:127], a[224:227], v[192:195], v[112:127]
ds_read_b128 a[252:255], v1 offset:23552
buffer_load_dwordx4 v1, s[4:7], s30 offen offset:1024  lds
v_exp_f32 v54, v54
v_mul_f32 v98, v98, v106
v_mfma_f32_32x32x16_bf16 v[112:127], a[228:231], v[196:199], v[112:127]
ds_read_b128 a[224:227], v1 offset:24576
buffer_load_dwordx4 a[116:119], v1, s[4:7], s34 offen offset:1024
v_exp_f32 v55, v55
v_mul_f32 v99, v99, v107
v_fma_f32 v52, v52, v50, v50
v_fma_f32 v53, v53, v50, v50
v_mfma_f32_32x32x16_bf16 v[112:127], a[232:235], v[200:203], v[112:127]
ds_read_b128 a[228:231], v1 offset:25600
v_fma_f32 v54, v54, v50, v50
v_fma_f32 v55, v55, v50, v50
v_rcp_f32 v52, v52
v_rcp_f32 v53, v53
v_mfma_f32_32x32x16_bf16 v[112:127], a[236:239], v[204:207], v[112:127]
ds_read_b128 a[232:235], v1 offset:26624
buffer_load_dwordx4 a[120:123], v1, s[4:7], s34 offen offset:2048
v_rcp_f32 v54, v54
v_rcp_f32 v55, v55
v_mul_f32 v96, v96, v52
s_waitcnt lgkmcnt(3)
v_mfma_f32_32x32x16_bf16 v[112:127], a[240:243], v[208:211], v[112:127]
ds_read_b128 a[236:239], v1 offset:27648
buffer_load_dwordx4 v1, s[4:7], s30 offen offset:2048  lds
v_mul_f32 v97, v97, v53
v_mul_f32 v98, v98, v54
v_mul_f32 v99, v99, v55
v_cvt_pk_bf16_f32 v42, v96, v97
v_mfma_f32_32x32x16_bf16 v[112:127], a[244:247], v[212:215], v[112:127]
ds_read_b128 a[240:243], v1 offset:28672
buffer_load_dwordx4 a[124:127], v1, s[4:7], s34 offen offset:3072
v_cvt_pk_bf16_f32 v43, v98, v99
v_mul_f32 v52, v100, v100
v_mul_f32 v53, v101, v101
v_mul_f32 v54, v102, v102
v_mul_f32 v55, v103, v103
v_mfma_f32_32x32x16_bf16 v[112:127], a[248:251], v[216:219], v[112:127]
s_waitcnt vmcnt(10)
s_barrier
ds_read_b128 a[244:247], v1 offset:29696
v_fma_f32 v52, v52, v39, v38
v_fma_f32 v53, v53, v39, v38
v_fma_f32 v54, v54, v39, v38
v_fma_f32 v55, v55, v39, v38
v_mfma_f32_32x32x16_bf16 v[112:127], a[252:255], v[220:223], v[112:127]
ds_read_b128 a[248:251], v1 offset:30720
s_add_u32 s34, s35, 32768
buffer_load_dwordx4 a[128:131], v1, s[4:7], s34 offen offset:0
v_mul_f32 v52, v52, v100
v_mul_f32 v53, v53, v101
v_mul_f32 v54, v54, v102
v_mul_f32 v55, v55, v103
s_waitcnt lgkmcnt(3)
v_mfma_f32_32x32x16_bf16 v[112:127], a[224:227], v[224:227], v[112:127]
ds_read_b128 a[252:255], v1 offset:31744
buffer_load_dwordx4 v1, s[4:7], s30 offen offset:3072  lds
v_exp_f32 v52, v52
v_mul_f32 v100, v100, v108
v_mfma_f32_32x32x16_bf16 v[112:127], a[228:231], v[228:231], v[112:127]
ds_read_b128 a[224:227], v3 offset:0
buffer_load_dwordx4 a[132:135], v1, s[4:7], s34 offen offset:1024
v_exp_f32 v53, v53
v_mul_f32 v101, v101, v109
v_exp_f32 v54, v54
v_mfma_f32_32x32x16_bf16 v[112:127], a[232:235], v[232:235], v[112:127]
ds_read_b128 a[228:231], v3 offset:1024
v_mul_f32 v102, v102, v110
v_exp_f32 v55, v55
v_mul_f32 v103, v103, v111
v_fma_f32 v52, v52, v50, v50
v_fma_f32 v53, v53, v50, v50
v_mfma_f32_32x32x16_bf16 v[112:127], a[236:239], v[236:239], v[112:127]
ds_read_b128 a[232:235], v3 offset:2048
buffer_load_dwordx4 a[136:139], v1, s[4:7], s34 offen offset:2048
v_fma_f32 v54, v54, v50, v50
v_fma_f32 v55, v55, v50, v50
v_rcp_f32 v52, v52
s_waitcnt lgkmcnt(3)
v_mfma_f32_32x32x16_bf16 v[112:127], a[240:243], v[240:243], v[112:127]
ds_read_b128 a[236:239], v3 offset:3072
s_add_u32 m0, s21, 102400
s_add_u32 s30, s20, 266240
buffer_load_dwordx4 v1, s[4:7], s30 offen offset:0  lds
v_rcp_f32 v53, v53
v_mfma_f32_32x32x16_bf16 v[112:127], a[244:247], v[244:247], v[112:127]
ds_read_b128 a[240:243], v3 offset:4096
v_rcp_f32 v54, v54
v_rcp_f32 v55, v55
v_mul_f32 v100, v100, v52
v_mul_f32 v101, v101, v53
v_mfma_f32_32x32x16_bf16 v[112:127], a[248:251], v[248:251], v[112:127]
ds_read_b128 a[244:247], v3 offset:5120
buffer_load_dwordx4 a[140:143], v1, s[4:7], s34 offen offset:3072
v_mul_f32 v102, v102, v54
v_mul_f32 v103, v103, v55
v_cvt_pk_bf16_f32 v44, v100, v101
v_cvt_pk_bf16_f32 v45, v102, v103
s_add_u32 s37, s36, 4096
buffer_store_dwordx4 v[42:45], v40, s[4:7], s37 offen sc1
v_mfma_f32_32x32x16_bf16 v[112:127], a[252:255], v[252:255], v[112:127]
ds_read_b128 a[248:251], v3 offset:6144
v_mfma_f32_32x32x16_bf16 v[64:79], v[26:29], v[34:37], 0
s_waitcnt lgkmcnt(3)
v_mfma_f32_32x32x16_bf16 v[64:79], a[224:227], v[128:131], v[64:79]
ds_read_b128 a[252:255], v3 offset:7168
buffer_load_dwordx4 v1, s[4:7], s30 offen offset:1024  lds
v_mfma_f32_32x32x16_bf16 v[64:79], a[228:231], v[132:135], v[64:79]
ds_read_b128 a[224:227], v3 offset:8192
s_add_u32 s34, s35, 36864
buffer_load_dwordx4 a[144:147], v1, s[4:7], s34 offen offset:0
v_mfma_f32_32x32x16_bf16 v[64:79], a[232:235], v[136:139], v[64:79]
ds_read_b128 a[228:231], v3 offset:9216
v_mul_f32 v52, v112, v112
v_mul_f32 v53, v113, v113
v_mul_f32 v54, v114, v114
v_mul_f32 v55, v115, v115
v_fma_f32 v52, v52, v39, v38
v_fma_f32 v53, v53, v39, v38
v_mfma_f32_32x32x16_bf16 v[64:79], a[236:239], v[140:143], v[64:79]
ds_read_b128 a[232:235], v3 offset:10240
v_fma_f32 v54, v54, v39, v38
v_fma_f32 v55, v55, v39, v38
v_mul_f32 v52, v52, v112
v_mul_f32 v53, v53, v113
v_mul_f32 v54, v54, v114
v_mul_f32 v55, v55, v115
s_waitcnt lgkmcnt(3)
v_mfma_f32_32x32x16_bf16 v[64:79], a[240:243], v[144:147], v[64:79]
ds_read_b128 a[236:239], v3 offset:11264
buffer_load_dwordx4 v1, s[4:7], s30 offen offset:2048  lds
v_exp_f32 v52, v52
v_mul_f32 v112, v112, v120
v_mfma_f32_32x32x16_bf16 v[64:79], a[244:247], v[148:151], v[64:79]
ds_read_b128 a[240:243], v3 offset:12288
buffer_load_dwordx4 a[148:151], v1, s[4:7], s34 offen offset:1024
v_exp_f32 v53, v53
v_mul_f32 v113, v113, v121
v_exp_f32 v54, v54
v_mfma_f32_32x32x16_bf16 v[64:79], a[248:251], v[152:155], v[64:79]
ds_read_b128 a[244:247], v3 offset:13312
v_mul_f32 v114, v114, v122
v_exp_f32 v55, v55
v_mul_f32 v115, v115, v123
v_fma_f32 v52, v52, v50, v50
v_fma_f32 v53, v53, v50, v50
v_mfma_f32_32x32x16_bf16 v[64:79], a[252:255], v[156:159], v[64:79]
ds_read_b128 a[248:251], v3 offset:14336
buffer_load_dwordx4 a[152:155], v1, s[4:7], s34 offen offset:2048
v_fma_f32 v54, v54, v50, v50
v_fma_f32 v55, v55, v50, v50
v_rcp_f32 v52, v52
s_waitcnt lgkmcnt(3)
v_mfma_f32_32x32x16_bf16 v[64:79], a[224:227], v[160:163], v[64:79]
ds_read_b128 a[252:255], v3 offset:15360
buffer_load_dwordx4 v1, s[4:7], s30 offen offset:3072  lds
v_rcp_f32 v53, v53
v_rcp_f32 v54, v54
v_mfma_f32_32x32x16_bf16 v[64:79], a[228:231], v[164:167], v[64:79]
ds_read_b128 a[224:227], v3 offset:16384
v_rcp_f32 v55, v55
v_mul_f32 v112, v112, v52
v_mul_f32 v113, v113, v53
v_mul_f32 v114, v114, v54
v_mul_f32 v115, v115, v55
v_mfma_f32_32x32x16_bf16 v[64:79], a[232:235], v[168:171], v[64:79]
ds_read_b128 a[228:231], v3 offset:17408
buffer_load_dwordx4 a[156:159], v1, s[4:7], s34 offen offset:3072
v_cvt_pk_bf16_f32 v46, v112, v113
v_cvt_pk_bf16_f32 v47, v114, v115
v_mul_f32 v52, v116, v116
v_mul_f32 v53, v117, v117
v_mul_f32 v54, v118, v118
v_mfma_f32_32x32x16_bf16 v[64:79], a[236:239], v[172:175], v[64:79]
ds_read_b128 a[232:235], v3 offset:18432
v_mul_f32 v55, v119, v119
v_fma_f32 v52, v52, v39, v38
v_fma_f32 v53, v53, v39, v38
v_fma_f32 v54, v54, v39, v38
v_fma_f32 v55, v55, v39, v38
v_mul_f32 v52, v52, v116
s_waitcnt lgkmcnt(3)
v_mfma_f32_32x32x16_bf16 v[64:79], a[240:243], v[176:179], v[64:79]
ds_read_b128 a[236:239], v3 offset:19456
s_add_u32 m0, s21, 32768
s_add_u32 s30, s20, 294912
buffer_load_dwordx4 v1, s[4:7], s30 offen offset:0  lds
v_mul_f32 v53, v53, v117
v_mul_f32 v54, v54, v118
v_mfma_f32_32x32x16_bf16 v[64:79], a[244:247], v[180:183], v[64:79]
ds_read_b128 a[240:243], v3 offset:20480
s_add_u32 s34, s35, 40960
buffer_load_dwordx4 a[160:163], v1, s[4:7], s34 offen offset:0
v_mul_f32 v55, v55, v119
v_exp_f32 v52, v52
v_mul_f32 v116, v116, v124
v_mfma_f32_32x32x16_bf16 v[64:79], a[248:251], v[184:187], v[64:79]
ds_read_b128 a[244:247], v3 offset:21504
v_exp_f32 v53, v53
v_mul_f32 v117, v117, v125
v_exp_f32 v54, v54
v_mul_f32 v118, v118, v126
v_mfma_f32_32x32x16_bf16 v[64:79], a[252:255], v[188:191], v[64:79]
ds_read_b128 a[248:251], v3 offset:22528
buffer_load_dwordx4 a[164:167], v1, s[4:7], s34 offen offset:1024
v_exp_f32 v55, v55
v_mul_f32 v119, v119, v127
v_fma_f32 v52, v52, v50, v50
v_fma_f32 v53, v53, v50, v50
s_waitcnt lgkmcnt(3)
v_mfma_f32_32x32x16_bf16 v[64:79], a[224:227], v[192:195], v[64:79]
ds_read_b128 a[252:255], v3 offset:23552
buffer_load_dwordx4 v1, s[4:7], s30 offen offset:1024  lds
v_fma_f32 v54, v54, v50, v50
v_fma_f32 v55, v55, v50, v50
v_rcp_f32 v52, v52
v_mfma_f32_32x32x16_bf16 v[64:79], a[228:231], v[196:199], v[64:79]
ds_read_b128 a[224:227], v3 offset:24576
buffer_load_dwordx4 a[168:171], v1, s[4:7], s34 offen offset:2048
v_rcp_f32 v53, v53
v_rcp_f32 v54, v54
v_mfma_f32_32x32x16_bf16 v[64:79], a[232:235], v[200:203], v[64:79]
ds_read_b128 a[228:231], v3 offset:25600
v_rcp_f32 v55, v55
v_mul_f32 v116, v116, v52
v_mul_f32 v117, v117, v53
v_mul_f32 v118, v118, v54
v_mul_f32 v119, v119, v55
v_mfma_f32_32x32x16_bf16 v[64:79], a[236:239], v[204:207], v[64:79]
ds_read_b128 a[232:235], v3 offset:26624
v_cvt_pk_bf16_f32 v48, v116, v117
v_cvt_pk_bf16_f32 v49, v118, v119
s_add_u32 s37, s36, 6144
buffer_store_dwordx4 v[46:49], v40, s[4:7], s37 offen sc1
s_waitcnt lgkmcnt(3)
v_mfma_f32_32x32x16_bf16 v[64:79], a[240:243], v[208:211], v[64:79]
ds_read_b128 a[236:239], v3 offset:27648
buffer_load_dwordx4 v1, s[4:7], s30 offen offset:2048  lds
v_mfma_f32_32x32x16_bf16 v[64:79], a[244:247], v[212:215], v[64:79]
ds_read_b128 a[240:243], v3 offset:28672
buffer_load_dwordx4 a[172:175], v1, s[4:7], s34 offen offset:3072
v_mfma_f32_32x32x16_bf16 v[64:79], a[248:251], v[216:219], v[64:79]
s_waitcnt vmcnt(9)
s_barrier
ds_read_b128 a[244:247], v3 offset:29696
v_mfma_f32_32x32x16_bf16 v[64:79], a[252:255], v[220:223], v[64:79]
ds_read_b128 a[248:251], v3 offset:30720
s_waitcnt lgkmcnt(3)
v_mfma_f32_32x32x16_bf16 v[64:79], a[224:227], v[224:227], v[64:79]
ds_read_b128 a[252:255], v3 offset:31744
buffer_load_dwordx4 v1, s[4:7], s30 offen offset:3072  lds
v_mfma_f32_32x32x16_bf16 v[64:79], a[228:231], v[228:231], v[64:79]
ds_read_b128 a[224:227], v2 offset:32768
s_add_u32 s34, s35, 16384
buffer_load_dwordx4 a[64:67], v1, s[4:7], s34 offen offset:0
v_mfma_f32_32x32x16_bf16 v[64:79], a[232:235], v[232:235], v[64:79]
ds_read_b128 a[228:231], v2 offset:33792
v_mfma_f32_32x32x16_bf16 v[64:79], a[236:239], v[236:239], v[64:79]
ds_read_b128 a[232:235], v2 offset:34816
s_waitcnt lgkmcnt(3)
v_mfma_f32_32x32x16_bf16 v[64:79], a[240:243], v[240:243], v[64:79]
ds_read_b128 a[236:239], v2 offset:35840
s_add_u32 m0, s21, 36864
s_add_u32 s30, s20, 299008
buffer_load_dwordx4 v1, s[4:7], s30 offen offset:0  lds
v_mfma_f32_32x32x16_bf16 v[64:79], a[244:247], v[244:247], v[64:79]
ds_read_b128 a[240:243], v2 offset:36864
buffer_load_dwordx4 a[68:71], v1, s[4:7], s34 offen offset:1024
v_mfma_f32_32x32x16_bf16 v[64:79], a[248:251], v[248:251], v[64:79]
ds_read_b128 a[244:247], v2 offset:37888
v_mfma_f32_32x32x16_bf16 v[64:79], a[252:255], v[252:255], v[64:79]
ds_read_b128 a[248:251], v2 offset:38912
v_mfma_f32_32x32x16_bf16 v[80:95], v[30:33], v[32:35], 0
s_waitcnt lgkmcnt(3)
v_mfma_f32_32x32x16_bf16 v[80:95], a[224:227], v[128:131], v[80:95]
ds_read_b128 a[252:255], v2 offset:39936
v_mov_b32 v4, 3
s_waitcnt vmcnt(6)
s_mov_b64 exec, 1
buffer_store_dword v4, off, s[4:7], s78
s_mov_b64 exec, -1
buffer_load_dwordx4 v1, s[4:7], s30 offen offset:1024  lds
v_mfma_f32_32x32x16_bf16 v[80:95], a[228:231], v[132:135], v[80:95]
ds_read_b128 a[224:227], v2 offset:40960
v_mfma_f32_32x32x16_bf16 v[80:95], a[232:235], v[136:139], v[80:95]
ds_read_b128 a[228:231], v2 offset:41984
buffer_load_dwordx4 a[72:75], v1, s[4:7], s34 offen offset:2048
v_mul_f32 v52, v64, v64
v_mul_f32 v53, v65, v65
v_mul_f32 v54, v66, v66
v_mul_f32 v55, v67, v67
v_fma_f32 v52, v52, v39, v38
v_mfma_f32_32x32x16_bf16 v[80:95], a[236:239], v[140:143], v[80:95]
ds_read_b128 a[232:235], v2 offset:43008
v_fma_f32 v53, v53, v39, v38
v_fma_f32 v54, v54, v39, v38
v_fma_f32 v55, v55, v39, v38
v_mul_f32 v52, v52, v64
v_mul_f32 v53, v53, v65
v_mul_f32 v54, v54, v66
s_waitcnt lgkmcnt(3)
v_mfma_f32_32x32x16_bf16 v[80:95], a[240:243], v[144:147], v[80:95]
ds_read_b128 a[236:239], v2 offset:44032
buffer_load_dwordx4 a[76:79], v1, s[4:7], s34 offen offset:3072
v_mul_f32 v55, v55, v67
v_exp_f32 v52, v52
v_mul_f32 v64, v64, v72
v_mfma_f32_32x32x16_bf16 v[80:95], a[244:247], v[148:151], v[80:95]
ds_read_b128 a[240:243], v2 offset:45056
buffer_load_dwordx4 v1, s[4:7], s30 offen offset:2048  lds
v_exp_f32 v53, v53
v_mul_f32 v65, v65, v73
v_exp_f32 v54, v54
v_mfma_f32_32x32x16_bf16 v[80:95], a[248:251], v[152:155], v[80:95]
ds_read_b128 a[244:247], v2 offset:46080
v_mul_f32 v66, v66, v74
v_exp_f32 v55, v55
v_mul_f32 v67, v67, v75
v_fma_f32 v52, v52, v50, v50
v_fma_f32 v53, v53, v50, v50
v_mfma_f32_32x32x16_bf16 v[80:95], a[252:255], v[156:159], v[80:95]
ds_read_b128 a[248:251], v2 offset:47104
s_add_u32 s34, s35, 20480
buffer_load_dwordx4 a[80:83], v1, s[4:7], s34 offen offset:0
v_fma_f32 v54, v54, v50, v50
v_fma_f32 v55, v55, v50, v50
v_rcp_f32 v52, v52
s_waitcnt lgkmcnt(3)
v_mfma_f32_32x32x16_bf16 v[80:95], a[224:227], v[160:163], v[80:95]
ds_read_b128 a[252:255], v2 offset:48128
v_rcp_f32 v53, v53
v_rcp_f32 v54, v54
v_mfma_f32_32x32x16_bf16 v[80:95], a[228:231], v[164:167], v[80:95]
ds_read_b128 a[224:227], v2 offset:49152
buffer_load_dwordx4 v1, s[4:7], s30 offen offset:3072  lds
v_rcp_f32 v55, v55
v_mul_f32 v64, v64, v52
v_mul_f32 v65, v65, v53
v_mul_f32 v66, v66, v54
v_mfma_f32_32x32x16_bf16 v[80:95], a[232:235], v[168:171], v[80:95]
ds_read_b128 a[228:231], v2 offset:50176
buffer_load_dwordx4 a[84:87], v1, s[4:7], s34 offen offset:1024
v_mul_f32 v67, v67, v55
v_cvt_pk_bf16_f32 v42, v64, v65
v_cvt_pk_bf16_f32 v43, v66, v67
v_mul_f32 v52, v68, v68
v_mul_f32 v53, v69, v69
v_mfma_f32_32x32x16_bf16 v[80:95], a[236:239], v[172:175], v[80:95]
ds_read_b128 a[232:235], v2 offset:51200
L_here_22:
s_add_u32 s99, s13, L_here_22-L_pc+2048
buffer_load_dword v5, off, s[92:95], s99
v_mul_f32 v54, v70, v70
v_mul_f32 v55, v71, v71
v_fma_f32 v52, v52, v39, v38
s_waitcnt lgkmcnt(3)
v_mfma_f32_32x32x16_bf16 v[80:95], a[240:243], v[176:179], v[80:95]
ds_read_b128 a[236:239], v2 offset:52224
buffer_load_dwordx4 a[88:91], v1, s[4:7], s34 offen offset:2048
v_fma_f32 v53, v53, v39, v38
v_fma_f32 v54, v54, v39, v38
v_fma_f32 v55, v55, v39, v38
v_mul_f32 v52, v52, v68
v_mfma_f32_32x32x16_bf16 v[80:95], a[244:247], v[180:183], v[80:95]
ds_read_b128 a[240:243], v2 offset:53248
buffer_load_dword v5, off, s[4:7], s77 sc1
v_mul_f32 v53, v53, v69
v_mul_f32 v54, v54, v70
v_mul_f32 v55, v55, v71
v_exp_f32 v52, v52
v_mfma_f32_32x32x16_bf16 v[80:95], a[248:251], v[184:187], v[80:95]
ds_read_b128 a[244:247], v2 offset:54272
v_mul_f32 v68, v68, v76
v_exp_f32 v53, v53
v_mul_f32 v69, v69, v77
v_exp_f32 v54, v54
v_mfma_f32_32x32x16_bf16 v[80:95], a[252:255], v[188:191], v[80:95]
ds_read_b128 a[248:251], v2 offset:55296
buffer_load_dwordx4 a[92:95], v1, s[4:7], s34 offen offset:3072
v_mul_f32 v70, v70, v78
v_exp_f32 v55, v55
v_mul_f32 v71, v71, v79
v_fma_f32 v52, v52, v50, v50
s_waitcnt lgkmcnt(3)
v_mfma_f32_32x32x16_bf16 v[80:95], a[224:227], v[192:195], v[80:95]
ds_read_b128 a[252:255], v2 offset:56320
v_fma_f32 v53, v53, v50, v50
v_fma_f32 v54, v54, v50, v50
v_fma_f32 v55, v55, v50, v50
v_rcp_f32 v52, v52
v_mfma_f32_32x32x16_bf16 v[80:95], a[228:231], v[196:199], v[80:95]
ds_read_b128 a[224:227], v2 offset:57344
s_add_u32 s34, s35, 45056
buffer_load_dwordx4 a[176:179], v1, s[4:7], s34 offen offset:0
v_rcp_f32 v53, v53
v_rcp_f32 v54, v54
v_mfma_f32_32x32x16_bf16 v[80:95], a[232:235], v[200:203], v[80:95]
ds_read_b128 a[228:231], v2 offset:58368
v_rcp_f32 v55, v55
v_mul_f32 v68, v68, v52
v_mul_f32 v69, v69, v53
v_mul_f32 v70, v70, v54
v_mul_f32 v71, v71, v55
v_mfma_f32_32x32x16_bf16 v[80:95], a[236:239], v[204:207], v[80:95]
ds_read_b128 a[232:235], v2 offset:59392
buffer_load_dwordx4 a[180:183], v1, s[4:7], s34 offen offset:1024
v_cvt_pk_bf16_f32 v44, v68, v69
v_cvt_pk_bf16_f32 v45, v70, v71
s_add_u32 s37, s36, 8192
buffer_store_dwordx4 v[42:45], v40, s[4:7], s37 offen sc1
s_waitcnt lgkmcnt(3)
v_mfma_f32_32x32x16_bf16 v[80:95], a[240:243], v[208:211], v[80:95]
ds_read_b128 a[236:239], v2 offset:60416
v_mfma_f32_32x32x16_bf16 v[80:95], a[244:247], v[212:215], v[80:95]
ds_read_b128 a[240:243], v2 offset:61440
buffer_load_dword v63, v62, s[4:7], s79 offen sc1
buffer_load_dwordx4 a[184:187], v1, s[4:7], s34 offen offset:2048
v_mfma_f32_32x32x16_bf16 v[80:95], a[248:251], v[216:219], v[80:95]
s_waitcnt vmcnt(10)
s_barrier
ds_read_b128 a[244:247], v2 offset:62464
v_mfma_f32_32x32x16_bf16 v[80:95], a[252:255], v[220:223], v[80:95]
ds_read_b128 a[248:251], v2 offset:63488
s_waitcnt lgkmcnt(3)
v_mfma_f32_32x32x16_bf16 v[80:95], a[224:227], v[224:227], v[80:95]
ds_read_b128 a[252:255], v2 offset:64512
buffer_load_dwordx4 a[188:191], v1, s[4:7], s34 offen offset:3072
v_mfma_f32_32x32x16_bf16 v[80:95], a[228:231], v[228:231], v[80:95]
ds_read_b128 a[224:227], v1 offset:32768
v_mfma_f32_32x32x16_bf16 v[80:95], a[232:235], v[232:235], v[80:95]
ds_read_b128 a[228:231], v1 offset:33792
v_mfma_f32_32x32x16_bf16 v[80:95], a[236:239], v[236:239], v[80:95]
ds_read_b128 a[232:235], v1 offset:34816
s_add_u32 s34, s35, 49152
buffer_load_dwordx4 a[192:195], v1, s[4:7], s34 offen offset:0
s_waitcnt lgkmcnt(3)
v_mfma_f32_32x32x16_bf16 v[80:95], a[240:243], v[240:243], v[80:95]
ds_read_b128 a[236:239], v1 offset:35840
v_mfma_f32_32x32x16_bf16 v[80:95], a[244:247], v[244:247], v[80:95]
ds_read_b128 a[240:243], v1 offset:36864
v_mfma_f32_32x32x16_bf16 v[80:95], a[248:251], v[248:251], v[80:95]
ds_read_b128 a[244:247], v1 offset:37888
buffer_load_dwordx4 a[196:199], v1, s[4:7], s34 offen offset:1024
v_mfma_f32_32x32x16_bf16 v[80:95], a[252:255], v[252:255], v[80:95]
ds_read_b128 a[248:251], v1 offset:38912
s_waitcnt vmcnt(4)
v_cmp_gt_u32 vcc, 3, v63
s_nop 0
s_cbranch_vccnz L_poll_23
L_polled_24:
v_mfma_f32_32x32x16_bf16 v[96:111], v[28:31], v[34:37], 0
s_waitcnt lgkmcnt(3)
v_mfma_f32_32x32x16_bf16 v[96:111], a[224:227], v[128:131], v[96:111]
ds_read_b128 a[252:255], v1 offset:39936
buffer_load_dwordx4 a[200:203], v1, s[4:7], s34 offen offset:2048
v_mfma_f32_32x32x16_bf16 v[96:111], a[228:231], v[132:135], v[96:111]
ds_read_b128 a[224:227], v1 offset:40960
s_add_u32 s23, s87, 25165824
buffer_load_dwordx4 v[128:131], v1, s[4:7], s23 offen offset:0 sc1
v_mfma_f32_32x32x16_bf16 v[96:111], a[232:235], v[136:139], v[96:111]
ds_read_b128 a[228:231], v1 offset:41984
buffer_load_dwordx4 v[132:135], v1, s[4:7], s23 offen offset:1024 sc1
v_mul_f32 v52, v80, v80
v_mul_f32 v53, v81, v81
v_mul_f32 v54, v82, v82
v_mul_f32 v55, v83, v83
v_fma_f32 v52, v52, v39, v38
v_mfma_f32_32x32x16_bf16 v[96:111], a[236:239], v[140:143], v[96:111]
ds_read_b128 a[232:235], v1 offset:43008
buffer_load_dwordx4 v[136:139], v1, s[4:7], s23 offen offset:2048 sc1
v_fma_f32 v53, v53, v39, v38
v_fma_f32 v54, v54, v39, v38
v_fma_f32 v55, v55, v39, v38
v_mul_f32 v52, v52, v80
v_mul_f32 v53, v53, v81
s_waitcnt lgkmcnt(3)
v_mfma_f32_32x32x16_bf16 v[96:111], a[240:243], v[144:147], v[96:111]
ds_read_b128 a[236:239], v1 offset:44032
buffer_load_dwordx4 v[140:143], v1, s[4:7], s23 offen offset:3072 sc1
v_mul_f32 v54, v54, v82
v_mul_f32 v55, v55, v83
v_exp_f32 v52, v52
v_mfma_f32_32x32x16_bf16 v[96:111], a[244:247], v[148:151], v[96:111]
ds_read_b128 a[240:243], v1 offset:45056
buffer_load_dwordx4 a[204:207], v1, s[4:7], s34 offen offset:3072
v_mul_f32 v80, v80, v88
v_exp_f32 v53, v53
v_mul_f32 v81, v81, v89
v_mfma_f32_32x32x16_bf16 v[96:111], a[248:251], v[152:155], v[96:111]
ds_read_b128 a[244:247], v1 offset:46080
s_add_u32 s23, s87, 25169920
buffer_load_dwordx4 v[144:147], v1, s[4:7], s23 offen offset:0 sc1
v_exp_f32 v54, v54
v_mul_f32 v82, v82, v90
v_mfma_f32_32x32x16_bf16 v[96:111], a[252:255], v[156:159], v[96:111]
ds_read_b128 a[248:251], v1 offset:47104
v_exp_f32 v55, v55
v_mul_f32 v83, v83, v91
v_fma_f32 v52, v52, v50, v50
v_fma_f32 v53, v53, v50, v50
v_fma_f32 v54, v54, v50, v50
s_waitcnt lgkmcnt(3)
v_mfma_f32_32x32x16_bf16 v[96:111], a[224:227], v[160:163], v[96:111]
ds_read_b128 a[252:255], v1 offset:48128
buffer_load_dwordx4 v[148:151], v1, s[4:7], s23 offen offset:1024 sc1
v_fma_f32 v55, v55, v50, v50
v_rcp_f32 v52, v52
v_mfma_f32_32x32x16_bf16 v[96:111], a[228:231], v[164:167], v[96:111]
ds_read_b128 a[224:227], v1 offset:49152
s_add_u32 s34, s35, 24576
buffer_load_dwordx4 a[96:99], v1, s[4:7], s34 offen offset:0
v_rcp_f32 v53, v53
v_rcp_f32 v54, v54
v_mfma_f32_32x32x16_bf16 v[96:111], a[232:235], v[168:171], v[96:111]
ds_read_b128 a[228:231], v1 offset:50176
buffer_load_dwordx4 v[152:155], v1, s[4:7], s23 offen offset:2048 sc1
v_rcp_f32 v55, v55
v_mul_f32 v80, v80, v52
v_mul_f32 v81, v81, v53
v_mul_f32 v82, v82, v54
v_mfma_f32_32x32x16_bf16 v[96:111], a[236:239], v[172:175], v[96:111]
ds_read_b128 a[232:235], v1 offset:51200
buffer_load_dwordx4 a[100:103], v1, s[4:7], s34 offen offset:1024
v_mul_f32 v83, v83, v55
v_cvt_pk_bf16_f32 v46, v80, v81
v_cvt_pk_bf16_f32 v47, v82, v83
v_mul_f32 v52, v84, v84
v_mul_f32 v53, v85, v85
s_waitcnt lgkmcnt(3)
v_mfma_f32_32x32x16_bf16 v[96:111], a[240:243], v[176:179], v[96:111]
ds_read_b128 a[236:239], v1 offset:52224
buffer_load_dwordx4 v[156:159], v1, s[4:7], s23 offen offset:3072 sc1
v_mul_f32 v54, v86, v86
v_mul_f32 v55, v87, v87
v_fma_f32 v52, v52, v39, v38
v_fma_f32 v53, v53, v39, v38
v_mfma_f32_32x32x16_bf16 v[96:111], a[244:247], v[180:183], v[96:111]
ds_read_b128 a[240:243], v1 offset:53248
buffer_load_dwordx4 a[104:107], v1, s[4:7], s34 offen offset:2048
v_fma_f32 v54, v54, v39, v38
v_fma_f32 v55, v55, v39, v38
v_mul_f32 v52, v52, v84
v_mul_f32 v53, v53, v85
v_mul_f32 v54, v54, v86
v_mfma_f32_32x32x16_bf16 v[96:111], a[248:251], v[184:187], v[96:111]
ds_read_b128 a[244:247], v1 offset:54272
s_add_u32 s23, s87, 25180160
buffer_load_dwordx4 v[160:163], v1, s[4:7], s23 offen offset:0 sc1
v_mul_f32 v55, v55, v87
v_exp_f32 v52, v52
v_mul_f32 v84, v84, v92
v_mfma_f32_32x32x16_bf16 v[96:111], a[252:255], v[188:191], v[96:111]
ds_read_b128 a[248:251], v1 offset:55296
buffer_load_dwordx4 a[108:111], v1, s[4:7], s34 offen offset:3072
v_exp_f32 v53, v53
v_mul_f32 v85, v85, v93
v_exp_f32 v54, v54
s_waitcnt lgkmcnt(3)
v_mfma_f32_32x32x16_bf16 v[96:111], a[224:227], v[192:195], v[96:111]
ds_read_b128 a[252:255], v1 offset:56320
buffer_load_dwordx4 v[164:167], v1, s[4:7], s23 offen offset:1024 sc1
v_mul_f32 v86, v86, v94
v_exp_f32 v55, v55
v_mul_f32 v87, v87, v95
v_mfma_f32_32x32x16_bf16 v[96:111], a[228:231], v[196:199], v[96:111]
ds_read_b128 a[224:227], v1 offset:57344
s_add_u32 s34, s35, 53248
buffer_load_dwordx4 a[208:211], v1, s[4:7], s34 offen offset:0
v_fma_f32 v52, v52, v50, v50
v_fma_f32 v53, v53, v50, v50
v_fma_f32 v54, v54, v50, v50
v_fma_f32 v55, v55, v50, v50
v_mfma_f32_32x32x16_bf16 v[96:111], a[232:235], v[200:203], v[96:111]
ds_read_b128 a[228:231], v1 offset:58368
buffer_load_dwordx4 v[168:171], v1, s[4:7], s23 offen offset:2048 sc1
v_rcp_f32 v52, v52
v_rcp_f32 v53, v53
v_mfma_f32_32x32x16_bf16 v[96:111], a[236:239], v[204:207], v[96:111]
ds_read_b128 a[232:235], v1 offset:59392
v_rcp_f32 v54, v54
v_rcp_f32 v55, v55
v_mul_f32 v84, v84, v52
v_mul_f32 v85, v85, v53
s_waitcnt lgkmcnt(3)
v_mfma_f32_32x32x16_bf16 v[96:111], a[240:243], v[208:211], v[96:111]
ds_read_b128 a[236:239], v1 offset:60416
buffer_load_dwordx4 v[172:175], v1, s[4:7], s23 offen offset:3072 sc1
v_mul_f32 v86, v86, v54
v_mul_f32 v87, v87, v55
v_cvt_pk_bf16_f32 v48, v84, v85
v_cvt_pk_bf16_f32 v49, v86, v87
v_mfma_f32_32x32x16_bf16 v[96:111], a[244:247], v[212:215], v[96:111]
ds_read_b128 a[240:243], v1 offset:61440
buffer_load_dwordx4 a[212:215], v1, s[4:7], s34 offen offset:1024
buffer_store_dwordx4 v[46:49], v40, s[4:7], s28 offen offset:0
v_mfma_f32_32x32x16_bf16 v[96:111], a[248:251], v[216:219], v[96:111]
ds_read_b128 a[244:247], v1 offset:62464
s_add_u32 s23, s87, 25184256
buffer_load_dwordx4 v[176:179], v1, s[4:7], s23 offen offset:0 sc1
v_mfma_f32_32x32x16_bf16 v[96:111], a[252:255], v[220:223], v[96:111]
ds_read_b128 a[248:251], v1 offset:63488
s_waitcnt lgkmcnt(3)
v_mfma_f32_32x32x16_bf16 v[96:111], a[224:227], v[224:227], v[96:111]
ds_read_b128 a[252:255], v1 offset:64512
buffer_load_dwordx4 v[180:183], v1, s[4:7], s23 offen offset:1024 sc1
v_mfma_f32_32x32x16_bf16 v[96:111], a[228:231], v[228:231], v[96:111]
buffer_load_dwordx4 a[216:219], v1, s[4:7], s34 offen offset:2048
v_mfma_f32_32x32x16_bf16 v[96:111], a[232:235], v[232:235], v[96:111]
buffer_load_dwordx4 v[184:187], v1, s[4:7], s23 offen offset:2048 sc1
v_mfma_f32_32x32x16_bf16 v[96:111], a[236:239], v[236:239], v[96:111]
s_waitcnt lgkmcnt(0)
v_mfma_f32_32x32x16_bf16 v[96:111], a[240:243], v[240:243], v[96:111]
buffer_load_dwordx4 v[188:191], v1, s[4:7], s23 offen offset:3072 sc1
v_mfma_f32_32x32x16_bf16 v[96:111], a[244:247], v[244:247], v[96:111]
buffer_load_dwordx4 a[220:223], v1, s[4:7], s34 offen offset:3072
v_mfma_f32_32x32x16_bf16 v[96:111], a[248:251], v[248:251], v[96:111]
s_add_u32 s23, s87, 25280512
buffer_load_dwordx4 v[192:195], v1, s[4:7], s23 offen offset:0 sc1
v_mfma_f32_32x32x16_bf16 v[96:111], a[252:255], v[252:255], v[96:111]
s_waitcnt vmcnt(26)
v_mfma_f32_16x16x32_bf16 v[64:67], a[0:3], v[128:131], 0
buffer_load_dwordx4 v[196:199], v1, s[4:7], s23 offen offset:1024 sc1
v_mfma_f32_16x16x32_bf16 v[68:71], a[4:7], v[128:131], 0
v_mfma_f32_16x16x32_bf16 v[72:75], a[8:11], v[128:131], 0
v_mfma_f32_16x16x32_bf16 v[76:79], a[12:15], v[128:131], 0
s_waitcnt vmcnt(26)
v_mfma_f32_16x16x32_bf16 v[92:95], a[12:15], v[132:135], 0
buffer_load_dwordx4 v[200:203], v1, s[4:7], s23 offen offset:2048 sc1
s_nop 2
v_mul_f32 v52, v96, v96
v_mul_f32 v53, v97, v97
v_mul_f32 v54, v98, v98
v_mfma_f32_16x16x32_bf16 v[88:91], a[8:11], v[132:135], 0
v_mul_f32 v55, v99, v99
v_fma_f32 v52, v52, v39, v38
v_fma_f32 v53, v53, v39, v38
v_fma_f32 v54, v54, v39, v38
v_mfma_f32_16x16x32_bf16 v[84:87], a[4:7], v[132:135], 0
v_fma_f32 v55, v55, v39, v38
v_mul_f32 v52, v52, v96
v_mul_f32 v53, v53, v97
v_mul_f32 v54, v54, v98
v_mfma_f32_16x16x32_bf16 v[80:83], a[0:3], v[132:135], 0
v_mul_f32 v55, v55, v99
v_exp_f32 v52, v52
v_mul_f32 v96, v96, v104
s_waitcnt vmcnt(26)
v_mfma_f32_16x16x32_bf16 v[64:67], a[16:19], v[136:139], v[64:67]
buffer_load_dwordx4 v[204:207], v1, s[4:7], s23 offen offset:3072 sc1
v_exp_f32 v53, v53
v_mul_f32 v97, v97, v105
v_mfma_f32_16x16x32_bf16 v[68:71], a[20:23], v[136:139], v[68:71]
v_exp_f32 v54, v54
v_mul_f32 v98, v98, v106
v_mfma_f32_16x16x32_bf16 v[72:75], a[24:27], v[136:139], v[72:75]
v_exp_f32 v55, v55
v_mul_f32 v99, v99, v107
v_fma_f32 v52, v52, v50, v50
v_mfma_f32_16x16x32_bf16 v[76:79], a[28:31], v[136:139], v[76:79]
v_fma_f32 v53, v53, v50, v50
v_fma_f32 v54, v54, v50, v50
v_fma_f32 v55, v55, v50, v50
s_barrier
s_waitcnt vmcnt(26)
v_mfma_f32_16x16x32_bf16 v[92:95], a[28:31], v[140:143], v[92:95]
s_add_u32 s23, s87, 25284608
buffer_load_dwordx4 v[208:211], v1, s[4:7], s23 offen offset:0 sc1
v_rcp_f32 v52, v52
v_mfma_f32_16x16x32_bf16 v[88:91], a[24:27], v[140:143], v[88:91]
v_rcp_f32 v53, v53
v_rcp_f32 v54, v54
v_mfma_f32_16x16x32_bf16 v[84:87], a[20:23], v[140:143], v[84:87]
v_rcp_f32 v55, v55
v_mul_f32 v96, v96, v52
v_mul_f32 v97, v97, v53
v_mfma_f32_16x16x32_bf16 v[80:83], a[16:19], v[140:143], v[80:83]
v_mul_f32 v98, v98, v54
v_mul_f32 v99, v99, v55
v_cvt_pk_bf16_f32 v42, v96, v97
v_cvt_pk_bf16_f32 v43, v98, v99
v_mov_b32 v4, 4
s_waitcnt vmcnt(11)
s_mov_b64 exec, 1
buffer_store_dword v4, off, s[4:7], s78
s_mov_b64 exec, -1
v_mfma_f32_16x16x32_bf16 v[64:67], a[32:35], v[144:147], v[64:67]
buffer_load_dwordx4 v[212:215], v1, s[4:7], s23 offen offset:1024 sc1
v_mul_f32 v52, v100, v100
v_mul_f32 v53, v101, v101
v_mul_f32 v54, v102, v102
v_mfma_f32_16x16x32_bf16 v[68:71], a[36:39], v[144:147], v[68:71]
v_mul_f32 v55, v103, v103
v_fma_f32 v52, v52, v39, v38
v_fma_f32 v53, v53, v39, v38
v_fma_f32 v54, v54, v39, v38
v_mfma_f32_16x16x32_bf16 v[72:75], a[40:43], v[144:147], v[72:75]
v_fma_f32 v55, v55, v39, v38
v_mul_f32 v52, v52, v100
v_mul_f32 v53, v53, v101
v_mul_f32 v54, v54, v102
v_mfma_f32_16x16x32_bf16 v[76:79], a[44:47], v[144:147], v[76:79]
v_mul_f32 v55, v55, v103
v_exp_f32 v52, v52
v_mul_f32 v100, v100, v108
v_mfma_f32_16x16x32_bf16 v[92:95], a[44:47], v[148:151], v[92:95]
buffer_load_dwordx4 v[216:219], v1, s[4:7], s23 offen offset:2048 sc1
v_exp_f32 v53, v53
v_mul_f32 v101, v101, v109
v_mfma_f32_16x16x32_bf16 v[88:91], a[40:43], v[148:151], v[88:91]
v_exp_f32 v54, v54
v_mul_f32 v102, v102, v110
v_mfma_f32_16x16x32_bf16 v[84:87], a[36:39], v[148:151], v[84:87]
v_exp_f32 v55, v55
v_mul_f32 v103, v103, v111
v_fma_f32 v52, v52, v50, v50
v_mfma_f32_16x16x32_bf16 v[80:83], a[32:35], v[148:151], v[80:83]
v_fma_f32 v53, v53, v50, v50
v_fma_f32 v54, v54, v50, v50
v_fma_f32 v55, v55, v50, v50
v_mfma_f32_16x16x32_bf16 v[64:67], a[48:51], v[152:155], v[64:67]
buffer_load_dwordx4 v[220:223], v1, s[4:7], s23 offen offset:3072 sc1
v_rcp_f32 v52, v52
v_mfma_f32_16x16x32_bf16 v[68:71], a[52:55], v[152:155], v[68:71]
v_rcp_f32 v53, v53
v_rcp_f32 v54, v54
v_mfma_f32_16x16x32_bf16 v[72:75], a[56:59], v[152:155], v[72:75]
v_rcp_f32 v55, v55
v_mul_f32 v100, v100, v52
v_mul_f32 v101, v101, v53
v_mfma_f32_16x16x32_bf16 v[76:79], a[60:63], v[152:155], v[76:79]
v_mul_f32 v102, v102, v54
v_mul_f32 v103, v103, v55
v_cvt_pk_bf16_f32 v44, v100, v101
v_cvt_pk_bf16_f32 v45, v102, v103
v_mfma_f32_16x16x32_bf16 v[92:95], a[60:63], v[156:159], v[92:95]
s_add_u32 s23, s87, 25294848
buffer_load_dwordx4 v[224:227], v1, s[4:7], s23 offen offset:0 sc1
buffer_store_dwordx4 v[42:45], v40, s[4:7], s28 offen offset:2048
v_mfma_f32_16x16x32_bf16 v[88:91], a[56:59], v[156:159], v[88:91]
s_add_u32 s36, s82, 12582912
s_add_u32 s37, s83, 7864320
v_mfma_f32_16x16x32_bf16 v[84:87], a[52:55], v[156:159], v[84:87]
v_permlane16_swap_b32 v6, v8
v_permlane16_swap_b32 v7, v9
v_mfma_f32_16x16x32_bf16 v[80:83], a[48:51], v[156:159], v[80:83]
v_permlane16_swap_b32 v10, v12
v_permlane16_swap_b32 v11, v13
v_mfma_f32_16x16x32_bf16 v[64:67], a[112:115], v[160:163], v[64:67]
buffer_load_dwordx4 v[228:231], v1, s[4:7], s23 offen offset:1024 sc1
s_add_u32 s15, s36, 32768
v_mfma_f32_16x16x32_bf16 v[68:71], a[116:119], v[160:163], v[68:71]
v_lshlrev_b32 v40, 16, v6
v_and_b32 v41, 0xffff0000, v6
v_mfma_f32_16x16x32_bf16 v[72:75], a[120:123], v[160:163], v[72:75]
v_lshlrev_b32 v42, 16, v7
v_and_b32 v43, 0xffff0000, v7
v_mfma_f32_16x16x32_bf16 v[76:79], a[124:127], v[160:163], v[76:79]
v_lshlrev_b32 v44, 16, v8
v_and_b32 v45, 0xffff0000, v8
buffer_load_dword v63, v62, s[4:7], s79 offen sc1
v_mfma_f32_16x16x32_bf16 v[92:95], a[124:127], v[164:167], v[92:95]
buffer_load_dwordx4 v[232:235], v1, s[4:7], s23 offen offset:2048 sc1
v_lshlrev_b32 v46, 16, v9
v_mfma_f32_16x16x32_bf16 v[88:91], a[120:123], v[164:167], v[88:91]
v_and_b32 v47, 0xffff0000, v9
v_lshlrev_b32 v48, 16, v10
v_mfma_f32_16x16x32_bf16 v[84:87], a[116:119], v[164:167], v[84:87]
v_and_b32 v49, 0xffff0000, v10
v_lshlrev_b32 v50, 16, v11
v_mfma_f32_16x16x32_bf16 v[80:83], a[112:115], v[164:167], v[80:83]
v_and_b32 v51, 0xffff0000, v11
v_lshlrev_b32 v52, 16, v12
v_mfma_f32_16x16x32_bf16 v[64:67], a[128:131], v[168:171], v[64:67]
buffer_load_dwordx4 v[236:239], v1, s[4:7], s23 offen offset:3072 sc1
v_and_b32 v53, 0xffff0000, v12
v_mfma_f32_16x16x32_bf16 v[68:71], a[132:135], v[168:171], v[68:71]
v_lshlrev_b32 v54, 16, v13
v_and_b32 v55, 0xffff0000, v13
v_mfma_f32_16x16x32_bf16 v[72:75], a[136:139], v[168:171], v[72:75]
v_and_b32 v38, 1, v0
v_lshlrev_b32 v38, 4, v38
v_mfma_f32_16x16x32_bf16 v[76:79], a[140:143], v[168:171], v[76:79]
v_mov_b32 v39, 0x3f80
v_lshlrev_b32 v38, v38, v39
v_mfma_f32_16x16x32_bf16 v[92:95], a[140:143], v[172:175], v[92:95]
s_add_u32 s23, s87, 25298944
buffer_load_dwordx4 v[240:243], v1, s[4:7], s23 offen offset:0 sc1
v_mfma_f32_16x16x32_bf16 v[88:91], a[136:139], v[172:175], v[88:91]
v_bfe_u32 v39, v0, 1, 3
v_cmp_eq_u32 s[96:97], 0, v39
v_mfma_f32_16x16x32_bf16 v[84:87], a[132:135], v[172:175], v[84:87]
v_cmp_eq_u32 s[26:27], 1, v39
v_cndmask_b32 v60, 0, v38, s[96:97]
v_mfma_f32_16x16x32_bf16 v[80:83], a[128:131], v[172:175], v[80:83]
v_cndmask_b32 v61, 0, v38, s[26:27]
v_cmp_eq_u32 s[96:97], 2, v39
s_waitcnt vmcnt(21)
v_mfma_f32_16x16x32_bf16 v[64:67], a[144:147], v[176:179], v[64:67]
buffer_load_dwordx4 v[244:247], v1, s[4:7], s23 offen offset:1024 sc1
v_cmp_eq_u32 s[26:27], 3, v39
v_mfma_f32_16x16x32_bf16 v[68:71], a[148:151], v[176:179], v[68:71]
v_accvgpr_write_b32 a240, v60
v_accvgpr_write_b32 a241, v61
v_mfma_f32_16x16x32_bf16 v[72:75], a[152:155], v[176:179], v[72:75]
v_cndmask_b32 v60, 0, v38, s[96:97]
v_cndmask_b32 v61, 0, v38, s[26:27]
v_mfma_f32_16x16x32_bf16 v[76:79], a[156:159], v[176:179], v[76:79]
v_cmp_eq_u32 s[96:97], 4, v39
v_cmp_eq_u32 s[26:27], 5, v39
s_waitcnt vmcnt(21)
v_mfma_f32_16x16x32_bf16 v[92:95], a[156:159], v[180:183], v[92:95]
buffer_load_dwordx4 v[248:251], v1, s[4:7], s23 offen offset:2048 sc1
v_accvgpr_write_b32 a242, v60
v_mfma_f32_16x16x32_bf16 v[88:91], a[152:155], v[180:183], v[88:91]
v_accvgpr_write_b32 a243, v61
v_cndmask_b32 v60, 0, v38, s[96:97]
v_mfma_f32_16x16x32_bf16 v[84:87], a[148:151], v[180:183], v[84:87]
v_cndmask_b32 v61, 0, v38, s[26:27]
v_cmp_eq_u32 s[96:97], 6, v39
v_mfma_f32_16x16x32_bf16 v[80:83], a[144:147], v[180:183], v[80:83]
v_cmp_eq_u32 s[26:27], 7, v39
v_accvgpr_write_b32 a244, v60
s_waitcnt vmcnt(20)
v_mfma_f32_16x16x32_bf16 v[64:67], a[160:163], v[184:187], v[64:67]
buffer_load_dwordx4 v[252:255], v1, s[4:7], s23 offen offset:3072 sc1
v_accvgpr_write_b32 a245, v61
v_mfma_f32_16x16x32_bf16 v[68:71], a[164:167], v[184:187], v[68:71]
v_cndmask_b32 v60, 0, v38, s[96:97]
v_cndmask_b32 v61, 0, v38, s[26:27]
v_mfma_f32_16x16x32_bf16 v[72:75], a[168:171], v[184:187], v[72:75]
v_accvgpr_write_b32 a246, v60
v_accvgpr_write_b32 a247, v61
v_mfma_f32_16x16x32_bf16 v[76:79], a[172:175], v[184:187], v[76:79]
s_waitcnt vmcnt(20)
v_mfma_f32_16x16x32_bf16 v[92:95], a[172:175], v[188:191], v[92:95]
v_mfma_f32_16x16x32_bf16 v[88:91], a[168:171], v[188:191], v[88:91]
v_mfma_f32_16x16x32_bf16 v[84:87], a[164:167], v[188:191], v[84:87]
v_mfma_f32_16x16x32_bf16 v[80:83], a[160:163], v[188:191], v[80:83]
s_waitcnt vmcnt(18)
v_mfma_f32_16x16x32_bf16 v[96:99], a[0:3], v[192:195], 0
v_mfma_f32_16x16x32_bf16 v[100:103], a[4:7], v[192:195], 0
v_mfma_f32_16x16x32_bf16 v[104:107], a[8:11], v[192:195], 0
v_mfma_f32_16x16x32_bf16 v[108:111], a[12:15], v[192:195], 0
s_waitcnt vmcnt(17)
v_mfma_f32_16x16x32_bf16 v[124:127], a[12:15], v[196:199], 0
v_mfma_f32_16x16x32_bf16 v[120:123], a[8:11], v[196:199], 0
v_mfma_f32_16x16x32_bf16 v[116:119], a[4:7], v[196:199], 0
v_mfma_f32_16x16x32_bf16 v[112:115], a[0:3], v[196:199], 0
v_mov_b32 v4, 5
s_waitcnt vmcnt(8)
s_mov_b64 exec, 1
buffer_store_dword v4, off, s[4:7], s78
s_mov_b64 exec, -1
v_mfma_f32_16x16x32_bf16 v[96:99], a[16:19], v[200:203], v[96:99]
v_mfma_f32_16x16x32_bf16 v[100:103], a[20:23], v[200:203], v[100:103]
v_mfma_f32_16x16x32_bf16 v[104:107], a[24:27], v[200:203], v[104:107]
v_mfma_f32_16x16x32_bf16 v[108:111], a[28:31], v[200:203], v[108:111]
s_waitcnt vmcnt(7)
v_cmp_gt_u32 vcc, 4, v63
s_nop 0
s_cbranch_vccnz L_poll_25
L_polled_26:
v_mfma_f32_16x16x32_bf16 v[124:127], a[28:31], v[204:207], v[124:127]
s_add_u32 s23, s87, 25174016
buffer_load_dwordx4 v[128:131], v1, s[4:7], s23 offen offset:0 sc1
v_mfma_f32_16x16x32_bf16 v[120:123], a[24:27], v[204:207], v[120:123]
v_mfma_f32_16x16x32_bf16 v[116:119], a[20:23], v[204:207], v[116:119]
v_mfma_f32_16x16x32_bf16 v[112:115], a[16:19], v[204:207], v[112:115]
v_mfma_f32_16x16x32_bf16 v[96:99], a[32:35], v[208:211], v[96:99]
buffer_load_dwordx4 v[132:135], v1, s[4:7], s23 offen offset:1024 sc1
v_mfma_f32_16x16x32_bf16 v[100:103], a[36:39], v[208:211], v[100:103]
v_mfma_f32_16x16x32_bf16 v[104:107], a[40:43], v[208:211], v[104:107]
v_mfma_f32_16x16x32_bf16 v[108:111], a[44:47], v[208:211], v[108:111]
v_mfma_f32_16x16x32_bf16 v[124:127], a[44:47], v[212:215], v[124:127]
s_add_u32 s23, s39, 20971520
buffer_load_dwordx4 v[136:139], v1, s[4:7], s23 offen offset:0 sc1
v_mfma_f32_16x16x32_bf16 v[120:123], a[40:43], v[212:215], v[120:123]
v_mfma_f32_16x16x32_bf16 v[116:119], a[36:39], v[212:215], v[116:119]
v_mfma_f32_16x16x32_bf16 v[112:115], a[32:35], v[212:215], v[112:115]
v_mfma_f32_16x16x32_bf16 v[96:99], a[48:51], v[216:219], v[96:99]
buffer_load_dwordx4 v[140:143], v1, s[4:7], s23 offen offset:1024 sc1
v_mfma_f32_16x16x32_bf16 v[100:103], a[52:55], v[216:219], v[100:103]
v_mfma_f32_16x16x32_bf16 v[104:107], a[56:59], v[216:219], v[104:107]
v_mfma_f32_16x16x32_bf16 v[108:111], a[60:63], v[216:219], v[108:111]
buffer_load_dword v63, v62, s[4:7], s79 offen sc1
v_mfma_f32_16x16x32_bf16 v[124:127], a[60:63], v[220:223], v[124:127]
s_add_u32 s23, s87, 25188352
buffer_load_dwordx4 v[144:147], v1, s[4:7], s23 offen offset:0 sc1
v_mfma_f32_16x16x32_bf16 v[120:123], a[56:59], v[220:223], v[120:123]
v_mfma_f32_16x16x32_bf16 v[116:119], a[52:55], v[220:223], v[116:119]
v_mfma_f32_16x16x32_bf16 v[112:115], a[48:51], v[220:223], v[112:115]
v_mfma_f32_16x16x32_bf16 v[96:99], a[112:115], v[224:227], v[96:99]
buffer_load_dwordx4 v[148:151], v1, s[4:7], s23 offen offset:1024 sc1
v_mfma_f32_16x16x32_bf16 v[100:103], a[116:119], v[224:227], v[100:103]
v_mfma_f32_16x16x32_bf16 v[104:107], a[120:123], v[224:227], v[104:107]
v_mfma_f32_16x16x32_bf16 v[108:111], a[124:127], v[224:227], v[108:111]
v_mfma_f32_16x16x32_bf16 v[124:127], a[124:127], v[228:231], v[124:127]
s_add_u32 s23, s39, 20975616
buffer_load_dwordx4 v[152:155], v1, s[4:7], s23 offen offset:0 sc1
v_mfma_f32_16x16x32_bf16 v[120:123], a[120:123], v[228:231], v[120:123]
v_mfma_f32_16x16x32_bf16 v[116:119], a[116:119], v[228:231], v[116:119]
v_mfma_f32_16x16x32_bf16 v[112:115], a[112:115], v[228:231], v[112:115]
s_waitcnt vmcnt(14)
v_mfma_f32_16x16x32_bf16 v[96:99], a[128:131], v[232:235], v[96:99]
buffer_load_dwordx4 v[156:159], v1, s[4:7], s23 offen offset:1024 sc1
v_mfma_f32_16x16x32_bf16 v[100:103], a[132:135], v[232:235], v[100:103]
v_mfma_f32_16x16x32_bf16 v[104:107], a[136:139], v[232:235], v[104:107]
v_mfma_f32_16x16x32_bf16 v[108:111], a[140:143], v[232:235], v[108:111]
s_waitcnt vmcnt(14)
v_mfma_f32_16x16x32_bf16 v[124:127], a[140:143], v[236:239], v[124:127]
v_mfma_f32_16x16x32_bf16 v[120:123], a[136:139], v[236:239], v[120:123]
v_mfma_f32_16x16x32_bf16 v[116:119], a[132:135], v[236:239], v[116:119]
v_mfma_f32_16x16x32_bf16 v[112:115], a[128:131], v[236:239], v[112:115]
s_waitcnt vmcnt(13)
v_mfma_f32_16x16x32_bf16 v[96:99], a[144:147], v[240:243], v[96:99]
v_mfma_f32_16x16x32_bf16 v[100:103], a[148:151], v[240:243], v[100:103]
v_mfma_f32_16x16x32_bf16 v[104:107], a[152:155], v[240:243], v[104:107]
v_mfma_f32_16x16x32_bf16 v[108:111], a[156:159], v[240:243], v[108:111]
s_waitcnt vmcnt(12)
v_mfma_f32_16x16x32_bf16 v[124:127], a[156:159], v[244:247], v[124:127]
v_mfma_f32_16x16x32_bf16 v[120:123], a[152:155], v[244:247], v[120:123]
v_mfma_f32_16x16x32_bf16 v[116:119], a[148:151], v[244:247], v[116:119]
v_mfma_f32_16x16x32_bf16 v[112:115], a[144:147], v[244:247], v[112:115]
s_waitcnt vmcnt(11)
v_mfma_f32_16x16x32_bf16 v[96:99], a[160:163], v[248:251], v[96:99]
v_mfma_f32_16x16x32_bf16 v[100:103], a[164:167], v[248:251], v[100:103]
v_mfma_f32_16x16x32_bf16 v[104:107], a[168:171], v[248:251], v[104:107]
v_mfma_f32_16x16x32_bf16 v[108:111], a[172:175], v[248:251], v[108:111]
s_waitcnt vmcnt(4)
v_cmp_gt_u32 vcc, 5, v63
s_nop 0
s_cbranch_vccnz L_poll_27
L_polled_28:
v_mfma_f32_16x16x32_bf16 v[124:127], a[172:175], v[252:255], v[124:127]
s_add_u32 s23, s39, 20973568
buffer_load_dwordx4 v[160:163], v1, s[4:7], s23 offen offset:0 sc1
v_mfma_f32_16x16x32_bf16 v[120:123], a[168:171], v[252:255], v[120:123]
v_mfma_f32_16x16x32_bf16 v[116:119], a[164:167], v[252:255], v[116:119]
s_add_u32 s23, s39, 20977664
buffer_load_dwordx4 v[164:167], v1, s[4:7], s23 offen offset:0 sc1
v_mfma_f32_16x16x32_bf16 v[112:115], a[160:163], v[252:255], v[112:115]
v_mfma_f32_16x16x32_bf16 v[64:67], a[64:67], v[128:131], v[64:67]
s_add_u32 s23, s39, 20974592
buffer_load_dwordx4 v[168:171], v1, s[4:7], s23 offen offset:0 sc1
v_mfma_f32_16x16x32_bf16 v[68:71], a[68:71], v[128:131], v[68:71]
v_mfma_f32_16x16x32_bf16 v[72:75], a[72:75], v[128:131], v[72:75]
s_add_u32 s23, s39, 20978688
buffer_load_dwordx4 v[172:175], v1, s[4:7], s23 offen offset:0 sc1
v_mfma_f32_16x16x32_bf16 v[76:79], a[76:79], v[128:131], v[76:79]
v_mfma_f32_16x16x32_bf16 v[92:95], a[76:79], v[132:135], v[92:95]
s_add_u32 s23, s87, 25288704
buffer_load_dwordx4 v[176:179], v1, s[4:7], s23 offen offset:0 sc1
v_mfma_f32_16x16x32_bf16 v[88:91], a[72:75], v[132:135], v[88:91]
v_mfma_f32_16x16x32_bf16 v[84:87], a[68:71], v[132:135], v[84:87]
s_add_u32 s23, s39, 21004288
buffer_load_dwordx4 v[180:183], v1, s[4:7], s23 offen offset:0 sc1
v_mfma_f32_16x16x32_bf16 v[80:83], a[64:67], v[132:135], v[80:83]
v_mfma_f32_16x16x32_bf16 v[64:67], a[80:83], v[136:139], v[64:67]
s_add_u32 s23, s87, 25303040
buffer_load_dwordx4 v[184:187], v1, s[4:7], s23 offen offset:0 sc1
v_mfma_f32_16x16x32_bf16 v[68:71], a[84:87], v[136:139], v[68:71]
v_mfma_f32_16x16x32_bf16 v[72:75], a[88:91], v[136:139], v[72:75]
s_add_u32 s23, s39, 21008384
buffer_load_dwordx4 v[188:191], v1, s[4:7], s23 offen offset:0 sc1
v_mfma_f32_16x16x32_bf16 v[76:79], a[92:95], v[136:139], v[76:79]
v_mfma_f32_16x16x32_bf16 v[92:95], a[92:95], v[140:143], v[92:95]
s_add_u32 s23, s39, 21006336
buffer_load_dwordx4 v[192:195], v1, s[4:7], s23 offen offset:0 sc1
v_mfma_f32_16x16x32_bf16 v[88:91], a[88:91], v[140:143], v[88:91]
v_mfma_f32_16x16x32_bf16 v[84:87], a[84:87], v[140:143], v[84:87]
s_mov_b32 exec_lo, 0x1010101
s_mov_b32 exec_hi, 0x1010101
buffer_load_dword v5, v58, s[4:7], s36 offen offset:0 sc1
buffer_load_dword v5, v58, s[4:7], s15 offen offset:0 sc1
s_mov_b64 exec, -1
v_mfma_f32_16x16x32_bf16 v[80:83], a[80:83], v[140:143], v[80:83]
s_waitcnt vmcnt(14)
v_mfma_f32_16x16x32_bf16 v[64:67], a[176:179], v[144:147], v[64:67]
s_add_u32 s23, s39, 21010432
buffer_load_dwordx4 v[196:199], v1, s[4:7], s23 offen offset:0 sc1
v_mfma_f32_16x16x32_bf16 v[68:71], a[180:183], v[144:147], v[68:71]
v_mfma_f32_16x16x32_bf16 v[72:75], a[184:187], v[144:147], v[72:75]
s_mov_b32 exec_lo, 0x1
s_mov_b32 exec_hi, 0x1
buffer_load_dword v5, v59, s[4:7], s37 offen offset:0 sc1
buffer_load_dword v5, v59, s[4:7], s37 offen offset:2048 sc1
s_mov_b64 exec, -1
v_mfma_f32_16x16x32_bf16 v[76:79], a[188:191], v[144:147], v[76:79]
s_waitcnt vmcnt(16)
v_mfma_f32_16x16x32_bf16 v[92:95], a[188:191], v[148:151], v[92:95]
s_add_u32 s23, s87, 25289728
buffer_load_dwordx4 v[200:203], v1, s[4:7], s23 offen offset:0 sc1
v_mfma_f32_16x16x32_bf16 v[88:91], a[184:187], v[148:151], v[88:91]
v_mfma_f32_16x16x32_bf16 v[84:87], a[180:183], v[148:151], v[84:87]
v_mfma_f32_16x16x32_bf16 v[80:83], a[176:179], v[148:151], v[80:83]
s_waitcnt vmcnt(16)
v_mfma_f32_16x16x32_bf16 v[64:67], a[192:195], v[152:155], v[64:67]
s_add_u32 s23, s39, 21005312
buffer_load_dwordx4 v[204:207], v1, s[4:7], s23 offen offset:0 sc1
v_mfma_f32_16x16x32_bf16 v[68:71], a[196:199], v[152:155], v[68:71]
v_mfma_f32_16x16x32_bf16 v[72:75], a[200:203], v[152:155], v[72:75]
v_mfma_f32_16x16x32_bf16 v[76:79], a[204:207], v[152:155], v[76:79]
s_waitcnt vmcnt(16)
v_mfma_f32_16x16x32_bf16 v[92:95], a[204:207], v[156:159], v[92:95]
s_add_u32 s23, s87, 25304064
buffer_load_dwordx4 v[208:211], v1, s[4:7], s23 offen offset:0 sc1
v_mfma_f32_16x16x32_bf16 v[88:91], a[200:203], v[156:159], v[88:91]
v_mfma_f32_16x16x32_bf16 v[84:87], a[196:199], v[156:159], v[84:87]
v_mfma_f32_16x16x32_bf16 v[80:83], a[192:195], v[156:159], v[80:83]
s_waitcnt vmcnt(16)
v_mfma_f32_16x16x32_bf16 v[64:67], a[96:99], v[160:163], v[64:67]
s_add_u32 s23, s39, 21009408
buffer_load_dwordx4 v[212:215], v1, s[4:7], s23 offen offset:0 sc1
v_mfma_f32_16x16x32_bf16 v[68:71], a[100:103], v[160:163], v[68:71]
v_mfma_f32_16x16x32_bf16 v[72:75], a[104:107], v[160:163], v[72:75]
v_mfma_f32_16x16x32_bf16 v[76:79], a[108:111], v[160:163], v[76:79]
s_waitcnt vmcnt(16)
v_mfma_f32_16x16x32_bf16 v[64:67], a[208:211], v[164:167], v[64:67]
s_add_u32 s23, s39, 21007360
buffer_load_dwordx4 v[216:219], v1, s[4:7], s23 offen offset:0 sc1
v_mfma_f32_16x16x32_bf16 v[68:71], a[212:215], v[164:167], v[68:71]
v_mfma_f32_16x16x32_bf16 v[72:75], a[216:219], v[164:167], v[72:75]
v_mfma_f32_16x16x32_bf16 v[76:79], a[220:223], v[164:167], v[76:79]
s_waitcnt vmcnt(16)
v_mfma_f32_16x16x32_bf16 v[92:95], a[108:111], v[168:171], v[92:95]
s_add_u32 s23, s39, 21011456
buffer_load_dwordx4 v[220:223], v1, s[4:7], s23 offen offset:0 sc1
v_mfma_f32_16x16x32_bf16 v[88:91], a[104:107], v[168:171], v[88:91]
v_mfma_f32_16x16x32_bf16 v[84:87], a[100:103], v[168:171], v[84:87]
s_add_u32 m0, s21, 32768
s_add_u32 s30, s20, 0
buffer_load_dwordx4 v1, s[4:7], s30 offen offset:0  lds
v_mfma_f32_16x16x32_bf16 v[80:83], a[96:99], v[168:171], v[80:83]
s_waitcnt vmcnt(17)
v_mfma_f32_16x16x32_bf16 v[92:95], a[220:223], v[172:175], v[92:95]
v_mfma_f32_16x16x32_bf16 v[88:91], a[216:219], v[172:175], v[88:91]
v_cvt_pk_bf16_f32 v64, v64, v65
v_cvt_pk_bf16_f32 v65, v66, v67
v_cvt_pk_bf16_f32 v66, v68, v69
v_cvt_pk_bf16_f32 v67, v70, v71
ds_write_b128 v56, v[64:67] offset:0
v_mfma_f32_16x16x32_bf16 v[84:87], a[212:215], v[172:175], v[84:87]
buffer_load_dwordx4 v1, s[4:7], s30 offen offset:1024  lds
v_mfma_f32_16x16x32_bf16 v[80:83], a[208:211], v[172:175], v[80:83]
s_waitcnt vmcnt(17)
v_mfma_f32_16x16x32_bf16 v[96:99], a[64:67], v[176:179], v[96:99]
v_mfma_f32_16x16x32_bf16 v[100:103], a[68:71], v[176:179], v[100:103]
v_cvt_pk_bf16_f32 v72, v72, v73
v_cvt_pk_bf16_f32 v73, v74, v75
v_cvt_pk_bf16_f32 v74, v76, v77
v_cvt_pk_bf16_f32 v75, v78, v79
ds_write_b128 v56, v[72:75] offset:2048
v_mfma_f32_16x16x32_bf16 v[104:107], a[72:75], v[176:179], v[104:107]
buffer_load_dwordx4 v1, s[4:7], s30 offen offset:2048  lds
v_mfma_f32_16x16x32_bf16 v[108:111], a[76:79], v[176:179], v[108:111]
s_waitcnt vmcnt(17)
v_mfma_f32_16x16x32_bf16 v[96:99], a[80:83], v[180:183], v[96:99]
v_mfma_f32_16x16x32_bf16 v[100:103], a[84:87], v[180:183], v[100:103]
v_cvt_pk_bf16_f32 v80, v80, v81
v_cvt_pk_bf16_f32 v81, v82, v83
v_cvt_pk_bf16_f32 v82, v84, v85
v_cvt_pk_bf16_f32 v83, v86, v87
ds_write_b128 v56, v[80:83] offset:256
v_mfma_f32_16x16x32_bf16 v[104:107], a[88:91], v[180:183], v[104:107]
buffer_load_dwordx4 v1, s[4:7], s30 offen offset:3072  lds
v_mfma_f32_16x16x32_bf16 v[108:111], a[92:95], v[180:183], v[108:111]
s_waitcnt vmcnt(17)
v_mfma_f32_16x16x32_bf16 v[96:99], a[176:179], v[184:187], v[96:99]
v_mfma_f32_16x16x32_bf16 v[100:103], a[180:183], v[184:187], v[100:103]
v_cvt_pk_bf16_f32 v88, v88, v89
v_cvt_pk_bf16_f32 v89, v90, v91
v_cvt_pk_bf16_f32 v90, v92, v93
v_cvt_pk_bf16_f32 v91, v94, v95
ds_write_b128 v56, v[88:91] offset:2304
v_mfma_f32_16x16x32_bf16 v[104:107], a[184:187], v[184:187], v[104:107]
s_add_u32 m0, s21, 36864
s_add_u32 s30, s20, 4096
buffer_load_dwordx4 v1, s[4:7], s30 offen offset:0  lds
v_mfma_f32_16x16x32_bf16 v[108:111], a[188:191], v[184:187], v[108:111]
s_waitcnt vmcnt(17)
v_mfma_f32_16x16x32_bf16 v[96:99], a[192:195], v[188:191], v[96:99]
v_mfma_f32_16x16x32_bf16 v[100:103], a[196:199], v[188:191], v[100:103]
v_mfma_f32_16x16x32_bf16 v[104:107], a[200:203], v[188:191], v[104:107]
buffer_load_dwordx4 v1, s[4:7], s30 offen offset:1024  lds
v_mfma_f32_16x16x32_bf16 v[108:111], a[204:207], v[188:191], v[108:111]
s_waitcnt lgkmcnt(0)
s_barrier
ds_read_b128 v[64:67], v57 offset:0
ds_read_b128 v[68:71], v57 offset:1024
ds_read_b128 v[72:75], v57 offset:2048
ds_read_b128 v[76:79], v57 offset:3072
s_waitcnt vmcnt(17)
v_mfma_f32_16x16x32_bf16 v[96:99], a[96:99], v[192:195], v[96:99]
v_mfma_f32_16x16x32_bf16 v[100:103], a[100:103], v[192:195], v[100:103]
v_mfma_f32_16x16x32_bf16 v[104:107], a[104:107], v[192:195], v[104:107]
buffer_load_dwordx4 v1, s[4:7], s30 offen offset:2048  lds
v_mfma_f32_16x16x32_bf16 v[108:111], a[108:111], v[192:195], v[108:111]
s_waitcnt vmcnt(15)
v_mfma_f32_16x16x32_bf16 v[96:99], a[208:211], v[196:199], v[96:99]
v_mfma_f32_16x16x32_bf16 v[100:103], a[212:215], v[196:199], v[100:103]
v_mfma_f32_16x16x32_bf16 v[104:107], a[216:219], v[196:199], v[104:107]
buffer_load_dwordx4 v1, s[4:7], s30 offen offset:3072  lds
v_mfma_f32_16x16x32_bf16 v[108:111], a[220:223], v[196:199], v[108:111]
s_waitcnt lgkmcnt(3)
v_mfma_f32_16x16x32_bf16 v[40:43], a[240:243], v[64:67], v[40:43]
s_waitcnt lgkmcnt(2)
v_mfma_f32_16x16x32_bf16 v[44:47], a[240:243], v[68:71], v[44:47]
s_waitcnt lgkmcnt(1)
v_mfma_f32_16x16x32_bf16 v[40:43], a[244:247], v[72:75], v[40:43]
s_waitcnt lgkmcnt(0)
v_mfma_f32_16x16x32_bf16 v[44:47], a[244:247], v[76:79], v[44:47]
s_waitcnt vmcnt(13)
v_mfma_f32_16x16x32_bf16 v[124:127], a[76:79], v[200:203], v[124:127]
v_mfma_f32_16x16x32_bf16 v[120:123], a[72:75], v[200:203], v[120:123]
v_mfma_f32_16x16x32_bf16 v[116:119], a[68:71], v[200:203], v[116:119]
v_mfma_f32_16x16x32_bf16 v[112:115], a[64:67], v[200:203], v[112:115]
s_waitcnt vmcnt(12)
v_mfma_f32_16x16x32_bf16 v[124:127], a[92:95], v[204:207], v[124:127]
v_mfma_f32_16x16x32_bf16 v[120:123], a[88:91], v[204:207], v[120:123]
v_cvt_pk_bf16_f32 v6, v40, v41
v_cvt_pk_bf16_f32 v7, v42, v43
v_cvt_pk_bf16_f32 v8, v44, v45
v_cvt_pk_bf16_f32 v9, v46, v47
s_nop 0
v_permlane16_swap_b32 v6, v8
v_permlane16_swap_b32 v7, v9
buffer_store_dwordx4 v[6:9], v58, s[4:7], s36 offen
v_mfma_f32_16x16x32_bf16 v[116:119], a[84:87], v[204:207], v[116:119]
v_mfma_f32_16x16x32_bf16 v[112:115], a[80:83], v[204:207], v[112:115]
v_cvt_pk_bf16_f32 v96, v96, v97
v_cvt_pk_bf16_f32 v97, v98, v99
v_cvt_pk_bf16_f32 v98, v100, v101
v_cvt_pk_bf16_f32 v99, v102, v103
ds_write_b128 v56, v[96:99] offset:16384
s_waitcnt vmcnt(12)
v_mfma_f32_16x16x32_bf16 v[124:127], a[188:191], v[208:211], v[124:127]
v_mfma_f32_16x16x32_bf16 v[120:123], a[184:187], v[208:211], v[120:123]
v_mfma_f32_16x16x32_bf16 v[116:119], a[180:183], v[208:211], v[116:119]
v_mfma_f32_16x16x32_bf16 v[112:115], a[176:179], v[208:211], v[112:115]
v_cvt_pk_bf16_f32 v104, v104, v105
v_cvt_pk_bf16_f32 v105, v106, v107
v_cvt_pk_bf16_f32 v106, v108, v109
v_cvt_pk_bf16_f32 v107, v110, v111
ds_write_b128 v56, v[104:107] offset:18432
s_waitcnt vmcnt(11)
v_mfma_f32_16x16x32_bf16 v[124:127], a[204:207], v[212:215], v[124:127]
v_mfma_f32_16x16x32_bf16 v[120:123], a[200:203], v[212:215], v[120:123]
v_mfma_f32_16x16x32_bf16 v[116:119], a[196:199], v[212:215], v[116:119]
v_mfma_f32_16x16x32_bf16 v[112:115], a[192:195], v[212:215], v[112:115]
s_waitcnt vmcnt(10)
v_mfma_f32_16x16x32_bf16 v[124:127], a[108:111], v[216:219], v[124:127]
v_mfma_f32_16x16x32_bf16 v[120:123], a[104:107], v[216:219], v[120:123]
v_mfma_f32_16x16x32_bf16 v[116:119], a[100:103], v[216:219], v[116:119]
v_mfma_f32_16x16x32_bf16 v[112:115], a[96:99], v[216:219], v[112:115]
s_waitcnt vmcnt(9)
v_mfma_f32_16x16x32_bf16 v[124:127], a[220:223], v[220:223], v[124:127]
v_mfma_f32_16x16x32_bf16 v[120:123], a[216:219], v[220:223], v[120:123]
v_mfma_f32_16x16x32_bf16 v[116:119], a[212:215], v[220:223], v[116:119]
v_mfma_f32_16x16x32_bf16 v[112:115], a[208:211], v[220:223], v[112:115]
s_nop 5
v_cvt_pk_bf16_f32 v120, v120, v121
v_cvt_pk_bf16_f32 v121, v122, v123
v_cvt_pk_bf16_f32 v122, v124, v125
v_cvt_pk_bf16_f32 v123, v126, v127
ds_write_b128 v56, v[120:123] offset:18688
v_cvt_pk_bf16_f32 v112, v112, v113
v_cvt_pk_bf16_f32 v113, v114, v115
v_cvt_pk_bf16_f32 v114, v116, v117
v_cvt_pk_bf16_f32 v115, v118, v119
ds_write_b128 v56, v[112:115] offset:16640
s_waitcnt lgkmcnt(0)
s_barrier
ds_read_b128 v[96:99], v57 offset:16384
ds_read_b128 v[100:103], v57 offset:17408
ds_read_b128 v[104:107], v57 offset:18432
ds_read_b128 v[108:111], v57 offset:19456
v_dot2_f32_bf16 v60, v6, s22, 0
v_dot2_f32_bf16 v61, v6, v6, 0
v_dot2_f32_bf16 v60, v7, s22, v60
v_dot2_f32_bf16 v61, v7, v7, v61
v_dot2_f32_bf16 v60, v8, s22, v60
v_dot2_f32_bf16 v61, v8, v8, v61
v_dot2_f32_bf16 v60, v9, s22, v60
v_dot2_f32_bf16 v61, v9, v9, v61
v_bfe_u32 v62, v0, 4, 1
v_lshl_add_u32 v62, v62, 11, v59
s_nop 0
v_permlane32_swap_b32 v60, v61
v_add_f32 v60, v60, v61
s_waitcnt lgkmcnt(3)
v_mfma_f32_16x16x32_bf16 v[48:51], a[240:243], v[96:99], v[48:51]
s_waitcnt lgkmcnt(2)
v_mfma_f32_16x16x32_bf16 v[52:55], a[240:243], v[100:103], v[52:55]
s_waitcnt lgkmcnt(1)
v_mfma_f32_16x16x32_bf16 v[48:51], a[244:247], v[104:107], v[48:51]
s_waitcnt lgkmcnt(0)
v_mfma_f32_16x16x32_bf16 v[52:55], a[244:247], v[108:111], v[52:55]
s_nop 5
v_cvt_pk_bf16_f32 v10, v48, v49
v_cvt_pk_bf16_f32 v11, v50, v51
v_cvt_pk_bf16_f32 v12, v52, v53
v_cvt_pk_bf16_f32 v13, v54, v55
v_dot2_f32_bf16 v38, v10, s22, 0
v_dot2_f32_bf16 v39, v10, v10, 0
v_dot2_f32_bf16 v38, v11, s22, v38
v_dot2_f32_bf16 v39, v11, v11, v39
v_dot2_f32_bf16 v38, v12, s22, v38
v_dot2_f32_bf16 v39, v12, v12, v39
v_dot2_f32_bf16 v38, v13, s22, v38
v_dot2_f32_bf16 v39, v13, v13, v39
v_permlane16_swap_b32 v10, v12
v_permlane16_swap_b32 v11, v13
buffer_store_dwordx4 v[10:13], v58, s[4:7], s15 offen
v_permlane32_swap_b32 v38, v39
v_add_f32 v38, v38, v39
s_nop 1
v_permlane16_swap_b32 v60, v38
v_add_f32 v60, v60, v38
s_nop 1
v_add_f32_dpp v60, v60, v60 row_ror:8 row_mask:0xf bank_mask:0xf
s_mov_b32 exec_lo, 0x00ff00ff
s_mov_b32 exec_hi, 0x00ff00ff
buffer_store_dword v60, v62, s[4:7], s37 offen
s_mov_b64 exec, -1
v_lshrrev_b32 v40, 5, v0
v_lshlrev_b32 v40, 10, v40
v_and_b32 v41, 31, v0
v_lshl_add_u32 v40, v41, 3, v40
s_add_u32 s23, s81, 7864320
s_add_u32 s15, s80, 12582912
v_and_b32 v62, 31, v0
v_lshlrev_b32 v62, 2, v62
v_mov_b32 v4, 6
s_waitcnt vmcnt(0)
s_mov_b64 exec, 1
buffer_store_dword v4, off, s[4:7], s76
s_mov_b64 exec, -1
s_barrier
buffer_load_dword v63, v62, s[4:7], s77 offen sc1
ds_read_b128 a[224:227], v1 offset:32768
ds_read_b128 a[228:231], v2 offset:0
ds_read_b128 a[232:235], v1 offset:33792
ds_read_b128 a[236:239], v2 offset:1024
ds_read_b128 a[240:243], v1 offset:34816
ds_read_b128 a[244:247], v2 offset:2048
ds_read_b128 a[248:251], v1 offset:35840
s_waitcnt vmcnt(0)
v_cmp_gt_u32 vcc, 6, v63
s_nop 0
s_cbranch_vccz L_spun_30
L_spin_29:
buffer_load_dword v63, v62, s[4:7], s77 offen sc1
s_sub_u32 s29, s29, 1
s_waitcnt vmcnt(0)
v_cmp_gt_u32 vcc, 6, v63
s_cbranch_scc1 L_spinout_31
s_cbranch_vccnz L_spin_29
L_spun_30:
s_add_u32 s27, s15, 0
buffer_load_dwordx4 v[128:131], v1, s[4:7], s27 offen offset:0 sc1
buffer_load_dwordx4 v[132:135], v1, s[4:7], s27 offen offset:1024 sc1
buffer_load_dwordx4 v[136:139], v1, s[4:7], s27 offen offset:2048 sc1
buffer_load_dwordx4 v[140:143], v1, s[4:7], s27 offen offset:3072 sc1
s_add_u32 s27, s15, 4096
buffer_load_dwordx4 v[144:147], v1, s[4:7], s27 offen offset:0 sc1
buffer_load_dwordx4 v[148:151], v1, s[4:7], s27 offen offset:1024 sc1
buffer_load_dwordx2 v[42:43], v40, s[4:7], s23 offen offset:0 sc1
buffer_load_dwordx2 v[44:45], v40, s[4:7], s23 offen offset:256 sc1
buffer_load_dwordx2 v[46:47], v40, s[4:7], s23 offen offset:512 sc1
buffer_load_dwordx2 v[48:49], v40, s[4:7], s23 offen offset:768 sc1
s_waitcnt vmcnt(9) lgkmcnt(5)
v_mfma_f32_32x32x16_bf16 v[64:79], a[224:227], v[128:131], 0
buffer_load_dwordx4 v[152:155], v1, s[4:7], s27 offen offset:2048 sc1
ds_read_b128 a[252:255], v2 offset:3072
v_mfma_f32_32x32x16_bf16 v[80:95], a[228:231], v[128:131], 0
ds_read_b128 a[224:227], v1 offset:36864
s_waitcnt vmcnt(9) lgkmcnt(5)
v_mfma_f32_32x32x16_bf16 v[64:79], a[232:235], v[132:135], v[64:79]
buffer_load_dwordx4 v[156:159], v1, s[4:7], s27 offen offset:3072 sc1
ds_read_b128 a[228:231], v2 offset:4096
v_mfma_f32_32x32x16_bf16 v[80:95], a[236:239], v[132:135], v[80:95]
ds_read_b128 a[232:235], v1 offset:37888
s_waitcnt vmcnt(9) lgkmcnt(5)
v_mfma_f32_32x32x16_bf16 v[64:79], a[240:243], v[136:139], v[64:79]
s_add_u32 s27, s15, 8192
buffer_load_dwordx4 v[160:163], v1, s[4:7], s27 offen offset:0 sc1
ds_read_b128 a[236:239], v2 offset:5120
v_mfma_f32_32x32x16_bf16 v[80:95], a[244:247], v[136:139], v[80:95]
ds_read_b128 a[240:243], v1 offset:38912
s_waitcnt vmcnt(9) lgkmcnt(5)
v_mfma_f32_32x32x16_bf16 v[64:79], a[248:251], v[140:143], v[64:79]
buffer_load_dwordx4 v[164:167], v1, s[4:7], s27 offen offset:1024 sc1
ds_read_b128 a[244:247], v2 offset:6144
v_mfma_f32_32x32x16_bf16 v[80:95], a[252:255], v[140:143], v[80:95]
ds_read_b128 a[248:251], v1 offset:39936
s_waitcnt vmcnt(9) lgkmcnt(5)
v_mfma_f32_32x32x16_bf16 v[64:79], a[224:227], v[144:147], v[64:79]
buffer_load_dwordx4 v[168:171], v1, s[4:7], s27 offen offset:2048 sc1
ds_read_b128 a[252:255], v2 offset:7168
v_mfma_f32_32x32x16_bf16 v[80:95], a[228:231], v[144:147], v[80:95]
ds_read_b128 a[224:227], v1 offset:40960
s_waitcnt vmcnt(9) lgkmcnt(5)
v_mfma_f32_32x32x16_bf16 v[64:79], a[232:235], v[148:151], v[64:79]
buffer_load_dwordx4 v[172:175], v1, s[4:7], s27 offen offset:3072 sc1
ds_read_b128 a[228:231], v2 offset:8192
v_mfma_f32_32x32x16_bf16 v[80:95], a[236:239], v[148:151], v[80:95]
ds_read_b128 a[232:235], v1 offset:41984
s_waitcnt vmcnt(5) lgkmcnt(5)
v_mfma_f32_32x32x16_bf16 v[64:79], a[240:243], v[152:155], v[64:79]
s_add_u32 s27, s15, 12288
buffer_load_dwordx4 v[176:179], v1, s[4:7], s27 offen offset:0 sc1
ds_read_b128 a[236:239], v2 offset:9216
v_add_f32 v42, v42, v44
v_add_f32 v43, v43, v45
v_mfma_f32_32x32x16_bf16 v[80:95], a[244:247], v[152:155], v[80:95]
ds_read_b128 a[240:243], v1 offset:43008
v_add_f32 v46, v46, v48
v_add_f32 v47, v47, v49
v_add_f32 v42, v42, v46
v_add_f32 v43, v43, v47
s_waitcnt vmcnt(5) lgkmcnt(5)
v_mfma_f32_32x32x16_bf16 v[64:79], a[248:251], v[156:159], v[64:79]
buffer_load_dwordx4 v[180:183], v1, s[4:7], s27 offen offset:1024 sc1
ds_read_b128 a[244:247], v2 offset:10240
v_permlane32_swap_b32 v42, v43
v_add_f32 v42, v42, v43
v_mov_b32 v43, v42
v_mfma_f32_32x32x16_bf16 v[80:95], a[252:255], v[156:159], v[80:95]
ds_read_b128 a[248:251], v1 offset:44032
v_permlane32_swap_b32 v42, v43
v_mul_f32 v42, 0xbb000000, v42
v_mul_f32 v43, 0x3b000000, v43
v_cvt_pk_bf16_f32 v44, v42, v42
s_waitcnt vmcnt(5) lgkmcnt(5)
v_mfma_f32_32x32x16_bf16 v[64:79], a[224:227], v[160:163], v[64:79]
buffer_load_dwordx4 v[184:187], v1, s[4:7], s27 offen offset:2048 sc1
ds_read_b128 a[252:255], v2 offset:11264
v_fma_f32 v43, -v42, v42, v43
v_and_b32 v45, 0xffff0000, v44
v_max_f32 v43, 0, v43
v_mfma_f32_32x32x16_bf16 v[80:95], a[228:231], v[160:163], v[80:95]
ds_read_b128 a[224:227], v1 offset:45056
v_sub_f32 v45, v42, v45
v_add_f32 v50, 0x3727c5ac, v43
v_cvt_pk_bf16_f32 v45, v45, v45
v_rsq_f32 v39, v50
s_waitcnt vmcnt(5) lgkmcnt(5)
v_mfma_f32_32x32x16_bf16 v[64:79], a[232:235], v[164:167], v[64:79]
buffer_load_dwordx4 v[188:191], v1, s[4:7], s27 offen offset:3072 sc1
ds_read_b128 a[228:231], v2 offset:12288
v_cndmask_b32 v32, v45, v44, s[24:25]
v_mov_b32 v37, v32
v_mfma_f32_32x32x16_bf16 v[80:95], a[236:239], v[164:167], v[80:95]
ds_read_b128 a[232:235], v1 offset:46080
v_mfma_f32_32x32x16_bf16 v[64:79], v[22:25], v[32:35], v[64:79]
v_mfma_f32_32x32x16_bf16 v[80:95], v[20:23], v[34:37], v[80:95]
s_waitcnt vmcnt(5) lgkmcnt(5)
v_mfma_f32_32x32x16_bf16 v[64:79], a[240:243], v[168:171], v[64:79]
s_add_u32 s27, s15, 16384
buffer_load_dwordx4 v[192:195], v1, s[4:7], s27 offen offset:0 sc1
ds_read_b128 a[236:239], v2 offset:13312
v_mul_f32 v38, 0x3fb8aa3b, v39
v_and_b32 v51, 31, v0
v_mfma_f32_32x32x16_bf16 v[80:95], a[244:247], v[168:171], v[80:95]
ds_read_b128 a[240:243], v1 offset:47104
v_lshl_add_u32 v51, s3, 5, v51
v_lshlrev_b32 v51, 4, v51
v_lshrrev_b32 v52, 5, v0
v_mul_u32_u24 v52, 2112, v52
s_waitcnt vmcnt(5) lgkmcnt(5)
v_mfma_f32_32x32x16_bf16 v[64:79], a[248:251], v[172:175], v[64:79]
buffer_load_dwordx4 v[196:199], v1, s[4:7], s27 offen offset:1024 sc1
ds_read_b128 a[244:247], v2 offset:14336
v_add_u32 v57, v51, v52
v_add_u32 v56, v57, v52
v_lshrrev_b32 v51, 4, v0
v_mfma_f32_32x32x16_bf16 v[80:95], a[252:255], v[172:175], v[80:95]
ds_read_b128 a[248:251], v1 offset:48128
v_bfe_u32 v52, v0, 2, 2
v_lshl_add_u32 v51, v51, 3, v52
v_lshlrev_b32 v51, 4, v51
v_and_b32 v52, 1, v0
s_waitcnt vmcnt(5) lgkmcnt(5)
v_mfma_f32_32x32x16_bf16 v[64:79], a[224:227], v[176:179], v[64:79]
buffer_load_dwordx4 v[200:203], v1, s[4:7], s27 offen offset:2048 sc1
ds_read_b128 a[252:255], v2 offset:15360
v_lshl_add_u32 v51, v52, 3, v51
v_bfe_u32 v52, v0, 1, 1
v_mul_u32_u24 v52, 2112, v52
v_mfma_f32_32x32x16_bf16 v[80:95], a[228:231], v[176:179], v[80:95]
ds_read_b128 a[224:227], v1 offset:49152
v_add_u32 v51, v51, v52
s_and_b32 s26, s3, 1
s_lshr_b32 s28, s3, 1
s_mul_i32 s36, s26, 4224
s_waitcnt vmcnt(5) lgkmcnt(5)
v_mfma_f32_32x32x16_bf16 v[64:79], a[232:235], v[180:183], v[64:79]
buffer_load_dwordx4 v[204:207], v1, s[4:7], s27 offen offset:3072 sc1
ds_read_b128 a[228:231], v2 offset:16384
s_mul_i32 s37, s28, 4224
v_add_u32 v59, s36, v51
s_add_u32 s37, s37, s36
v_mfma_f32_32x32x16_bf16 v[80:95], a[236:239], v[180:183], v[80:95]
ds_read_b128 a[232:235], v1 offset:50176
v_add_u32 v58, s37, v59
s_lshl_b32 s26, s26, 11
s_lshl_b32 s28, s28, 9
s_add_u32 s26, s26, s28
s_waitcnt vmcnt(5) lgkmcnt(5)
v_mfma_f32_32x32x16_bf16 v[64:79], a[240:243], v[184:187], v[64:79]
s_add_u32 s27, s15, 20480
buffer_load_dwordx4 v[208:211], v1, s[4:7], s27 offen offset:0 sc1
ds_read_b128 a[236:239], v2 offset:17408
v_and_b32 v51, 15, v0
v_lshlrev_b32 v51, 4, v51
v_mfma_f32_32x32x16_bf16 v[80:95], a[244:247], v[184:187], v[80:95]
ds_read_b128 a[240:243], v1 offset:51200
v_bfe_u32 v52, v0, 4, 1
v_lshl_add_u32 v51, v52, 3, v51
v_lshrrev_b32 v52, 5, v0
v_lshl_add_u32 v51, v52, 10, v51
s_waitcnt vmcnt(5) lgkmcnt(5)
v_mfma_f32_32x32x16_bf16 v[64:79], a[248:251], v[188:191], v[64:79]
buffer_load_dwordx4 v[212:215], v1, s[4:7], s27 offen offset:1024 sc1
ds_read_b128 a[244:247], v2 offset:18432
v_add_u32 v61, s26, v51
v_and_b32 v51, 1, v0
v_lshl_add_u32 v51, v51, 1, v52
v_mfma_f32_32x32x16_bf16 v[80:95], a[252:255], v[188:191], v[80:95]
ds_read_b128 a[248:251], v1 offset:52224
v_bfe_u32 v52, v0, 1, 1
v_lshl_add_u32 v51, v52, 3, v51
v_bfe_u32 v52, v0, 2, 1
v_lshl_add_u32 v51, v52, 2, v51
s_waitcnt vmcnt(5) lgkmcnt(5)
v_mfma_f32_32x32x16_bf16 v[64:79], a[224:227], v[192:195], v[64:79]
buffer_load_dwordx4 v[216:219], v1, s[4:7], s27 offen offset:2048 sc1
ds_read_b128 a[252:255], v2 offset:19456
v_lshlrev_b32 v51, 4, v51
v_bfe_u32 v52, v0, 3, 1
v_lshl_add_u32 v51, v52, 3, v51
v_mfma_f32_32x32x16_bf16 v[80:95], a[228:231], v[192:195], v[80:95]
ds_read_b128 a[224:227], v1 offset:53248
v_bfe_u32 v52, v0, 4, 1
v_lshl_add_u32 v51, v52, 10, v51
v_add_u32 v60, s26, v51
v_and_b32 v62, 0x30, v0
s_waitcnt vmcnt(5) lgkmcnt(5)
v_mfma_f32_32x32x16_bf16 v[64:79], a[232:235], v[196:199], v[64:79]
buffer_load_dwordx4 v[220:223], v1, s[4:7], s27 offen offset:3072 sc1
ds_read_b128 a[228:231], v2 offset:20480
v_lshlrev_b32 v63, 3, v0
s_add_u32 s36, s86, 9043968
s_add_u32 s37, s31, 9568256
v_mfma_f32_32x32x16_bf16 v[80:95], a[236:239], v[196:199], v[80:95]
ds_read_b128 a[232:235], v1 offset:54272
s_lshl_b32 s26, s16, 9
s_add_u32 s26, s26, s36
s_lshl_b32 s28, s16, 6
s_add_u32 s28, s28, s37
s_waitcnt vmcnt(5) lgkmcnt(5)
v_mfma_f32_32x32x16_bf16 v[64:79], a[240:243], v[200:203], v[64:79]
s_add_u32 s27, s15, 24576
buffer_load_dwordx4 v[224:227], v1, s[4:7], s27 offen offset:0 sc1
ds_read_b128 a[236:239], v2 offset:21504
v_mov_b32 v44, s22
v_mov_b32 v45, s22
v_mfma_f32_32x32x16_bf16 v[80:95], a[244:247], v[200:203], v[80:95]
ds_read_b128 a[240:243], v1 offset:55296
v_mov_b32 v46, s22
v_mov_b32 v47, s22
s_waitcnt vmcnt(5) lgkmcnt(5)
v_mfma_f32_32x32x16_bf16 v[64:79], a[248:251], v[204:207], v[64:79]
buffer_load_dwordx4 v[228:231], v1, s[4:7], s27 offen offset:1024 sc1
ds_read_b128 a[244:247], v2 offset:22528
v_mfma_f32_32x32x16_bf16 v[80:95], a[252:255], v[204:207], v[80:95]
ds_read_b128 a[248:251], v1 offset:56320
s_waitcnt vmcnt(5) lgkmcnt(5)
v_mfma_f32_32x32x16_bf16 v[64:79], a[224:227], v[208:211], v[64:79]
buffer_load_dwordx4 v[232:235], v1, s[4:7], s27 offen offset:2048 sc1
ds_read_b128 a[252:255], v2 offset:23552
v_mfma_f32_32x32x16_bf16 v[80:95], a[228:231], v[208:211], v[80:95]
ds_read_b128 a[224:227], v1 offset:57344
s_waitcnt vmcnt(5) lgkmcnt(5)
v_mfma_f32_32x32x16_bf16 v[64:79], a[232:235], v[212:215], v[64:79]
buffer_load_dwordx4 v[236:239], v1, s[4:7], s27 offen offset:3072 sc1
ds_read_b128 a[228:231], v2 offset:24576
v_mfma_f32_32x32x16_bf16 v[80:95], a[236:239], v[212:215], v[80:95]
ds_read_b128 a[232:235], v1 offset:58368
s_waitcnt vmcnt(5) lgkmcnt(5)
v_mfma_f32_32x32x16_bf16 v[64:79], a[240:243], v[216:219], v[64:79]
s_add_u32 s27, s15, 28672
buffer_load_dwordx4 v[240:243], v1, s[4:7], s27 offen offset:0 sc1
ds_read_b128 a[236:239], v2 offset:25600
v_mfma_f32_32x32x16_bf16 v[80:95], a[244:247], v[216:219], v[80:95]
ds_read_b128 a[240:243], v1 offset:59392
s_waitcnt vmcnt(5) lgkmcnt(5)
v_mfma_f32_32x32x16_bf16 v[64:79], a[248:251], v[220:223], v[64:79]
buffer_load_dwordx4 v[244:247], v1, s[4:7], s27 offen offset:1024 sc1
ds_read_b128 a[244:247], v2 offset:26624
v_mfma_f32_32x32x16_bf16 v[80:95], a[252:255], v[220:223], v[80:95]
ds_read_b128 a[248:251], v1 offset:60416
s_waitcnt vmcnt(5) lgkmcnt(5)
v_mfma_f32_32x32x16_bf16 v[64:79], a[224:227], v[224:227], v[64:79]
buffer_load_dwordx4 v[248:251], v1, s[4:7], s27 offen offset:2048 sc1
ds_read_b128 a[252:255], v2 offset:27648
v_mfma_f32_32x32x16_bf16 v[80:95], a[228:231], v[224:227], v[80:95]
ds_read_b128 a[224:227], v1 offset:61440
s_waitcnt vmcnt(5) lgkmcnt(5)
v_mfma_f32_32x32x16_bf16 v[64:79], a[232:235], v[228:231], v[64:79]
buffer_load_dwordx4 v[252:255], v1, s[4:7], s27 offen offset:3072 sc1
ds_read_b128 a[228:231], v2 offset:28672
v_mfma_f32_32x32x16_bf16 v[80:95], a[236:239], v[228:231], v[80:95]
ds_read_b128 a[232:235], v1 offset:62464
s_waitcnt vmcnt(5) lgkmcnt(5)
v_mfma_f32_32x32x16_bf16 v[64:79], a[240:243], v[232:235], v[64:79]
ds_read_b128 a[236:239], v2 offset:29696
v_mfma_f32_32x32x16_bf16 v[80:95], a[244:247], v[232:235], v[80:95]
ds_read_b128 a[240:243], v1 offset:63488
s_waitcnt vmcnt(4) lgkmcnt(5)
v_mfma_f32_32x32x16_bf16 v[64:79], a[248:251], v[236:239], v[64:79]
ds_read_b128 a[244:247], v2 offset:30720
v_mfma_f32_32x32x16_bf16 v[80:95], a[252:255], v[236:239], v[80:95]
ds_read_b128 a[248:251], v1 offset:64512
s_waitcnt vmcnt(3) lgkmcnt(5)
v_mfma_f32_32x32x16_bf16 v[64:79], a[224:227], v[240:243], v[64:79]
ds_read_b128 a[252:255], v2 offset:31744
v_mfma_f32_32x32x16_bf16 v[80:95], a[228:231], v[240:243], v[80:95]
s_waitcnt vmcnt(2) lgkmcnt(4)
v_mfma_f32_32x32x16_bf16 v[64:79], a[232:235], v[244:247], v[64:79]
v_mfma_f32_32x32x16_bf16 v[80:95], a[236:239], v[244:247], v[80:95]
s_waitcnt vmcnt(1) lgkmcnt(2)
v_mfma_f32_32x32x16_bf16 v[64:79], a[240:243], v[248:251], v[64:79]
v_mfma_f32_32x32x16_bf16 v[80:95], a[244:247], v[248:251], v[80:95]
s_waitcnt vmcnt(0) lgkmcnt(0)
v_mfma_f32_32x32x16_bf16 v[64:79], a[248:251], v[252:255], v[64:79]
v_mfma_f32_32x32x16_bf16 v[80:95], a[252:255], v[252:255], v[80:95]
s_barrier
L_here_32:
s_add_u32 s99, s13, L_here_32-L_pc+2048
buffer_load_dword v5, off, s[92:95], s99
s_add_u32 m0, s21, 32768
s_add_u32 s30, s20, 65536
buffer_load_dwordx4 v1, s[4:7], s30 offen offset:0  lds
buffer_load_dwordx4 v1, s[4:7], s30 offen offset:1024  lds
s_nop 3
v_cvt_pk_bf16_f32 v48, v64, v65
v_cvt_pk_bf16_f32 v49, v66, v67
v_cvt_pk_bf16_f32 v50, v68, v69
v_cvt_pk_bf16_f32 v51, v70, v71
v_cvt_pk_bf16_f32 v52, v72, v73
v_cvt_pk_bf16_f32 v53, v74, v75
v_cvt_pk_bf16_f32 v54, v76, v77
v_cvt_pk_bf16_f32 v55, v78, v79
v_mfma_f32_32x32x16_bf16 v[96:111], v[14:17], v[48:51], 0
s_nop 0
v_mfma_f32_32x32x16_bf16 v[112:127], v[18:21], v[52:55], 0
v_mul_f32 v80, v39, v80
buffer_load_dwordx4 v1, s[4:7], s30 offen offset:2048  lds
v_mul_f32 v81, v39, v81
v_mul_f32 v82, v39, v82
v_mul_f32 v83, v39, v83
v_mul_f32 v84, v39, v84
v_mul_f32 v85, v39, v85
v_mul_f32 v86, v39, v86
v_mul_f32 v87, v39, v87
v_mul_f32 v88, v39, v88
v_mul_f32 v89, v39, v89
v_mul_f32 v90, v39, v90
v_mul_f32 v91, v39, v91
buffer_load_dwordx4 v1, s[4:7], s30 offen offset:3072  lds
v_mul_f32 v92, v39, v92
v_mul_f32 v93, v39, v93
v_mul_f32 v94, v39, v94
v_mul_f32 v95, v39, v95
v_cvt_pk_bf16_f32 v80, v80, v81
v_cvt_pk_bf16_f32 v81, v82, v83
v_cvt_pk_bf16_f32 v82, v84, v85
v_cvt_pk_bf16_f32 v83, v86, v87
v_cvt_pk_bf16_f32 v84, v88, v89
v_cvt_pk_bf16_f32 v85, v90, v91
v_cvt_pk_bf16_f32 v86, v92, v93
s_add_u32 m0, s21, 36864
s_add_u32 s30, s20, 69632
buffer_load_dwordx4 v1, s[4:7], s30 offen offset:0  lds
v_cvt_pk_bf16_f32 v87, v94, v95
ds_write_b128 v57, v[80:83] offset:16896
ds_write_b128 v57, v[84:87] offset:21120
v_max3_f32 v40, v96, v97, v98
v_max3_f32 v42, v112, v113, v114
v_max3_f32 v40, v40, v99, v100
v_max3_f32 v42, v42, v115, v116
v_max3_f32 v40, v40, v101, v102
v_max3_f32 v42, v42, v117, v118
buffer_load_dwordx4 v1, s[4:7], s30 offen offset:1024  lds
v_max3_f32 v40, v40, v103, v104
v_max3_f32 v42, v42, v119, v120
v_max3_f32 v40, v40, v105, v106
v_max3_f32 v42, v42, v121, v122
v_max3_f32 v40, v40, v107, v108
v_max3_f32 v42, v42, v123, v124
v_max3_f32 v40, v40, v109, v110
v_max3_f32 v42, v42, v125, v126
v_max_f32 v40, v40, v111
v_max_f32 v42, v42, v127
v_mul_f32 v40, -v40, v38
buffer_load_dwordx4 v1, s[4:7], s30 offen offset:2048  lds
v_mul_f32 v42, -v42, v38
v_pk_fma_f32 v[96:97], v[96:97], v[38:39], v[40:41] op_sel_hi:[1,0,0]
v_pk_fma_f32 v[112:113], v[112:113], v[38:39], v[42:43] op_sel_hi:[1,0,0]
v_pk_fma_f32 v[98:99], v[98:99], v[38:39], v[40:41] op_sel_hi:[1,0,0]
v_pk_fma_f32 v[114:115], v[114:115], v[38:39], v[42:43] op_sel_hi:[1,0,0]
v_pk_fma_f32 v[100:101], v[100:101], v[38:39], v[40:41] op_sel_hi:[1,0,0]
v_pk_fma_f32 v[116:117], v[116:117], v[38:39], v[42:43] op_sel_hi:[1,0,0]
v_pk_fma_f32 v[102:103], v[102:103], v[38:39], v[40:41] op_sel_hi:[1,0,0]
v_pk_fma_f32 v[118:119], v[118:119], v[38:39], v[42:43] op_sel_hi:[1,0,0]
v_pk_fma_f32 v[104:105], v[104:105], v[38:39], v[40:41] op_sel_hi:[1,0,0]
v_pk_fma_f32 v[120:121], v[120:121], v[38:39], v[42:43] op_sel_hi:[1,0,0]
buffer_load_dwordx4 v1, s[4:7], s30 offen offset:3072  lds
v_pk_fma_f32 v[106:107], v[106:107], v[38:39], v[40:41] op_sel_hi:[1,0,0]
v_pk_fma_f32 v[122:123], v[122:123], v[38:39], v[42:43] op_sel_hi:[1,0,0]
v_pk_fma_f32 v[108:109], v[108:109], v[38:39], v[40:41] op_sel_hi:[1,0,0]
v_pk_fma_f32 v[124:125], v[124:125], v[38:39], v[42:43] op_sel_hi:[1,0,0]
v_pk_fma_f32 v[110:111], v[110:111], v[38:39], v[40:41] op_sel_hi:[1,0,0]
v_pk_fma_f32 v[126:127], v[126:127], v[38:39], v[42:43] op_sel_hi:[1,0,0]
v_exp_f32 v96, v96
v_exp_f32 v112, v112
v_exp_f32 v97, v97
v_exp_f32 v113, v113
v_exp_f32 v98, v98
v_exp_f32 v114, v114
v_exp_f32 v99, v99
v_exp_f32 v115, v115
v_exp_f32 v100, v100
v_exp_f32 v116, v116
v_exp_f32 v101, v101
v_exp_f32 v117, v117
v_exp_f32 v102, v102
v_exp_f32 v118, v118
v_exp_f32 v103, v103
v_exp_f32 v119, v119
v_exp_f32 v104, v104
v_exp_f32 v120, v120
v_exp_f32 v105, v105
v_exp_f32 v121, v121
v_exp_f32 v106, v106
v_exp_f32 v122, v122
s_lshr_b32 s96, s16, 3
s_lshl_b32 s96, s96, 1
s_add_u32 s96, s96, s18
s_lshl_b32 s96, s96, 12
s_add_u32 s97, s96, s85
buffer_load_dword v5, v1, s[4:7], s97 offen offset:0
v_exp_f32 v107, v107
v_exp_f32 v123, v123
v_exp_f32 v108, v108
buffer_load_dword v5, v1, s[4:7], s97 offen offset:1024
v_exp_f32 v124, v124
v_exp_f32 v109, v109
v_exp_f32 v125, v125
v_exp_f32 v110, v110
v_exp_f32 v126, v126
v_exp_f32 v111, v111
buffer_load_dword v5, v1, s[4:7], s97 offen offset:2048
v_exp_f32 v127, v127
v_pk_add_f32 v[40:41], v[96:97], v[98:99]
v_pk_add_f32 v[42:43], v[112:113], v[114:115]
v_pk_add_f32 v[40:41], v[40:41], v[100:101]
v_pk_add_f32 v[42:43], v[42:43], v[116:117]
v_pk_add_f32 v[40:41], v[40:41], v[102:103]
v_pk_add_f32 v[42:43], v[42:43], v[118:119]
v_pk_add_f32 v[40:41], v[40:41], v[104:105]
v_pk_add_f32 v[42:43], v[42:43], v[120:121]
v_pk_add_f32 v[40:41], v[40:41], v[106:107]
buffer_load_dword v5, v1, s[4:7], s97 offen offset:3072
v_pk_add_f32 v[42:43], v[42:43], v[122:123]
v_pk_add_f32 v[40:41], v[40:41], v[108:109]
v_pk_add_f32 v[42:43], v[42:43], v[124:125]
v_pk_add_f32 v[40:41], v[40:41], v[110:111]
v_pk_add_f32 v[42:43], v[42:43], v[126:127]
v_add_f32 v40, v40, v41
v_add_f32 v42, v42, v43
v_rcp_f32 v40, v40
v_rcp_f32 v42, v42
v_pk_mul_f32 v[96:97], v[96:97], v[40:41] op_sel_hi:[1,0]
v_pk_mul_f32 v[98:99], v[98:99], v[40:41] op_sel_hi:[1,0]
v_pk_mul_f32 v[100:101], v[100:101], v[40:41] op_sel_hi:[1,0]
v_pk_mul_f32 v[102:103], v[102:103], v[40:41] op_sel_hi:[1,0]
v_pk_mul_f32 v[104:105], v[104:105], v[40:41] op_sel_hi:[1,0]
v_pk_mul_f32 v[106:107], v[106:107], v[40:41] op_sel_hi:[1,0]
v_pk_mul_f32 v[108:109], v[108:109], v[40:41] op_sel_hi:[1,0]
v_pk_mul_f32 v[110:111], v[110:111], v[40:41] op_sel_hi:[1,0]
v_cvt_pk_bf16_f32 v64, v96, v97
v_cvt_pk_bf16_f32 v65, v98, v99
v_cvt_pk_bf16_f32 v66, v100, v101
v_cvt_pk_bf16_f32 v67, v102, v103
ds_write_b128 v56, v[64:67] offset:0
v_cvt_pk_bf16_f32 v68, v104, v105
v_cvt_pk_bf16_f32 v69, v106, v107
v_cvt_pk_bf16_f32 v70, v108, v109
v_cvt_pk_bf16_f32 v71, v110, v111
ds_write_b128 v56, v[68:71] offset:2112
v_pk_mul_f32 v[112:113], v[112:113], v[42:43] op_sel_hi:[1,0]
v_pk_mul_f32 v[114:115], v[114:115], v[42:43] op_sel_hi:[1,0]
v_pk_mul_f32 v[116:117], v[116:117], v[42:43] op_sel_hi:[1,0]
v_pk_mul_f32 v[118:119], v[118:119], v[42:43] op_sel_hi:[1,0]
v_pk_mul_f32 v[120:121], v[120:121], v[42:43] op_sel_hi:[1,0]
v_pk_mul_f32 v[122:123], v[122:123], v[42:43] op_sel_hi:[1,0]
v_pk_mul_f32 v[124:125], v[124:125], v[42:43] op_sel_hi:[1,0]
v_pk_mul_f32 v[126:127], v[126:127], v[42:43] op_sel_hi:[1,0]
v_cvt_pk_bf16_f32 v72, v112, v113
v_cvt_pk_bf16_f32 v73, v114, v115
v_cvt_pk_bf16_f32 v74, v116, v117
v_cvt_pk_bf16_f32 v75, v118, v119
ds_write_b128 v56, v[72:75] offset:8448
v_cvt_pk_bf16_f32 v76, v120, v121
v_cvt_pk_bf16_f32 v77, v122, v123
v_cvt_pk_bf16_f32 v78, v124, v125
v_cvt_pk_bf16_f32 v79, v126, v127
ds_write_b128 v56, v[76:79] offset:10560
s_waitcnt vmcnt(4) lgkmcnt(0)
s_barrier
ds_read_b64_tr_b16 v[64:65], v58 offset:0
ds_read_b64_tr_b16 v[66:67], v58 offset:64
ds_read_b64_tr_b16 v[80:81], v59 offset:16896
ds_read_b64_tr_b16 v[82:83], v59 offset:16960
ds_read_b64_tr_b16 v[68:69], v58 offset:512
ds_read_b64_tr_b16 v[70:71], v58 offset:576
ds_read_b64_tr_b16 v[84:85], v59 offset:17408
ds_read_b64_tr_b16 v[86:87], v59 offset:17472
ds_read_b64_tr_b16 v[72:73], v58 offset:1024
ds_read_b64_tr_b16 v[74:75], v58 offset:1088
ds_read_b64_tr_b16 v[88:89], v59 offset:17920
ds_read_b64_tr_b16 v[90:91], v59 offset:17984
ds_read_b64_tr_b16 v[76:77], v58 offset:1536
ds_read_b64_tr_b16 v[78:79], v58 offset:1600
ds_read_b64_tr_b16 v[92:93], v59 offset:18432
ds_read_b64_tr_b16 v[94:95], v59 offset:18496
s_waitcnt lgkmcnt(12)
v_mfma_f32_16x16x32_bf16 v[96:99], v[64:67], v[80:83], 0
v_mfma_f32_16x16x32_bf16 v[100:103], v[64:67], v[44:47], 0
s_waitcnt lgkmcnt(8)
v_mfma_f32_16x16x32_bf16 v[96:99], v[68:71], v[84:87], v[96:99]
v_mfma_f32_16x16x32_bf16 v[100:103], v[68:71], v[44:47], v[100:103]
s_waitcnt lgkmcnt(4)
v_mfma_f32_16x16x32_bf16 v[96:99], v[72:75], v[88:91], v[96:99]
v_mfma_f32_16x16x32_bf16 v[100:103], v[72:75], v[44:47], v[100:103]
s_waitcnt lgkmcnt(0)
v_mfma_f32_16x16x32_bf16 v[96:99], v[76:79], v[92:95], v[96:99]
v_mfma_f32_16x16x32_bf16 v[100:103], v[76:79], v[44:47], v[100:103]
ds_read_b128 a[224:227], v1 offset:32768
ds_read_b128 a[228:231], v1 offset:33792
ds_read_b128 a[232:235], v1 offset:34816
ds_read_b128 a[236:239], v1 offset:35840
ds_read_b128 a[240:243], v1 offset:36864
ds_read_b128 a[244:247], v1 offset:37888
ds_read_b128 a[248:251], v1 offset:38912
v_cvt_pk_bf16_f32 v96, v96, v97
v_cvt_pk_bf16_f32 v97, v98, v99
buffer_store_dwordx2 v[96:97], v63, s[4:7], s26 offen sc1
s_mov_b32 exec_lo, 0x00010001
s_mov_b32 exec_hi, 0x00010001
buffer_store_dwordx4 v[100:103], v62, s[4:7], s28 offen sc1
s_mov_b64 exec, -1
v_mfma_f32_32x32x16_bf16 v[112:127], v[24:27], v[32:35], 0
s_waitcnt lgkmcnt(3)
v_mfma_f32_32x32x16_bf16 v[112:127], a[224:227], v[128:131], v[112:127]
ds_read_b128 a[252:255], v1 offset:39936
s_add_u32 m0, s21, 65536
s_add_u32 s30, s20, 294912
buffer_load_dwordx4 v1, s[4:7], s30 offen offset:0  lds
v_mfma_f32_32x32x16_bf16 v[112:127], a[228:231], v[132:135], v[112:127]
ds_read_b128 a[224:227], v1 offset:40960
v_mfma_f32_32x32x16_bf16 v[112:127], a[232:235], v[136:139], v[112:127]
ds_read_b128 a[228:231], v1 offset:41984
buffer_load_dwordx4 v1, s[4:7], s30 offen offset:1024  lds
v_and_b32 v51, 15, v0
v_lshl_add_u32 v62, v51, 6, v62
v_and_b32 v51, 31, v0
v_mfma_f32_32x32x16_bf16 v[112:127], a[236:239], v[140:143], v[112:127]
ds_read_b128 a[232:235], v1 offset:43008
v_and_b32 v52, 1, v0
v_lshlrev_b32 v52, 4, v52
v_mov_b32 v53, 0x3f80
v_lshlrev_b32 v52, v52, v53
s_waitcnt lgkmcnt(3)
v_mfma_f32_32x32x16_bf16 v[112:127], a[240:243], v[144:147], v[112:127]
ds_read_b128 a[236:239], v1 offset:44032
buffer_load_dwordx4 v1, s[4:7], s30 offen offset:2048  lds
v_lshrrev_b32 v51, 1, v51
s_add_u32 s28, s38, 20971520
v_bfe_u32 v54, v0, 4, 1
v_mfma_f32_32x32x16_bf16 v[112:127], a[244:247], v[148:151], v[112:127]
ds_read_b128 a[240:243], v1 offset:45056
v_lshlrev_b32 v63, 10, v54
v_lshrrev_b32 v54, 5, v0
v_lshl_add_u32 v63, v54, 8, v63
v_and_b32 v54, 15, v0
v_mfma_f32_32x32x16_bf16 v[112:127], a[248:251], v[152:155], v[112:127]
ds_read_b128 a[244:247], v1 offset:46080
buffer_load_dwordx4 v1, s[4:7], s30 offen offset:3072  lds
v_lshl_add_u32 v63, v54, 4, v63
v_cmp_eq_u32 vcc, 0, v51
s_nop 1
v_mfma_f32_32x32x16_bf16 v[112:127], a[252:255], v[156:159], v[112:127]
ds_read_b128 a[248:251], v1 offset:47104
v_cndmask_b32 v44, 0, v52, vcc
v_cmp_eq_u32 vcc, 1, v51
s_nop 1
v_cndmask_b32 v45, 0, v52, vcc
s_waitcnt lgkmcnt(3)
v_mfma_f32_32x32x16_bf16 v[112:127], a[224:227], v[160:163], v[112:127]
ds_read_b128 a[252:255], v1 offset:48128
s_add_u32 m0, s21, 69632
s_add_u32 s30, s20, 299008
buffer_load_dwordx4 v1, s[4:7], s30 offen offset:0  lds
v_cmp_eq_u32 vcc, 2, v51
v_mfma_f32_32x32x16_bf16 v[112:127], a[228:231], v[164:167], v[112:127]
ds_read_b128 a[224:227], v1 offset:49152
s_nop 1
v_cndmask_b32 v46, 0, v52, vcc
v_cmp_eq_u32 vcc, 3, v51
s_nop 1
v_mfma_f32_32x32x16_bf16 v[112:127], a[232:235], v[168:171], v[112:127]
ds_read_b128 a[228:231], v1 offset:50176
buffer_load_dwordx4 v1, s[4:7], s30 offen offset:1024  lds
v_cndmask_b32 v47, 0, v52, vcc
v_mfma_f32_32x32x16_bf16 v[112:127], a[236:239], v[172:175], v[112:127]
ds_read_b128 a[232:235], v1 offset:51200
s_waitcnt lgkmcnt(3)
v_mfma_f32_32x32x16_bf16 v[112:127], a[240:243], v[176:179], v[112:127]
ds_read_b128 a[236:239], v1 offset:52224
buffer_load_dwordx4 v1, s[4:7], s30 offen offset:2048  lds
v_mfma_f32_32x32x16_bf16 v[112:127], a[244:247], v[180:183], v[112:127]
ds_read_b128 a[240:243], v1 offset:53248
v_mfma_f32_32x32x16_bf16 v[112:127], a[248:251], v[184:187], v[112:127]
ds_read_b128 a[244:247], v1 offset:54272
buffer_load_dwordx4 v1, s[4:7], s30 offen offset:3072  lds
v_mfma_f32_32x32x16_bf16 v[112:127], a[252:255], v[188:191], v[112:127]
ds_read_b128 a[248:251], v1 offset:55296
s_waitcnt lgkmcnt(3)
v_mfma_f32_32x32x16_bf16 v[112:127], a[224:227], v[192:195], v[112:127]
ds_read_b128 a[252:255], v1 offset:56320
s_add_u32 s27, s85, 0
buffer_load_dwordx4 v[128:131], v1, s[4:7], s27 offen offset:0
v_mfma_f32_32x32x16_bf16 v[112:127], a[228:231], v[196:199], v[112:127]
ds_read_b128 a[224:227], v1 offset:57344
v_mfma_f32_32x32x16_bf16 v[112:127], a[232:235], v[200:203], v[112:127]
ds_read_b128 a[228:231], v1 offset:58368
buffer_load_dwordx4 v[132:135], v1, s[4:7], s27 offen offset:1024
v_mfma_f32_32x32x16_bf16 v[112:127], a[236:239], v[204:207], v[112:127]
ds_read_b128 a[232:235], v1 offset:59392
s_waitcnt lgkmcnt(3)
v_mfma_f32_32x32x16_bf16 v[112:127], a[240:243], v[208:211], v[112:127]
ds_read_b128 a[236:239], v1 offset:60416
buffer_load_dwordx4 v[136:139], v1, s[4:7], s27 offen offset:2048
v_mfma_f32_32x32x16_bf16 v[112:127], a[244:247], v[212:215], v[112:127]
ds_read_b128 a[240:243], v1 offset:61440
v_mfma_f32_32x32x16_bf16 v[112:127], a[248:251], v[216:219], v[112:127]
ds_read_b128 a[244:247], v1 offset:62464
buffer_load_dwordx4 v[140:143], v1, s[4:7], s27 offen offset:3072
v_mfma_f32_32x32x16_bf16 v[112:127], a[252:255], v[220:223], v[112:127]
ds_read_b128 a[248:251], v1 offset:63488
s_waitcnt lgkmcnt(3)
v_mfma_f32_32x32x16_bf16 v[112:127], a[224:227], v[224:227], v[112:127]
ds_read_b128 a[252:255], v1 offset:64512
s_add_u32 s27, s85, 4096
buffer_load_dwordx4 v[144:147], v1, s[4:7], s27 offen offset:0
v_mfma_f32_32x32x16_bf16 v[112:127], a[228:231], v[228:231], v[112:127]
v_mfma_f32_32x32x16_bf16 v[112:127], a[232:235], v[232:235], v[112:127]
buffer_load_dwordx4 v[148:151], v1, s[4:7], s27 offen offset:1024
v_mfma_f32_32x32x16_bf16 v[112:127], a[236:239], v[236:239], v[112:127]
s_waitcnt lgkmcnt(0)
v_mfma_f32_32x32x16_bf16 v[112:127], a[240:243], v[240:243], v[112:127]
buffer_load_dwordx4 v[152:155], v1, s[4:7], s27 offen offset:2048
v_mfma_f32_32x32x16_bf16 v[112:127], a[244:247], v[244:247], v[112:127]
v_mfma_f32_32x32x16_bf16 v[112:127], a[248:251], v[248:251], v[112:127]
buffer_load_dwordx4 v[156:159], v1, s[4:7], s27 offen offset:3072
v_mfma_f32_32x32x16_bf16 v[112:127], a[252:255], v[252:255], v[112:127]
s_nop 11
v_cvt_pk_bf16_f32 v48, v112, v113
v_cvt_pk_bf16_f32 v49, v114, v115
v_cvt_pk_bf16_f32 v50, v116, v117
v_cvt_pk_bf16_f32 v51, v118, v119
v_cvt_pk_bf16_f32 v52, v120, v121
v_cvt_pk_bf16_f32 v53, v122, v123
v_cvt_pk_bf16_f32 v54, v124, v125
v_cvt_pk_bf16_f32 v55, v126, v127
v_mfma_f32_32x32x16_bf16 v[64:79], v[14:17], v[48:51], 0
s_nop 0
v_mfma_f32_32x32x16_bf16 v[80:95], v[18:21], v[52:55], 0
s_nop 9
v_max3_f32 v40, v64, v65, v66
s_nop 0
v_max3_f32 v42, v80, v81, v82
v_max3_f32 v40, v40, v67, v68
v_max3_f32 v42, v42, v83, v84
v_max3_f32 v40, v40, v69, v70
v_max3_f32 v42, v42, v85, v86
buffer_load_dwordx4 v[224:227], v62, s[4:7], s37 offen sc1
v_max3_f32 v40, v40, v71, v72
v_max3_f32 v42, v42, v87, v88
v_max3_f32 v40, v40, v73, v74
v_max3_f32 v42, v42, v89, v90
v_max3_f32 v40, v40, v75, v76
v_max3_f32 v42, v42, v91, v92
v_max3_f32 v40, v40, v77, v78
v_max3_f32 v42, v42, v93, v94
v_max_f32 v40, v40, v79
v_max_f32 v42, v42, v95
v_mul_f32 v40, -v40, v38
v_mul_f32 v42, -v42, v38
v_pk_fma_f32 v[64:65], v[64:65], v[38:39], v[40:41] op_sel_hi:[1,0,0]
v_pk_fma_f32 v[80:81], v[80:81], v[38:39], v[42:43] op_sel_hi:[1,0,0]
v_pk_fma_f32 v[66:67], v[66:67], v[38:39], v[40:41] op_sel_hi:[1,0,0]
s_add_u32 s23, s36, 0
buffer_load_dwordx4 v[192:195], v1, s[4:7], s23 offen offset:0 sc1
v_pk_fma_f32 v[82:83], v[82:83], v[38:39], v[42:43] op_sel_hi:[1,0,0]
v_pk_fma_f32 v[68:69], v[68:69], v[38:39], v[40:41] op_sel_hi:[1,0,0]
v_pk_fma_f32 v[84:85], v[84:85], v[38:39], v[42:43] op_sel_hi:[1,0,0]
v_pk_fma_f32 v[70:71], v[70:71], v[38:39], v[40:41] op_sel_hi:[1,0,0]
v_pk_fma_f32 v[86:87], v[86:87], v[38:39], v[42:43] op_sel_hi:[1,0,0]
v_pk_fma_f32 v[72:73], v[72:73], v[38:39], v[40:41] op_sel_hi:[1,0,0]
v_pk_fma_f32 v[88:89], v[88:89], v[38:39], v[42:43] op_sel_hi:[1,0,0]
v_pk_fma_f32 v[74:75], v[74:75], v[38:39], v[40:41] op_sel_hi:[1,0,0]
v_pk_fma_f32 v[90:91], v[90:91], v[38:39], v[42:43] op_sel_hi:[1,0,0]
v_pk_fma_f32 v[76:77], v[76:77], v[38:39], v[40:41] op_sel_hi:[1,0,0]
v_pk_fma_f32 v[92:93], v[92:93], v[38:39], v[42:43] op_sel_hi:[1,0,0]
v_pk_fma_f32 v[78:79], v[78:79], v[38:39], v[40:41] op_sel_hi:[1,0,0]
v_pk_fma_f32 v[94:95], v[94:95], v[38:39], v[42:43] op_sel_hi:[1,0,0]
v_exp_f32 v64, v64
buffer_load_dwordx4 v[196:199], v1, s[4:7], s23 offen offset:1024 sc1
v_exp_f32 v80, v80
v_exp_f32 v65, v65
v_exp_f32 v81, v81
v_exp_f32 v66, v66
v_exp_f32 v82, v82
v_exp_f32 v67, v67
v_exp_f32 v83, v83
v_exp_f32 v68, v68
buffer_load_dwordx4 v[200:203], v1, s[4:7], s23 offen offset:2048 sc1
v_exp_f32 v84, v84
v_exp_f32 v69, v69
v_exp_f32 v85, v85
v_exp_f32 v70, v70
v_exp_f32 v86, v86
v_exp_f32 v71, v71
v_exp_f32 v87, v87
v_exp_f32 v72, v72
buffer_load_dwordx4 v[204:207], v1, s[4:7], s23 offen offset:3072 sc1
v_exp_f32 v88, v88
v_exp_f32 v73, v73
v_exp_f32 v89, v89
v_exp_f32 v74, v74
v_exp_f32 v90, v90
v_exp_f32 v75, v75
v_exp_f32 v91, v91
v_exp_f32 v76, v76
s_add_u32 s23, s36, 4096
buffer_load_dwordx4 v[208:211], v1, s[4:7], s23 offen offset:0 sc1
v_exp_f32 v92, v92
v_exp_f32 v77, v77
v_exp_f32 v93, v93
v_exp_f32 v78, v78
v_exp_f32 v94, v94
v_exp_f32 v79, v79
v_exp_f32 v95, v95
buffer_load_dwordx4 v[212:215], v1, s[4:7], s23 offen offset:1024 sc1
v_pk_add_f32 v[40:41], v[64:65], v[66:67]
v_pk_add_f32 v[42:43], v[80:81], v[82:83]
v_pk_add_f32 v[40:41], v[40:41], v[68:69]
v_pk_add_f32 v[42:43], v[42:43], v[84:85]
v_pk_add_f32 v[40:41], v[40:41], v[70:71]
v_pk_add_f32 v[42:43], v[42:43], v[86:87]
v_pk_add_f32 v[40:41], v[40:41], v[72:73]
v_pk_add_f32 v[42:43], v[42:43], v[88:89]
v_pk_add_f32 v[40:41], v[40:41], v[74:75]
v_pk_add_f32 v[42:43], v[42:43], v[90:91]
v_pk_add_f32 v[40:41], v[40:41], v[76:77]
v_pk_add_f32 v[42:43], v[42:43], v[92:93]
v_pk_add_f32 v[40:41], v[40:41], v[78:79]
v_pk_add_f32 v[42:43], v[42:43], v[94:95]
v_add_f32 v40, v40, v41
buffer_load_dwordx4 v[216:219], v1, s[4:7], s23 offen offset:2048 sc1
v_add_f32 v42, v42, v43
v_rcp_f32 v40, v40
v_rcp_f32 v42, v42
v_pk_mul_f32 v[64:65], v[64:65], v[40:41] op_sel_hi:[1,0]
v_pk_mul_f32 v[66:67], v[66:67], v[40:41] op_sel_hi:[1,0]
v_pk_mul_f32 v[68:69], v[68:69], v[40:41] op_sel_hi:[1,0]
v_pk_mul_f32 v[70:71], v[70:71], v[40:41] op_sel_hi:[1,0]
v_pk_mul_f32 v[72:73], v[72:73], v[40:41] op_sel_hi:[1,0]
v_pk_mul_f32 v[74:75], v[74:75], v[40:41] op_sel_hi:[1,0]
v_pk_mul_f32 v[76:77], v[76:77], v[40:41] op_sel_hi:[1,0]
v_pk_mul_f32 v[78:79], v[78:79], v[40:41] op_sel_hi:[1,0]
v_cvt_pk_bf16_f32 v96, v64, v65
v_cvt_pk_bf16_f32 v97, v66, v67
buffer_load_dwordx4 v[220:223], v1, s[4:7], s23 offen offset:3072 sc1
v_cvt_pk_bf16_f32 v98, v68, v69
v_cvt_pk_bf16_f32 v99, v70, v71
v_cvt_pk_bf16_f32 v100, v72, v73
v_cvt_pk_bf16_f32 v101, v74, v75
v_cvt_pk_bf16_f32 v102, v76, v77
v_cvt_pk_bf16_f32 v103, v78, v79
v_pk_mul_f32 v[80:81], v[80:81], v[42:43] op_sel_hi:[1,0]
v_pk_mul_f32 v[82:83], v[82:83], v[42:43] op_sel_hi:[1,0]
v_pk_mul_f32 v[84:85], v[84:85], v[42:43] op_sel_hi:[1,0]
v_pk_mul_f32 v[86:87], v[86:87], v[42:43] op_sel_hi:[1,0]
v_pk_mul_f32 v[88:89], v[88:89], v[42:43] op_sel_hi:[1,0]
v_pk_mul_f32 v[90:91], v[90:91], v[42:43] op_sel_hi:[1,0]
v_pk_mul_f32 v[92:93], v[92:93], v[42:43] op_sel_hi:[1,0]
v_pk_mul_f32 v[94:95], v[94:95], v[42:43] op_sel_hi:[1,0]
v_cvt_pk_bf16_f32 v104, v80, v81
s_add_u32 s27, s85, 8192
buffer_load_dwordx4 v[160:163], v1, s[4:7], s27 offen offset:0
v_cvt_pk_bf16_f32 v105, v82, v83
v_cvt_pk_bf16_f32 v106, v84, v85
v_cvt_pk_bf16_f32 v107, v86, v87
v_cvt_pk_bf16_f32 v108, v88, v89
v_cvt_pk_bf16_f32 v109, v90, v91
v_cvt_pk_bf16_f32 v110, v92, v93
v_cvt_pk_bf16_f32 v111, v94, v95
s_waitcnt vmcnt(9)
s_waitcnt vmcnt(8)
v_mfma_f32_32x32x16_bf16 v[112:127], v[44:47], v[192:195], 0
v_add_f32_dpp v224, v224, v224 row_ror:8 row_mask:0xf bank_mask:0xf
v_add_f32_dpp v225, v225, v225 row_ror:8 row_mask:0xf bank_mask:0xf
v_add_f32_dpp v226, v226, v226 row_ror:8 row_mask:0xf bank_mask:0xf
v_add_f32_dpp v227, v227, v227 row_ror:8 row_mask:0xf bank_mask:0xf
s_waitcnt vmcnt(7)
v_mfma_f32_32x32x16_bf16 v[112:127], v[44:47], v[196:199], v[112:127]
buffer_load_dwordx4 v[164:167], v1, s[4:7], s27 offen offset:1024
v_add_f32_dpp v224, v224, v224 row_ror:4 row_mask:0xf bank_mask:0xf
v_add_f32_dpp v225, v225, v225 row_ror:4 row_mask:0xf bank_mask:0xf
v_add_f32_dpp v226, v226, v226 row_ror:4 row_mask:0xf bank_mask:0xf
v_add_f32_dpp v227, v227, v227 row_ror:4 row_mask:0xf bank_mask:0xf
s_waitcnt vmcnt(7)
v_mfma_f32_32x32x16_bf16 v[112:127], v[44:47], v[200:203], v[112:127]
v_add_f32_dpp v224, v224, v224 row_ror:2 row_mask:0xf bank_mask:0xf
v_add_f32_dpp v225, v225, v225 row_ror:2 row_mask:0xf bank_mask:0xf
v_add_f32_dpp v226, v226, v226 row_ror:2 row_mask:0xf bank_mask:0xf
v_add_f32_dpp v227, v227, v227 row_ror:2 row_mask:0xf bank_mask:0xf
s_waitcnt vmcnt(6)
v_mfma_f32_32x32x16_bf16 v[112:127], v[44:47], v[204:207], v[112:127]
buffer_load_dwordx4 v[168:171], v1, s[4:7], s27 offen offset:2048
v_add_f32_dpp v224, v224, v224 row_ror:1 row_mask:0xf bank_mask:0xf
v_add_f32_dpp v225, v225, v225 row_ror:1 row_mask:0xf bank_mask:0xf
v_add_f32_dpp v226, v226, v226 row_ror:1 row_mask:0xf bank_mask:0xf
v_add_f32_dpp v227, v227, v227 row_ror:1 row_mask:0xf bank_mask:0xf
s_waitcnt vmcnt(6)
v_mfma_f32_32x32x16_bf16 v[112:127], v[44:47], v[208:211], v[112:127]
v_add_f32 v52, v224, v225
v_add_f32 v53, v226, v227
v_cvt_pk_bf16_f32 v54, v224, v225
v_cvt_pk_bf16_f32 v55, v226, v227
s_waitcnt vmcnt(5)
v_mfma_f32_32x32x16_bf16 v[112:127], v[44:47], v[212:215], v[112:127]
buffer_load_dwordx4 v[172:175], v1, s[4:7], s27 offen offset:3072
v_add_f32 v52, v52, v53
s_waitcnt vmcnt(5)
v_mfma_f32_32x32x16_bf16 v[112:127], v[44:47], v[216:219], v[112:127]
s_waitcnt vmcnt(4)
v_mfma_f32_32x32x16_bf16 v[112:127], v[44:47], v[220:223], v[112:127]
s_add_u32 s27, s85, 12288
buffer_load_dwordx4 v[176:179], v1, s[4:7], s27 offen offset:0
s_nop 9
v_cmp_u_f32 vcc, v112, v52
v_cvt_pk_bf16_f32 v50, v112, v113
s_cbranch_vccnz L_kvagain_34
L_kvok_33:
v_cvt_pk_bf16_f32 v51, v114, v115
ds_write_b64 v61, v[54:55] offset:25600
ds_write_b64 v60, v[50:51] offset:25344
s_waitcnt lgkmcnt(0)
s_barrier
ds_read_b128 a[224:227], v1 offset:25344
ds_read_b128 a[232:235], v1 offset:27392
ds_read_b128 a[228:231], v1 offset:26368
ds_read_b128 a[236:239], v1 offset:28416
buffer_load_dwordx4 v[180:183], v1, s[4:7], s27 offen offset:1024
buffer_load_dwordx4 v[184:187], v1, s[4:7], s27 offen offset:2048
buffer_load_dwordx4 v[188:191], v1, s[4:7], s27 offen offset:3072
s_waitcnt lgkmcnt(2)
v_mfma_f32_32x32x16_bf16 v[64:79], a[224:227], v[96:99], 0
v_mfma_f32_32x32x16_bf16 v[80:95], a[232:235], v[104:107], 0
s_waitcnt lgkmcnt(0)
v_mfma_f32_32x32x16_bf16 v[64:79], a[228:231], v[100:103], v[64:79]
v_mfma_f32_32x32x16_bf16 v[80:95], a[236:239], v[108:111], v[80:95]
v_and_b32 v59, 7, v0
v_lshl_add_u32 v59, s3, 3, v59
v_bfe_u32 v61, v0, 4, 1
v_and_b32 v56, 15, v0
v_lshlrev_b32 v60, 3, v61
v_xor_b32 v56, v56, v60
v_lshlrev_b32 v56, 4, v56
v_lshrrev_b32 v60, 4, v0
v_lshl_add_u32 v56, v60, 9, v56
v_lshl_add_u32 v56, s3, 12, v56
s_nop 0
v_add_f32 v72, 0x358637bd, v72
v_rcp_f32 v72, v72
v_add_f32 v88, 0x358637bd, v88
v_rcp_f32 v88, v88
v_pk_mul_f32 v[64:65], v[64:65], v[72:73] op_sel_hi:[1,0]
v_pk_mul_f32 v[66:67], v[66:67], v[72:73] op_sel_hi:[1,0]
v_pk_mul_f32 v[68:69], v[68:69], v[72:73] op_sel_hi:[1,0]
v_pk_mul_f32 v[70:71], v[70:71], v[72:73] op_sel_hi:[1,0]
v_cvt_pk_bf16_f32 v76, v64, v65
v_cvt_pk_bf16_f32 v77, v66, v67
v_cvt_pk_bf16_f32 v78, v68, v69
v_cvt_pk_bf16_f32 v79, v70, v71
buffer_store_dwordx4 v[76:79], v63, s[4:7], s28 offen offset:0
v_pk_mul_f32 v[80:81], v[80:81], v[88:89] op_sel_hi:[1,0]
v_pk_mul_f32 v[82:83], v[82:83], v[88:89] op_sel_hi:[1,0]
v_pk_mul_f32 v[84:85], v[84:85], v[88:89] op_sel_hi:[1,0]
v_pk_mul_f32 v[86:87], v[86:87], v[88:89] op_sel_hi:[1,0]
v_cvt_pk_bf16_f32 v92, v80, v81
v_cvt_pk_bf16_f32 v93, v82, v83
v_cvt_pk_bf16_f32 v94, v84, v85
v_cvt_pk_bf16_f32 v95, v86, v87
buffer_store_dwordx4 v[92:95], v63, s[4:7], s28 offen offset:512
v_bfe_u32 v61, v0, 3, 1
v_lshlrev_b32 v57, 3, v61
v_xor_b32 v57, v57, v59
v_lshlrev_b32 v57, 4, v57
v_lshl_add_u32 v57, v61, 9, v57
v_lshl_add_u32 v57, v60, 12, v57
v_lshlrev_b32 v58, 4, v59
v_lshl_add_u32 v58, v61, 9, v58
v_lshl_add_u32 v58, v60, 10, v58
v_lshrrev_b32 v60, 5, v0
v_lshlrev_b32 v59, 3, v59
v_lshl_add_u32 v59, v60, 2, v59
v_and_b32 v62, 7, v0
v_lshlrev_b32 v62, 2, v62
s_add_u32 s36, s82, 12582912
s_add_u32 s37, s83, 7864320
v_permlane16_swap_b32 v6, v8
v_permlane16_swap_b32 v7, v9
v_permlane16_swap_b32 v10, v12
v_permlane16_swap_b32 v11, v13
s_add_u32 s15, s36, 32768
v_lshlrev_b32 v40, 16, v6
v_and_b32 v41, 0xffff0000, v6
v_lshlrev_b32 v42, 16, v7
v_and_b32 v43, 0xffff0000, v7
v_lshlrev_b32 v44, 16, v8
v_and_b32 v45, 0xffff0000, v8
v_lshlrev_b32 v46, 16, v9
v_and_b32 v47, 0xffff0000, v9
v_lshlrev_b32 v48, 16, v10
v_and_b32 v49, 0xffff0000, v10
v_lshlrev_b32 v50, 16, v11
v_and_b32 v51, 0xffff0000, v11
v_lshlrev_b32 v52, 16, v12
v_and_b32 v53, 0xffff0000, v12
v_lshlrev_b32 v54, 16, v13
v_and_b32 v55, 0xffff0000, v13
v_mov_b32 v4, 9
s_waitcnt vmcnt(0)
s_mov_b64 exec, 1
buffer_store_dword v4, off, s[4:7], s78
s_mov_b64 exec, -1
v_and_b32 v38, 1, v0
v_lshlrev_b32 v38, 4, v38
v_mov_b32 v39, 0x3f80
v_lshlrev_b32 v38, v38, v39
v_bfe_u32 v39, v0, 1, 3
v_cmp_eq_u32 s[96:97], 0, v39
v_cmp_eq_u32 s[26:27], 1, v39
s_nop 0
v_cndmask_b32 v60, 0, v38, s[96:97]
v_cndmask_b32 v61, 0, v38, s[26:27]
v_cmp_eq_u32 s[96:97], 2, v39
v_cmp_eq_u32 s[26:27], 3, v39
v_accvgpr_write_b32 a240, v60
v_accvgpr_write_b32 a241, v61
v_cndmask_b32 v60, 0, v38, s[96:97]
v_cndmask_b32 v61, 0, v38, s[26:27]
v_cmp_eq_u32 s[96:97], 4, v39
v_cmp_eq_u32 s[26:27], 5, v39
v_accvgpr_write_b32 a242, v60
v_accvgpr_write_b32 a243, v61
v_cndmask_b32 v60, 0, v38, s[96:97]
v_cndmask_b32 v61, 0, v38, s[26:27]
v_cmp_eq_u32 s[96:97], 6, v39
v_cmp_eq_u32 s[26:27], 7, v39
v_accvgpr_write_b32 a244, v60
v_accvgpr_write_b32 a245, v61
v_cndmask_b32 v60, 0, v38, s[96:97]
v_cndmask_b32 v61, 0, v38, s[26:27]
v_accvgpr_write_b32 a246, v60
v_accvgpr_write_b32 a247, v61
L_spin_37:
buffer_load_dword v63, v62, s[4:7], s79 offen sc1
s_sub_u32 s29, s29, 1
s_waitcnt vmcnt(0)
v_cmp_gt_u32 vcc, 9, v63
s_cbranch_scc1 L_spinout_39
s_cbranch_vccnz L_spin_37
L_spun_38:
s_add_u32 s23, s39, 20971520
buffer_load_dwordx4 v[192:195], v1, s[4:7], s23 offen offset:0 sc1
buffer_load_dwordx4 v[196:199], v1, s[4:7], s23 offen offset:2048 sc1
s_add_u32 s23, s39, 20975616
buffer_load_dwordx4 v[200:203], v1, s[4:7], s23 offen offset:0 sc1
buffer_load_dwordx4 v[204:207], v1, s[4:7], s23 offen offset:2048 sc1
s_add_u32 s23, s39, 20972544
buffer_load_dwordx4 v[208:211], v1, s[4:7], s23 offen offset:0 sc1
buffer_load_dwordx4 v[212:215], v1, s[4:7], s23 offen offset:2048 sc1
s_add_u32 s23, s39, 20976640
buffer_load_dwordx4 v[216:219], v1, s[4:7], s23 offen offset:0 sc1
buffer_load_dwordx4 v[220:223], v1, s[4:7], s23 offen offset:2048 sc1
s_add_u32 s23, s39, 21004288
buffer_load_dwordx4 v[224:227], v1, s[4:7], s23 offen offset:0 sc1
buffer_load_dwordx4 v[228:231], v1, s[4:7], s23 offen offset:2048 sc1
s_waitcnt vmcnt(9)
v_mfma_f32_16x16x32_bf16 v[64:67], v[128:131], v[192:195], 0
s_add_u32 s23, s39, 21008384
buffer_load_dwordx4 v[232:235], v1, s[4:7], s23 offen offset:0 sc1
v_mfma_f32_16x16x32_bf16 v[68:71], v[132:135], v[192:195], 0
v_mfma_f32_16x16x32_bf16 v[72:75], v[136:139], v[192:195], 0
v_mfma_f32_16x16x32_bf16 v[76:79], v[140:143], v[192:195], 0
s_waitcnt vmcnt(9)
v_mfma_f32_16x16x32_bf16 v[64:67], v[144:147], v[196:199], v[64:67]
buffer_load_dwordx4 v[236:239], v1, s[4:7], s23 offen offset:2048 sc1
v_mfma_f32_16x16x32_bf16 v[68:71], v[148:151], v[196:199], v[68:71]
v_mfma_f32_16x16x32_bf16 v[72:75], v[152:155], v[196:199], v[72:75]
v_mfma_f32_16x16x32_bf16 v[76:79], v[156:159], v[196:199], v[76:79]
s_waitcnt vmcnt(9)
v_mfma_f32_16x16x32_bf16 v[64:67], v[160:163], v[200:203], v[64:67]
s_add_u32 s23, s39, 21005312
buffer_load_dwordx4 v[240:243], v1, s[4:7], s23 offen offset:0 sc1
v_mfma_f32_16x16x32_bf16 v[68:71], v[164:167], v[200:203], v[68:71]
v_mfma_f32_16x16x32_bf16 v[72:75], v[168:171], v[200:203], v[72:75]
v_mfma_f32_16x16x32_bf16 v[76:79], v[172:175], v[200:203], v[76:79]
s_waitcnt vmcnt(9)
v_mfma_f32_16x16x32_bf16 v[64:67], v[176:179], v[204:207], v[64:67]
buffer_load_dwordx4 v[244:247], v1, s[4:7], s23 offen offset:2048 sc1
v_mfma_f32_16x16x32_bf16 v[68:71], v[180:183], v[204:207], v[68:71]
v_mfma_f32_16x16x32_bf16 v[72:75], v[184:187], v[204:207], v[72:75]
v_mfma_f32_16x16x32_bf16 v[76:79], v[188:191], v[204:207], v[76:79]
s_waitcnt vmcnt(9)
v_mfma_f32_16x16x32_bf16 v[80:83], v[128:131], v[208:211], 0
s_add_u32 s23, s39, 21009408
buffer_load_dwordx4 v[248:251], v1, s[4:7], s23 offen offset:0 sc1
v_mfma_f32_16x16x32_bf16 v[84:87], v[132:135], v[208:211], 0
v_mfma_f32_16x16x32_bf16 v[88:91], v[136:139], v[208:211], 0
v_mfma_f32_16x16x32_bf16 v[92:95], v[140:143], v[208:211], 0
s_waitcnt vmcnt(9)
v_mfma_f32_16x16x32_bf16 v[80:83], v[144:147], v[212:215], v[80:83]
buffer_load_dwordx4 v[252:255], v1, s[4:7], s23 offen offset:2048 sc1
v_mfma_f32_16x16x32_bf16 v[84:87], v[148:151], v[212:215], v[84:87]
v_cvt_pk_bf16_f32 v64, v64, v65
v_cvt_pk_bf16_f32 v65, v66, v67
v_cvt_pk_bf16_f32 v66, v68, v69
v_cvt_pk_bf16_f32 v67, v70, v71
ds_write_b128 v56, v[64:67] offset:0
v_mfma_f32_16x16x32_bf16 v[88:91], v[152:155], v[212:215], v[88:91]
v_mfma_f32_16x16x32_bf16 v[92:95], v[156:159], v[212:215], v[92:95]
s_waitcnt vmcnt(9)
v_mfma_f32_16x16x32_bf16 v[80:83], v[160:163], v[216:219], v[80:83]
s_mov_b32 exec_lo, 0x1010101
s_mov_b32 exec_hi, 0x1010101
buffer_load_dword v5, v58, s[4:7], s36 offen offset:0 sc1
buffer_load_dword v5, v58, s[4:7], s15 offen offset:0 sc1
s_mov_b64 exec, -1
v_mfma_f32_16x16x32_bf16 v[84:87], v[164:167], v[216:219], v[84:87]
v_mfma_f32_16x16x32_bf16 v[88:91], v[168:171], v[216:219], v[88:91]
v_mfma_f32_16x16x32_bf16 v[92:95], v[172:175], v[216:219], v[92:95]
v_cvt_pk_bf16_f32 v72, v72, v73
v_cvt_pk_bf16_f32 v73, v74, v75
v_cvt_pk_bf16_f32 v74, v76, v77
v_cvt_pk_bf16_f32 v75, v78, v79
ds_write_b128 v56, v[72:75] offset:2048
s_waitcnt vmcnt(10)
v_mfma_f32_16x16x32_bf16 v[80:83], v[176:179], v[220:223], v[80:83]
s_mov_b32 exec_lo, 0x1
s_mov_b32 exec_hi, 0x1
buffer_load_dword v5, v59, s[4:7], s37 offen offset:0 sc1
buffer_load_dword v5, v59, s[4:7], s37 offen offset:2048 sc1
s_mov_b64 exec, -1
v_mfma_f32_16x16x32_bf16 v[84:87], v[180:183], v[220:223], v[84:87]
v_mfma_f32_16x16x32_bf16 v[88:91], v[184:187], v[220:223], v[88:91]
v_mfma_f32_16x16x32_bf16 v[92:95], v[188:191], v[220:223], v[92:95]
s_waitcnt vmcnt(11)
v_mfma_f32_16x16x32_bf16 v[96:99], v[128:131], v[224:227], 0
s_add_u32 m0, s21, 32768
s_add_u32 s30, s20, 196608
buffer_load_dwordx4 v1, s[4:7], s30 offen offset:0  lds
v_mfma_f32_16x16x32_bf16 v[100:103], v[132:135], v[224:227], 0
v_mfma_f32_16x16x32_bf16 v[104:107], v[136:139], v[224:227], 0
v_mfma_f32_16x16x32_bf16 v[108:111], v[140:143], v[224:227], 0
v_cvt_pk_bf16_f32 v80, v80, v81
v_cvt_pk_bf16_f32 v81, v82, v83
v_cvt_pk_bf16_f32 v82, v84, v85
v_cvt_pk_bf16_f32 v83, v86, v87
ds_write_b128 v56, v[80:83] offset:256
s_waitcnt vmcnt(11)
v_mfma_f32_16x16x32_bf16 v[96:99], v[144:147], v[228:231], v[96:99]
buffer_load_dwordx4 v1, s[4:7], s30 offen offset:1024  lds
v_mfma_f32_16x16x32_bf16 v[100:103], v[148:151], v[228:231], v[100:103]
v_cvt_pk_bf16_f32 v88, v88, v89
v_cvt_pk_bf16_f32 v89, v90, v91
v_cvt_pk_bf16_f32 v90, v92, v93
v_cvt_pk_bf16_f32 v91, v94, v95
ds_write_b128 v56, v[88:91] offset:2304
v_mfma_f32_16x16x32_bf16 v[104:107], v[152:155], v[228:231], v[104:107]
v_mfma_f32_16x16x32_bf16 v[108:111], v[156:159], v[228:231], v[108:111]
s_waitcnt vmcnt(11)
v_mfma_f32_16x16x32_bf16 v[96:99], v[160:163], v[232:235], v[96:99]
buffer_load_dwordx4 v1, s[4:7], s30 offen offset:2048  lds
v_mfma_f32_16x16x32_bf16 v[100:103], v[164:167], v[232:235], v[100:103]
s_waitcnt lgkmcnt(0)
s_barrier
ds_read_b128 v[64:67], v57 offset:0
ds_read_b128 v[68:71], v57 offset:1024
ds_read_b128 v[72:75], v57 offset:2048
ds_read_b128 v[76:79], v57 offset:3072
v_mfma_f32_16x16x32_bf16 v[104:107], v[168:171], v[232:235], v[104:107]
v_mfma_f32_16x16x32_bf16 v[108:111], v[172:175], v[232:235], v[108:111]
s_waitcnt vmcnt(11)
v_mfma_f32_16x16x32_bf16 v[96:99], v[176:179], v[236:239], v[96:99]
buffer_load_dwordx4 v1, s[4:7], s30 offen offset:3072  lds
v_mfma_f32_16x16x32_bf16 v[100:103], v[180:183], v[236:239], v[100:103]
v_mfma_f32_16x16x32_bf16 v[104:107], v[184:187], v[236:239], v[104:107]
v_mfma_f32_16x16x32_bf16 v[108:111], v[188:191], v[236:239], v[108:111]
s_waitcnt vmcnt(11)
v_mfma_f32_16x16x32_bf16 v[112:115], v[128:131], v[240:243], 0
s_add_u32 m0, s21, 36864
s_add_u32 s30, s20, 200704
buffer_load_dwordx4 v1, s[4:7], s30 offen offset:0  lds
v_mfma_f32_16x16x32_bf16 v[116:119], v[132:135], v[240:243], 0
s_waitcnt lgkmcnt(3)
v_mfma_f32_16x16x32_bf16 v[40:43], a[240:243], v[64:67], v[40:43]
s_waitcnt lgkmcnt(2)
v_mfma_f32_16x16x32_bf16 v[44:47], a[240:243], v[68:71], v[44:47]
s_waitcnt lgkmcnt(1)
v_mfma_f32_16x16x32_bf16 v[40:43], a[244:247], v[72:75], v[40:43]
s_waitcnt lgkmcnt(0)
v_mfma_f32_16x16x32_bf16 v[44:47], a[244:247], v[76:79], v[44:47]
v_mfma_f32_16x16x32_bf16 v[120:123], v[136:139], v[240:243], 0
v_mfma_f32_16x16x32_bf16 v[124:127], v[140:143], v[240:243], 0
s_waitcnt vmcnt(11)
v_mfma_f32_16x16x32_bf16 v[112:115], v[144:147], v[244:247], v[112:115]
buffer_load_dwordx4 v1, s[4:7], s30 offen offset:1024  lds
v_mfma_f32_16x16x32_bf16 v[116:119], v[148:151], v[244:247], v[116:119]
v_cvt_pk_bf16_f32 v96, v96, v97
v_cvt_pk_bf16_f32 v97, v98, v99
v_cvt_pk_bf16_f32 v98, v100, v101
v_cvt_pk_bf16_f32 v99, v102, v103
ds_write_b128 v56, v[96:99] offset:16384
v_mfma_f32_16x16x32_bf16 v[120:123], v[152:155], v[244:247], v[120:123]
v_mfma_f32_16x16x32_bf16 v[124:127], v[156:159], v[244:247], v[124:127]
s_waitcnt vmcnt(11)
v_mfma_f32_16x16x32_bf16 v[112:115], v[160:163], v[248:251], v[112:115]
buffer_load_dwordx4 v1, s[4:7], s30 offen offset:2048  lds
v_mfma_f32_16x16x32_bf16 v[116:119], v[164:167], v[248:251], v[116:119]
v_cvt_pk_bf16_f32 v104, v104, v105
v_cvt_pk_bf16_f32 v105, v106, v107
v_cvt_pk_bf16_f32 v106, v108, v109
v_cvt_pk_bf16_f32 v107, v110, v111
ds_write_b128 v56, v[104:107] offset:18432
v_mfma_f32_16x16x32_bf16 v[120:123], v[168:171], v[248:251], v[120:123]
v_mfma_f32_16x16x32_bf16 v[124:127], v[172:175], v[248:251], v[124:127]
s_waitcnt vmcnt(11)
v_mfma_f32_16x16x32_bf16 v[112:115], v[176:179], v[252:255], v[112:115]
buffer_load_dwordx4 v1, s[4:7], s30 offen offset:3072  lds
v_mfma_f32_16x16x32_bf16 v[116:119], v[180:183], v[252:255], v[116:119]
v_cvt_pk_bf16_f32 v6, v40, v41
v_cvt_pk_bf16_f32 v7, v42, v43
v_cvt_pk_bf16_f32 v8, v44, v45
v_cvt_pk_bf16_f32 v9, v46, v47
s_nop 0
v_permlane16_swap_b32 v6, v8
v_permlane16_swap_b32 v7, v9
buffer_store_dwordx4 v[6:9], v58, s[4:7], s36 offen
v_mfma_f32_16x16x32_bf16 v[120:123], v[184:187], v[252:255], v[120:123]
v_mfma_f32_16x16x32_bf16 v[124:127], v[188:191], v[252:255], v[124:127]
v_cvt_pk_bf16_f32 v112, v112, v113
v_cvt_pk_bf16_f32 v113, v114, v115
v_cvt_pk_bf16_f32 v114, v116, v117
v_cvt_pk_bf16_f32 v115, v118, v119
ds_write_b128 v56, v[112:115] offset:16640
s_nop 1
v_cvt_pk_bf16_f32 v120, v120, v121
v_cvt_pk_bf16_f32 v121, v122, v123
v_cvt_pk_bf16_f32 v122, v124, v125
v_cvt_pk_bf16_f32 v123, v126, v127
ds_write_b128 v56, v[120:123] offset:18688
s_waitcnt lgkmcnt(0)
s_barrier
ds_read_b128 v[96:99], v57 offset:16384
ds_read_b128 v[100:103], v57 offset:17408
ds_read_b128 v[104:107], v57 offset:18432
ds_read_b128 v[108:111], v57 offset:19456
v_dot2_f32_bf16 v60, v6, s22, 0
v_dot2_f32_bf16 v61, v6, v6, 0
v_dot2_f32_bf16 v60, v7, s22, v60
v_dot2_f32_bf16 v61, v7, v7, v61
v_dot2_f32_bf16 v60, v8, s22, v60
v_dot2_f32_bf16 v61, v8, v8, v61
v_dot2_f32_bf16 v60, v9, s22, v60
v_dot2_f32_bf16 v61, v9, v9, v61
v_bfe_u32 v62, v0, 4, 1
v_lshl_add_u32 v62, v62, 11, v59
s_nop 0
v_permlane32_swap_b32 v60, v61
v_add_f32 v60, v60, v61
s_waitcnt lgkmcnt(3)
v_mfma_f32_16x16x32_bf16 v[48:51], a[240:243], v[96:99], v[48:51]
s_waitcnt lgkmcnt(2)
v_mfma_f32_16x16x32_bf16 v[52:55], a[240:243], v[100:103], v[52:55]
s_waitcnt lgkmcnt(1)
v_mfma_f32_16x16x32_bf16 v[48:51], a[244:247], v[104:107], v[48:51]
s_waitcnt lgkmcnt(0)
v_mfma_f32_16x16x32_bf16 v[52:55], a[244:247], v[108:111], v[52:55]
s_nop 5
v_cvt_pk_bf16_f32 v10, v48, v49
v_cvt_pk_bf16_f32 v11, v50, v51
v_cvt_pk_bf16_f32 v12, v52, v53
v_cvt_pk_bf16_f32 v13, v54, v55
v_dot2_f32_bf16 v38, v10, s22, 0
v_dot2_f32_bf16 v39, v10, v10, 0
v_dot2_f32_bf16 v38, v11, s22, v38
v_dot2_f32_bf16 v39, v11, v11, v39
v_dot2_f32_bf16 v38, v12, s22, v38
v_dot2_f32_bf16 v39, v12, v12, v39
v_dot2_f32_bf16 v38, v13, s22, v38
v_dot2_f32_bf16 v39, v13, v13, v39
v_permlane16_swap_b32 v10, v12
v_permlane16_swap_b32 v11, v13
buffer_store_dwordx4 v[10:13], v58, s[4:7], s15 offen
v_permlane32_swap_b32 v38, v39
v_add_f32 v38, v38, v39
s_nop 1
v_permlane16_swap_b32 v60, v38
v_add_f32 v60, v60, v38
s_nop 1
v_add_f32_dpp v60, v60, v60 row_ror:8 row_mask:0xf bank_mask:0xf
s_mov_b32 exec_lo, 0x00ff00ff
s_mov_b32 exec_hi, 0x00ff00ff
buffer_store_dword v60, v62, s[4:7], s37 offen
s_mov_b64 exec, -1
v_lshrrev_b32 v40, 5, v0
v_lshlrev_b32 v40, 10, v40
v_and_b32 v41, 31, v0
v_lshl_add_u32 v40, v41, 3, v40
s_add_u32 s23, s81, 7864320
s_add_u32 s15, s80, 12582912
v_and_b32 v62, 31, v0
v_lshlrev_b32 v62, 2, v62
v_mov_b32 v4, 10
s_waitcnt vmcnt(0)
s_mov_b64 exec, 1
buffer_store_dword v4, off, s[4:7], s76
s_mov_b64 exec, -1
s_barrier
buffer_load_dword v63, v62, s[4:7], s77 offen sc1
ds_read_b128 a[224:227], v3 offset:0
ds_read_b128 a[228:231], v2 offset:32768
ds_read_b128 a[232:235], v3 offset:1024
ds_read_b128 a[236:239], v2 offset:33792
ds_read_b128 a[240:243], v3 offset:2048
ds_read_b128 a[244:247], v2 offset:34816
ds_read_b128 a[248:251], v3 offset:3072
s_waitcnt vmcnt(0)
v_cmp_gt_u32 vcc, 10, v63
s_nop 0
s_cbranch_vccz L_spun_41
L_spin_40:
buffer_load_dword v63, v62, s[4:7], s77 offen sc1
s_sub_u32 s29, s29, 1
s_waitcnt vmcnt(0)
v_cmp_gt_u32 vcc, 10, v63
s_cbranch_scc1 L_spinout_42
s_cbranch_vccnz L_spin_40
L_spun_41:
s_add_u32 s27, s15, 0
buffer_load_dwordx4 v[128:131], v1, s[4:7], s27 offen offset:0 sc1
buffer_load_dwordx4 v[132:135], v1, s[4:7], s27 offen offset:1024 sc1
buffer_load_dwordx4 v[136:139], v1, s[4:7], s27 offen offset:2048 sc1
buffer_load_dwordx4 v[140:143], v1, s[4:7], s27 offen offset:3072 sc1
s_add_u32 s27, s15, 4096
buffer_load_dwordx4 v[144:147], v1, s[4:7], s27 offen offset:0 sc1
buffer_load_dwordx4 v[148:151], v1, s[4:7], s27 offen offset:1024 sc1
buffer_load_dwordx4 v[152:155], v1, s[4:7], s27 offen offset:2048 sc1
buffer_load_dwordx4 v[156:159], v1, s[4:7], s27 offen offset:3072 sc1
buffer_load_dwordx2 v[42:43], v40, s[4:7], s23 offen offset:0 sc1
buffer_load_dwordx2 v[44:45], v40, s[4:7], s23 offen offset:256 sc1
buffer_load_dwordx2 v[46:47], v40, s[4:7], s23 offen offset:512 sc1
buffer_load_dwordx2 v[48:49], v40, s[4:7], s23 offen offset:768 sc1
s_waitcnt vmcnt(11) lgkmcnt(5)
v_mfma_f32_32x32x16_bf16 v[64:79], a[224:227], v[128:131], 0
s_add_u32 s27, s15, 8192
buffer_load_dwordx4 v[160:163], v1, s[4:7], s27 offen offset:0 sc1
ds_read_b128 a[252:255], v2 offset:35840
v_mfma_f32_32x32x16_bf16 v[80:95], a[228:231], v[128:131], 0
ds_read_b128 a[224:227], v3 offset:4096
s_waitcnt vmcnt(11) lgkmcnt(5)
v_mfma_f32_32x32x16_bf16 v[64:79], a[232:235], v[132:135], v[64:79]
buffer_load_dwordx4 v[164:167], v1, s[4:7], s27 offen offset:1024 sc1
ds_read_b128 a[228:231], v2 offset:36864
v_mfma_f32_32x32x16_bf16 v[80:95], a[236:239], v[132:135], v[80:95]
ds_read_b128 a[232:235], v3 offset:5120
s_waitcnt vmcnt(11) lgkmcnt(5)
v_mfma_f32_32x32x16_bf16 v[64:79], a[240:243], v[136:139], v[64:79]
buffer_load_dwordx4 v[168:171], v1, s[4:7], s27 offen offset:2048 sc1
ds_read_b128 a[236:239], v2 offset:37888
v_mfma_f32_32x32x16_bf16 v[80:95], a[244:247], v[136:139], v[80:95]
ds_read_b128 a[240:243], v3 offset:6144
s_waitcnt vmcnt(11) lgkmcnt(5)
v_mfma_f32_32x32x16_bf16 v[64:79], a[248:251], v[140:143], v[64:79]
buffer_load_dwordx4 v[172:175], v1, s[4:7], s27 offen offset:3072 sc1
ds_read_b128 a[244:247], v2 offset:38912
v_mfma_f32_32x32x16_bf16 v[80:95], a[252:255], v[140:143], v[80:95]
ds_read_b128 a[248:251], v3 offset:7168
s_waitcnt vmcnt(11) lgkmcnt(5)
v_mfma_f32_32x32x16_bf16 v[64:79], a[224:227], v[144:147], v[64:79]
s_add_u32 s27, s15, 12288
buffer_load_dwordx4 v[176:179], v1, s[4:7], s27 offen offset:0 sc1
ds_read_b128 a[252:255], v2 offset:39936
v_mfma_f32_32x32x16_bf16 v[80:95], a[228:231], v[144:147], v[80:95]
ds_read_b128 a[224:227], v2 offset:0
s_waitcnt vmcnt(11) lgkmcnt(5)
v_mfma_f32_32x32x16_bf16 v[64:79], a[232:235], v[148:151], v[64:79]
buffer_load_dwordx4 v[180:183], v1, s[4:7], s27 offen offset:1024 sc1
ds_read_b128 a[228:231], v3 offset:8192
v_mfma_f32_32x32x16_bf16 v[80:95], a[236:239], v[148:151], v[80:95]
ds_read_b128 a[232:235], v2 offset:40960
s_waitcnt vmcnt(11) lgkmcnt(5)
v_mfma_f32_32x32x16_bf16 v[64:79], a[240:243], v[152:155], v[64:79]
buffer_load_dwordx4 v[184:187], v1, s[4:7], s27 offen offset:2048 sc1
ds_read_b128 a[236:239], v3 offset:9216
v_mfma_f32_32x32x16_bf16 v[80:95], a[244:247], v[152:155], v[80:95]
ds_read_b128 a[240:243], v2 offset:41984
s_waitcnt vmcnt(11) lgkmcnt(4)
v_mfma_f32_32x32x16_bf16 v[64:79], a[248:251], v[156:159], v[64:79]
buffer_load_dwordx4 v[188:191], v1, s[4:7], s27 offen offset:3072 sc1
ds_read_b128 a[244:247], v3 offset:10240
v_mfma_f32_32x32x16_bf16 v[80:95], a[252:255], v[156:159], v[80:95]
ds_read_b128 a[248:251], v2 offset:43008
v_mfma_f32_32x32x16_bf16 v[96:111], a[224:227], v[128:131], 0
ds_read_b128 a[252:255], v3 offset:11264
s_waitcnt vmcnt(7) lgkmcnt(5)
v_mfma_f32_32x32x16_bf16 v[64:79], a[228:231], v[160:163], v[64:79]
s_add_u32 s27, s15, 16384
buffer_load_dwordx4 v[192:195], v1, s[4:7], s27 offen offset:0 sc1
ds_read_b128 a[224:227], v2 offset:44032
v_add_f32 v42, v42, v44
v_add_f32 v43, v43, v45
v_mfma_f32_32x32x16_bf16 v[80:95], a[232:235], v[160:163], v[80:95]
ds_read_b128 a[228:231], v3 offset:12288
v_add_f32 v46, v46, v48
v_add_f32 v47, v47, v49
v_add_f32 v42, v42, v46
v_add_f32 v43, v43, v47
s_waitcnt vmcnt(7) lgkmcnt(5)
v_mfma_f32_32x32x16_bf16 v[64:79], a[236:239], v[164:167], v[64:79]
buffer_load_dwordx4 v[196:199], v1, s[4:7], s27 offen offset:1024 sc1
ds_read_b128 a[232:235], v2 offset:45056
v_permlane32_swap_b32 v42, v43
v_add_f32 v42, v42, v43
v_mov_b32 v43, v42
v_mfma_f32_32x32x16_bf16 v[80:95], a[240:243], v[164:167], v[80:95]
ds_read_b128 a[236:239], v3 offset:13312
v_permlane32_swap_b32 v42, v43
v_mul_f32 v42, 0xbb000000, v42
v_mul_f32 v43, 0x3b000000, v43
v_cvt_pk_bf16_f32 v44, v42, v42
s_waitcnt vmcnt(7) lgkmcnt(5)
v_mfma_f32_32x32x16_bf16 v[64:79], a[244:247], v[168:171], v[64:79]
buffer_load_dwordx4 v[200:203], v1, s[4:7], s27 offen offset:2048 sc1
ds_read_b128 a[240:243], v2 offset:46080
v_fma_f32 v43, -v42, v42, v43
v_and_b32 v45, 0xffff0000, v44
v_max_f32 v43, 0, v43
v_mfma_f32_32x32x16_bf16 v[80:95], a[248:251], v[168:171], v[80:95]
ds_read_b128 a[244:247], v3 offset:14336
v_sub_f32 v45, v42, v45
v_add_f32 v50, 0x3727c5ac, v43
v_cvt_pk_bf16_f32 v45, v45, v45
v_rsq_f32 v51, v50
s_waitcnt vmcnt(7) lgkmcnt(5)
v_mfma_f32_32x32x16_bf16 v[64:79], a[252:255], v[172:175], v[64:79]
buffer_load_dwordx4 v[204:207], v1, s[4:7], s27 offen offset:3072 sc1
ds_read_b128 a[248:251], v2 offset:47104
v_cndmask_b32 v32, v45, v44, s[24:25]
v_mov_b32 v37, v32
v_mfma_f32_32x32x16_bf16 v[80:95], a[224:227], v[172:175], v[80:95]
ds_read_b128 a[252:255], v3 offset:15360
v_mfma_f32_32x32x16_bf16 v[64:79], v[26:29], v[34:37], v[64:79]
v_mfma_f32_32x32x16_bf16 v[80:95], v[30:33], v[32:35], v[80:95]
v_mfma_f32_32x32x16_bf16 v[96:111], v[28:31], v[34:37], v[96:111]
s_waitcnt vmcnt(7) lgkmcnt(5)
v_mfma_f32_32x32x16_bf16 v[64:79], a[228:231], v[176:179], v[64:79]
s_add_u32 s27, s15, 20480
buffer_load_dwordx4 v[208:211], v1, s[4:7], s27 offen offset:0 sc1
ds_read_b128 a[224:227], v2 offset:48128
v_mul_f32 v38, 0xc0135761, v51
v_mul_f32 v39, v51, v51
v_mfma_f32_32x32x16_bf16 v[80:95], a[232:235], v[176:179], v[80:95]
ds_read_b128 a[228:231], v2 offset:1024
v_mul_f32 v39, v39, v38
v_mul_f32 v39, 0x3d372713, v39
s_add_u32 s36, s32, 32505856
s_mul_i32 s28, s18, 1536
s_waitcnt vmcnt(7) lgkmcnt(5)
v_mfma_f32_32x32x16_bf16 v[64:79], a[236:239], v[180:183], v[64:79]
buffer_load_dwordx4 v[212:215], v1, s[4:7], s27 offen offset:1024 sc1
ds_read_b128 a[232:235], v3 offset:16384
s_sub_u32 s28, s38, s28
s_add_u32 s28, s28, 20971520
v_bfe_u32 v41, v0, 4, 1
v_mfma_f32_32x32x16_bf16 v[80:95], a[240:243], v[180:183], v[80:95]
ds_read_b128 a[236:239], v2 offset:49152
v_lshlrev_b32 v40, 10, v41
v_lshrrev_b32 v41, 5, v0
v_lshl_add_u32 v40, v41, 8, v40
v_and_b32 v41, 15, v0
s_waitcnt vmcnt(7) lgkmcnt(5)
v_mfma_f32_32x32x16_bf16 v[64:79], a[244:247], v[184:187], v[64:79]
buffer_load_dwordx4 v[216:219], v1, s[4:7], s27 offen offset:2048 sc1
ds_read_b128 a[240:243], v3 offset:17408
v_lshl_add_u32 v40, v41, 4, v40
v_mov_b32 v41, v58
v_and_b32 v62, 7, v0
v_mfma_f32_32x32x16_bf16 v[80:95], a[248:251], v[184:187], v[80:95]
ds_read_b128 a[244:247], v2 offset:50176
v_lshlrev_b32 v62, 2, v62
v_lshrrev_b32 v60, 4, v0
v_and_b32 v56, 15, v0
v_lshlrev_b32 v61, 1, v60
s_waitcnt vmcnt(7) lgkmcnt(4)
v_mfma_f32_32x32x16_bf16 v[64:79], a[252:255], v[188:191], v[64:79]
buffer_load_dwordx4 v[220:223], v1, s[4:7], s27 offen offset:3072 sc1
ds_read_b128 a[248:251], v3 offset:18432
v_xor_b32 v56, v56, v61
v_lshlrev_b32 v56, 4, v56
v_lshl_add_u32 v56, v60, 9, v56
v_mfma_f32_32x32x16_bf16 v[80:95], a[224:227], v[188:191], v[80:95]
ds_read_b128 a[252:255], v2 offset:51200
v_lshl_add_u32 v56, s3, 12, v56
v_bfe_u32 v57, v0, 3, 1
v_lshl_add_u32 v57, s3, 3, v57
v_and_b32 v61, 7, v0
v_mfma_f32_32x32x16_bf16 v[96:111], a[228:231], v[132:135], v[96:111]
ds_read_b128 a[224:227], v3 offset:19456
v_lshlrev_b32 v59, 1, v61
v_xor_b32 v57, v57, v59
v_lshlrev_b32 v57, 4, v57
v_lshl_add_u32 v57, v61, 9, v57
s_waitcnt vmcnt(7) lgkmcnt(5)
v_mfma_f32_32x32x16_bf16 v[64:79], a[232:235], v[192:195], v[64:79]
s_add_u32 s27, s15, 24576
buffer_load_dwordx4 v[224:227], v1, s[4:7], s27 offen offset:0 sc1
ds_read_b128 a[228:231], v2 offset:52224
v_lshl_add_u32 v57, v60, 12, v57
v_lshrrev_b32 v60, 3, v0
v_mfma_f32_32x32x16_bf16 v[80:95], a[236:239], v[192:195], v[80:95]
ds_read_b128 a[232:235], v3 offset:20480
v_lshl_add_u32 v58, s3, 3, v60
v_lshlrev_b32 v58, 10, v58
v_lshl_add_u32 v58, v61, 4, v58
v_lshl_add_u32 v60, v61, 3, v60
s_waitcnt vmcnt(7) lgkmcnt(5)
v_mfma_f32_32x32x16_bf16 v[64:79], a[240:243], v[196:199], v[64:79]
buffer_load_dwordx4 v[228:231], v1, s[4:7], s27 offen offset:1024 sc1
ds_read_b128 a[236:239], v2 offset:53248
v_lshlrev_b32 v60, 2, v60
v_xor_b32 v59, 0x80, v56
v_mfma_f32_32x32x16_bf16 v[80:95], a[244:247], v[196:199], v[80:95]
ds_read_b128 a[240:243], v3 offset:21504
s_waitcnt vmcnt(7) lgkmcnt(5)
v_mfma_f32_32x32x16_bf16 v[64:79], a[248:251], v[200:203], v[64:79]
buffer_load_dwordx4 v[232:235], v1, s[4:7], s27 offen offset:2048 sc1
ds_read_b128 a[244:247], v2 offset:54272
v_mfma_f32_32x32x16_bf16 v[80:95], a[252:255], v[200:203], v[80:95]
ds_read_b128 a[248:251], v3 offset:22528
s_waitcnt vmcnt(7) lgkmcnt(5)
v_mfma_f32_32x32x16_bf16 v[64:79], a[224:227], v[204:207], v[64:79]
buffer_load_dwordx4 v[236:239], v1, s[4:7], s27 offen offset:3072 sc1
ds_read_b128 a[252:255], v2 offset:55296
v_mfma_f32_32x32x16_bf16 v[80:95], a[228:231], v[204:207], v[80:95]
ds_read_b128 a[224:227], v3 offset:23552
s_waitcnt vmcnt(7) lgkmcnt(5)
v_mfma_f32_32x32x16_bf16 v[64:79], a[232:235], v[208:211], v[64:79]
s_add_u32 s27, s15, 28672
buffer_load_dwordx4 v[240:243], v1, s[4:7], s27 offen offset:0 sc1
ds_read_b128 a[228:231], v2 offset:56320
v_mfma_f32_32x32x16_bf16 v[80:95], a[236:239], v[208:211], v[80:95]
ds_read_b128 a[232:235], v2 offset:2048
s_waitcnt vmcnt(7) lgkmcnt(5)
v_mfma_f32_32x32x16_bf16 v[64:79], a[240:243], v[212:215], v[64:79]
buffer_load_dwordx4 v[244:247], v1, s[4:7], s27 offen offset:1024 sc1
ds_read_b128 a[236:239], v3 offset:24576
v_mfma_f32_32x32x16_bf16 v[80:95], a[244:247], v[212:215], v[80:95]
ds_read_b128 a[240:243], v2 offset:57344
s_waitcnt vmcnt(7) lgkmcnt(5)
v_mfma_f32_32x32x16_bf16 v[64:79], a[248:251], v[216:219], v[64:79]
buffer_load_dwordx4 v[248:251], v1, s[4:7], s27 offen offset:2048 sc1
ds_read_b128 a[244:247], v3 offset:25600
v_mfma_f32_32x32x16_bf16 v[80:95], a[252:255], v[216:219], v[80:95]
ds_read_b128 a[248:251], v2 offset:58368
s_waitcnt vmcnt(7) lgkmcnt(4)
v_mfma_f32_32x32x16_bf16 v[64:79], a[224:227], v[220:223], v[64:79]
buffer_load_dwordx4 v[252:255], v1, s[4:7], s27 offen offset:3072 sc1
ds_read_b128 a[252:255], v3 offset:26624
v_mfma_f32_32x32x16_bf16 v[80:95], a[228:231], v[220:223], v[80:95]
ds_read_b128 a[224:227], v2 offset:59392
v_mfma_f32_32x32x16_bf16 v[96:111], a[232:235], v[136:139], v[96:111]
ds_read_b128 a[228:231], v3 offset:27648
s_waitcnt vmcnt(7) lgkmcnt(5)
v_mfma_f32_32x32x16_bf16 v[64:79], a[236:239], v[224:227], v[64:79]
ds_read_b128 a[232:235], v2 offset:60416
v_mfma_f32_32x32x16_bf16 v[80:95], a[240:243], v[224:227], v[80:95]
ds_read_b128 a[236:239], v3 offset:28672
s_waitcnt vmcnt(6) lgkmcnt(5)
v_mfma_f32_32x32x16_bf16 v[64:79], a[244:247], v[228:231], v[64:79]
ds_read_b128 a[240:243], v2 offset:61440
v_mfma_f32_32x32x16_bf16 v[80:95], a[248:251], v[228:231], v[80:95]
ds_read_b128 a[244:247], v3 offset:29696
s_waitcnt vmcnt(5) lgkmcnt(5)
v_mfma_f32_32x32x16_bf16 v[64:79], a[252:255], v[232:235], v[64:79]
ds_read_b128 a[248:251], v2 offset:62464
v_mfma_f32_32x32x16_bf16 v[80:95], a[224:227], v[232:235], v[80:95]
ds_read_b128 a[252:255], v3 offset:30720
s_waitcnt vmcnt(4) lgkmcnt(5)
v_mfma_f32_32x32x16_bf16 v[64:79], a[228:231], v[236:239], v[64:79]
ds_read_b128 a[224:227], v2 offset:63488
v_mfma_f32_32x32x16_bf16 v[80:95], a[232:235], v[236:239], v[80:95]
ds_read_b128 a[228:231], v3 offset:31744
s_waitcnt vmcnt(3) lgkmcnt(5)
v_mfma_f32_32x32x16_bf16 v[64:79], a[236:239], v[240:243], v[64:79]
ds_read_b128 a[232:235], v2 offset:64512
v_mfma_f32_32x32x16_bf16 v[80:95], a[240:243], v[240:243], v[80:95]
ds_read_b128 a[236:239], v2 offset:3072
s_waitcnt vmcnt(2) lgkmcnt(5)
v_mfma_f32_32x32x16_bf16 v[64:79], a[244:247], v[244:247], v[64:79]
ds_read_b128 a[240:243], v2 offset:4096
v_mfma_f32_32x32x16_bf16 v[80:95], a[248:251], v[244:247], v[80:95]
ds_read_b128 a[244:247], v2 offset:5120
s_waitcnt vmcnt(1) lgkmcnt(5)
v_mfma_f32_32x32x16_bf16 v[64:79], a[252:255], v[248:251], v[64:79]
ds_read_b128 a[248:251], v2 offset:6144
v_mfma_f32_32x32x16_bf16 v[80:95], a[224:227], v[248:251], v[80:95]
ds_read_b128 a[252:255], v2 offset:7168
s_waitcnt vmcnt(0) lgkmcnt(4)
v_mfma_f32_32x32x16_bf16 v[64:79], a[228:231], v[252:255], v[64:79]
ds_read_b128 a[224:227], v2 offset:8192
v_mfma_f32_32x32x16_bf16 v[80:95], a[232:235], v[252:255], v[80:95]
ds_read_b128 a[228:231], v2 offset:9216
v_mfma_f32_32x32x16_bf16 v[96:111], a[236:239], v[140:143], v[96:111]
ds_read_b128 a[232:235], v2 offset:10240
s_waitcnt lgkmcnt(3)
v_mfma_f32_32x32x16_bf16 v[96:111], a[240:243], v[144:147], v[96:111]
s_barrier
ds_read_b128 a[236:239], v2 offset:11264
L_here_43:
s_add_u32 s99, s13, L_here_43-L_pc+2048
buffer_load_dword v5, off, s[92:95], s99
v_mfma_f32_32x32x16_bf16 v[96:111], a[244:247], v[148:151], v[96:111]
ds_read_b128 a[240:243], v2 offset:12288
v_mfma_f32_32x32x16_bf16 v[96:111], a[248:251], v[152:155], v[96:111]
ds_read_b128 a[244:247], v2 offset:13312
v_mul_f32 v52, v64, v64
v_mul_f32 v53, v65, v65
v_mul_f32 v54, v66, v66
v_mul_f32 v55, v67, v67
v_fma_f32 v52, v52, v39, v38
v_mfma_f32_32x32x16_bf16 v[96:111], a[252:255], v[156:159], v[96:111]
ds_read_b128 a[248:251], v2 offset:14336
s_add_u32 m0, s21, 131072
s_add_u32 s30, s20, 163840
buffer_load_dwordx4 v1, s[4:7], s30 offen offset:0  lds
v_fma_f32 v53, v53, v39, v38
v_fma_f32 v54, v54, v39, v38
s_waitcnt lgkmcnt(3)
v_mfma_f32_32x32x16_bf16 v[96:111], a[224:227], v[160:163], v[96:111]
ds_read_b128 a[252:255], v2 offset:15360
v_fma_f32 v55, v55, v39, v38
v_mul_f32 v52, v52, v64
v_mul_f32 v53, v53, v65
v_mul_f32 v54, v54, v66
v_mfma_f32_32x32x16_bf16 v[96:111], a[228:231], v[164:167], v[96:111]
ds_read_b128 a[224:227], v2 offset:16384
buffer_load_dwordx4 v1, s[4:7], s30 offen offset:1024  lds
v_mul_f32 v55, v55, v67
v_exp_f32 v52, v52
v_mul_f32 v64, v64, v72
v_mfma_f32_32x32x16_bf16 v[96:111], a[232:235], v[168:171], v[96:111]
ds_read_b128 a[228:231], v2 offset:17408
v_exp_f32 v53, v53
v_mul_f32 v65, v65, v73
v_exp_f32 v54, v54
v_mfma_f32_32x32x16_bf16 v[96:111], a[236:239], v[172:175], v[96:111]
ds_read_b128 a[232:235], v2 offset:18432
buffer_load_dwordx4 v1, s[4:7], s30 offen offset:2048  lds
v_mul_f32 v66, v66, v74
v_exp_f32 v55, v55
v_mul_f32 v67, v67, v75
s_waitcnt lgkmcnt(3)
v_mfma_f32_32x32x16_bf16 v[96:111], a[240:243], v[176:179], v[96:111]
ds_read_b128 a[236:239], v2 offset:19456
v_fma_f32 v52, v52, v50, v50
v_fma_f32 v53, v53, v50, v50
v_fma_f32 v54, v54, v50, v50
v_fma_f32 v55, v55, v50, v50
v_mfma_f32_32x32x16_bf16 v[96:111], a[244:247], v[180:183], v[96:111]
ds_read_b128 a[240:243], v2 offset:20480
buffer_load_dwordx4 v1, s[4:7], s30 offen offset:3072  lds
v_rcp_f32 v52, v52
v_rcp_f32 v53, v53
v_mfma_f32_32x32x16_bf16 v[96:111], a[248:251], v[184:187], v[96:111]
ds_read_b128 a[244:247], v2 offset:21504
v_rcp_f32 v54, v54
v_rcp_f32 v55, v55
v_mul_f32 v64, v64, v52
v_mfma_f32_32x32x16_bf16 v[96:111], a[252:255], v[188:191], v[96:111]
ds_read_b128 a[248:251], v2 offset:22528
s_add_u32 m0, s21, 135168
s_add_u32 s30, s20, 167936
buffer_load_dwordx4 v1, s[4:7], s30 offen offset:0  lds
v_mul_f32 v65, v65, v53
v_mul_f32 v66, v66, v54
s_waitcnt lgkmcnt(3)
v_mfma_f32_32x32x16_bf16 v[96:111], a[224:227], v[192:195], v[96:111]
ds_read_b128 a[252:255], v2 offset:23552
v_mul_f32 v67, v67, v55
v_cvt_pk_bf16_f32 v42, v64, v65
v_cvt_pk_bf16_f32 v43, v66, v67
v_mul_f32 v52, v68, v68
v_mfma_f32_32x32x16_bf16 v[96:111], a[228:231], v[196:199], v[96:111]
ds_read_b128 a[224:227], v2 offset:24576
buffer_load_dwordx4 v1, s[4:7], s30 offen offset:1024  lds
v_mul_f32 v53, v69, v69
v_mul_f32 v54, v70, v70
v_mul_f32 v55, v71, v71
v_fma_f32 v52, v52, v39, v38
v_mfma_f32_32x32x16_bf16 v[96:111], a[232:235], v[200:203], v[96:111]
ds_read_b128 a[228:231], v2 offset:25600
v_fma_f32 v53, v53, v39, v38
v_fma_f32 v54, v54, v39, v38
v_fma_f32 v55, v55, v39, v38
v_mul_f32 v52, v52, v68
v_mul_f32 v53, v53, v69
v_mfma_f32_32x32x16_bf16 v[96:111], a[236:239], v[204:207], v[96:111]
ds_read_b128 a[232:235], v2 offset:26624
buffer_load_dwordx4 v1, s[4:7], s30 offen offset:2048  lds
v_mul_f32 v54, v54, v70
v_mul_f32 v55, v55, v71
v_exp_f32 v52, v52
s_waitcnt lgkmcnt(3)
v_mfma_f32_32x32x16_bf16 v[96:111], a[240:243], v[208:211], v[96:111]
ds_read_b128 a[236:239], v2 offset:27648
v_mul_f32 v68, v68, v76
v_exp_f32 v53, v53
v_mul_f32 v69, v69, v77
v_mfma_f32_32x32x16_bf16 v[96:111], a[244:247], v[212:215], v[96:111]
ds_read_b128 a[240:243], v2 offset:28672
buffer_load_dwordx4 v1, s[4:7], s30 offen offset:3072  lds
v_exp_f32 v54, v54
v_mul_f32 v70, v70, v78
v_mfma_f32_32x32x16_bf16 v[96:111], a[248:251], v[216:219], v[96:111]
s_barrier
ds_read_b128 a[244:247], v2 offset:29696
v_exp_f32 v55, v55
v_mul_f32 v71, v71, v79
v_fma_f32 v52, v52, v50, v50
v_mfma_f32_32x32x16_bf16 v[96:111], a[252:255], v[220:223], v[96:111]
ds_read_b128 a[248:251], v2 offset:30720
s_add_u32 m0, s21, 98304
s_add_u32 s30, s20, 131072
buffer_load_dwordx4 v1, s[4:7], s30 offen offset:0  lds
v_fma_f32 v53, v53, v50, v50
v_fma_f32 v54, v54, v50, v50
s_waitcnt lgkmcnt(3)
v_mfma_f32_32x32x16_bf16 v[96:111], a[224:227], v[224:227], v[96:111]
ds_read_b128 a[252:255], v2 offset:31744
v_fma_f32 v55, v55, v50, v50
v_rcp_f32 v52, v52
v_mfma_f32_32x32x16_bf16 v[96:111], a[228:231], v[228:231], v[96:111]
ds_read_b128 a[224:227], v1 offset:32768
buffer_load_dwordx4 v1, s[4:7], s30 offen offset:1024  lds
v_rcp_f32 v53, v53
v_rcp_f32 v54, v54
v_mfma_f32_32x32x16_bf16 v[96:111], a[232:235], v[232:235], v[96:111]
ds_read_b128 a[228:231], v1 offset:33792
v_rcp_f32 v55, v55
v_mul_f32 v68, v68, v52
v_mul_f32 v69, v69, v53
v_mul_f32 v70, v70, v54
v_mfma_f32_32x32x16_bf16 v[96:111], a[236:239], v[236:239], v[96:111]
ds_read_b128 a[232:235], v1 offset:34816
buffer_load_dwordx4 v1, s[4:7], s30 offen offset:2048  lds
v_mul_f32 v71, v71, v55
v_cvt_pk_bf16_f32 v44, v68, v69
v_cvt_pk_bf16_f32 v45, v70, v71
s_add_u32 s37, s36, 8192
buffer_store_dwordx4 v[42:45], v40, s[4:7], s37 offen sc1
s_waitcnt lgkmcnt(3)
v_mfma_f32_32x32x16_bf16 v[96:111], a[240:243], v[240:243], v[96:111]
ds_read_b128 a[236:239], v1 offset:35840
v_mul_f32 v52, v80, v80
v_mul_f32 v53, v81, v81
v_mul_f32 v54, v82, v82
v_mul_f32 v55, v83, v83
v_mfma_f32_32x32x16_bf16 v[96:111], a[244:247], v[244:247], v[96:111]
ds_read_b128 a[240:243], v1 offset:36864
buffer_load_dwordx4 v1, s[4:7], s30 offen offset:3072  lds
v_fma_f32 v52, v52, v39, v38
v_fma_f32 v53, v53, v39, v38
v_fma_f32 v54, v54, v39, v38
v_fma_f32 v55, v55, v39, v38
v_mfma_f32_32x32x16_bf16 v[96:111], a[248:251], v[248:251], v[96:111]
ds_read_b128 a[244:247], v1 offset:37888
v_mul_f32 v52, v52, v80
v_mul_f32 v53, v53, v81
v_mul_f32 v54, v54, v82
v_mul_f32 v55, v55, v83
v_mfma_f32_32x32x16_bf16 v[96:111], a[252:255], v[252:255], v[96:111]
ds_read_b128 a[248:251], v1 offset:38912
s_add_u32 m0, s21, 102400
s_add_u32 s30, s20, 135168
buffer_load_dwordx4 v1, s[4:7], s30 offen offset:0  lds
v_exp_f32 v52, v52
v_mfma_f32_32x32x16_bf16 v[112:127], v[28:31], v[32:35], 0
s_waitcnt lgkmcnt(3)
v_mfma_f32_32x32x16_bf16 v[112:127], a[224:227], v[128:131], v[112:127]
ds_read_b128 a[252:255], v1 offset:39936
buffer_load_dwordx4 v1, s[4:7], s30 offen offset:1024  lds
v_mfma_f32_32x32x16_bf16 v[112:127], a[228:231], v[132:135], v[112:127]
ds_read_b128 a[224:227], v1 offset:40960
v_mfma_f32_32x32x16_bf16 v[112:127], a[232:235], v[136:139], v[112:127]
ds_read_b128 a[228:231], v1 offset:41984
buffer_load_dwordx4 v1, s[4:7], s30 offen offset:2048  lds
v_mul_f32 v80, v80, v88
v_exp_f32 v53, v53
v_mul_f32 v81, v81, v89
v_mfma_f32_32x32x16_bf16 v[112:127], a[236:239], v[140:143], v[112:127]
ds_read_b128 a[232:235], v1 offset:43008
v_exp_f32 v54, v54
v_mul_f32 v82, v82, v90
v_exp_f32 v55, v55
s_waitcnt lgkmcnt(3)
v_mfma_f32_32x32x16_bf16 v[112:127], a[240:243], v[144:147], v[112:127]
ds_read_b128 a[236:239], v1 offset:44032
buffer_load_dwordx4 v1, s[4:7], s30 offen offset:3072  lds
v_mul_f32 v83, v83, v91
v_fma_f32 v52, v52, v50, v50
v_fma_f32 v53, v53, v50, v50
v_mfma_f32_32x32x16_bf16 v[112:127], a[244:247], v[148:151], v[112:127]
ds_read_b128 a[240:243], v1 offset:45056
v_fma_f32 v54, v54, v50, v50
v_fma_f32 v55, v55, v50, v50
v_rcp_f32 v52, v52
v_mfma_f32_32x32x16_bf16 v[112:127], a[248:251], v[152:155], v[112:127]
ds_read_b128 a[244:247], v1 offset:46080
v_rcp_f32 v53, v53
v_rcp_f32 v54, v54
v_mfma_f32_32x32x16_bf16 v[112:127], a[252:255], v[156:159], v[112:127]
ds_read_b128 a[248:251], v1 offset:47104
v_rcp_f32 v55, v55
v_mul_f32 v80, v80, v52
v_mul_f32 v81, v81, v53
v_mul_f32 v82, v82, v54
s_waitcnt lgkmcnt(3)
v_mfma_f32_32x32x16_bf16 v[112:127], a[224:227], v[160:163], v[112:127]
ds_read_b128 a[252:255], v1 offset:48128
v_mul_f32 v83, v83, v55
v_cvt_pk_bf16_f32 v46, v80, v81
v_cvt_pk_bf16_f32 v47, v82, v83
v_mul_f32 v52, v84, v84
v_mfma_f32_32x32x16_bf16 v[112:127], a[228:231], v[164:167], v[112:127]
ds_read_b128 a[224:227], v1 offset:49152
v_mul_f32 v53, v85, v85
v_mul_f32 v54, v86, v86
v_mul_f32 v55, v87, v87
v_fma_f32 v52, v52, v39, v38
v_fma_f32 v53, v53, v39, v38
v_mfma_f32_32x32x16_bf16 v[112:127], a[232:235], v[168:171], v[112:127]
ds_read_b128 a[228:231], v1 offset:50176
v_fma_f32 v54, v54, v39, v38
v_fma_f32 v55, v55, v39, v38
v_mul_f32 v52, v52, v84
v_mul_f32 v53, v53, v85
v_mul_f32 v54, v54, v86
v_mfma_f32_32x32x16_bf16 v[112:127], a[236:239], v[172:175], v[112:127]
ds_read_b128 a[232:235], v1 offset:51200
v_mul_f32 v55, v55, v87
v_exp_f32 v52, v52
v_mul_f32 v84, v84, v92
s_waitcnt lgkmcnt(3)
v_mfma_f32_32x32x16_bf16 v[112:127], a[240:243], v[176:179], v[112:127]
ds_read_b128 a[236:239], v1 offset:52224
v_exp_f32 v53, v53
v_mul_f32 v85, v85, v93
v_mfma_f32_32x32x16_bf16 v[112:127], a[244:247], v[180:183], v[112:127]
ds_read_b128 a[240:243], v1 offset:53248
v_exp_f32 v54, v54
v_mul_f32 v86, v86, v94
v_exp_f32 v55, v55
v_mfma_f32_32x32x16_bf16 v[112:127], a[248:251], v[184:187], v[112:127]
ds_read_b128 a[244:247], v1 offset:54272
v_mul_f32 v87, v87, v95
v_fma_f32 v52, v52, v50, v50
v_fma_f32 v53, v53, v50, v50
v_fma_f32 v54, v54, v50, v50
v_fma_f32 v55, v55, v50, v50
v_mfma_f32_32x32x16_bf16 v[112:127], a[252:255], v[188:191], v[112:127]
ds_read_b128 a[248:251], v1 offset:55296
v_rcp_f32 v52, v52
v_rcp_f32 v53, v53
s_waitcnt lgkmcnt(3)
v_mfma_f32_32x32x16_bf16 v[112:127], a[224:227], v[192:195], v[112:127]
ds_read_b128 a[252:255], v1 offset:56320
v_rcp_f32 v54, v54
v_rcp_f32 v55, v55
v_mfma_f32_32x32x16_bf16 v[112:127], a[228:231], v[196:199], v[112:127]
ds_read_b128 a[224:227], v1 offset:57344
v_mul_f32 v84, v84, v52
v_mul_f32 v85, v85, v53
v_mul_f32 v86, v86, v54
v_mul_f32 v87, v87, v55
v_cvt_pk_bf16_f32 v48, v84, v85
v_mfma_f32_32x32x16_bf16 v[112:127], a[232:235], v[200:203], v[112:127]
ds_read_b128 a[228:231], v1 offset:58368
v_cvt_pk_bf16_f32 v49, v86, v87
s_add_u32 s37, s36, 10240
buffer_store_dwordx4 v[46:49], v40, s[4:7], s37 offen sc1
v_mul_f32 v52, v96, v96
v_mul_f32 v53, v97, v97
v_mul_f32 v54, v98, v98
v_mfma_f32_32x32x16_bf16 v[112:127], a[236:239], v[204:207], v[112:127]
ds_read_b128 a[232:235], v1 offset:59392
v_mul_f32 v55, v99, v99
v_fma_f32 v52, v52, v39, v38
v_fma_f32 v53, v53, v39, v38
v_fma_f32 v54, v54, v39, v38
v_fma_f32 v55, v55, v39, v38
s_waitcnt lgkmcnt(3)
v_mfma_f32_32x32x16_bf16 v[112:127], a[240:243], v[208:211], v[112:127]
ds_read_b128 a[236:239], v1 offset:60416
v_mul_f32 v52, v52, v96
v_mul_f32 v53, v53, v97
v_mul_f32 v54, v54, v98
v_mul_f32 v55, v55, v99
v_mfma_f32_32x32x16_bf16 v[112:127], a[244:247], v[212:215], v[112:127]
ds_read_b128 a[240:243], v1 offset:61440
v_exp_f32 v52, v52
v_mul_f32 v96, v96, v104
v_exp_f32 v53, v53
v_mfma_f32_32x32x16_bf16 v[112:127], a[248:251], v[216:219], v[112:127]
s_waitcnt vmcnt(10)
s_barrier
ds_read_b128 a[244:247], v1 offset:62464
s_add_u32 m0, s21, 65536
s_add_u32 s30, s20, 98304
buffer_load_dwordx4 v1, s[4:7], s30 offen offset:0  lds
v_mfma_f32_32x32x16_bf16 v[112:127], a[252:255], v[220:223], v[112:127]
ds_read_b128 a[248:251], v1 offset:63488
v_mul_f32 v97, v97, v105
v_exp_f32 v54, v54
v_mul_f32 v98, v98, v106
s_waitcnt lgkmcnt(3)
v_mfma_f32_32x32x16_bf16 v[112:127], a[224:227], v[224:227], v[112:127]
ds_read_b128 a[252:255], v1 offset:64512
v_exp_f32 v55, v55
v_mul_f32 v99, v99, v107
v_fma_f32 v52, v52, v50, v50
v_mfma_f32_32x32x16_bf16 v[112:127], a[228:231], v[228:231], v[112:127]
ds_read_b128 a[224:227], v3 offset:0
buffer_load_dwordx4 v1, s[4:7], s30 offen offset:1024  lds
v_fma_f32 v53, v53, v50, v50
v_fma_f32 v54, v54, v50, v50
v_fma_f32 v55, v55, v50, v50
v_mfma_f32_32x32x16_bf16 v[112:127], a[232:235], v[232:235], v[112:127]
ds_read_b128 a[228:231], v3 offset:1024
v_rcp_f32 v52, v52
v_rcp_f32 v53, v53
v_mfma_f32_32x32x16_bf16 v[112:127], a[236:239], v[236:239], v[112:127]
ds_read_b128 a[232:235], v3 offset:2048
buffer_load_dwordx4 v1, s[4:7], s30 offen offset:2048  lds
v_rcp_f32 v54, v54
v_rcp_f32 v55, v55
s_waitcnt lgkmcnt(3)
v_mfma_f32_32x32x16_bf16 v[112:127], a[240:243], v[240:243], v[112:127]
ds_read_b128 a[236:239], v3 offset:3072
v_mul_f32 v96, v96, v52
v_mul_f32 v97, v97, v53
v_mul_f32 v98, v98, v54
v_mul_f32 v99, v99, v55
v_mfma_f32_32x32x16_bf16 v[112:127], a[244:247], v[244:247], v[112:127]
ds_read_b128 a[240:243], v3 offset:4096
buffer_load_dwordx4 v1, s[4:7], s30 offen offset:3072  lds
v_cvt_pk_bf16_f32 v42, v96, v97
v_cvt_pk_bf16_f32 v43, v98, v99
v_mul_f32 v52, v100, v100
v_mul_f32 v53, v101, v101
v_mfma_f32_32x32x16_bf16 v[112:127], a[248:251], v[248:251], v[112:127]
ds_read_b128 a[244:247], v3 offset:5120
v_mul_f32 v54, v102, v102
v_mul_f32 v55, v103, v103
v_fma_f32 v52, v52, v39, v38
v_fma_f32 v53, v53, v39, v38
v_fma_f32 v54, v54, v39, v38
v_mfma_f32_32x32x16_bf16 v[112:127], a[252:255], v[252:255], v[112:127]
ds_read_b128 a[248:251], v3 offset:6144
s_add_u32 m0, s21, 69632
s_add_u32 s30, s20, 102400
buffer_load_dwordx4 v1, s[4:7], s30 offen offset:0  lds
v_fma_f32 v55, v55, v39, v38
v_mul_f32 v52, v52, v100
v_mfma_f32_32x32x16_bf16 v[64:79], v[24:27], v[34:37], 0
s_waitcnt lgkmcnt(3)
v_mfma_f32_32x32x16_bf16 v[64:79], a[224:227], v[128:131], v[64:79]
ds_read_b128 a[252:255], v3 offset:7168
buffer_load_dwordx4 v1, s[4:7], s30 offen offset:1024  lds
v_mfma_f32_32x32x16_bf16 v[64:79], a[228:231], v[132:135], v[64:79]
ds_read_b128 a[224:227], v3 offset:8192
v_mfma_f32_32x32x16_bf16 v[64:79], a[232:235], v[136:139], v[64:79]
ds_read_b128 a[228:231], v3 offset:9216
buffer_load_dwordx4 v1, s[4:7], s30 offen offset:2048  lds
v_mul_f32 v53, v53, v101
v_mul_f32 v54, v54, v102
v_mul_f32 v55, v55, v103
v_mfma_f32_32x32x16_bf16 v[64:79], a[236:239], v[140:143], v[64:79]
ds_read_b128 a[232:235], v3 offset:10240
v_exp_f32 v52, v52
v_mul_f32 v100, v100, v108
v_exp_f32 v53, v53
s_waitcnt lgkmcnt(3)
v_mfma_f32_32x32x16_bf16 v[64:79], a[240:243], v[144:147], v[64:79]
ds_read_b128 a[236:239], v3 offset:11264
buffer_load_dwordx4 v1, s[4:7], s30 offen offset:3072  lds
v_mul_f32 v101, v101, v109
v_exp_f32 v54, v54
v_mfma_f32_32x32x16_bf16 v[64:79], a[244:247], v[148:151], v[64:79]
ds_read_b128 a[240:243], v3 offset:12288
v_mul_f32 v102, v102, v110
v_exp_f32 v55, v55
v_mul_f32 v103, v103, v111
v_fma_f32 v52, v52, v50, v50
v_mfma_f32_32x32x16_bf16 v[64:79], a[248:251], v[152:155], v[64:79]
ds_read_b128 a[244:247], v3 offset:13312
v_fma_f32 v53, v53, v50, v50
v_fma_f32 v54, v54, v50, v50
v_fma_f32 v55, v55, v50, v50
v_rcp_f32 v52, v52
v_mfma_f32_32x32x16_bf16 v[64:79], a[252:255], v[156:159], v[64:79]
ds_read_b128 a[248:251], v3 offset:14336
v_rcp_f32 v53, v53
v_rcp_f32 v54, v54
s_waitcnt lgkmcnt(3)
v_mfma_f32_32x32x16_bf16 v[64:79], a[224:227], v[160:163], v[64:79]
ds_read_b128 a[252:255], v3 offset:15360
v_rcp_f32 v55, v55
v_mul_f32 v100, v100, v52
v_mul_f32 v101, v101, v53
v_mfma_f32_32x32x16_bf16 v[64:79], a[228:231], v[164:167], v[64:79]
ds_read_b128 a[224:227], v3 offset:16384
v_mul_f32 v102, v102, v54
v_mul_f32 v103, v103, v55
v_cvt_pk_bf16_f32 v44, v100, v101
v_cvt_pk_bf16_f32 v45, v102, v103
s_add_u32 s37, s36, 12288
buffer_store_dwordx4 v[42:45], v40, s[4:7], s37 offen sc1
v_mfma_f32_32x32x16_bf16 v[64:79], a[232:235], v[168:171], v[64:79]
ds_read_b128 a[228:231], v3 offset:17408
v_mul_f32 v52, v112, v112
v_mul_f32 v53, v113, v113
v_mul_f32 v54, v114, v114
v_mul_f32 v55, v115, v115
v_fma_f32 v52, v52, v39, v38
v_mfma_f32_32x32x16_bf16 v[64:79], a[236:239], v[172:175], v[64:79]
ds_read_b128 a[232:235], v3 offset:18432
v_fma_f32 v53, v53, v39, v38
v_fma_f32 v54, v54, v39, v38
v_fma_f32 v55, v55, v39, v38
v_mul_f32 v52, v52, v112
v_mul_f32 v53, v53, v113
s_waitcnt lgkmcnt(3)
v_mfma_f32_32x32x16_bf16 v[64:79], a[240:243], v[176:179], v[64:79]
ds_read_b128 a[236:239], v3 offset:19456
v_mul_f32 v54, v54, v114
v_mul_f32 v55, v55, v115
v_exp_f32 v52, v52
v_mfma_f32_32x32x16_bf16 v[64:79], a[244:247], v[180:183], v[64:79]
ds_read_b128 a[240:243], v3 offset:20480
v_mul_f32 v112, v112, v120
v_exp_f32 v53, v53
v_mul_f32 v113, v113, v121
v_mfma_f32_32x32x16_bf16 v[64:79], a[248:251], v[184:187], v[64:79]
ds_read_b128 a[244:247], v3 offset:21504
v_exp_f32 v54, v54
v_mul_f32 v114, v114, v122
v_exp_f32 v55, v55
v_mfma_f32_32x32x16_bf16 v[64:79], a[252:255], v[188:191], v[64:79]
ds_read_b128 a[248:251], v3 offset:22528
v_mul_f32 v115, v115, v123
v_fma_f32 v52, v52, v50, v50
v_fma_f32 v53, v53, v50, v50
v_fma_f32 v54, v54, v50, v50
v_fma_f32 v55, v55, v50, v50
s_waitcnt lgkmcnt(3)
v_mfma_f32_32x32x16_bf16 v[64:79], a[224:227], v[192:195], v[64:79]
ds_read_b128 a[252:255], v3 offset:23552
v_rcp_f32 v52, v52
v_rcp_f32 v53, v53
v_mfma_f32_32x32x16_bf16 v[64:79], a[228:231], v[196:199], v[64:79]
ds_read_b128 a[224:227], v3 offset:24576
v_rcp_f32 v54, v54
v_rcp_f32 v55, v55
v_mul_f32 v112, v112, v52
v_mfma_f32_32x32x16_bf16 v[64:79], a[232:235], v[200:203], v[64:79]
ds_read_b128 a[228:231], v3 offset:25600
v_mul_f32 v113, v113, v53
v_mul_f32 v114, v114, v54
v_mul_f32 v115, v115, v55
v_cvt_pk_bf16_f32 v46, v112, v113
v_cvt_pk_bf16_f32 v47, v114, v115
v_mfma_f32_32x32x16_bf16 v[64:79], a[236:239], v[204:207], v[64:79]
ds_read_b128 a[232:235], v3 offset:26624
v_mul_f32 v52, v116, v116
v_mul_f32 v53, v117, v117
v_mul_f32 v54, v118, v118
v_mul_f32 v55, v119, v119
v_fma_f32 v52, v52, v39, v38
s_waitcnt lgkmcnt(3)
v_mfma_f32_32x32x16_bf16 v[64:79], a[240:243], v[208:211], v[64:79]
ds_read_b128 a[236:239], v3 offset:27648
v_fma_f32 v53, v53, v39, v38
v_fma_f32 v54, v54, v39, v38
v_fma_f32 v55, v55, v39, v38
v_mul_f32 v52, v52, v116
v_mfma_f32_32x32x16_bf16 v[64:79], a[244:247], v[212:215], v[64:79]
ds_read_b128 a[240:243], v3 offset:28672
v_mul_f32 v53, v53, v117
v_mul_f32 v54, v54, v118
v_mul_f32 v55, v55, v119
v_exp_f32 v52, v52
v_mfma_f32_32x32x16_bf16 v[64:79], a[248:251], v[216:219], v[64:79]
s_waitcnt vmcnt(10)
s_barrier
ds_read_b128 a[244:247], v3 offset:29696
L_here_44:
s_add_u32 s99, s13, L_here_44-L_pc+2048
buffer_load_dword v5, off, s[92:95], s99
v_mfma_f32_32x32x16_bf16 v[64:79], a[252:255], v[220:223], v[64:79]
ds_read_b128 a[248:251], v3 offset:30720
v_mul_f32 v116, v116, v124
v_exp_f32 v53, v53
v_mul_f32 v117, v117, v125
s_waitcnt lgkmcnt(3)
v_mfma_f32_32x32x16_bf16 v[64:79], a[224:227], v[224:227], v[64:79]
ds_read_b128 a[252:255], v3 offset:31744
v_exp_f32 v54, v54
v_mul_f32 v118, v118, v126
v_mfma_f32_32x32x16_bf16 v[64:79], a[228:231], v[228:231], v[64:79]
ds_read_b128 a[224:227], v2 offset:32768
v_exp_f32 v55, v55
v_mul_f32 v119, v119, v127
v_fma_f32 v52, v52, v50, v50
v_fma_f32 v53, v53, v50, v50
v_mfma_f32_32x32x16_bf16 v[64:79], a[232:235], v[232:235], v[64:79]
ds_read_b128 a[228:231], v2 offset:33792
v_fma_f32 v54, v54, v50, v50
v_fma_f32 v55, v55, v50, v50
v_rcp_f32 v52, v52
v_mfma_f32_32x32x16_bf16 v[64:79], a[236:239], v[236:239], v[64:79]
ds_read_b128 a[232:235], v2 offset:34816
v_rcp_f32 v53, v53
v_rcp_f32 v54, v54
s_waitcnt lgkmcnt(3)
v_mfma_f32_32x32x16_bf16 v[64:79], a[240:243], v[240:243], v[64:79]
ds_read_b128 a[236:239], v2 offset:35840
v_rcp_f32 v55, v55
v_mul_f32 v116, v116, v52
v_mul_f32 v117, v117, v53
v_mfma_f32_32x32x16_bf16 v[64:79], a[244:247], v[244:247], v[64:79]
ds_read_b128 a[240:243], v2 offset:36864
v_mul_f32 v118, v118, v54
v_mul_f32 v119, v119, v55
v_cvt_pk_bf16_f32 v48, v116, v117
v_cvt_pk_bf16_f32 v49, v118, v119
s_add_u32 s37, s36, 6144
buffer_store_dwordx4 v[46:49], v40, s[4:7], s37 offen sc1
v_mfma_f32_32x32x16_bf16 v[64:79], a[248:251], v[248:251], v[64:79]
ds_read_b128 a[244:247], v2 offset:37888
v_mfma_f32_32x32x16_bf16 v[64:79], a[252:255], v[252:255], v[64:79]
ds_read_b128 a[248:251], v2 offset:38912
v_mfma_f32_32x32x16_bf16 v[80:95], v[26:29], v[32:35], 0
s_waitcnt lgkmcnt(3)
v_mfma_f32_32x32x16_bf16 v[80:95], a[224:227], v[128:131], v[80:95]
ds_read_b128 a[252:255], v2 offset:39936
v_mfma_f32_32x32x16_bf16 v[80:95], a[228:231], v[132:135], v[80:95]
ds_read_b128 a[224:227], v2 offset:40960
v_mfma_f32_32x32x16_bf16 v[80:95], a[232:235], v[136:139], v[80:95]
ds_read_b128 a[228:231], v2 offset:41984
s_nop 2
v_mul_f32 v52, v64, v64
v_mul_f32 v53, v65, v65
v_mul_f32 v54, v66, v66
v_mul_f32 v55, v67, v67
v_fma_f32 v52, v52, v39, v38
v_mfma_f32_32x32x16_bf16 v[80:95], a[236:239], v[140:143], v[80:95]
ds_read_b128 a[232:235], v2 offset:43008
v_fma_f32 v53, v53, v39, v38
v_fma_f32 v54, v54, v39, v38
v_fma_f32 v55, v55, v39, v38
v_mul_f32 v52, v52, v64
v_mul_f32 v53, v53, v65
s_waitcnt lgkmcnt(3)
v_mfma_f32_32x32x16_bf16 v[80:95], a[240:243], v[144:147], v[80:95]
ds_read_b128 a[236:239], v2 offset:44032
v_mul_f32 v54, v54, v66
v_mul_f32 v55, v55, v67
v_exp_f32 v52, v52
v_mfma_f32_32x32x16_bf16 v[80:95], a[244:247], v[148:151], v[80:95]
ds_read_b128 a[240:243], v2 offset:45056
v_mul_f32 v64, v64, v72
v_exp_f32 v53, v53
v_mul_f32 v65, v65, v73
v_mfma_f32_32x32x16_bf16 v[80:95], a[248:251], v[152:155], v[80:95]
ds_read_b128 a[244:247], v2 offset:46080
v_exp_f32 v54, v54
v_mul_f32 v66, v66, v74
v_exp_f32 v55, v55
v_mfma_f32_32x32x16_bf16 v[80:95], a[252:255], v[156:159], v[80:95]
ds_read_b128 a[248:251], v2 offset:47104
v_mul_f32 v67, v67, v75
v_fma_f32 v52, v52, v50, v50
v_fma_f32 v53, v53, v50, v50
v_fma_f32 v54, v54, v50, v50
v_fma_f32 v55, v55, v50, v50
s_waitcnt lgkmcnt(3)
v_mfma_f32_32x32x16_bf16 v[80:95], a[224:227], v[160:163], v[80:95]
ds_read_b128 a[252:255], v2 offset:48128
v_rcp_f32 v52, v52
v_rcp_f32 v53, v53
v_mfma_f32_32x32x16_bf16 v[80:95], a[228:231], v[164:167], v[80:95]
ds_read_b128 a[224:227], v2 offset:49152
v_rcp_f32 v54, v54
v_rcp_f32 v55, v55
v_mul_f32 v64, v64, v52
v_mfma_f32_32x32x16_bf16 v[80:95], a[232:235], v[168:171], v[80:95]
ds_read_b128 a[228:231], v2 offset:50176
v_mov_b32 v4, 11
s_waitcnt vmcnt(0)
s_mov_b64 exec, 1
buffer_store_dword v4, off, s[4:7], s78
s_mov_b64 exec, -1
v_mfma_f32_32x32x16_bf16 v[80:95], a[236:239], v[172:175], v[80:95]
ds_read_b128 a[232:235], v2 offset:51200
v_mul_f32 v65, v65, v53
v_mul_f32 v66, v66, v54
v_mul_f32 v67, v67, v55
v_cvt_pk_bf16_f32 v42, v64, v65
v_cvt_pk_bf16_f32 v43, v66, v67
s_waitcnt lgkmcnt(3)
v_mfma_f32_32x32x16_bf16 v[80:95], a[240:243], v[176:179], v[80:95]
ds_read_b128 a[236:239], v2 offset:52224
v_mul_f32 v52, v68, v68
v_mul_f32 v53, v69, v69
v_mul_f32 v54, v70, v70
v_mul_f32 v55, v71, v71
v_mfma_f32_32x32x16_bf16 v[80:95], a[244:247], v[180:183], v[80:95]
ds_read_b128 a[240:243], v2 offset:53248
v_fma_f32 v52, v52, v39, v38
v_fma_f32 v53, v53, v39, v38
v_fma_f32 v54, v54, v39, v38
v_fma_f32 v55, v55, v39, v38
v_mul_f32 v52, v52, v68
v_mfma_f32_32x32x16_bf16 v[80:95], a[248:251], v[184:187], v[80:95]
ds_read_b128 a[244:247], v2 offset:54272
v_mul_f32 v53, v53, v69
v_mul_f32 v54, v54, v70
v_mul_f32 v55, v55, v71
v_exp_f32 v52, v52
v_mfma_f32_32x32x16_bf16 v[80:95], a[252:255], v[188:191], v[80:95]
ds_read_b128 a[248:251], v2 offset:55296
v_mul_f32 v68, v68, v76
v_exp_f32 v53, v53
v_mul_f32 v69, v69, v77
s_waitcnt lgkmcnt(3)
v_mfma_f32_32x32x16_bf16 v[80:95], a[224:227], v[192:195], v[80:95]
ds_read_b128 a[252:255], v2 offset:56320
v_exp_f32 v54, v54
v_mul_f32 v70, v70, v78
v_mfma_f32_32x32x16_bf16 v[80:95], a[228:231], v[196:199], v[80:95]
ds_read_b128 a[224:227], v2 offset:57344
v_exp_f32 v55, v55
v_mul_f32 v71, v71, v79
v_fma_f32 v52, v52, v50, v50
v_fma_f32 v53, v53, v50, v50
v_mfma_f32_32x32x16_bf16 v[80:95], a[232:235], v[200:203], v[80:95]
ds_read_b128 a[228:231], v2 offset:58368
v_fma_f32 v54, v54, v50, v50
v_fma_f32 v55, v55, v50, v50
v_rcp_f32 v52, v52
v_mfma_f32_32x32x16_bf16 v[80:95], a[236:239], v[204:207], v[80:95]
ds_read_b128 a[232:235], v2 offset:59392
v_rcp_f32 v53, v53
v_rcp_f32 v54, v54
s_waitcnt lgkmcnt(3)
v_mfma_f32_32x32x16_bf16 v[80:95], a[240:243], v[208:211], v[80:95]
ds_read_b128 a[236:239], v2 offset:60416
v_rcp_f32 v55, v55
v_mul_f32 v68, v68, v52
v_mul_f32 v69, v69, v53
v_mfma_f32_32x32x16_bf16 v[80:95], a[244:247], v[212:215], v[80:95]
ds_read_b128 a[240:243], v2 offset:61440
buffer_load_dword v63, v62, s[4:7], s79 offen sc1
v_mul_f32 v70, v70, v54
v_mul_f32 v71, v71, v55
v_cvt_pk_bf16_f32 v44, v68, v69
v_cvt_pk_bf16_f32 v45, v70, v71
v_mfma_f32_32x32x16_bf16 v[80:95], a[248:251], v[216:219], v[80:95]
s_barrier
ds_read_b128 a[244:247], v2 offset:62464
s_add_u32 s37, s36, 4096
buffer_store_dwordx4 v[42:45], v40, s[4:7], s37 offen sc1
v_mfma_f32_32x32x16_bf16 v[80:95], a[252:255], v[220:223], v[80:95]
ds_read_b128 a[248:251], v2 offset:63488
s_waitcnt lgkmcnt(3)
v_mfma_f32_32x32x16_bf16 v[80:95], a[224:227], v[224:227], v[80:95]
ds_read_b128 a[252:255], v2 offset:64512
v_mfma_f32_32x32x16_bf16 v[80:95], a[228:231], v[228:231], v[80:95]
ds_read_b128 a[224:227], v2 offset:0
v_mfma_f32_32x32x16_bf16 v[80:95], a[232:235], v[232:235], v[80:95]
ds_read_b128 a[228:231], v2 offset:1024
v_mfma_f32_32x32x16_bf16 v[80:95], a[236:239], v[236:239], v[80:95]
ds_read_b128 a[232:235], v2 offset:2048
s_waitcnt lgkmcnt(3)
v_mfma_f32_32x32x16_bf16 v[80:95], a[240:243], v[240:243], v[80:95]
ds_read_b128 a[236:239], v2 offset:3072
v_mfma_f32_32x32x16_bf16 v[80:95], a[244:247], v[244:247], v[80:95]
ds_read_b128 a[240:243], v2 offset:4096
v_mfma_f32_32x32x16_bf16 v[80:95], a[248:251], v[248:251], v[80:95]
ds_read_b128 a[244:247], v2 offset:5120
v_mfma_f32_32x32x16_bf16 v[80:95], a[252:255], v[252:255], v[80:95]
ds_read_b128 a[248:251], v2 offset:6144
s_waitcnt vmcnt(1)
v_cmp_gt_u32 vcc, 11, v63
s_nop 0
s_cbranch_vccnz L_poll_45
L_polled_46:
v_mfma_f32_32x32x16_bf16 v[96:111], v[22:25], v[34:37], 0
s_waitcnt lgkmcnt(3)
v_mfma_f32_32x32x16_bf16 v[96:111], a[224:227], v[128:131], v[96:111]
ds_read_b128 a[252:255], v2 offset:7168
v_mfma_f32_32x32x16_bf16 v[96:111], a[228:231], v[132:135], v[96:111]
ds_read_b128 a[224:227], v2 offset:8192
s_add_u32 s23, s87, 32512000
buffer_load_dwordx4 v[128:131], v1, s[4:7], s23 offen offset:0 sc1
v_mfma_f32_32x32x16_bf16 v[96:111], a[232:235], v[136:139], v[96:111]
ds_read_b128 a[228:231], v2 offset:9216
buffer_load_dwordx4 v[132:135], v1, s[4:7], s23 offen offset:1024 sc1
v_mul_f32 v52, v80, v80
v_mul_f32 v53, v81, v81
v_mul_f32 v54, v82, v82
v_mul_f32 v55, v83, v83
v_mfma_f32_32x32x16_bf16 v[96:111], a[236:239], v[140:143], v[96:111]
ds_read_b128 a[232:235], v2 offset:10240
buffer_load_dwordx4 v[136:139], v1, s[4:7], s23 offen offset:2048 sc1
v_fma_f32 v52, v52, v39, v38
v_fma_f32 v53, v53, v39, v38
v_fma_f32 v54, v54, v39, v38
v_fma_f32 v55, v55, v39, v38
s_waitcnt lgkmcnt(3)
v_mfma_f32_32x32x16_bf16 v[96:111], a[240:243], v[144:147], v[96:111]
ds_read_b128 a[236:239], v2 offset:11264
buffer_load_dwordx4 v[140:143], v1, s[4:7], s23 offen offset:3072 sc1
v_mul_f32 v52, v52, v80
v_mul_f32 v53, v53, v81
v_mul_f32 v54, v54, v82
v_mfma_f32_32x32x16_bf16 v[96:111], a[244:247], v[148:151], v[96:111]
ds_read_b128 a[240:243], v2 offset:12288
v_mul_f32 v55, v55, v83
v_exp_f32 v52, v52
v_mul_f32 v80, v80, v88
v_mfma_f32_32x32x16_bf16 v[96:111], a[248:251], v[152:155], v[96:111]
ds_read_b128 a[244:247], v2 offset:13312
s_add_u32 s23, s87, 32516096
buffer_load_dwordx4 v[144:147], v1, s[4:7], s23 offen offset:0 sc1
v_exp_f32 v53, v53
v_mul_f32 v81, v81, v89
v_mfma_f32_32x32x16_bf16 v[96:111], a[252:255], v[156:159], v[96:111]
ds_read_b128 a[248:251], v2 offset:14336
v_exp_f32 v54, v54
v_mul_f32 v82, v82, v90
v_exp_f32 v55, v55
s_waitcnt lgkmcnt(3)
v_mfma_f32_32x32x16_bf16 v[96:111], a[224:227], v[160:163], v[96:111]
ds_read_b128 a[252:255], v2 offset:15360
buffer_load_dwordx4 v[148:151], v1, s[4:7], s23 offen offset:1024 sc1
v_mul_f32 v83, v83, v91
v_fma_f32 v52, v52, v50, v50
v_fma_f32 v53, v53, v50, v50
v_mfma_f32_32x32x16_bf16 v[96:111], a[228:231], v[164:167], v[96:111]
ds_read_b128 a[224:227], v2 offset:16384
v_fma_f32 v54, v54, v50, v50
v_fma_f32 v55, v55, v50, v50
v_rcp_f32 v52, v52
v_mfma_f32_32x32x16_bf16 v[96:111], a[232:235], v[168:171], v[96:111]
ds_read_b128 a[228:231], v2 offset:17408
buffer_load_dwordx4 v[152:155], v1, s[4:7], s23 offen offset:2048 sc1
v_rcp_f32 v53, v53
v_rcp_f32 v54, v54
v_mfma_f32_32x32x16_bf16 v[96:111], a[236:239], v[172:175], v[96:111]
ds_read_b128 a[232:235], v2 offset:18432
v_rcp_f32 v55, v55
v_mul_f32 v80, v80, v52
v_mul_f32 v81, v81, v53
v_mul_f32 v82, v82, v54
s_waitcnt lgkmcnt(3)
v_mfma_f32_32x32x16_bf16 v[96:111], a[240:243], v[176:179], v[96:111]
ds_read_b128 a[236:239], v2 offset:19456
buffer_load_dwordx4 v[156:159], v1, s[4:7], s23 offen offset:3072 sc1
v_mul_f32 v83, v83, v55
v_cvt_pk_bf16_f32 v46, v80, v81
v_cvt_pk_bf16_f32 v47, v82, v83
v_mfma_f32_32x32x16_bf16 v[96:111], a[244:247], v[180:183], v[96:111]
ds_read_b128 a[240:243], v2 offset:20480
v_mul_f32 v52, v84, v84
v_mul_f32 v53, v85, v85
v_mul_f32 v54, v86, v86
v_mul_f32 v55, v87, v87
v_fma_f32 v52, v52, v39, v38
v_mfma_f32_32x32x16_bf16 v[96:111], a[248:251], v[184:187], v[96:111]
ds_read_b128 a[244:247], v2 offset:21504
s_add_u32 s23, s87, 32526336
buffer_load_dwordx4 v[160:163], v1, s[4:7], s23 offen offset:0 sc1
v_fma_f32 v53, v53, v39, v38
v_fma_f32 v54, v54, v39, v38
v_fma_f32 v55, v55, v39, v38
v_mfma_f32_32x32x16_bf16 v[96:111], a[252:255], v[188:191], v[96:111]
ds_read_b128 a[248:251], v2 offset:22528
v_mul_f32 v52, v52, v84
v_mul_f32 v53, v53, v85
v_mul_f32 v54, v54, v86
v_mul_f32 v55, v55, v87
s_waitcnt lgkmcnt(3)
v_mfma_f32_32x32x16_bf16 v[96:111], a[224:227], v[192:195], v[96:111]
ds_read_b128 a[252:255], v2 offset:23552
buffer_load_dwordx4 v[164:167], v1, s[4:7], s23 offen offset:1024 sc1
v_exp_f32 v52, v52
v_mul_f32 v84, v84, v92
v_mfma_f32_32x32x16_bf16 v[96:111], a[228:231], v[196:199], v[96:111]
ds_read_b128 a[224:227], v2 offset:24576
v_exp_f32 v53, v53
v_mul_f32 v85, v85, v93
v_exp_f32 v54, v54
v_mfma_f32_32x32x16_bf16 v[96:111], a[232:235], v[200:203], v[96:111]
ds_read_b128 a[228:231], v2 offset:25600
buffer_load_dwordx4 v[168:171], v1, s[4:7], s23 offen offset:2048 sc1
v_mul_f32 v86, v86, v94
v_exp_f32 v55, v55
v_mul_f32 v87, v87, v95
v_mfma_f32_32x32x16_bf16 v[96:111], a[236:239], v[204:207], v[96:111]
ds_read_b128 a[232:235], v2 offset:26624
v_fma_f32 v52, v52, v50, v50
v_fma_f32 v53, v53, v50, v50
v_fma_f32 v54, v54, v50, v50
v_fma_f32 v55, v55, v50, v50
s_waitcnt lgkmcnt(3)
v_mfma_f32_32x32x16_bf16 v[96:111], a[240:243], v[208:211], v[96:111]
ds_read_b128 a[236:239], v2 offset:27648
buffer_load_dwordx4 v[172:175], v1, s[4:7], s23 offen offset:3072 sc1
v_rcp_f32 v52, v52
v_mfma_f32_32x32x16_bf16 v[96:111], a[244:247], v[212:215], v[96:111]
ds_read_b128 a[240:243], v2 offset:28672
v_rcp_f32 v53, v53
v_rcp_f32 v54, v54
v_mfma_f32_32x32x16_bf16 v[96:111], a[248:251], v[216:219], v[96:111]
ds_read_b128 a[244:247], v2 offset:29696
s_add_u32 s23, s87, 32530432
buffer_load_dwordx4 v[176:179], v1, s[4:7], s23 offen offset:0 sc1
v_rcp_f32 v55, v55
v_mul_f32 v84, v84, v52
v_mfma_f32_32x32x16_bf16 v[96:111], a[252:255], v[220:223], v[96:111]
ds_read_b128 a[248:251], v2 offset:30720
v_mul_f32 v85, v85, v53
v_mul_f32 v86, v86, v54
v_mul_f32 v87, v87, v55
v_cvt_pk_bf16_f32 v48, v84, v85
v_cvt_pk_bf16_f32 v49, v86, v87
s_waitcnt lgkmcnt(3)
v_mfma_f32_32x32x16_bf16 v[96:111], a[224:227], v[224:227], v[96:111]
ds_read_b128 a[252:255], v2 offset:31744
buffer_load_dwordx4 v[180:183], v1, s[4:7], s23 offen offset:1024 sc1
buffer_store_dwordx4 v[46:49], v40, s[4:7], s28 offen offset:0
v_mfma_f32_32x32x16_bf16 v[96:111], a[228:231], v[228:231], v[96:111]
v_mfma_f32_32x32x16_bf16 v[96:111], a[232:235], v[232:235], v[96:111]
buffer_load_dwordx4 v[184:187], v1, s[4:7], s23 offen offset:2048 sc1
v_mfma_f32_32x32x16_bf16 v[96:111], a[236:239], v[236:239], v[96:111]
s_waitcnt lgkmcnt(0)
v_mfma_f32_32x32x16_bf16 v[96:111], a[240:243], v[240:243], v[96:111]
buffer_load_dwordx4 v[188:191], v1, s[4:7], s23 offen offset:3072 sc1
v_mfma_f32_32x32x16_bf16 v[96:111], a[244:247], v[244:247], v[96:111]
v_mfma_f32_32x32x16_bf16 v[96:111], a[248:251], v[248:251], v[96:111]
s_add_u32 s23, s87, 32626688
buffer_load_dwordx4 v[192:195], v1, s[4:7], s23 offen offset:0 sc1
v_mfma_f32_32x32x16_bf16 v[96:111], a[252:255], v[252:255], v[96:111]
ds_bpermute_b32 v6, v60, v6
ds_bpermute_b32 v7, v60, v7
ds_bpermute_b32 v8, v60, v8
ds_bpermute_b32 v9, v60, v9
ds_bpermute_b32 v10, v60, v10
ds_bpermute_b32 v11, v60, v11
ds_bpermute_b32 v12, v60, v12
ds_bpermute_b32 v13, v60, v13
s_waitcnt vmcnt(17)
v_mfma_f32_16x16x32_bf16 v[64:67], a[48:51], v[128:131], 0
buffer_load_dwordx4 v[196:199], v1, s[4:7], s23 offen offset:1024 sc1
v_mfma_f32_16x16x32_bf16 v[68:71], a[52:55], v[128:131], 0
v_mfma_f32_16x16x32_bf16 v[72:75], a[56:59], v[128:131], 0
v_mfma_f32_16x16x32_bf16 v[76:79], a[60:63], v[128:131], 0
s_waitcnt vmcnt(17)
v_mfma_f32_16x16x32_bf16 v[92:95], a[60:63], v[132:135], 0
buffer_load_dwordx4 v[200:203], v1, s[4:7], s23 offen offset:2048 sc1
v_mul_f32 v52, v96, v96
v_mul_f32 v53, v97, v97
v_mul_f32 v54, v98, v98
v_mfma_f32_16x16x32_bf16 v[88:91], a[56:59], v[132:135], 0
v_mul_f32 v55, v99, v99
v_fma_f32 v52, v52, v39, v38
v_fma_f32 v53, v53, v39, v38
v_fma_f32 v54, v54, v39, v38
v_mfma_f32_16x16x32_bf16 v[84:87], a[52:55], v[132:135], 0
v_fma_f32 v55, v55, v39, v38
v_mul_f32 v52, v52, v96
v_mul_f32 v53, v53, v97
v_mul_f32 v54, v54, v98
v_mfma_f32_16x16x32_bf16 v[80:83], a[48:51], v[132:135], 0
v_mul_f32 v55, v55, v99
v_exp_f32 v52, v52
v_mul_f32 v96, v96, v104
s_waitcnt vmcnt(17)
v_mfma_f32_16x16x32_bf16 v[64:67], a[64:67], v[136:139], v[64:67]
buffer_load_dwordx4 v[204:207], v1, s[4:7], s23 offen offset:3072 sc1
v_exp_f32 v53, v53
v_mul_f32 v97, v97, v105
v_mfma_f32_16x16x32_bf16 v[68:71], a[68:71], v[136:139], v[68:71]
v_exp_f32 v54, v54
v_mul_f32 v98, v98, v106
v_mfma_f32_16x16x32_bf16 v[72:75], a[72:75], v[136:139], v[72:75]
v_exp_f32 v55, v55
v_mul_f32 v99, v99, v107
v_fma_f32 v52, v52, v50, v50
v_mfma_f32_16x16x32_bf16 v[76:79], a[76:79], v[136:139], v[76:79]
v_fma_f32 v53, v53, v50, v50
v_fma_f32 v54, v54, v50, v50
v_fma_f32 v55, v55, v50, v50
s_waitcnt vmcnt(17)
v_mfma_f32_16x16x32_bf16 v[92:95], a[76:79], v[140:143], v[92:95]
s_add_u32 s23, s87, 32630784
buffer_load_dwordx4 v[208:211], v1, s[4:7], s23 offen offset:0 sc1
v_rcp_f32 v52, v52
v_mfma_f32_16x16x32_bf16 v[88:91], a[72:75], v[140:143], v[88:91]
v_rcp_f32 v53, v53
v_rcp_f32 v54, v54
v_mfma_f32_16x16x32_bf16 v[84:87], a[68:71], v[140:143], v[84:87]
v_rcp_f32 v55, v55
v_mul_f32 v96, v96, v52
v_mul_f32 v97, v97, v53
v_mfma_f32_16x16x32_bf16 v[80:83], a[64:67], v[140:143], v[80:83]
v_mul_f32 v98, v98, v54
v_mul_f32 v99, v99, v55
v_cvt_pk_bf16_f32 v42, v96, v97
v_cvt_pk_bf16_f32 v43, v98, v99
v_mov_b32 v4, 12
s_waitcnt vmcnt(7)
s_mov_b64 exec, 1
buffer_store_dword v4, off, s[4:7], s78
s_mov_b64 exec, -1
v_mfma_f32_16x16x32_bf16 v[64:67], a[80:83], v[144:147], v[64:67]
buffer_load_dwordx4 v[212:215], v1, s[4:7], s23 offen offset:1024 sc1
v_mul_f32 v52, v100, v100
v_mul_f32 v53, v101, v101
v_mul_f32 v54, v102, v102
v_mfma_f32_16x16x32_bf16 v[68:71], a[84:87], v[144:147], v[68:71]
v_mul_f32 v55, v103, v103
v_fma_f32 v52, v52, v39, v38
v_fma_f32 v53, v53, v39, v38
v_fma_f32 v54, v54, v39, v38
v_mfma_f32_16x16x32_bf16 v[72:75], a[88:91], v[144:147], v[72:75]
v_fma_f32 v55, v55, v39, v38
v_mul_f32 v52, v52, v100
v_mul_f32 v53, v53, v101
v_mul_f32 v54, v54, v102
v_mfma_f32_16x16x32_bf16 v[76:79], a[92:95], v[144:147], v[76:79]
v_mul_f32 v55, v55, v103
v_exp_f32 v52, v52
v_mul_f32 v100, v100, v108
v_mfma_f32_16x16x32_bf16 v[92:95], a[92:95], v[148:151], v[92:95]
buffer_load_dwordx4 v[216:219], v1, s[4:7], s23 offen offset:2048 sc1
v_exp_f32 v53, v53
v_mul_f32 v101, v101, v109
v_mfma_f32_16x16x32_bf16 v[88:91], a[88:91], v[148:151], v[88:91]
v_exp_f32 v54, v54
v_mul_f32 v102, v102, v110
v_mfma_f32_16x16x32_bf16 v[84:87], a[84:87], v[148:151], v[84:87]
v_exp_f32 v55, v55
v_mul_f32 v103, v103, v111
v_fma_f32 v52, v52, v50, v50
v_mfma_f32_16x16x32_bf16 v[80:83], a[80:83], v[148:151], v[80:83]
v_fma_f32 v53, v53, v50, v50
v_fma_f32 v54, v54, v50, v50
v_fma_f32 v55, v55, v50, v50
v_mfma_f32_16x16x32_bf16 v[64:67], a[96:99], v[152:155], v[64:67]
buffer_load_dwordx4 v[220:223], v1, s[4:7], s23 offen offset:3072 sc1
v_rcp_f32 v52, v52
v_mfma_f32_16x16x32_bf16 v[68:71], a[100:103], v[152:155], v[68:71]
v_rcp_f32 v53, v53
v_rcp_f32 v54, v54
v_mfma_f32_16x16x32_bf16 v[72:75], a[104:107], v[152:155], v[72:75]
v_rcp_f32 v55, v55
v_mul_f32 v100, v100, v52
v_mul_f32 v101, v101, v53
v_mfma_f32_16x16x32_bf16 v[76:79], a[108:111], v[152:155], v[76:79]
v_mul_f32 v102, v102, v54
v_mul_f32 v103, v103, v55
v_cvt_pk_bf16_f32 v44, v100, v101
v_cvt_pk_bf16_f32 v45, v102, v103
v_mfma_f32_16x16x32_bf16 v[92:95], a[108:111], v[156:159], v[92:95]
s_add_u32 s23, s87, 32641024
buffer_load_dwordx4 v[224:227], v1, s[4:7], s23 offen offset:0 sc1
buffer_store_dwordx4 v[42:45], v40, s[4:7], s28 offen offset:2048
s_waitcnt lgkmcnt(0)
v_mfma_f32_16x16x32_bf16 v[88:91], a[104:107], v[156:159], v[88:91]
s_mov_b32 s36, s88
v_permlane16_swap_b32 v6, v8
v_mfma_f32_16x16x32_bf16 v[84:87], a[100:103], v[156:159], v[84:87]
v_permlane16_swap_b32 v7, v9
v_permlane16_swap_b32 v10, v12
v_mfma_f32_16x16x32_bf16 v[80:83], a[96:99], v[156:159], v[80:83]
v_permlane16_swap_b32 v11, v13
s_add_u32 s15, s36, 32768
v_mfma_f32_16x16x32_bf16 v[64:67], a[160:163], v[160:163], v[64:67]
buffer_load_dwordx4 v[228:231], v1, s[4:7], s23 offen offset:1024 sc1
v_lshlrev_b32 v40, 16, v6
v_mfma_f32_16x16x32_bf16 v[68:71], a[164:167], v[160:163], v[68:71]
v_and_b32 v41, 0xffff0000, v6
v_lshlrev_b32 v42, 16, v7
v_mfma_f32_16x16x32_bf16 v[72:75], a[168:171], v[160:163], v[72:75]
v_and_b32 v43, 0xffff0000, v7
v_lshlrev_b32 v44, 16, v8
v_mfma_f32_16x16x32_bf16 v[76:79], a[172:175], v[160:163], v[76:79]
v_and_b32 v45, 0xffff0000, v8
v_lshlrev_b32 v46, 16, v9
buffer_load_dword v63, v62, s[4:7], s79 offen sc1
v_mfma_f32_16x16x32_bf16 v[92:95], a[172:175], v[164:167], v[92:95]
buffer_load_dwordx4 v[232:235], v1, s[4:7], s23 offen offset:2048 sc1
v_and_b32 v47, 0xffff0000, v9
v_mfma_f32_16x16x32_bf16 v[88:91], a[168:171], v[164:167], v[88:91]
v_lshlrev_b32 v48, 16, v10
v_and_b32 v49, 0xffff0000, v10
v_mfma_f32_16x16x32_bf16 v[84:87], a[164:167], v[164:167], v[84:87]
v_lshlrev_b32 v50, 16, v11
v_and_b32 v51, 0xffff0000, v11
v_mfma_f32_16x16x32_bf16 v[80:83], a[160:163], v[164:167], v[80:83]
v_lshlrev_b32 v52, 16, v12
v_and_b32 v53, 0xffff0000, v12
v_mfma_f32_16x16x32_bf16 v[64:67], a[176:179], v[168:171], v[64:67]
buffer_load_dwordx4 v[236:239], v1, s[4:7], s23 offen offset:3072 sc1
v_lshlrev_b32 v54, 16, v13
v_mfma_f32_16x16x32_bf16 v[68:71], a[180:183], v[168:171], v[68:71]
v_and_b32 v55, 0xffff0000, v13
v_and_b32 v38, 1, v0
v_mfma_f32_16x16x32_bf16 v[72:75], a[184:187], v[168:171], v[72:75]
v_lshlrev_b32 v38, 4, v38
v_mov_b32 v39, 0x3f80
v_mfma_f32_16x16x32_bf16 v[76:79], a[188:191], v[168:171], v[76:79]
v_lshlrev_b32 v38, v38, v39
v_bfe_u32 v39, v0, 1, 3
v_mfma_f32_16x16x32_bf16 v[92:95], a[188:191], v[172:175], v[92:95]
s_add_u32 s23, s87, 32645120
buffer_load_dwordx4 v[240:243], v1, s[4:7], s23 offen offset:0 sc1
v_mfma_f32_16x16x32_bf16 v[88:91], a[184:187], v[172:175], v[88:91]
v_cmp_eq_u32 s[96:97], 0, v39
v_cmp_eq_u32 s[26:27], 1, v39
v_mfma_f32_16x16x32_bf16 v[84:87], a[180:183], v[172:175], v[84:87]
v_cndmask_b32 v60, 0, v38, s[96:97]
v_cndmask_b32 v61, 0, v38, s[26:27]
v_mfma_f32_16x16x32_bf16 v[80:83], a[176:179], v[172:175], v[80:83]
v_cmp_eq_u32 s[96:97], 2, v39
v_cmp_eq_u32 s[26:27], 3, v39
v_mfma_f32_16x16x32_bf16 v[64:67], a[192:195], v[176:179], v[64:67]
buffer_load_dwordx4 v[244:247], v1, s[4:7], s23 offen offset:1024 sc1
v_accvgpr_write_b32 a240, v60
v_mfma_f32_16x16x32_bf16 v[68:71], a[196:199], v[176:179], v[68:71]
v_accvgpr_write_b32 a241, v61
v_cndmask_b32 v60, 0, v38, s[96:97]
v_mfma_f32_16x16x32_bf16 v[72:75], a[200:203], v[176:179], v[72:75]
v_cndmask_b32 v61, 0, v38, s[26:27]
v_cmp_eq_u32 s[96:97], 4, v39
v_mfma_f32_16x16x32_bf16 v[76:79], a[204:207], v[176:179], v[76:79]
v_cmp_eq_u32 s[26:27], 5, v39
v_accvgpr_write_b32 a242, v60
v_mfma_f32_16x16x32_bf16 v[92:95], a[204:207], v[180:183], v[92:95]
buffer_load_dwordx4 v[248:251], v1, s[4:7], s23 offen offset:2048 sc1
v_accvgpr_write_b32 a243, v61
v_mfma_f32_16x16x32_bf16 v[88:91], a[200:203], v[180:183], v[88:91]
v_cndmask_b32 v60, 0, v38, s[96:97]
v_cndmask_b32 v61, 0, v38, s[26:27]
v_mfma_f32_16x16x32_bf16 v[84:87], a[196:199], v[180:183], v[84:87]
v_cmp_eq_u32 s[96:97], 6, v39
v_cmp_eq_u32 s[26:27], 7, v39
v_mfma_f32_16x16x32_bf16 v[80:83], a[192:195], v[180:183], v[80:83]
v_accvgpr_write_b32 a244, v60
v_accvgpr_write_b32 a245, v61
s_waitcnt vmcnt(19)
v_mfma_f32_16x16x32_bf16 v[64:67], a[208:211], v[184:187], v[64:67]
buffer_load_dwordx4 v[252:255], v1, s[4:7], s23 offen offset:3072 sc1
v_cndmask_b32 v60, 0, v38, s[96:97]
v_mfma_f32_16x16x32_bf16 v[68:71], a[212:215], v[184:187], v[68:71]
v_cndmask_b32 v61, 0, v38, s[26:27]
v_accvgpr_write_b32 a246, v60
v_mfma_f32_16x16x32_bf16 v[72:75], a[216:219], v[184:187], v[72:75]
v_accvgpr_write_b32 a247, v61
v_xor_b32 v38, 32, v57
v_mfma_f32_16x16x32_bf16 v[76:79], a[220:223], v[184:187], v[76:79]
v_xor_b32 v39, 64, v57
v_xor_b32 v60, 96, v57
s_waitcnt vmcnt(19)
v_mfma_f32_16x16x32_bf16 v[92:95], a[220:223], v[188:191], v[92:95]
v_mfma_f32_16x16x32_bf16 v[88:91], a[216:219], v[188:191], v[88:91]
v_mfma_f32_16x16x32_bf16 v[84:87], a[212:215], v[188:191], v[84:87]
v_mfma_f32_16x16x32_bf16 v[80:83], a[208:211], v[188:191], v[80:83]
s_waitcnt vmcnt(18)
v_mfma_f32_16x16x32_bf16 v[96:99], a[48:51], v[192:195], 0
v_mfma_f32_16x16x32_bf16 v[100:103], a[52:55], v[192:195], 0
v_mfma_f32_16x16x32_bf16 v[104:107], a[56:59], v[192:195], 0
v_mfma_f32_16x16x32_bf16 v[108:111], a[60:63], v[192:195], 0
s_waitcnt vmcnt(17)
v_mfma_f32_16x16x32_bf16 v[124:127], a[60:63], v[196:199], 0
v_mfma_f32_16x16x32_bf16 v[120:123], a[56:59], v[196:199], 0
v_mfma_f32_16x16x32_bf16 v[116:119], a[52:55], v[196:199], 0
v_mfma_f32_16x16x32_bf16 v[112:115], a[48:51], v[196:199], 0
v_mov_b32 v4, 13
s_waitcnt vmcnt(8)
s_mov_b64 exec, 1
buffer_store_dword v4, off, s[4:7], s78
s_mov_b64 exec, -1
v_mfma_f32_16x16x32_bf16 v[96:99], a[64:67], v[200:203], v[96:99]
v_mfma_f32_16x16x32_bf16 v[100:103], a[68:71], v[200:203], v[100:103]
v_mfma_f32_16x16x32_bf16 v[104:107], a[72:75], v[200:203], v[104:107]
v_mfma_f32_16x16x32_bf16 v[108:111], a[76:79], v[200:203], v[108:111]
s_waitcnt vmcnt(7)
v_cmp_gt_u32 vcc, 12, v63
s_nop 0
s_cbranch_vccnz L_poll_47
L_polled_48:
v_mfma_f32_16x16x32_bf16 v[124:127], a[76:79], v[204:207], v[124:127]
s_add_u32 s23, s39, 20971520
buffer_load_dwordx4 v[128:131], v1, s[4:7], s23 offen offset:0 sc1
v_mfma_f32_16x16x32_bf16 v[120:123], a[72:75], v[204:207], v[120:123]
v_mfma_f32_16x16x32_bf16 v[116:119], a[68:71], v[204:207], v[116:119]
v_mfma_f32_16x16x32_bf16 v[112:115], a[64:67], v[204:207], v[112:115]
v_mfma_f32_16x16x32_bf16 v[96:99], a[80:83], v[208:211], v[96:99]
buffer_load_dwordx4 v[132:135], v1, s[4:7], s23 offen offset:1024 sc1
v_mfma_f32_16x16x32_bf16 v[100:103], a[84:87], v[208:211], v[100:103]
v_mfma_f32_16x16x32_bf16 v[104:107], a[88:91], v[208:211], v[104:107]
v_mfma_f32_16x16x32_bf16 v[108:111], a[92:95], v[208:211], v[108:111]
v_mfma_f32_16x16x32_bf16 v[124:127], a[92:95], v[212:215], v[124:127]
s_add_u32 s23, s87, 32509952
buffer_load_dwordx4 v[136:139], v1, s[4:7], s23 offen offset:0 sc1
v_mfma_f32_16x16x32_bf16 v[120:123], a[88:91], v[212:215], v[120:123]
v_mfma_f32_16x16x32_bf16 v[116:119], a[84:87], v[212:215], v[116:119]
v_mfma_f32_16x16x32_bf16 v[112:115], a[80:83], v[212:215], v[112:115]
v_mfma_f32_16x16x32_bf16 v[96:99], a[96:99], v[216:219], v[96:99]
buffer_load_dwordx4 v[140:143], v1, s[4:7], s23 offen offset:1024 sc1
v_mfma_f32_16x16x32_bf16 v[100:103], a[100:103], v[216:219], v[100:103]
v_mfma_f32_16x16x32_bf16 v[104:107], a[104:107], v[216:219], v[104:107]
v_mfma_f32_16x16x32_bf16 v[108:111], a[108:111], v[216:219], v[108:111]
buffer_load_dword v63, v62, s[4:7], s79 offen sc1
v_mfma_f32_16x16x32_bf16 v[124:127], a[108:111], v[220:223], v[124:127]
s_add_u32 s23, s39, 20975616
buffer_load_dwordx4 v[144:147], v1, s[4:7], s23 offen offset:0 sc1
v_mfma_f32_16x16x32_bf16 v[120:123], a[104:107], v[220:223], v[120:123]
v_mfma_f32_16x16x32_bf16 v[116:119], a[100:103], v[220:223], v[116:119]
v_mfma_f32_16x16x32_bf16 v[112:115], a[96:99], v[220:223], v[112:115]
v_mfma_f32_16x16x32_bf16 v[96:99], a[160:163], v[224:227], v[96:99]
buffer_load_dwordx4 v[148:151], v1, s[4:7], s23 offen offset:1024 sc1
v_mfma_f32_16x16x32_bf16 v[100:103], a[164:167], v[224:227], v[100:103]
v_mfma_f32_16x16x32_bf16 v[104:107], a[168:171], v[224:227], v[104:107]
v_mfma_f32_16x16x32_bf16 v[108:111], a[172:175], v[224:227], v[108:111]
v_mfma_f32_16x16x32_bf16 v[124:127], a[172:175], v[228:231], v[124:127]
s_add_u32 s23, s87, 32524288
buffer_load_dwordx4 v[152:155], v1, s[4:7], s23 offen offset:0 sc1
v_mfma_f32_16x16x32_bf16 v[120:123], a[168:171], v[228:231], v[120:123]
v_mfma_f32_16x16x32_bf16 v[116:119], a[164:167], v[228:231], v[116:119]
v_mfma_f32_16x16x32_bf16 v[112:115], a[160:163], v[228:231], v[112:115]
s_waitcnt vmcnt(14)
v_mfma_f32_16x16x32_bf16 v[96:99], a[176:179], v[232:235], v[96:99]
buffer_load_dwordx4 v[156:159], v1, s[4:7], s23 offen offset:1024 sc1
v_mfma_f32_16x16x32_bf16 v[100:103], a[180:183], v[232:235], v[100:103]
v_mfma_f32_16x16x32_bf16 v[104:107], a[184:187], v[232:235], v[104:107]
v_mfma_f32_16x16x32_bf16 v[108:111], a[188:191], v[232:235], v[108:111]
s_waitcnt vmcnt(14)
v_mfma_f32_16x16x32_bf16 v[124:127], a[188:191], v[236:239], v[124:127]
v_mfma_f32_16x16x32_bf16 v[120:123], a[184:187], v[236:239], v[120:123]
v_mfma_f32_16x16x32_bf16 v[116:119], a[180:183], v[236:239], v[116:119]
v_mfma_f32_16x16x32_bf16 v[112:115], a[176:179], v[236:239], v[112:115]
s_waitcnt vmcnt(13)
v_mfma_f32_16x16x32_bf16 v[96:99], a[192:195], v[240:243], v[96:99]
v_mfma_f32_16x16x32_bf16 v[100:103], a[196:199], v[240:243], v[100:103]
v_mfma_f32_16x16x32_bf16 v[104:107], a[200:203], v[240:243], v[104:107]
v_mfma_f32_16x16x32_bf16 v[108:111], a[204:207], v[240:243], v[108:111]
s_waitcnt vmcnt(12)
v_mfma_f32_16x16x32_bf16 v[124:127], a[204:207], v[244:247], v[124:127]
v_mfma_f32_16x16x32_bf16 v[120:123], a[200:203], v[244:247], v[120:123]
v_mfma_f32_16x16x32_bf16 v[116:119], a[196:199], v[244:247], v[116:119]
v_mfma_f32_16x16x32_bf16 v[112:115], a[192:195], v[244:247], v[112:115]
s_waitcnt vmcnt(11)
v_mfma_f32_16x16x32_bf16 v[96:99], a[208:211], v[248:251], v[96:99]
v_mfma_f32_16x16x32_bf16 v[100:103], a[212:215], v[248:251], v[100:103]
v_mfma_f32_16x16x32_bf16 v[104:107], a[216:219], v[248:251], v[104:107]
v_mfma_f32_16x16x32_bf16 v[108:111], a[220:223], v[248:251], v[108:111]
s_waitcnt vmcnt(4)
v_cmp_gt_u32 vcc, 13, v63
s_nop 0
s_cbranch_vccnz L_poll_49
L_polled_50:
v_mfma_f32_16x16x32_bf16 v[124:127], a[220:223], v[252:255], v[124:127]
s_add_u32 s23, s39, 20973568
buffer_load_dwordx4 v[160:163], v1, s[4:7], s23 offen offset:0 sc1
v_mfma_f32_16x16x32_bf16 v[120:123], a[216:219], v[252:255], v[120:123]
v_mfma_f32_16x16x32_bf16 v[116:119], a[212:215], v[252:255], v[116:119]
s_add_u32 s23, s39, 20977664
buffer_load_dwordx4 v[164:167], v1, s[4:7], s23 offen offset:0 sc1
v_mfma_f32_16x16x32_bf16 v[112:115], a[208:211], v[252:255], v[112:115]
v_mfma_f32_16x16x32_bf16 v[64:67], a[16:19], v[128:131], v[64:67]
s_add_u32 s23, s39, 20974592
buffer_load_dwordx4 v[168:171], v1, s[4:7], s23 offen offset:0 sc1
v_mfma_f32_16x16x32_bf16 v[68:71], a[20:23], v[128:131], v[68:71]
v_mfma_f32_16x16x32_bf16 v[72:75], a[24:27], v[128:131], v[72:75]
s_add_u32 s23, s39, 20978688
buffer_load_dwordx4 v[172:175], v1, s[4:7], s23 offen offset:0 sc1
v_mfma_f32_16x16x32_bf16 v[76:79], a[28:31], v[128:131], v[76:79]
v_mfma_f32_16x16x32_bf16 v[92:95], a[28:31], v[132:135], v[92:95]
s_add_u32 s23, s39, 21004288
buffer_load_dwordx4 v[176:179], v1, s[4:7], s23 offen offset:0 sc1
v_mfma_f32_16x16x32_bf16 v[88:91], a[24:27], v[132:135], v[88:91]
v_mfma_f32_16x16x32_bf16 v[84:87], a[20:23], v[132:135], v[84:87]
s_add_u32 s23, s87, 32624640
buffer_load_dwordx4 v[180:183], v1, s[4:7], s23 offen offset:0 sc1
v_mfma_f32_16x16x32_bf16 v[80:83], a[16:19], v[132:135], v[80:83]
v_mfma_f32_16x16x32_bf16 v[64:67], a[32:35], v[136:139], v[64:67]
s_add_u32 s23, s39, 21008384
buffer_load_dwordx4 v[184:187], v1, s[4:7], s23 offen offset:0 sc1
v_mfma_f32_16x16x32_bf16 v[68:71], a[36:39], v[136:139], v[68:71]
v_mfma_f32_16x16x32_bf16 v[72:75], a[40:43], v[136:139], v[72:75]
s_add_u32 s23, s87, 32638976
buffer_load_dwordx4 v[188:191], v1, s[4:7], s23 offen offset:0 sc1
v_mfma_f32_16x16x32_bf16 v[76:79], a[44:47], v[136:139], v[76:79]
v_mfma_f32_16x16x32_bf16 v[92:95], a[44:47], v[140:143], v[92:95]
s_add_u32 s23, s39, 21006336
buffer_load_dwordx4 v[192:195], v1, s[4:7], s23 offen offset:0 sc1
v_mfma_f32_16x16x32_bf16 v[88:91], a[40:43], v[140:143], v[88:91]
v_mfma_f32_16x16x32_bf16 v[84:87], a[36:39], v[140:143], v[84:87]
v_mfma_f32_16x16x32_bf16 v[80:83], a[32:35], v[140:143], v[80:83]
s_waitcnt vmcnt(12)
v_mfma_f32_16x16x32_bf16 v[64:67], a[128:131], v[144:147], v[64:67]
s_add_u32 s23, s39, 21010432
buffer_load_dwordx4 v[196:199], v1, s[4:7], s23 offen offset:0 sc1
v_mfma_f32_16x16x32_bf16 v[68:71], a[132:135], v[144:147], v[68:71]
v_mfma_f32_16x16x32_bf16 v[72:75], a[136:139], v[144:147], v[72:75]
v_mfma_f32_16x16x32_bf16 v[76:79], a[140:143], v[144:147], v[76:79]
s_waitcnt vmcnt(12)
v_mfma_f32_16x16x32_bf16 v[92:95], a[140:143], v[148:151], v[92:95]
s_add_u32 s23, s39, 21005312
buffer_load_dwordx4 v[200:203], v1, s[4:7], s23 offen offset:0 sc1
v_mfma_f32_16x16x32_bf16 v[88:91], a[136:139], v[148:151], v[88:91]
v_mfma_f32_16x16x32_bf16 v[84:87], a[132:135], v[148:151], v[84:87]
v_mfma_f32_16x16x32_bf16 v[80:83], a[128:131], v[148:151], v[80:83]
s_waitcnt vmcnt(12)
v_mfma_f32_16x16x32_bf16 v[64:67], a[144:147], v[152:155], v[64:67]
s_add_u32 s23, s87, 32625664
buffer_load_dwordx4 v[204:207], v1, s[4:7], s23 offen offset:0 sc1
v_mfma_f32_16x16x32_bf16 v[68:71], a[148:151], v[152:155], v[68:71]
v_mfma_f32_16x16x32_bf16 v[72:75], a[152:155], v[152:155], v[72:75]
v_mfma_f32_16x16x32_bf16 v[76:79], a[156:159], v[152:155], v[76:79]
s_waitcnt vmcnt(12)
v_mfma_f32_16x16x32_bf16 v[92:95], a[156:159], v[156:159], v[92:95]
s_add_u32 s23, s39, 21009408
buffer_load_dwordx4 v[208:211], v1, s[4:7], s23 offen offset:0 sc1
v_mfma_f32_16x16x32_bf16 v[88:91], a[152:155], v[156:159], v[88:91]
v_mfma_f32_16x16x32_bf16 v[84:87], a[148:151], v[156:159], v[84:87]
v_mfma_f32_16x16x32_bf16 v[80:83], a[144:147], v[156:159], v[80:83]
s_waitcnt vmcnt(12)
v_mfma_f32_16x16x32_bf16 v[64:67], a[0:3], v[160:163], v[64:67]
s_add_u32 s23, s87, 32640000
buffer_load_dwordx4 v[212:215], v1, s[4:7], s23 offen offset:0 sc1
v_mfma_f32_16x16x32_bf16 v[68:71], a[4:7], v[160:163], v[68:71]
v_mfma_f32_16x16x32_bf16 v[72:75], a[8:11], v[160:163], v[72:75]
v_mfma_f32_16x16x32_bf16 v[76:79], a[12:15], v[160:163], v[76:79]
s_waitcnt vmcnt(12)
v_mfma_f32_16x16x32_bf16 v[64:67], a[112:115], v[164:167], v[64:67]
s_add_u32 s23, s39, 21007360
buffer_load_dwordx4 v[216:219], v1, s[4:7], s23 offen offset:0 sc1
v_mfma_f32_16x16x32_bf16 v[68:71], a[116:119], v[164:167], v[68:71]
v_mfma_f32_16x16x32_bf16 v[72:75], a[120:123], v[164:167], v[72:75]
v_mfma_f32_16x16x32_bf16 v[76:79], a[124:127], v[164:167], v[76:79]
s_waitcnt vmcnt(12)
v_mfma_f32_16x16x32_bf16 v[92:95], a[12:15], v[168:171], v[92:95]
s_add_u32 s23, s39, 21011456
buffer_load_dwordx4 v[220:223], v1, s[4:7], s23 offen offset:0 sc1
v_mfma_f32_16x16x32_bf16 v[88:91], a[8:11], v[168:171], v[88:91]
v_mfma_f32_16x16x32_bf16 v[84:87], a[4:7], v[168:171], v[84:87]
v_mfma_f32_16x16x32_bf16 v[80:83], a[0:3], v[168:171], v[80:83]
s_waitcnt vmcnt(12)
v_mfma_f32_16x16x32_bf16 v[92:95], a[124:127], v[172:175], v[92:95]
v_mfma_f32_16x16x32_bf16 v[88:91], a[120:123], v[172:175], v[88:91]
v_cvt_pk_bf16_f32 v64, v64, v65
v_cvt_pk_bf16_f32 v65, v66, v67
v_cvt_pk_bf16_f32 v66, v68, v69
v_cvt_pk_bf16_f32 v67, v70, v71
ds_write_b128 v56, v[64:67] offset:0
v_mfma_f32_16x16x32_bf16 v[84:87], a[116:119], v[172:175], v[84:87]
v_mfma_f32_16x16x32_bf16 v[80:83], a[112:115], v[172:175], v[80:83]
s_waitcnt vmcnt(11)
v_mfma_f32_16x16x32_bf16 v[96:99], a[16:19], v[176:179], v[96:99]
v_mfma_f32_16x16x32_bf16 v[100:103], a[20:23], v[176:179], v[100:103]
v_cvt_pk_bf16_f32 v72, v72, v73
v_cvt_pk_bf16_f32 v73, v74, v75
v_cvt_pk_bf16_f32 v74, v76, v77
v_cvt_pk_bf16_f32 v75, v78, v79
ds_write_b128 v59, v[72:75] offset:2048
v_mfma_f32_16x16x32_bf16 v[104:107], a[24:27], v[176:179], v[104:107]
v_mfma_f32_16x16x32_bf16 v[108:111], a[28:31], v[176:179], v[108:111]
s_waitcnt vmcnt(10)
v_mfma_f32_16x16x32_bf16 v[96:99], a[32:35], v[180:183], v[96:99]
v_mfma_f32_16x16x32_bf16 v[100:103], a[36:39], v[180:183], v[100:103]
v_cvt_pk_bf16_f32 v80, v80, v81
v_cvt_pk_bf16_f32 v81, v82, v83
v_cvt_pk_bf16_f32 v82, v84, v85
v_cvt_pk_bf16_f32 v83, v86, v87
ds_write_b128 v56, v[80:83] offset:256
v_mfma_f32_16x16x32_bf16 v[104:107], a[40:43], v[180:183], v[104:107]
v_mfma_f32_16x16x32_bf16 v[108:111], a[44:47], v[180:183], v[108:111]
s_waitcnt vmcnt(9)
v_mfma_f32_16x16x32_bf16 v[96:99], a[128:131], v[184:187], v[96:99]
v_mfma_f32_16x16x32_bf16 v[100:103], a[132:135], v[184:187], v[100:103]
v_cvt_pk_bf16_f32 v88, v88, v89
v_cvt_pk_bf16_f32 v89, v90, v91
v_cvt_pk_bf16_f32 v90, v92, v93
v_cvt_pk_bf16_f32 v91, v94, v95
ds_write_b128 v59, v[88:91] offset:2304
v_mfma_f32_16x16x32_bf16 v[104:107], a[136:139], v[184:187], v[104:107]
v_mfma_f32_16x16x32_bf16 v[108:111], a[140:143], v[184:187], v[108:111]
s_waitcnt vmcnt(8)
v_mfma_f32_16x16x32_bf16 v[96:99], a[144:147], v[188:191], v[96:99]
v_mfma_f32_16x16x32_bf16 v[100:103], a[148:151], v[188:191], v[100:103]
v_mfma_f32_16x16x32_bf16 v[104:107], a[152:155], v[188:191], v[104:107]
v_mfma_f32_16x16x32_bf16 v[108:111], a[156:159], v[188:191], v[108:111]
s_waitcnt lgkmcnt(0)
s_barrier
ds_read_b128 v[64:67], v57 offset:0
ds_read_b128 v[68:71], v38 offset:0
ds_read_b128 v[72:75], v39 offset:0
ds_read_b128 v[76:79], v60 offset:0
s_waitcnt vmcnt(7)
v_mfma_f32_16x16x32_bf16 v[96:99], a[0:3], v[192:195], v[96:99]
v_mfma_f32_16x16x32_bf16 v[100:103], a[4:7], v[192:195], v[100:103]
v_mfma_f32_16x16x32_bf16 v[104:107], a[8:11], v[192:195], v[104:107]
v_mfma_f32_16x16x32_bf16 v[108:111], a[12:15], v[192:195], v[108:111]
s_waitcnt vmcnt(6)
v_mfma_f32_16x16x32_bf16 v[96:99], a[112:115], v[196:199], v[96:99]
v_mfma_f32_16x16x32_bf16 v[100:103], a[116:119], v[196:199], v[100:103]
v_mfma_f32_16x16x32_bf16 v[104:107], a[120:123], v[196:199], v[104:107]
v_mfma_f32_16x16x32_bf16 v[108:111], a[124:127], v[196:199], v[108:111]
s_waitcnt lgkmcnt(3)
v_mfma_f32_16x16x32_bf16 v[40:43], a[240:243], v[64:67], v[40:43]
s_waitcnt lgkmcnt(2)
v_mfma_f32_16x16x32_bf16 v[44:47], a[240:243], v[68:71], v[44:47]
s_waitcnt lgkmcnt(1)
v_mfma_f32_16x16x32_bf16 v[40:43], a[244:247], v[72:75], v[40:43]
s_waitcnt lgkmcnt(0)
v_mfma_f32_16x16x32_bf16 v[44:47], a[244:247], v[76:79], v[44:47]
s_waitcnt vmcnt(5)
s_waitcnt vmcnt(0)
s_lshr_b32 s26, s2, 3
s_or_b32 s26, s26, s3
s_cbranch_scc1 L_nowb_51
buffer_wbl2 sc1
L_nowb_51:
v_mfma_f32_16x16x32_bf16 v[124:127], a[28:31], v[200:203], v[124:127]
v_mfma_f32_16x16x32_bf16 v[120:123], a[24:27], v[200:203], v[120:123]
v_mfma_f32_16x16x32_bf16 v[116:119], a[20:23], v[200:203], v[116:119]
v_mfma_f32_16x16x32_bf16 v[112:115], a[16:19], v[200:203], v[112:115]
v_mfma_f32_16x16x32_bf16 v[124:127], a[44:47], v[204:207], v[124:127]
v_mfma_f32_16x16x32_bf16 v[120:123], a[40:43], v[204:207], v[120:123]
v_cvt_pk_bf16_f32 v6, v40, v41
v_cvt_pk_bf16_f32 v7, v42, v43
v_cvt_pk_bf16_f32 v8, v44, v45
v_cvt_pk_bf16_f32 v9, v46, v47
s_nop 0
v_permlane16_swap_b32 v6, v8
v_permlane16_swap_b32 v7, v9
buffer_store_dwordx4 v[6:9], v58, s[8:11], s36 offen sc1
v_mfma_f32_16x16x32_bf16 v[116:119], a[36:39], v[204:207], v[116:119]
v_mfma_f32_16x16x32_bf16 v[112:115], a[32:35], v[204:207], v[112:115]
v_cvt_pk_bf16_f32 v96, v96, v97
v_cvt_pk_bf16_f32 v97, v98, v99
v_cvt_pk_bf16_f32 v98, v100, v101
v_cvt_pk_bf16_f32 v99, v102, v103
ds_write_b128 v56, v[96:99] offset:16384
v_mfma_f32_16x16x32_bf16 v[124:127], a[140:143], v[208:211], v[124:127]
v_mfma_f32_16x16x32_bf16 v[120:123], a[136:139], v[208:211], v[120:123]
v_mfma_f32_16x16x32_bf16 v[116:119], a[132:135], v[208:211], v[116:119]
v_mfma_f32_16x16x32_bf16 v[112:115], a[128:131], v[208:211], v[112:115]
v_cvt_pk_bf16_f32 v104, v104, v105
v_cvt_pk_bf16_f32 v105, v106, v107
v_cvt_pk_bf16_f32 v106, v108, v109
v_cvt_pk_bf16_f32 v107, v110, v111
ds_write_b128 v59, v[104:107] offset:18432
v_mfma_f32_16x16x32_bf16 v[124:127], a[156:159], v[212:215], v[124:127]
v_mfma_f32_16x16x32_bf16 v[120:123], a[152:155], v[212:215], v[120:123]
v_mfma_f32_16x16x32_bf16 v[116:119], a[148:151], v[212:215], v[116:119]
v_mfma_f32_16x16x32_bf16 v[112:115], a[144:147], v[212:215], v[112:115]
v_mfma_f32_16x16x32_bf16 v[124:127], a[12:15], v[216:219], v[124:127]
v_mfma_f32_16x16x32_bf16 v[120:123], a[8:11], v[216:219], v[120:123]
v_mfma_f32_16x16x32_bf16 v[116:119], a[4:7], v[216:219], v[116:119]
v_mfma_f32_16x16x32_bf16 v[112:115], a[0:3], v[216:219], v[112:115]
v_mfma_f32_16x16x32_bf16 v[124:127], a[124:127], v[220:223], v[124:127]
v_mfma_f32_16x16x32_bf16 v[120:123], a[120:123], v[220:223], v[120:123]
v_mfma_f32_16x16x32_bf16 v[116:119], a[116:119], v[220:223], v[116:119]
v_mfma_f32_16x16x32_bf16 v[112:115], a[112:115], v[220:223], v[112:115]
s_nop 5
v_cvt_pk_bf16_f32 v120, v120, v121
v_cvt_pk_bf16_f32 v121, v122, v123
v_cvt_pk_bf16_f32 v122, v124, v125
v_cvt_pk_bf16_f32 v123, v126, v127
ds_write_b128 v59, v[120:123] offset:18688
v_cvt_pk_bf16_f32 v112, v112, v113
v_cvt_pk_bf16_f32 v113, v114, v115
v_cvt_pk_bf16_f32 v114, v116, v117
v_cvt_pk_bf16_f32 v115, v118, v119
ds_write_b128 v56, v[112:115] offset:16640
s_waitcnt lgkmcnt(0)
s_barrier
ds_read_b128 v[96:99], v57 offset:16384
ds_read_b128 v[100:103], v38 offset:16384
ds_read_b128 v[104:107], v39 offset:16384
ds_read_b128 v[108:111], v60 offset:16384
s_waitcnt lgkmcnt(3)
v_mfma_f32_16x16x32_bf16 v[48:51], a[240:243], v[96:99], v[48:51]
s_waitcnt lgkmcnt(2)
v_mfma_f32_16x16x32_bf16 v[52:55], a[240:243], v[100:103], v[52:55]
s_waitcnt lgkmcnt(1)
v_mfma_f32_16x16x32_bf16 v[48:51], a[244:247], v[104:107], v[48:51]
s_waitcnt lgkmcnt(0)
v_mfma_f32_16x16x32_bf16 v[52:55], a[244:247], v[108:111], v[52:55]
s_nop 5
v_cvt_pk_bf16_f32 v10, v48, v49
v_cvt_pk_bf16_f32 v11, v50, v51
v_cvt_pk_bf16_f32 v12, v52, v53
v_cvt_pk_bf16_f32 v13, v54, v55
s_nop 0
v_permlane16_swap_b32 v10, v12
v_permlane16_swap_b32 v11, v13
buffer_store_dwordx4 v[10:13], v58, s[8:11], s15 offen sc1
s_endpgm
L_tag_2:
s_sleep 2
global_load_dwordx2 v[40:41], v42, s[90:91] sc1
s_waitcnt vmcnt(0)
v_min_u32 v43, v40, v41
v_cmp_eq_u32 vcc, 0, v43
s_nop 0
s_cbranch_vccz L_tagok_3
s_sub_u32 s29, s29, 1
s_cbranch_scc0 L_tag_2
s_mov_b32 s29, 0
s_branch L_tagok_3
L_spoll_5:
s_sleep 2
buffer_load_dwordx2 v[60:61], v50, s[4:7], s36 offen sc1
s_waitcnt vmcnt(0)
v_xor_b32 v60, s73, v60
v_xor_b32 v61, s74, v61
v_and_b32 v61, 0xffffff, v61
v_or_b32 v60, v60, v61
v_cmp_ne_u32 vcc, 0, v60
s_nop 0
s_cbranch_vccz L_spolled_6
s_sub_u32 s29, s29, 1
s_cbranch_scc0 L_spoll_5
s_mov_b32 s29, 0
s_branch L_spolled_6
L_spoll_8:
s_sleep 2
buffer_load_dwordx2 v[98:99], v96, s[4:7], s68 offen sc1
s_waitcnt vmcnt(0)
v_xor_b32 v98, s73, v98
v_xor_b32 v99, s74, v99
v_and_b32 v99, 0xffffff, v99
v_or_b32 v98, v98, v99
v_cmp_ne_u32 vcc, 0, v98
s_nop 0
s_cbranch_vccz L_spolled_9
s_sub_u32 s29, s29, 1
s_cbranch_scc0 L_spoll_8
s_mov_b32 s29, 0
s_branch L_spolled_9
L_kvagain_12:
s_mov_b32 s98, 4096
L_kvmore_14:
s_sub_u32 s98, s98, 1
s_cbranch_scc1 L_kvok_11
s_sleep 2
buffer_load_dwordx4 v[224:227], v62, s[4:7], s37 offen sc1
s_add_u32 s23, s36, 0
buffer_load_dwordx4 v[192:195], v1, s[4:7], s23 offen offset:0 sc1
buffer_load_dwordx4 v[196:199], v1, s[4:7], s23 offen offset:1024 sc1
buffer_load_dwordx4 v[200:203], v1, s[4:7], s23 offen offset:2048 sc1
buffer_load_dwordx4 v[204:207], v1, s[4:7], s23 offen offset:3072 sc1
s_add_u32 s23, s36, 4096
buffer_load_dwordx4 v[208:211], v1, s[4:7], s23 offen offset:0 sc1
buffer_load_dwordx4 v[212:215], v1, s[4:7], s23 offen offset:1024 sc1
buffer_load_dwordx4 v[216:219], v1, s[4:7], s23 offen offset:2048 sc1
buffer_load_dwordx4 v[220:223], v1, s[4:7], s23 offen offset:3072 sc1
s_waitcnt vmcnt(8)
s_waitcnt vmcnt(7)
v_mfma_f32_32x32x16_bf16 v[112:127], v[44:47], v[192:195], 0
v_add_f32_dpp v224, v224, v224 row_ror:8 row_mask:0xf bank_mask:0xf
v_add_f32_dpp v225, v225, v225 row_ror:8 row_mask:0xf bank_mask:0xf
v_add_f32_dpp v226, v226, v226 row_ror:8 row_mask:0xf bank_mask:0xf
v_add_f32_dpp v227, v227, v227 row_ror:8 row_mask:0xf bank_mask:0xf
s_waitcnt vmcnt(6)
v_mfma_f32_32x32x16_bf16 v[112:127], v[44:47], v[196:199], v[112:127]
v_add_f32_dpp v224, v224, v224 row_ror:4 row_mask:0xf bank_mask:0xf
v_add_f32_dpp v225, v225, v225 row_ror:4 row_mask:0xf bank_mask:0xf
v_add_f32_dpp v226, v226, v226 row_ror:4 row_mask:0xf bank_mask:0xf
v_add_f32_dpp v227, v227, v227 row_ror:4 row_mask:0xf bank_mask:0xf
s_waitcnt vmcnt(5)
v_mfma_f32_32x32x16_bf16 v[112:127], v[44:47], v[200:203], v[112:127]
v_add_f32_dpp v224, v224, v224 row_ror:2 row_mask:0xf bank_mask:0xf
v_add_f32_dpp v225, v225, v225 row_ror:2 row_mask:0xf bank_mask:0xf
v_add_f32_dpp v226, v226, v226 row_ror:2 row_mask:0xf bank_mask:0xf
v_add_f32_dpp v227, v227, v227 row_ror:2 row_mask:0xf bank_mask:0xf
s_waitcnt vmcnt(4)
v_mfma_f32_32x32x16_bf16 v[112:127], v[44:47], v[204:207], v[112:127]
v_add_f32_dpp v224, v224, v224 row_ror:1 row_mask:0xf bank_mask:0xf
v_add_f32_dpp v225, v225, v225 row_ror:1 row_mask:0xf bank_mask:0xf
v_add_f32_dpp v226, v226, v226 row_ror:1 row_mask:0xf bank_mask:0xf
v_add_f32_dpp v227, v227, v227 row_ror:1 row_mask:0xf bank_mask:0xf
s_waitcnt vmcnt(3)
v_mfma_f32_32x32x16_bf16 v[112:127], v[44:47], v[208:211], v[112:127]
v_add_f32 v52, v224, v225
v_add_f32 v53, v226, v227
v_cvt_pk_bf16_f32 v54, v224, v225
v_cvt_pk_bf16_f32 v55, v226, v227
s_waitcnt vmcnt(2)
v_mfma_f32_32x32x16_bf16 v[112:127], v[44:47], v[212:215], v[112:127]
v_add_f32 v52, v52, v53
s_waitcnt vmcnt(1)
v_mfma_f32_32x32x16_bf16 v[112:127], v[44:47], v[216:219], v[112:127]
s_waitcnt vmcnt(0)
v_mfma_f32_32x32x16_bf16 v[112:127], v[44:47], v[220:223], v[112:127]
s_nop 11
v_cmp_u_f32 vcc, v112, v52
v_cvt_pk_bf16_f32 v50, v112, v113
s_cbranch_vccnz L_kvmore_14
s_branch L_kvok_11
L_spinout_17:
s_mov_b32 s29, 0
s_branch L_spun_16
L_spinout_20:
s_mov_b32 s29, 0
s_branch L_spun_19
L_poll_23:
buffer_load_dword v63, v62, s[4:7], s79 offen sc1
s_waitcnt vmcnt(0)
v_cmp_gt_u32 vcc, 3, v63
s_nop 0
s_cbranch_vccz L_polled_24
s_sub_u32 s29, s29, 1
s_cbranch_scc0 L_poll_23
s_mov_b32 s29, 0
s_branch L_polled_24
L_poll_25:
buffer_load_dword v63, v62, s[4:7], s79 offen sc1
s_waitcnt vmcnt(0)
v_cmp_gt_u32 vcc, 4, v63
s_nop 0
s_cbranch_vccz L_polled_26
s_sub_u32 s29, s29, 1
s_cbranch_scc0 L_poll_25
s_mov_b32 s29, 0
s_branch L_polled_26
L_poll_27:
buffer_load_dword v63, v62, s[4:7], s79 offen sc1
s_waitcnt vmcnt(0)
v_cmp_gt_u32 vcc, 5, v63
s_nop 0
s_cbranch_vccz L_polled_28
s_sub_u32 s29, s29, 1
s_cbranch_scc0 L_poll_27
s_mov_b32 s29, 0
s_branch L_polled_28
L_spinout_31:
s_mov_b32 s29, 0
s_branch L_spun_30
L_kvagain_34:
s_mov_b32 s98, 4096
L_kvmore_36:
s_sub_u32 s98, s98, 1
s_cbranch_scc1 L_kvok_33
s_sleep 2
buffer_load_dwordx4 v[224:227], v62, s[4:7], s37 offen sc1
s_add_u32 s23, s36, 0
buffer_load_dwordx4 v[192:195], v1, s[4:7], s23 offen offset:0 sc1
buffer_load_dwordx4 v[196:199], v1, s[4:7], s23 offen offset:1024 sc1
buffer_load_dwordx4 v[200:203], v1, s[4:7], s23 offen offset:2048 sc1
buffer_load_dwordx4 v[204:207], v1, s[4:7], s23 offen offset:3072 sc1
s_add_u32 s23, s36, 4096
buffer_load_dwordx4 v[208:211], v1, s[4:7], s23 offen offset:0 sc1
buffer_load_dwordx4 v[212:215], v1, s[4:7], s23 offen offset:1024 sc1
buffer_load_dwordx4 v[216:219], v1, s[4:7], s23 offen offset:2048 sc1
buffer_load_dwordx4 v[220:223], v1, s[4:7], s23 offen offset:3072 sc1
s_waitcnt vmcnt(8)
s_waitcnt vmcnt(7)
v_mfma_f32_32x32x16_bf16 v[112:127], v[44:47], v[192:195], 0
v_add_f32_dpp v224, v224, v224 row_ror:8 row_mask:0xf bank_mask:0xf
v_add_f32_dpp v225, v225, v225 row_ror:8 row_mask:0xf bank_mask:0xf
v_add_f32_dpp v226, v226, v226 row_ror:8 row_mask:0xf bank_mask:0xf
v_add_f32_dpp v227, v227, v227 row_ror:8 row_mask:0xf bank_mask:0xf
s_waitcnt vmcnt(6)
v_mfma_f32_32x32x16_bf16 v[112:127], v[44:47], v[196:199], v[112:127]
v_add_f32_dpp v224, v224, v224 row_ror:4 row_mask:0xf bank_mask:0xf
v_add_f32_dpp v225, v225, v225 row_ror:4 row_mask:0xf bank_mask:0xf
v_add_f32_dpp v226, v226, v226 row_ror:4 row_mask:0xf bank_mask:0xf
v_add_f32_dpp v227, v227, v227 row_ror:4 row_mask:0xf bank_mask:0xf
s_waitcnt vmcnt(5)
v_mfma_f32_32x32x16_bf16 v[112:127], v[44:47], v[200:203], v[112:127]
v_add_f32_dpp v224, v224, v224 row_ror:2 row_mask:0xf bank_mask:0xf
v_add_f32_dpp v225, v225, v225 row_ror:2 row_mask:0xf bank_mask:0xf
v_add_f32_dpp v226, v226, v226 row_ror:2 row_mask:0xf bank_mask:0xf
v_add_f32_dpp v227, v227, v227 row_ror:2 row_mask:0xf bank_mask:0xf
s_waitcnt vmcnt(4)
v_mfma_f32_32x32x16_bf16 v[112:127], v[44:47], v[204:207], v[112:127]
v_add_f32_dpp v224, v224, v224 row_ror:1 row_mask:0xf bank_mask:0xf
v_add_f32_dpp v225, v225, v225 row_ror:1 row_mask:0xf bank_mask:0xf
v_add_f32_dpp v226, v226, v226 row_ror:1 row_mask:0xf bank_mask:0xf
v_add_f32_dpp v227, v227, v227 row_ror:1 row_mask:0xf bank_mask:0xf
s_waitcnt vmcnt(3)
v_mfma_f32_32x32x16_bf16 v[112:127], v[44:47], v[208:211], v[112:127]
v_add_f32 v52, v224, v225
v_add_f32 v53, v226, v227
v_cvt_pk_bf16_f32 v54, v224, v225
v_cvt_pk_bf16_f32 v55, v226, v227
s_waitcnt vmcnt(2)
v_mfma_f32_32x32x16_bf16 v[112:127], v[44:47], v[212:215], v[112:127]
v_add_f32 v52, v52, v53
s_waitcnt vmcnt(1)
v_mfma_f32_32x32x16_bf16 v[112:127], v[44:47], v[216:219], v[112:127]
s_waitcnt vmcnt(0)
v_mfma_f32_32x32x16_bf16 v[112:127], v[44:47], v[220:223], v[112:127]
s_nop 11
v_cmp_u_f32 vcc, v112, v52
v_cvt_pk_bf16_f32 v50, v112, v113
s_cbranch_vccnz L_kvmore_36
s_branch L_kvok_33
L_spinout_39:
s_mov_b32 s29, 0
s_branch L_spun_38
L_spinout_42:
s_mov_b32 s29, 0
s_branch L_spun_41
L_poll_45:
buffer_load_dword v63, v62, s[4:7], s79 offen sc1
s_waitcnt vmcnt(0)
v_cmp_gt_u32 vcc, 11, v63
s_nop 0
s_cbranch_vccz L_polled_46
s_sub_u32 s29, s29, 1
s_cbranch_scc0 L_poll_45
s_mov_b32 s29, 0
s_branch L_polled_46
L_poll_47:
buffer_load_dword v63, v62, s[4:7], s79 offen sc1
s_waitcnt vmcnt(0)
v_cmp_gt_u32 vcc, 12, v63
s_nop 0
s_cbranch_vccz L_polled_48
s_sub_u32 s29, s29, 1
s_cbranch_scc0 L_poll_47
s_mov_b32 s29, 0
s_branch L_polled_48
L_poll_49:
buffer_load_dword v63, v62, s[4:7], s79 offen sc1
s_waitcnt vmcnt(0)
v_cmp_gt_u32 vcc, 13, v63
s_nop 0
s_cbranch_vccz L_polled_50
s_sub_u32 s29, s29, 1
s_cbranch_scc0 L_poll_49
s_mov_b32 s29, 0
s_branch L_polled_50
L_code_end:
L_done:
s_endpgm
L_slow_tail:
ds_read_b128 a[224:227], v1 offset:25344
ds_read_b128 a[232:235], v1 offset:27392
ds_read_b128 a[228:231], v1 offset:26368
ds_read_b128 a[236:239], v1 offset:28416
ds_read_b32 v25, v57 offset:29440
ds_read_b32 v26, v57 offset:29696
ds_read_b32 v27, v57 offset:29952
ds_read_b32 v28, v57 offset:30208
ds_read_b32 v29, v57 offset:30464
ds_read_b32 v30, v57 offset:30720
ds_read_b32 v31, v57 offset:30976
buffer_load_dwordx4 v[188:191], v1, s[4:7], s27 offen offset:3072
s_waitcnt lgkmcnt(9)
v_mfma_f32_32x32x16_bf16 v[64:79], a[224:227], v[96:99], 0
v_mfma_f32_32x32x16_bf16 v[80:95], a[232:235], v[104:107], 0
s_waitcnt lgkmcnt(7)
v_mfma_f32_32x32x16_bf16 v[64:79], a[228:231], v[100:103], v[64:79]
v_mfma_f32_32x32x16_bf16 v[80:95], a[236:239], v[108:111], v[80:95]
v_and_b32 v59, 7, v0
v_lshl_add_u32 v59, s3, 3, v59
v_bfe_u32 v61, v0, 4, 1
v_and_b32 v56, 15, v0
v_lshlrev_b32 v60, 3, v61
v_xor_b32 v56, v56, v60
v_lshlrev_b32 v56, 4, v56
v_lshrrev_b32 v60, 4, v0
v_lshl_add_u32 v56, v60, 9, v56
v_lshl_add_u32 v56, s3, 12, v56
s_nop 0
v_add_f32 v72, 0x358637bd, v72
v_rcp_f32 v72, v72
v_add_f32 v88, 0x358637bd, v88
v_rcp_f32 v88, v88
v_pk_mul_f32 v[64:65], v[64:65], v[72:73] op_sel_hi:[1,0]
v_pk_mul_f32 v[66:67], v[66:67], v[72:73] op_sel_hi:[1,0]
v_pk_mul_f32 v[68:69], v[68:69], v[72:73] op_sel_hi:[1,0]
v_pk_mul_f32 v[70:71], v[70:71], v[72:73] op_sel_hi:[1,0]
v_cvt_pk_bf16_f32 v76, v64, v65
v_cvt_pk_bf16_f32 v77, v66, v67
v_cvt_pk_bf16_f32 v78, v68, v69
v_cvt_pk_bf16_f32 v79, v70, v71
buffer_store_dwordx4 v[76:79], v63, s[4:7], s28 offen offset:0 sc1
v_pk_mul_f32 v[80:81], v[80:81], v[88:89] op_sel_hi:[1,0]
v_pk_mul_f32 v[82:83], v[82:83], v[88:89] op_sel_hi:[1,0]
v_pk_mul_f32 v[84:85], v[84:85], v[88:89] op_sel_hi:[1,0]
v_pk_mul_f32 v[86:87], v[86:87], v[88:89] op_sel_hi:[1,0]
v_cvt_pk_bf16_f32 v92, v80, v81
v_cvt_pk_bf16_f32 v93, v82, v83
v_cvt_pk_bf16_f32 v94, v84, v85
v_cvt_pk_bf16_f32 v95, v86, v87
buffer_store_dwordx4 v[92:95], v63, s[4:7], s28 offen offset:512 sc1
s_waitcnt lgkmcnt(0)
v_bfe_u32 v61, v0, 3, 1
v_lshlrev_b32 v57, 3, v61
v_xor_b32 v57, v57, v59
v_lshlrev_b32 v57, 4, v57
v_lshl_add_u32 v57, v61, 9, v57
v_lshl_add_u32 v57, v60, 12, v57
v_lshlrev_b32 v58, 4, v59
v_lshl_add_u32 v58, v61, 9, v58
v_lshl_add_u32 v58, v60, 10, v58
v_lshrrev_b32 v60, 5, v0
v_lshlrev_b32 v59, 3, v59
v_lshl_add_u32 v59, v60, 2, v59
v_and_b32 v62, 7, v0
v_lshlrev_b32 v62, 2, v62
s_add_u32 s36, s82, 12582912
s_add_u32 s37, s83, 7864320
v_permlane16_swap_b32 v6, v8
v_permlane16_swap_b32 v7, v9
v_permlane16_swap_b32 v10, v12
v_permlane16_swap_b32 v11, v13
s_add_u32 s15, s36, 32768
v_lshlrev_b32 v40, 16, v6
v_and_b32 v41, 0xffff0000, v6
v_lshlrev_b32 v42, 16, v7
v_and_b32 v43, 0xffff0000, v7
v_lshlrev_b32 v44, 16, v8
v_and_b32 v45, 0xffff0000, v8
v_lshlrev_b32 v46, 16, v9
v_and_b32 v47, 0xffff0000, v9
v_lshlrev_b32 v48, 16, v10
v_and_b32 v49, 0xffff0000, v10
v_lshlrev_b32 v50, 16, v11
v_and_b32 v51, 0xffff0000, v11
v_lshlrev_b32 v52, 16, v12
v_and_b32 v53, 0xffff0000, v12
v_lshlrev_b32 v54, 16, v13
v_and_b32 v55, 0xffff0000, v13
v_mov_b32 v4, 1
s_waitcnt vmcnt(0)
s_mov_b64 exec, 1
buffer_store_dword v4, off, s[4:7], s78 sc1
s_mov_b64 exec, -1
v_and_b32 v38, 1, v0
v_lshlrev_b32 v38, 4, v38
v_mov_b32 v39, 0x3f80
v_lshlrev_b32 v38, v38, v39
v_bfe_u32 v39, v0, 1, 3
v_cmp_eq_u32 s[96:97], 0, v39
v_cmp_eq_u32 s[26:27], 1, v39
s_nop 0
v_cndmask_b32 v60, 0, v38, s[96:97]
v_cndmask_b32 v61, 0, v38, s[26:27]
v_cmp_eq_u32 s[96:97], 2, v39
v_cmp_eq_u32 s[26:27], 3, v39
v_accvgpr_write_b32 a240, v60
v_accvgpr_write_b32 a241, v61
v_cndmask_b32 v60, 0, v38, s[96:97]
v_cndmask_b32 v61, 0, v38, s[26:27]
v_cmp_eq_u32 s[96:97], 4, v39
v_cmp_eq_u32 s[26:27], 5, v39
v_accvgpr_write_b32 a242, v60
v_accvgpr_write_b32 a243, v61
v_cndmask_b32 v60, 0, v38, s[96:97]
v_cndmask_b32 v61, 0, v38, s[26:27]
v_cmp_eq_u32 s[96:97], 6, v39
v_cmp_eq_u32 s[26:27], 7, v39
v_accvgpr_write_b32 a244, v60
v_accvgpr_write_b32 a245, v61
v_cndmask_b32 v60, 0, v38, s[96:97]
v_cndmask_b32 v61, 0, v38, s[26:27]
v_accvgpr_write_b32 a246, v60
v_accvgpr_write_b32 a247, v61
L_spin_66:
s_sleep 8
buffer_load_dword v63, v62, s[4:7], s79 offen sc1
s_sub_u32 s29, s29, 1
s_waitcnt vmcnt(0)
v_cmp_gt_u32 vcc, 1, v63
s_cbranch_scc1 L_spinout_68
s_cbranch_vccnz L_spin_66
L_spun_67:
s_add_u32 s23, s39, 20971520
buffer_load_dwordx4 v[192:195], v1, s[4:7], s23 offen offset:0 sc1
buffer_load_dwordx4 v[196:199], v1, s[4:7], s23 offen offset:2048 sc1
s_add_u32 s23, s39, 20975616
buffer_load_dwordx4 v[200:203], v1, s[4:7], s23 offen offset:0 sc1
buffer_load_dwordx4 v[204:207], v1, s[4:7], s23 offen offset:2048 sc1
s_add_u32 s23, s39, 20972544
buffer_load_dwordx4 v[208:211], v1, s[4:7], s23 offen offset:0 sc1
buffer_load_dwordx4 v[212:215], v1, s[4:7], s23 offen offset:2048 sc1
s_add_u32 s23, s39, 20976640
buffer_load_dwordx4 v[216:219], v1, s[4:7], s23 offen offset:0 sc1
buffer_load_dwordx4 v[220:223], v1, s[4:7], s23 offen offset:2048 sc1
s_add_u32 s23, s39, 21004288
buffer_load_dwordx4 v[224:227], v1, s[4:7], s23 offen offset:0 sc1
buffer_load_dwordx4 v[228:231], v1, s[4:7], s23 offen offset:2048 sc1
s_waitcnt vmcnt(9)
v_mfma_f32_16x16x32_bf16 v[64:67], v[128:131], v[192:195], 0
s_add_u32 s23, s39, 21008384
buffer_load_dwordx4 v[232:235], v1, s[4:7], s23 offen offset:0 sc1
v_mfma_f32_16x16x32_bf16 v[68:71], v[132:135], v[192:195], 0
v_mfma_f32_16x16x32_bf16 v[72:75], v[136:139], v[192:195], 0
v_mfma_f32_16x16x32_bf16 v[76:79], v[140:143], v[192:195], 0
s_waitcnt vmcnt(9)
v_mfma_f32_16x16x32_bf16 v[64:67], v[144:147], v[196:199], v[64:67]
buffer_load_dwordx4 v[236:239], v1, s[4:7], s23 offen offset:2048 sc1
v_mfma_f32_16x16x32_bf16 v[68:71], v[148:151], v[196:199], v[68:71]
v_mfma_f32_16x16x32_bf16 v[72:75], v[152:155], v[196:199], v[72:75]
v_mfma_f32_16x16x32_bf16 v[76:79], v[156:159], v[196:199], v[76:79]
s_waitcnt vmcnt(9)
v_mfma_f32_16x16x32_bf16 v[64:67], v[160:163], v[200:203], v[64:67]
s_add_u32 s23, s39, 21005312
buffer_load_dwordx4 v[240:243], v1, s[4:7], s23 offen offset:0 sc1
v_mfma_f32_16x16x32_bf16 v[68:71], v[164:167], v[200:203], v[68:71]
v_mfma_f32_16x16x32_bf16 v[72:75], v[168:171], v[200:203], v[72:75]
v_mfma_f32_16x16x32_bf16 v[76:79], v[172:175], v[200:203], v[76:79]
s_waitcnt vmcnt(9)
v_mfma_f32_16x16x32_bf16 v[64:67], v[176:179], v[204:207], v[64:67]
buffer_load_dwordx4 v[244:247], v1, s[4:7], s23 offen offset:2048 sc1
v_mfma_f32_16x16x32_bf16 v[68:71], v[180:183], v[204:207], v[68:71]
v_mfma_f32_16x16x32_bf16 v[72:75], v[184:187], v[204:207], v[72:75]
v_mfma_f32_16x16x32_bf16 v[76:79], v[188:191], v[204:207], v[76:79]
s_waitcnt vmcnt(9)
v_mfma_f32_16x16x32_bf16 v[80:83], v[128:131], v[208:211], 0
s_add_u32 s23, s39, 21009408
buffer_load_dwordx4 v[248:251], v1, s[4:7], s23 offen offset:0 sc1
v_mfma_f32_16x16x32_bf16 v[84:87], v[132:135], v[208:211], 0
v_mfma_f32_16x16x32_bf16 v[88:91], v[136:139], v[208:211], 0
v_mfma_f32_16x16x32_bf16 v[92:95], v[140:143], v[208:211], 0
s_waitcnt vmcnt(9)
v_mfma_f32_16x16x32_bf16 v[80:83], v[144:147], v[212:215], v[80:83]
buffer_load_dwordx4 v[252:255], v1, s[4:7], s23 offen offset:2048 sc1
v_mfma_f32_16x16x32_bf16 v[84:87], v[148:151], v[212:215], v[84:87]
v_cvt_pk_bf16_f32 v64, v64, v65
v_cvt_pk_bf16_f32 v65, v66, v67
v_cvt_pk_bf16_f32 v66, v68, v69
v_cvt_pk_bf16_f32 v67, v70, v71
ds_write_b128 v56, v[64:67] offset:0
v_mfma_f32_16x16x32_bf16 v[88:91], v[152:155], v[212:215], v[88:91]
v_mfma_f32_16x16x32_bf16 v[92:95], v[156:159], v[212:215], v[92:95]
s_waitcnt vmcnt(9)
v_mfma_f32_16x16x32_bf16 v[80:83], v[160:163], v[216:219], v[80:83]
s_add_u32 m0, s21, 98304
s_add_u32 s30, s20, 131072
buffer_load_dwordx4 v1, s[4:7], s30 offen offset:0  lds
v_mfma_f32_16x16x32_bf16 v[84:87], v[164:167], v[216:219], v[84:87]
v_mfma_f32_16x16x32_bf16 v[88:91], v[168:171], v[216:219], v[88:91]
v_mfma_f32_16x16x32_bf16 v[92:95], v[172:175], v[216:219], v[92:95]
v_cvt_pk_bf16_f32 v72, v72, v73
v_cvt_pk_bf16_f32 v73, v74, v75
v_cvt_pk_bf16_f32 v74, v76, v77
v_cvt_pk_bf16_f32 v75, v78, v79
ds_write_b128 v56, v[72:75] offset:2048
s_waitcnt vmcnt(9)
v_mfma_f32_16x16x32_bf16 v[80:83], v[176:179], v[220:223], v[80:83]
buffer_load_dwordx4 v1, s[4:7], s30 offen offset:1024  lds
v_mfma_f32_16x16x32_bf16 v[84:87], v[180:183], v[220:223], v[84:87]
v_mfma_f32_16x16x32_bf16 v[88:91], v[184:187], v[220:223], v[88:91]
v_mfma_f32_16x16x32_bf16 v[92:95], v[188:191], v[220:223], v[92:95]
s_waitcnt vmcnt(9)
v_mfma_f32_16x16x32_bf16 v[96:99], v[128:131], v[224:227], 0
buffer_load_dwordx4 v1, s[4:7], s30 offen offset:2048  lds
v_mfma_f32_16x16x32_bf16 v[100:103], v[132:135], v[224:227], 0
v_mfma_f32_16x16x32_bf16 v[104:107], v[136:139], v[224:227], 0
v_mfma_f32_16x16x32_bf16 v[108:111], v[140:143], v[224:227], 0
v_cvt_pk_bf16_f32 v80, v80, v81
v_cvt_pk_bf16_f32 v81, v82, v83
v_cvt_pk_bf16_f32 v82, v84, v85
v_cvt_pk_bf16_f32 v83, v86, v87
ds_write_b128 v56, v[80:83] offset:256
s_waitcnt vmcnt(9)
v_mfma_f32_16x16x32_bf16 v[96:99], v[144:147], v[228:231], v[96:99]
buffer_load_dwordx4 v1, s[4:7], s30 offen offset:3072  lds
v_mfma_f32_16x16x32_bf16 v[100:103], v[148:151], v[228:231], v[100:103]
v_cvt_pk_bf16_f32 v88, v88, v89
v_cvt_pk_bf16_f32 v89, v90, v91
v_cvt_pk_bf16_f32 v90, v92, v93
v_cvt_pk_bf16_f32 v91, v94, v95
ds_write_b128 v56, v[88:91] offset:2304
v_mfma_f32_16x16x32_bf16 v[104:107], v[152:155], v[228:231], v[104:107]
v_mfma_f32_16x16x32_bf16 v[108:111], v[156:159], v[228:231], v[108:111]
s_waitcnt vmcnt(9)
v_mfma_f32_16x16x32_bf16 v[96:99], v[160:163], v[232:235], v[96:99]
s_add_u32 m0, s21, 102400
s_add_u32 s30, s20, 135168
buffer_load_dwordx4 v1, s[4:7], s30 offen offset:0  lds
v_mfma_f32_16x16x32_bf16 v[100:103], v[164:167], v[232:235], v[100:103]
s_waitcnt lgkmcnt(0)
s_barrier
ds_read_b128 v[64:67], v57 offset:0
ds_read_b128 v[68:71], v57 offset:1024
ds_read_b128 v[72:75], v57 offset:2048
ds_read_b128 v[76:79], v57 offset:3072
v_mfma_f32_16x16x32_bf16 v[104:107], v[168:171], v[232:235], v[104:107]
v_mfma_f32_16x16x32_bf16 v[108:111], v[172:175], v[232:235], v[108:111]
s_waitcnt vmcnt(9)
v_mfma_f32_16x16x32_bf16 v[96:99], v[176:179], v[236:239], v[96:99]
buffer_load_dwordx4 v1, s[4:7], s30 offen offset:1024  lds
v_mfma_f32_16x16x32_bf16 v[100:103], v[180:183], v[236:239], v[100:103]
v_mfma_f32_16x16x32_bf16 v[104:107], v[184:187], v[236:239], v[104:107]
v_mfma_f32_16x16x32_bf16 v[108:111], v[188:191], v[236:239], v[108:111]
s_waitcnt vmcnt(9)
v_mfma_f32_16x16x32_bf16 v[112:115], v[128:131], v[240:243], 0
buffer_load_dwordx4 v1, s[4:7], s30 offen offset:2048  lds
v_mfma_f32_16x16x32_bf16 v[116:119], v[132:135], v[240:243], 0
s_waitcnt lgkmcnt(3)
v_mfma_f32_16x16x32_bf16 v[40:43], a[240:243], v[64:67], v[40:43]
s_waitcnt lgkmcnt(2)
v_mfma_f32_16x16x32_bf16 v[44:47], a[240:243], v[68:71], v[44:47]
s_waitcnt lgkmcnt(1)
v_mfma_f32_16x16x32_bf16 v[40:43], a[244:247], v[72:75], v[40:43]
s_waitcnt lgkmcnt(0)
v_mfma_f32_16x16x32_bf16 v[44:47], a[244:247], v[76:79], v[44:47]
v_mfma_f32_16x16x32_bf16 v[120:123], v[136:139], v[240:243], 0
v_mfma_f32_16x16x32_bf16 v[124:127], v[140:143], v[240:243], 0
s_waitcnt vmcnt(9)
v_mfma_f32_16x16x32_bf16 v[112:115], v[144:147], v[244:247], v[112:115]
buffer_load_dwordx4 v1, s[4:7], s30 offen offset:3072  lds
v_mfma_f32_16x16x32_bf16 v[116:119], v[148:151], v[244:247], v[116:119]
v_cvt_pk_bf16_f32 v96, v96, v97
v_cvt_pk_bf16_f32 v97, v98, v99
v_cvt_pk_bf16_f32 v98, v100, v101
v_cvt_pk_bf16_f32 v99, v102, v103
ds_write_b128 v56, v[96:99] offset:16384
v_mfma_f32_16x16x32_bf16 v[120:123], v[152:155], v[244:247], v[120:123]
v_mfma_f32_16x16x32_bf16 v[124:127], v[156:159], v[244:247], v[124:127]
s_waitcnt vmcnt(9)
v_mfma_f32_16x16x32_bf16 v[112:115], v[160:163], v[248:251], v[112:115]
v_mfma_f32_16x16x32_bf16 v[116:119], v[164:167], v[248:251], v[116:119]
v_cvt_pk_bf16_f32 v104, v104, v105
v_cvt_pk_bf16_f32 v105, v106, v107
v_cvt_pk_bf16_f32 v106, v108, v109
v_cvt_pk_bf16_f32 v107, v110, v111
ds_write_b128 v56, v[104:107] offset:18432
v_mfma_f32_16x16x32_bf16 v[120:123], v[168:171], v[248:251], v[120:123]
v_mfma_f32_16x16x32_bf16 v[124:127], v[172:175], v[248:251], v[124:127]
s_waitcnt vmcnt(8)
v_mfma_f32_16x16x32_bf16 v[112:115], v[176:179], v[252:255], v[112:115]
v_mfma_f32_16x16x32_bf16 v[116:119], v[180:183], v[252:255], v[116:119]
v_cvt_pk_bf16_f32 v6, v40, v41
v_cvt_pk_bf16_f32 v7, v42, v43
v_cvt_pk_bf16_f32 v8, v44, v45
v_cvt_pk_bf16_f32 v9, v46, v47
s_nop 0
v_permlane16_swap_b32 v6, v8
v_permlane16_swap_b32 v7, v9
buffer_store_dwordx4 v[6:9], v58, s[4:7], s36 offen sc1
v_mfma_f32_16x16x32_bf16 v[120:123], v[184:187], v[252:255], v[120:123]
v_mfma_f32_16x16x32_bf16 v[124:127], v[188:191], v[252:255], v[124:127]
v_cvt_pk_bf16_f32 v112, v112, v113
v_cvt_pk_bf16_f32 v113, v114, v115
v_cvt_pk_bf16_f32 v114, v116, v117
v_cvt_pk_bf16_f32 v115, v118, v119
ds_write_b128 v56, v[112:115] offset:16640
s_nop 1
v_cvt_pk_bf16_f32 v120, v120, v121
v_cvt_pk_bf16_f32 v121, v122, v123
v_cvt_pk_bf16_f32 v122, v124, v125
v_cvt_pk_bf16_f32 v123, v126, v127
ds_write_b128 v56, v[120:123] offset:18688
s_waitcnt lgkmcnt(0)
s_barrier
ds_read_b128 v[96:99], v57 offset:16384
ds_read_b128 v[100:103], v57 offset:17408
ds_read_b128 v[104:107], v57 offset:18432
ds_read_b128 v[108:111], v57 offset:19456
v_dot2_f32_bf16 v60, v6, s22, 0
v_dot2_f32_bf16 v61, v6, v6, 0
v_dot2_f32_bf16 v60, v7, s22, v60
v_dot2_f32_bf16 v61, v7, v7, v61
v_dot2_f32_bf16 v60, v8, s22, v60
v_dot2_f32_bf16 v61, v8, v8, v61
v_dot2_f32_bf16 v60, v9, s22, v60
v_dot2_f32_bf16 v61, v9, v9, v61
v_bfe_u32 v62, v0, 4, 1
v_lshl_add_u32 v62, v62, 11, v59
s_nop 0
v_permlane32_swap_b32 v60, v61
v_add_f32 v60, v60, v61
s_waitcnt lgkmcnt(3)
v_mfma_f32_16x16x32_bf16 v[48:51], a[240:243], v[96:99], v[48:51]
s_waitcnt lgkmcnt(2)
v_mfma_f32_16x16x32_bf16 v[52:55], a[240:243], v[100:103], v[52:55]
s_waitcnt lgkmcnt(1)
v_mfma_f32_16x16x32_bf16 v[48:51], a[244:247], v[104:107], v[48:51]
s_waitcnt lgkmcnt(0)
v_mfma_f32_16x16x32_bf16 v[52:55], a[244:247], v[108:111], v[52:55]
s_nop 5
v_cvt_pk_bf16_f32 v10, v48, v49
v_cvt_pk_bf16_f32 v11, v50, v51
v_cvt_pk_bf16_f32 v12, v52, v53
v_cvt_pk_bf16_f32 v13, v54, v55
v_dot2_f32_bf16 v38, v10, s22, 0
v_dot2_f32_bf16 v39, v10, v10, 0
v_dot2_f32_bf16 v38, v11, s22, v38
v_dot2_f32_bf16 v39, v11, v11, v39
v_dot2_f32_bf16 v38, v12, s22, v38
v_dot2_f32_bf16 v39, v12, v12, v39
v_dot2_f32_bf16 v38, v13, s22, v38
v_dot2_f32_bf16 v39, v13, v13, v39
v_permlane16_swap_b32 v10, v12
v_permlane16_swap_b32 v11, v13
buffer_store_dwordx4 v[10:13], v58, s[4:7], s15 offen sc1
v_permlane32_swap_b32 v38, v39
v_add_f32 v38, v38, v39
s_nop 1
v_permlane16_swap_b32 v60, v38
v_add_f32 v60, v60, v38
s_nop 1
v_add_f32_dpp v60, v60, v60 row_ror:8 row_mask:0xf bank_mask:0xf
s_mov_b32 exec_lo, 0x00ff00ff
s_mov_b32 exec_hi, 0x00ff00ff
buffer_store_dword v60, v62, s[4:7], s37 offen sc1
s_mov_b64 exec, -1
v_lshrrev_b32 v40, 5, v0
v_lshlrev_b32 v40, 10, v40
v_and_b32 v41, 31, v0
v_lshl_add_u32 v40, v41, 3, v40
s_add_u32 s23, s81, 7864320
s_add_u32 s15, s80, 12582912
v_and_b32 v62, 31, v0
v_lshlrev_b32 v62, 2, v62
v_mov_b32 v4, 2
s_waitcnt vmcnt(0)
s_mov_b64 exec, 1
buffer_store_dword v4, off, s[4:7], s76 sc1
s_mov_b64 exec, -1
s_barrier
buffer_load_dword v63, v62, s[4:7], s77 offen sc1
ds_read_b128 a[224:227], v3 offset:0
ds_read_b128 a[228:231], v2 offset:32768
ds_read_b128 a[232:235], v3 offset:1024
ds_read_b128 a[236:239], v2 offset:33792
ds_read_b128 a[240:243], v3 offset:2048
ds_read_b128 a[244:247], v2 offset:34816
ds_read_b128 a[248:251], v3 offset:3072
s_waitcnt vmcnt(0)
v_cmp_gt_u32 vcc, 2, v63
s_nop 0
s_cbranch_vccz L_spun_70
L_spin_69:
s_sleep 8
buffer_load_dword v63, v62, s[4:7], s77 offen sc1
s_sub_u32 s29, s29, 1
s_waitcnt vmcnt(0)
v_cmp_gt_u32 vcc, 2, v63
s_cbranch_scc1 L_spinout_71
s_cbranch_vccnz L_spin_69
L_spun_70:
s_add_u32 s27, s15, 0
buffer_load_dwordx4 v[128:131], v1, s[4:7], s27 offen offset:0 sc1
buffer_load_dwordx4 v[132:135], v1, s[4:7], s27 offen offset:1024 sc1
buffer_load_dwordx4 v[136:139], v1, s[4:7], s27 offen offset:2048 sc1
buffer_load_dwordx4 v[140:143], v1, s[4:7], s27 offen offset:3072 sc1
s_add_u32 s27, s15, 4096
buffer_load_dwordx4 v[144:147], v1, s[4:7], s27 offen offset:0 sc1
buffer_load_dwordx4 v[148:151], v1, s[4:7], s27 offen offset:1024 sc1
buffer_load_dwordx4 v[152:155], v1, s[4:7], s27 offen offset:2048 sc1
buffer_load_dwordx4 v[156:159], v1, s[4:7], s27 offen offset:3072 sc1
buffer_load_dwordx2 v[42:43], v40, s[4:7], s23 offen offset:0 sc1
buffer_load_dwordx2 v[44:45], v40, s[4:7], s23 offen offset:256 sc1
buffer_load_dwordx2 v[46:47], v40, s[4:7], s23 offen offset:512 sc1
buffer_load_dwordx2 v[48:49], v40, s[4:7], s23 offen offset:768 sc1
s_waitcnt vmcnt(11) lgkmcnt(5)
v_mfma_f32_32x32x16_bf16 v[64:79], a[224:227], v[128:131], 0
s_add_u32 s27, s15, 8192
buffer_load_dwordx4 v[160:163], v1, s[4:7], s27 offen offset:0 sc1
ds_read_b128 a[252:255], v2 offset:35840
v_mfma_f32_32x32x16_bf16 v[80:95], a[228:231], v[128:131], 0
ds_read_b128 a[224:227], v3 offset:4096
s_waitcnt vmcnt(11) lgkmcnt(5)
v_mfma_f32_32x32x16_bf16 v[64:79], a[232:235], v[132:135], v[64:79]
buffer_load_dwordx4 v[164:167], v1, s[4:7], s27 offen offset:1024 sc1
ds_read_b128 a[228:231], v2 offset:36864
v_mfma_f32_32x32x16_bf16 v[80:95], a[236:239], v[132:135], v[80:95]
ds_read_b128 a[232:235], v3 offset:5120
s_waitcnt vmcnt(11) lgkmcnt(5)
v_mfma_f32_32x32x16_bf16 v[64:79], a[240:243], v[136:139], v[64:79]
buffer_load_dwordx4 v[168:171], v1, s[4:7], s27 offen offset:2048 sc1
ds_read_b128 a[236:239], v2 offset:37888
v_mfma_f32_32x32x16_bf16 v[80:95], a[244:247], v[136:139], v[80:95]
ds_read_b128 a[240:243], v3 offset:6144
s_waitcnt vmcnt(11) lgkmcnt(5)
v_mfma_f32_32x32x16_bf16 v[64:79], a[248:251], v[140:143], v[64:79]
buffer_load_dwordx4 v[172:175], v1, s[4:7], s27 offen offset:3072 sc1
ds_read_b128 a[244:247], v2 offset:38912
v_mfma_f32_32x32x16_bf16 v[80:95], a[252:255], v[140:143], v[80:95]
ds_read_b128 a[248:251], v3 offset:7168
s_waitcnt vmcnt(11) lgkmcnt(5)
v_mfma_f32_32x32x16_bf16 v[64:79], a[224:227], v[144:147], v[64:79]
s_add_u32 s27, s15, 12288
buffer_load_dwordx4 v[176:179], v1, s[4:7], s27 offen offset:0 sc1
ds_read_b128 a[252:255], v2 offset:39936
v_mfma_f32_32x32x16_bf16 v[80:95], a[228:231], v[144:147], v[80:95]
ds_read_b128 a[224:227], v1 offset:32768
s_waitcnt vmcnt(11) lgkmcnt(5)
v_mfma_f32_32x32x16_bf16 v[64:79], a[232:235], v[148:151], v[64:79]
buffer_load_dwordx4 v[180:183], v1, s[4:7], s27 offen offset:1024 sc1
ds_read_b128 a[228:231], v3 offset:8192
v_mfma_f32_32x32x16_bf16 v[80:95], a[236:239], v[148:151], v[80:95]
ds_read_b128 a[232:235], v2 offset:40960
s_waitcnt vmcnt(11) lgkmcnt(5)
v_mfma_f32_32x32x16_bf16 v[64:79], a[240:243], v[152:155], v[64:79]
buffer_load_dwordx4 v[184:187], v1, s[4:7], s27 offen offset:2048 sc1
ds_read_b128 a[236:239], v3 offset:9216
v_mfma_f32_32x32x16_bf16 v[80:95], a[244:247], v[152:155], v[80:95]
ds_read_b128 a[240:243], v2 offset:41984
s_waitcnt vmcnt(11) lgkmcnt(4)
v_mfma_f32_32x32x16_bf16 v[64:79], a[248:251], v[156:159], v[64:79]
buffer_load_dwordx4 v[188:191], v1, s[4:7], s27 offen offset:3072 sc1
ds_read_b128 a[244:247], v3 offset:10240
v_mfma_f32_32x32x16_bf16 v[80:95], a[252:255], v[156:159], v[80:95]
ds_read_b128 a[248:251], v2 offset:43008
v_mfma_f32_32x32x16_bf16 v[96:111], a[224:227], v[128:131], 0
ds_read_b128 a[252:255], v3 offset:11264
s_waitcnt vmcnt(7) lgkmcnt(5)
v_mfma_f32_32x32x16_bf16 v[64:79], a[228:231], v[160:163], v[64:79]
s_add_u32 s27, s15, 16384
buffer_load_dwordx4 v[192:195], v1, s[4:7], s27 offen offset:0 sc1
ds_read_b128 a[224:227], v2 offset:44032
v_add_f32 v42, v42, v44
v_add_f32 v43, v43, v45
v_mfma_f32_32x32x16_bf16 v[80:95], a[232:235], v[160:163], v[80:95]
ds_read_b128 a[228:231], v3 offset:12288
v_add_f32 v46, v46, v48
v_add_f32 v47, v47, v49
v_add_f32 v42, v42, v46
v_add_f32 v43, v43, v47
s_waitcnt vmcnt(7) lgkmcnt(5)
v_mfma_f32_32x32x16_bf16 v[64:79], a[236:239], v[164:167], v[64:79]
buffer_load_dwordx4 v[196:199], v1, s[4:7], s27 offen offset:1024 sc1
ds_read_b128 a[232:235], v2 offset:45056
v_permlane32_swap_b32 v42, v43
v_add_f32 v42, v42, v43
v_mov_b32 v43, v42
v_mfma_f32_32x32x16_bf16 v[80:95], a[240:243], v[164:167], v[80:95]
ds_read_b128 a[236:239], v3 offset:13312
v_permlane32_swap_b32 v42, v43
v_mul_f32 v42, 0xbb000000, v42
v_mul_f32 v43, 0x3b000000, v43
v_cvt_pk_bf16_f32 v44, v42, v42
s_waitcnt vmcnt(7) lgkmcnt(5)
v_mfma_f32_32x32x16_bf16 v[64:79], a[244:247], v[168:171], v[64:79]
buffer_load_dwordx4 v[200:203], v1, s[4:7], s27 offen offset:2048 sc1
ds_read_b128 a[240:243], v2 offset:46080
v_fma_f32 v43, -v42, v42, v43
v_and_b32 v45, 0xffff0000, v44
v_max_f32 v43, 0, v43
v_mfma_f32_32x32x16_bf16 v[80:95], a[248:251], v[168:171], v[80:95]
ds_read_b128 a[244:247], v3 offset:14336
v_sub_f32 v45, v42, v45
v_add_f32 v50, 0x3727c5ac, v43
v_cvt_pk_bf16_f32 v45, v45, v45
v_rsq_f32 v51, v50
s_waitcnt vmcnt(7) lgkmcnt(5)
v_mfma_f32_32x32x16_bf16 v[64:79], a[252:255], v[172:175], v[64:79]
buffer_load_dwordx4 v[204:207], v1, s[4:7], s27 offen offset:3072 sc1
ds_read_b128 a[248:251], v2 offset:47104
v_cndmask_b32 v32, v45, v44, s[24:25]
v_mov_b32 v37, v32
v_mfma_f32_32x32x16_bf16 v[80:95], a[224:227], v[172:175], v[80:95]
ds_read_b128 a[252:255], v3 offset:15360
v_mfma_f32_32x32x16_bf16 v[64:79], v[22:25], v[34:37], v[64:79]
v_mfma_f32_32x32x16_bf16 v[80:95], v[26:29], v[32:35], v[80:95]
v_mfma_f32_32x32x16_bf16 v[96:111], v[24:27], v[34:37], v[96:111]
s_waitcnt vmcnt(7) lgkmcnt(5)
v_mfma_f32_32x32x16_bf16 v[64:79], a[228:231], v[176:179], v[64:79]
s_add_u32 s27, s15, 20480
buffer_load_dwordx4 v[208:211], v1, s[4:7], s27 offen offset:0 sc1
ds_read_b128 a[224:227], v2 offset:48128
v_mul_f32 v38, 0xc0135761, v51
v_mul_f32 v39, v51, v51
v_mfma_f32_32x32x16_bf16 v[80:95], a[232:235], v[176:179], v[80:95]
ds_read_b128 a[228:231], v1 offset:33792
v_mul_f32 v39, v39, v38
v_mul_f32 v39, 0x3d372713, v39
s_add_u32 s36, s32, 25165824
s_mul_i32 s28, s18, 1536
s_waitcnt vmcnt(7) lgkmcnt(5)
v_mfma_f32_32x32x16_bf16 v[64:79], a[236:239], v[180:183], v[64:79]
buffer_load_dwordx4 v[212:215], v1, s[4:7], s27 offen offset:1024 sc1
ds_read_b128 a[232:235], v3 offset:16384
s_sub_u32 s28, s38, s28
s_add_u32 s28, s28, 20971520
v_bfe_u32 v41, v0, 4, 1
v_mfma_f32_32x32x16_bf16 v[80:95], a[240:243], v[180:183], v[80:95]
ds_read_b128 a[236:239], v2 offset:49152
v_lshlrev_b32 v40, 10, v41
v_lshrrev_b32 v41, 5, v0
v_lshl_add_u32 v40, v41, 8, v40
v_and_b32 v41, 15, v0
s_waitcnt vmcnt(7) lgkmcnt(5)
v_mfma_f32_32x32x16_bf16 v[64:79], a[244:247], v[184:187], v[64:79]
buffer_load_dwordx4 v[216:219], v1, s[4:7], s27 offen offset:2048 sc1
ds_read_b128 a[240:243], v3 offset:17408
v_lshl_add_u32 v40, v41, 4, v40
v_mov_b32 v41, v58
v_and_b32 v62, 7, v0
v_mfma_f32_32x32x16_bf16 v[80:95], a[248:251], v[184:187], v[80:95]
ds_read_b128 a[244:247], v2 offset:50176
v_lshlrev_b32 v62, 2, v62
v_and_b32 v59, 7, v0
v_lshl_add_u32 v59, s3, 3, v59
v_bfe_u32 v61, v0, 4, 1
s_waitcnt vmcnt(7) lgkmcnt(4)
v_mfma_f32_32x32x16_bf16 v[64:79], a[252:255], v[188:191], v[64:79]
buffer_load_dwordx4 v[220:223], v1, s[4:7], s27 offen offset:3072 sc1
ds_read_b128 a[248:251], v3 offset:18432
v_and_b32 v56, 15, v0
v_lshlrev_b32 v60, 3, v61
v_xor_b32 v56, v56, v60
v_mfma_f32_32x32x16_bf16 v[80:95], a[224:227], v[188:191], v[80:95]
ds_read_b128 a[252:255], v2 offset:51200
v_lshlrev_b32 v56, 4, v56
v_lshrrev_b32 v60, 4, v0
v_lshl_add_u32 v56, v60, 9, v56
v_lshl_add_u32 v56, s3, 12, v56
v_mfma_f32_32x32x16_bf16 v[96:111], a[228:231], v[132:135], v[96:111]
ds_read_b128 a[224:227], v3 offset:19456
v_bfe_u32 v61, v0, 3, 1
v_lshlrev_b32 v57, 3, v61
v_xor_b32 v57, v57, v59
v_lshlrev_b32 v57, 4, v57
s_waitcnt vmcnt(7) lgkmcnt(5)
v_mfma_f32_32x32x16_bf16 v[64:79], a[232:235], v[192:195], v[64:79]
s_add_u32 s27, s15, 24576
buffer_load_dwordx4 v[224:227], v1, s[4:7], s27 offen offset:0 sc1
ds_read_b128 a[228:231], v2 offset:52224
v_lshl_add_u32 v57, v61, 9, v57
v_lshl_add_u32 v57, v60, 12, v57
v_mfma_f32_32x32x16_bf16 v[80:95], a[236:239], v[192:195], v[80:95]
ds_read_b128 a[232:235], v3 offset:20480
v_lshlrev_b32 v58, 4, v59
v_lshl_add_u32 v58, v61, 9, v58
v_lshl_add_u32 v58, v60, 10, v58
v_lshrrev_b32 v60, 5, v0
s_waitcnt vmcnt(7) lgkmcnt(5)
v_mfma_f32_32x32x16_bf16 v[64:79], a[240:243], v[196:199], v[64:79]
buffer_load_dwordx4 v[228:231], v1, s[4:7], s27 offen offset:1024 sc1
ds_read_b128 a[236:239], v2 offset:53248
v_lshlrev_b32 v59, 3, v59
v_lshl_add_u32 v59, v60, 2, v59
v_mfma_f32_32x32x16_bf16 v[80:95], a[244:247], v[196:199], v[80:95]
ds_read_b128 a[240:243], v3 offset:21504
s_waitcnt vmcnt(7) lgkmcnt(5)
v_mfma_f32_32x32x16_bf16 v[64:79], a[248:251], v[200:203], v[64:79]
buffer_load_dwordx4 v[232:235], v1, s[4:7], s27 offen offset:2048 sc1
ds_read_b128 a[244:247], v2 offset:54272
v_mfma_f32_32x32x16_bf16 v[80:95], a[252:255], v[200:203], v[80:95]
ds_read_b128 a[248:251], v3 offset:22528
s_waitcnt vmcnt(7) lgkmcnt(5)
v_mfma_f32_32x32x16_bf16 v[64:79], a[224:227], v[204:207], v[64:79]
buffer_load_dwordx4 v[236:239], v1, s[4:7], s27 offen offset:3072 sc1
ds_read_b128 a[252:255], v2 offset:55296
v_mfma_f32_32x32x16_bf16 v[80:95], a[228:231], v[204:207], v[80:95]
ds_read_b128 a[224:227], v3 offset:23552
s_waitcnt vmcnt(7) lgkmcnt(5)
v_mfma_f32_32x32x16_bf16 v[64:79], a[232:235], v[208:211], v[64:79]
s_add_u32 s27, s15, 28672
buffer_load_dwordx4 v[240:243], v1, s[4:7], s27 offen offset:0 sc1
ds_read_b128 a[228:231], v2 offset:56320
v_mfma_f32_32x32x16_bf16 v[80:95], a[236:239], v[208:211], v[80:95]
ds_read_b128 a[232:235], v1 offset:34816
s_waitcnt vmcnt(7) lgkmcnt(5)
v_mfma_f32_32x32x16_bf16 v[64:79], a[240:243], v[212:215], v[64:79]
buffer_load_dwordx4 v[244:247], v1, s[4:7], s27 offen offset:1024 sc1
ds_read_b128 a[236:239], v3 offset:24576
v_mfma_f32_32x32x16_bf16 v[80:95], a[244:247], v[212:215], v[80:95]
ds_read_b128 a[240:243], v2 offset:57344
s_waitcnt vmcnt(7) lgkmcnt(5)
v_mfma_f32_32x32x16_bf16 v[64:79], a[248:251], v[216:219], v[64:79]
buffer_load_dwordx4 v[248:251], v1, s[4:7], s27 offen offset:2048 sc1
ds_read_b128 a[244:247], v3 offset:25600
v_mfma_f32_32x32x16_bf16 v[80:95], a[252:255], v[216:219], v[80:95]
ds_read_b128 a[248:251], v2 offset:58368
s_waitcnt vmcnt(7) lgkmcnt(4)
v_mfma_f32_32x32x16_bf16 v[64:79], a[224:227], v[220:223], v[64:79]
buffer_load_dwordx4 v[252:255], v1, s[4:7], s27 offen offset:3072 sc1
ds_read_b128 a[252:255], v3 offset:26624
v_mfma_f32_32x32x16_bf16 v[80:95], a[228:231], v[220:223], v[80:95]
ds_read_b128 a[224:227], v2 offset:59392
v_mfma_f32_32x32x16_bf16 v[96:111], a[232:235], v[136:139], v[96:111]
ds_read_b128 a[228:231], v3 offset:27648
s_waitcnt vmcnt(7) lgkmcnt(5)
v_mfma_f32_32x32x16_bf16 v[64:79], a[236:239], v[224:227], v[64:79]
s_add_u32 m0, s21, 0
s_add_u32 s30, s20, 196608
buffer_load_dwordx4 v1, s[4:7], s30 offen offset:0  lds
ds_read_b128 a[232:235], v2 offset:60416
v_mfma_f32_32x32x16_bf16 v[80:95], a[240:243], v[224:227], v[80:95]
ds_read_b128 a[236:239], v3 offset:28672
s_waitcnt vmcnt(7) lgkmcnt(5)
v_mfma_f32_32x32x16_bf16 v[64:79], a[244:247], v[228:231], v[64:79]
buffer_load_dwordx4 v1, s[4:7], s30 offen offset:1024  lds
ds_read_b128 a[240:243], v2 offset:61440
v_mfma_f32_32x32x16_bf16 v[80:95], a[248:251], v[228:231], v[80:95]
ds_read_b128 a[244:247], v3 offset:29696
s_waitcnt vmcnt(7) lgkmcnt(5)
v_mfma_f32_32x32x16_bf16 v[64:79], a[252:255], v[232:235], v[64:79]
buffer_load_dwordx4 v1, s[4:7], s30 offen offset:2048  lds
ds_read_b128 a[248:251], v2 offset:62464
v_mfma_f32_32x32x16_bf16 v[80:95], a[224:227], v[232:235], v[80:95]
ds_read_b128 a[252:255], v3 offset:30720
s_waitcnt vmcnt(7) lgkmcnt(5)
v_mfma_f32_32x32x16_bf16 v[64:79], a[228:231], v[236:239], v[64:79]
buffer_load_dwordx4 v1, s[4:7], s30 offen offset:3072  lds
ds_read_b128 a[224:227], v2 offset:63488
v_mfma_f32_32x32x16_bf16 v[80:95], a[232:235], v[236:239], v[80:95]
ds_read_b128 a[228:231], v3 offset:31744
s_waitcnt vmcnt(7) lgkmcnt(5)
v_mfma_f32_32x32x16_bf16 v[64:79], a[236:239], v[240:243], v[64:79]
s_add_u32 m0, s21, 4096
s_add_u32 s30, s20, 200704
buffer_load_dwordx4 v1, s[4:7], s30 offen offset:0  lds
ds_read_b128 a[232:235], v2 offset:64512
v_mfma_f32_32x32x16_bf16 v[80:95], a[240:243], v[240:243], v[80:95]
ds_read_b128 a[236:239], v1 offset:35840
s_waitcnt vmcnt(7) lgkmcnt(5)
v_mfma_f32_32x32x16_bf16 v[64:79], a[244:247], v[244:247], v[64:79]
buffer_load_dwordx4 v1, s[4:7], s30 offen offset:1024  lds
ds_read_b128 a[240:243], v1 offset:36864
v_mfma_f32_32x32x16_bf16 v[80:95], a[248:251], v[244:247], v[80:95]
ds_read_b128 a[244:247], v1 offset:37888
s_waitcnt vmcnt(7) lgkmcnt(5)
v_mfma_f32_32x32x16_bf16 v[64:79], a[252:255], v[248:251], v[64:79]
buffer_load_dwordx4 v1, s[4:7], s30 offen offset:2048  lds
ds_read_b128 a[248:251], v1 offset:38912
v_mfma_f32_32x32x16_bf16 v[80:95], a[224:227], v[248:251], v[80:95]
ds_read_b128 a[252:255], v1 offset:39936
s_waitcnt vmcnt(7) lgkmcnt(4)
v_mfma_f32_32x32x16_bf16 v[64:79], a[228:231], v[252:255], v[64:79]
buffer_load_dwordx4 v1, s[4:7], s30 offen offset:3072  lds
ds_read_b128 a[224:227], v1 offset:40960
v_mfma_f32_32x32x16_bf16 v[80:95], a[232:235], v[252:255], v[80:95]
ds_read_b128 a[228:231], v1 offset:41984
v_mfma_f32_32x32x16_bf16 v[96:111], a[236:239], v[140:143], v[96:111]
ds_read_b128 a[232:235], v1 offset:43008
s_waitcnt lgkmcnt(3)
v_mfma_f32_32x32x16_bf16 v[96:111], a[240:243], v[144:147], v[96:111]
s_barrier
ds_read_b128 a[236:239], v1 offset:44032
s_add_u32 s34, s35, 0
buffer_load_dwordx4 a[0:3], v1, s[4:7], s34 offen offset:0
v_mfma_f32_32x32x16_bf16 v[96:111], a[244:247], v[148:151], v[96:111]
ds_read_b128 a[240:243], v1 offset:45056
v_mfma_f32_32x32x16_bf16 v[96:111], a[248:251], v[152:155], v[96:111]
ds_read_b128 a[244:247], v1 offset:46080
v_mul_f32 v52, v64, v64
v_mul_f32 v53, v65, v65
v_mul_f32 v54, v66, v66
v_mul_f32 v55, v67, v67
v_fma_f32 v52, v52, v39, v38
v_fma_f32 v53, v53, v39, v38
v_mfma_f32_32x32x16_bf16 v[96:111], a[252:255], v[156:159], v[96:111]
ds_read_b128 a[248:251], v1 offset:47104
buffer_load_dwordx4 a[4:7], v1, s[4:7], s34 offen offset:1024
v_fma_f32 v54, v54, v39, v38
v_fma_f32 v55, v55, v39, v38
v_mul_f32 v52, v52, v64
v_mul_f32 v53, v53, v65
v_mul_f32 v54, v54, v66
s_waitcnt lgkmcnt(3)
v_mfma_f32_32x32x16_bf16 v[96:111], a[224:227], v[160:163], v[96:111]
ds_read_b128 a[252:255], v1 offset:48128
v_mul_f32 v55, v55, v67
v_exp_f32 v52, v52
v_mul_f32 v64, v64, v72
v_mfma_f32_32x32x16_bf16 v[96:111], a[228:231], v[164:167], v[96:111]
ds_read_b128 a[224:227], v1 offset:49152
buffer_load_dword v5, off, s[4:7], s79 sc1
v_exp_f32 v53, v53
v_mul_f32 v65, v65, v73
v_exp_f32 v54, v54
v_mfma_f32_32x32x16_bf16 v[96:111], a[232:235], v[168:171], v[96:111]
ds_read_b128 a[228:231], v1 offset:50176
buffer_load_dwordx4 a[8:11], v1, s[4:7], s34 offen offset:2048
v_mul_f32 v66, v66, v74
v_exp_f32 v55, v55
v_mul_f32 v67, v67, v75
v_fma_f32 v52, v52, v50, v50
v_mfma_f32_32x32x16_bf16 v[96:111], a[236:239], v[172:175], v[96:111]
ds_read_b128 a[232:235], v1 offset:51200
v_fma_f32 v53, v53, v50, v50
v_fma_f32 v54, v54, v50, v50
v_fma_f32 v55, v55, v50, v50
v_rcp_f32 v52, v52
s_waitcnt lgkmcnt(3)
v_mfma_f32_32x32x16_bf16 v[96:111], a[240:243], v[176:179], v[96:111]
ds_read_b128 a[236:239], v1 offset:52224
buffer_load_dwordx4 a[12:15], v1, s[4:7], s34 offen offset:3072
v_rcp_f32 v53, v53
v_rcp_f32 v54, v54
v_mfma_f32_32x32x16_bf16 v[96:111], a[244:247], v[180:183], v[96:111]
ds_read_b128 a[240:243], v1 offset:53248
s_add_u32 m0, s21, 131072
s_add_u32 s30, s20, 229376
buffer_load_dwordx4 v1, s[4:7], s30 offen offset:0  lds
v_rcp_f32 v55, v55
v_mul_f32 v64, v64, v52
v_mfma_f32_32x32x16_bf16 v[96:111], a[248:251], v[184:187], v[96:111]
ds_read_b128 a[244:247], v1 offset:54272
v_mul_f32 v65, v65, v53
v_mul_f32 v66, v66, v54
v_mul_f32 v67, v67, v55
v_cvt_pk_bf16_f32 v42, v64, v65
v_cvt_pk_bf16_f32 v43, v66, v67
v_mul_f32 v52, v68, v68
v_mfma_f32_32x32x16_bf16 v[96:111], a[252:255], v[188:191], v[96:111]
ds_read_b128 a[248:251], v1 offset:55296
s_add_u32 s34, s35, 4096
buffer_load_dwordx4 a[16:19], v1, s[4:7], s34 offen offset:0
v_mul_f32 v53, v69, v69
v_mul_f32 v54, v70, v70
v_mul_f32 v55, v71, v71
v_fma_f32 v52, v52, v39, v38
s_waitcnt lgkmcnt(3)
v_mfma_f32_32x32x16_bf16 v[96:111], a[224:227], v[192:195], v[96:111]
ds_read_b128 a[252:255], v1 offset:56320
v_fma_f32 v53, v53, v39, v38
v_fma_f32 v54, v54, v39, v38
v_fma_f32 v55, v55, v39, v38
v_mul_f32 v52, v52, v68
v_mul_f32 v53, v53, v69
v_mfma_f32_32x32x16_bf16 v[96:111], a[228:231], v[196:199], v[96:111]
ds_read_b128 a[224:227], v1 offset:57344
buffer_load_dwordx4 v1, s[4:7], s30 offen offset:1024  lds
v_mul_f32 v54, v54, v70
v_mul_f32 v55, v55, v71
v_exp_f32 v52, v52
v_mul_f32 v68, v68, v76
v_mfma_f32_32x32x16_bf16 v[96:111], a[232:235], v[200:203], v[96:111]
ds_read_b128 a[228:231], v1 offset:58368
buffer_load_dwordx4 a[20:23], v1, s[4:7], s34 offen offset:1024
v_exp_f32 v53, v53
v_mul_f32 v69, v69, v77
v_exp_f32 v54, v54
v_mfma_f32_32x32x16_bf16 v[96:111], a[236:239], v[204:207], v[96:111]
ds_read_b128 a[232:235], v1 offset:59392
v_mul_f32 v70, v70, v78
v_exp_f32 v55, v55
v_mul_f32 v71, v71, v79
v_fma_f32 v52, v52, v50, v50
v_fma_f32 v53, v53, v50, v50
s_waitcnt lgkmcnt(3)
v_mfma_f32_32x32x16_bf16 v[96:111], a[240:243], v[208:211], v[96:111]
ds_read_b128 a[236:239], v1 offset:60416
buffer_load_dwordx4 a[24:27], v1, s[4:7], s34 offen offset:2048
v_fma_f32 v54, v54, v50, v50
v_fma_f32 v55, v55, v50, v50
v_rcp_f32 v52, v52
v_mfma_f32_32x32x16_bf16 v[96:111], a[244:247], v[212:215], v[96:111]
ds_read_b128 a[240:243], v1 offset:61440
buffer_load_dwordx4 v1, s[4:7], s30 offen offset:2048  lds
v_rcp_f32 v53, v53
v_rcp_f32 v54, v54
v_mfma_f32_32x32x16_bf16 v[96:111], a[248:251], v[216:219], v[96:111]
s_waitcnt vmcnt(11)
s_barrier
ds_read_b128 a[244:247], v1 offset:62464
buffer_load_dwordx4 a[28:31], v1, s[4:7], s34 offen offset:3072
v_rcp_f32 v55, v55
v_mul_f32 v68, v68, v52
v_mfma_f32_32x32x16_bf16 v[96:111], a[252:255], v[220:223], v[96:111]
ds_read_b128 a[248:251], v1 offset:63488
v_mul_f32 v69, v69, v53
v_mul_f32 v70, v70, v54
v_mul_f32 v71, v71, v55
v_cvt_pk_bf16_f32 v44, v68, v69
v_cvt_pk_bf16_f32 v45, v70, v71
s_add_u32 s37, s36, 0
buffer_store_dwordx4 v[42:45], v40, s[4:7], s37 offen sc1
s_waitcnt lgkmcnt(3)
v_mfma_f32_32x32x16_bf16 v[96:111], a[224:227], v[224:227], v[96:111]
ds_read_b128 a[252:255], v1 offset:64512
s_add_u32 s34, s35, 8192
buffer_load_dwordx4 a[32:35], v1, s[4:7], s34 offen offset:0
v_mul_f32 v52, v80, v80
v_mul_f32 v53, v81, v81
v_mul_f32 v54, v82, v82
v_mfma_f32_32x32x16_bf16 v[96:111], a[228:231], v[228:231], v[96:111]
ds_read_b128 a[224:227], v1 offset:0
buffer_load_dwordx4 v1, s[4:7], s30 offen offset:3072  lds
v_mul_f32 v55, v83, v83
v_fma_f32 v52, v52, v39, v38
v_fma_f32 v53, v53, v39, v38
v_fma_f32 v54, v54, v39, v38
v_fma_f32 v55, v55, v39, v38
v_mfma_f32_32x32x16_bf16 v[96:111], a[232:235], v[232:235], v[96:111]
ds_read_b128 a[228:231], v1 offset:1024
v_mul_f32 v52, v52, v80
v_mul_f32 v53, v53, v81
v_mul_f32 v54, v54, v82
v_mul_f32 v55, v55, v83
v_exp_f32 v52, v52
v_mfma_f32_32x32x16_bf16 v[96:111], a[236:239], v[236:239], v[96:111]
ds_read_b128 a[232:235], v1 offset:2048
buffer_load_dwordx4 a[36:39], v1, s[4:7], s34 offen offset:1024
v_mul_f32 v80, v80, v88
v_exp_f32 v53, v53
v_mul_f32 v81, v81, v89
s_waitcnt lgkmcnt(3)
v_mfma_f32_32x32x16_bf16 v[96:111], a[240:243], v[240:243], v[96:111]
ds_read_b128 a[236:239], v1 offset:3072
v_exp_f32 v54, v54
v_mul_f32 v82, v82, v90
v_exp_f32 v55, v55
v_mfma_f32_32x32x16_bf16 v[96:111], a[244:247], v[244:247], v[96:111]
ds_read_b128 a[240:243], v1 offset:4096
s_add_u32 m0, s21, 135168
s_add_u32 s30, s20, 233472
buffer_load_dwordx4 v1, s[4:7], s30 offen offset:0  lds
v_mul_f32 v83, v83, v91
v_fma_f32 v52, v52, v50, v50
v_fma_f32 v53, v53, v50, v50
v_mfma_f32_32x32x16_bf16 v[96:111], a[248:251], v[248:251], v[96:111]
ds_read_b128 a[244:247], v1 offset:5120
buffer_load_dwordx4 a[40:43], v1, s[4:7], s34 offen offset:2048
v_fma_f32 v54, v54, v50, v50
v_fma_f32 v55, v55, v50, v50
v_rcp_f32 v52, v52
v_mfma_f32_32x32x16_bf16 v[96:111], a[252:255], v[252:255], v[96:111]
ds_read_b128 a[248:251], v1 offset:6144
v_rcp_f32 v53, v53
v_rcp_f32 v54, v54
v_rcp_f32 v55, v55
v_mfma_f32_32x32x16_bf16 v[112:127], v[28:31], v[32:35], 0
s_waitcnt lgkmcnt(3)
v_mfma_f32_32x32x16_bf16 v[112:127], a[224:227], v[128:131], v[112:127]
ds_read_b128 a[252:255], v1 offset:7168
buffer_load_dwordx4 v1, s[4:7], s30 offen offset:1024  lds
v_mfma_f32_32x32x16_bf16 v[112:127], a[228:231], v[132:135], v[112:127]
ds_read_b128 a[224:227], v1 offset:8192
buffer_load_dwordx4 a[44:47], v1, s[4:7], s34 offen offset:3072
v_mfma_f32_32x32x16_bf16 v[112:127], a[232:235], v[136:139], v[112:127]
ds_read_b128 a[228:231], v1 offset:9216
v_mul_f32 v80, v80, v52
v_mul_f32 v81, v81, v53
v_mul_f32 v82, v82, v54
v_mul_f32 v83, v83, v55
v_cvt_pk_bf16_f32 v46, v80, v81
v_cvt_pk_bf16_f32 v47, v82, v83
v_mfma_f32_32x32x16_bf16 v[112:127], a[236:239], v[140:143], v[112:127]
ds_read_b128 a[232:235], v1 offset:10240
v_mul_f32 v52, v84, v84
v_mul_f32 v53, v85, v85
v_mul_f32 v54, v86, v86
v_mul_f32 v55, v87, v87
v_fma_f32 v52, v52, v39, v38
v_fma_f32 v53, v53, v39, v38
s_waitcnt lgkmcnt(3)
v_mfma_f32_32x32x16_bf16 v[112:127], a[240:243], v[144:147], v[112:127]
ds_read_b128 a[236:239], v1 offset:11264
buffer_load_dwordx4 v1, s[4:7], s30 offen offset:2048  lds
v_fma_f32 v54, v54, v39, v38
v_fma_f32 v55, v55, v39, v38
v_mul_f32 v52, v52, v84
v_mul_f32 v53, v53, v85
v_mfma_f32_32x32x16_bf16 v[112:127], a[244:247], v[148:151], v[112:127]
ds_read_b128 a[240:243], v1 offset:12288
s_add_u32 s34, s35, 12288
buffer_load_dwordx4 a[48:51], v1, s[4:7], s34 offen offset:0
v_mul_f32 v54, v54, v86
v_mul_f32 v55, v55, v87
v_exp_f32 v52, v52
v_mfma_f32_32x32x16_bf16 v[112:127], a[248:251], v[152:155], v[112:127]
ds_read_b128 a[244:247], v1 offset:13312
v_mul_f32 v84, v84, v92
v_exp_f32 v53, v53
v_mul_f32 v85, v85, v93
v_exp_f32 v54, v54
v_mfma_f32_32x32x16_bf16 v[112:127], a[252:255], v[156:159], v[112:127]
ds_read_b128 a[248:251], v1 offset:14336
buffer_load_dwordx4 a[52:55], v1, s[4:7], s34 offen offset:1024
v_mul_f32 v86, v86, v94
v_exp_f32 v55, v55
v_mul_f32 v87, v87, v95
v_fma_f32 v52, v52, v50, v50
s_waitcnt lgkmcnt(3)
v_mfma_f32_32x32x16_bf16 v[112:127], a[224:227], v[160:163], v[112:127]
ds_read_b128 a[252:255], v1 offset:15360
buffer_load_dwordx4 v1, s[4:7], s30 offen offset:3072  lds
v_fma_f32 v53, v53, v50, v50
v_fma_f32 v54, v54, v50, v50
v_fma_f32 v55, v55, v50, v50
v_mfma_f32_32x32x16_bf16 v[112:127], a[228:231], v[164:167], v[112:127]
ds_read_b128 a[224:227], v1 offset:16384
buffer_load_dwordx4 a[56:59], v1, s[4:7], s34 offen offset:2048
v_rcp_f32 v52, v52
v_rcp_f32 v53, v53
v_mfma_f32_32x32x16_bf16 v[112:127], a[232:235], v[168:171], v[112:127]
ds_read_b128 a[228:231], v1 offset:17408
v_rcp_f32 v54, v54
v_rcp_f32 v55, v55
v_mul_f32 v84, v84, v52
v_mul_f32 v85, v85, v53
v_mfma_f32_32x32x16_bf16 v[112:127], a[236:239], v[172:175], v[112:127]
ds_read_b128 a[232:235], v1 offset:18432
v_mul_f32 v86, v86, v54
v_mul_f32 v87, v87, v55
v_cvt_pk_bf16_f32 v48, v84, v85
v_cvt_pk_bf16_f32 v49, v86, v87
s_add_u32 s37, s36, 2048
buffer_store_dwordx4 v[46:49], v40, s[4:7], s37 offen sc1
v_mul_f32 v52, v96, v96
s_waitcnt lgkmcnt(3)
v_mfma_f32_32x32x16_bf16 v[112:127], a[240:243], v[176:179], v[112:127]
ds_read_b128 a[236:239], v1 offset:19456
s_add_u32 m0, s21, 98304
s_add_u32 s30, s20, 262144
buffer_load_dwordx4 v1, s[4:7], s30 offen offset:0  lds
v_mul_f32 v53, v97, v97
v_mul_f32 v54, v98, v98
v_mfma_f32_32x32x16_bf16 v[112:127], a[244:247], v[180:183], v[112:127]
ds_read_b128 a[240:243], v1 offset:20480
buffer_load_dwordx4 a[60:63], v1, s[4:7], s34 offen offset:3072
v_mul_f32 v55, v99, v99
v_fma_f32 v52, v52, v39, v38
v_fma_f32 v53, v53, v39, v38
v_fma_f32 v54, v54, v39, v38
v_fma_f32 v55, v55, v39, v38
v_mfma_f32_32x32x16_bf16 v[112:127], a[248:251], v[184:187], v[112:127]
ds_read_b128 a[244:247], v1 offset:21504
v_mul_f32 v52, v52, v96
v_mul_f32 v53, v53, v97
v_mul_f32 v54, v54, v98
v_mul_f32 v55, v55, v99
v_exp_f32 v52, v52
v_mfma_f32_32x32x16_bf16 v[112:127], a[252:255], v[188:191], v[112:127]
ds_read_b128 a[248:251], v1 offset:22528
s_add_u32 s34, s35, 28672
buffer_load_dwordx4 a[112:115], v1, s[4:7], s34 offen offset:0
v_mul_f32 v96, v96, v104
v_exp_f32 v53, v53
v_mul_f32 v97, v97, v105
s_waitcnt lgkmcnt(3)
v_mfma_f32_32x32x16_bf16 v[112:127], a[224:227], v[192:195], v[112:127]
ds_read_b128 a[252:255], v1 offset:23552
buffer_load_dwordx4 v1, s[4:7], s30 offen offset:1024  lds
v_exp_f32 v54, v54
v_mul_f32 v98, v98, v106
v_mfma_f32_32x32x16_bf16 v[112:127], a[228:231], v[196:199], v[112:127]
ds_read_b128 a[224:227], v1 offset:24576
buffer_load_dwordx4 a[116:119], v1, s[4:7], s34 offen offset:1024
v_exp_f32 v55, v55
v_mul_f32 v99, v99, v107
v_fma_f32 v52, v52, v50, v50
v_fma_f32 v53, v53, v50, v50
v_mfma_f32_32x32x16_bf16 v[112:127], a[232:235], v[200:203], v[112:127]
ds_read_b128 a[228:231], v1 offset:25600
v_fma_f32 v54, v54, v50, v50
v_fma_f32 v55, v55, v50, v50
v_rcp_f32 v52, v52
v_rcp_f32 v53, v53
v_mfma_f32_32x32x16_bf16 v[112:127], a[236:239], v[204:207], v[112:127]
ds_read_b128 a[232:235], v1 offset:26624
buffer_load_dwordx4 a[120:123], v1, s[4:7], s34 offen offset:2048
v_rcp_f32 v54, v54
v_rcp_f32 v55, v55
v_mul_f32 v96, v96, v52
s_waitcnt lgkmcnt(3)
v_mfma_f32_32x32x16_bf16 v[112:127], a[240:243], v[208:211], v[112:127]
ds_read_b128 a[236:239], v1 offset:27648
buffer_load_dwordx4 v1, s[4:7], s30 offen offset:2048  lds
v_mul_f32 v97, v97, v53
v_mul_f32 v98, v98, v54
v_mul_f32 v99, v99, v55
v_cvt_pk_bf16_f32 v42, v96, v97
v_mfma_f32_32x32x16_bf16 v[112:127], a[244:247], v[212:215], v[112:127]
ds_read_b128 a[240:243], v1 offset:28672
buffer_load_dwordx4 a[124:127], v1, s[4:7], s34 offen offset:3072
v_cvt_pk_bf16_f32 v43, v98, v99
v_mul_f32 v52, v100, v100
v_mul_f32 v53, v101, v101
v_mul_f32 v54, v102, v102
v_mul_f32 v55, v103, v103
v_mfma_f32_32x32x16_bf16 v[112:127], a[248:251], v[216:219], v[112:127]
s_waitcnt vmcnt(10)
s_barrier
ds_read_b128 a[244:247], v1 offset:29696
v_fma_f32 v52, v52, v39, v38
v_fma_f32 v53, v53, v39, v38
v_fma_f32 v54, v54, v39, v38
v_fma_f32 v55, v55, v39, v38
v_mfma_f32_32x32x16_bf16 v[112:127], a[252:255], v[220:223], v[112:127]
ds_read_b128 a[248:251], v1 offset:30720
s_add_u32 s34, s35, 32768
buffer_load_dwordx4 a[128:131], v1, s[4:7], s34 offen offset:0
v_mul_f32 v52, v52, v100
v_mul_f32 v53, v53, v101
v_mul_f32 v54, v54, v102
v_mul_f32 v55, v55, v103
s_waitcnt lgkmcnt(3)
v_mfma_f32_32x32x16_bf16 v[112:127], a[224:227], v[224:227], v[112:127]
ds_read_b128 a[252:255], v1 offset:31744
buffer_load_dwordx4 v1, s[4:7], s30 offen offset:3072  lds
v_exp_f32 v52, v52
v_mul_f32 v100, v100, v108
v_mfma_f32_32x32x16_bf16 v[112:127], a[228:231], v[228:231], v[112:127]
ds_read_b128 a[224:227], v3 offset:0
buffer_load_dwordx4 a[132:135], v1, s[4:7], s34 offen offset:1024
v_exp_f32 v53, v53
v_mul_f32 v101, v101, v109
v_exp_f32 v54, v54
v_mfma_f32_32x32x16_bf16 v[112:127], a[232:235], v[232:235], v[112:127]
ds_read_b128 a[228:231], v3 offset:1024
v_mul_f32 v102, v102, v110
v_exp_f32 v55, v55
v_mul_f32 v103, v103, v111
v_fma_f32 v52, v52, v50, v50
v_fma_f32 v53, v53, v50, v50
v_mfma_f32_32x32x16_bf16 v[112:127], a[236:239], v[236:239], v[112:127]
ds_read_b128 a[232:235], v3 offset:2048
buffer_load_dwordx4 a[136:139], v1, s[4:7], s34 offen offset:2048
v_fma_f32 v54, v54, v50, v50
v_fma_f32 v55, v55, v50, v50
v_rcp_f32 v52, v52
s_waitcnt lgkmcnt(3)
v_mfma_f32_32x32x16_bf16 v[112:127], a[240:243], v[240:243], v[112:127]
ds_read_b128 a[236:239], v3 offset:3072
s_add_u32 m0, s21, 102400
s_add_u32 s30, s20, 266240
buffer_load_dwordx4 v1, s[4:7], s30 offen offset:0  lds
v_rcp_f32 v53, v53
v_mfma_f32_32x32x16_bf16 v[112:127], a[244:247], v[244:247], v[112:127]
ds_read_b128 a[240:243], v3 offset:4096
v_rcp_f32 v54, v54
v_rcp_f32 v55, v55
v_mul_f32 v100, v100, v52
v_mul_f32 v101, v101, v53
v_mfma_f32_32x32x16_bf16 v[112:127], a[248:251], v[248:251], v[112:127]
ds_read_b128 a[244:247], v3 offset:5120
buffer_load_dwordx4 a[140:143], v1, s[4:7], s34 offen offset:3072
v_mul_f32 v102, v102, v54
v_mul_f32 v103, v103, v55
v_cvt_pk_bf16_f32 v44, v100, v101
v_cvt_pk_bf16_f32 v45, v102, v103
s_add_u32 s37, s36, 4096
buffer_store_dwordx4 v[42:45], v40, s[4:7], s37 offen sc1
v_mfma_f32_32x32x16_bf16 v[112:127], a[252:255], v[252:255], v[112:127]
ds_read_b128 a[248:251], v3 offset:6144
v_mfma_f32_32x32x16_bf16 v[64:79], v[26:29], v[34:37], 0
s_waitcnt lgkmcnt(3)
v_mfma_f32_32x32x16_bf16 v[64:79], a[224:227], v[128:131], v[64:79]
ds_read_b128 a[252:255], v3 offset:7168
buffer_load_dwordx4 v1, s[4:7], s30 offen offset:1024  lds
v_mfma_f32_32x32x16_bf16 v[64:79], a[228:231], v[132:135], v[64:79]
ds_read_b128 a[224:227], v3 offset:8192
s_add_u32 s34, s35, 36864
buffer_load_dwordx4 a[144:147], v1, s[4:7], s34 offen offset:0
v_mfma_f32_32x32x16_bf16 v[64:79], a[232:235], v[136:139], v[64:79]
ds_read_b128 a[228:231], v3 offset:9216
v_mul_f32 v52, v112, v112
v_mul_f32 v53, v113, v113
v_mul_f32 v54, v114, v114
v_mul_f32 v55, v115, v115
v_fma_f32 v52, v52, v39, v38
v_fma_f32 v53, v53, v39, v38
v_mfma_f32_32x32x16_bf16 v[64:79], a[236:239], v[140:143], v[64:79]
ds_read_b128 a[232:235], v3 offset:10240
v_fma_f32 v54, v54, v39, v38
v_fma_f32 v55, v55, v39, v38
v_mul_f32 v52, v52, v112
v_mul_f32 v53, v53, v113
v_mul_f32 v54, v54, v114
v_mul_f32 v55, v55, v115
s_waitcnt lgkmcnt(3)
v_mfma_f32_32x32x16_bf16 v[64:79], a[240:243], v[144:147], v[64:79]
ds_read_b128 a[236:239], v3 offset:11264
buffer_load_dwordx4 v1, s[4:7], s30 offen offset:2048  lds
v_exp_f32 v52, v52
v_mul_f32 v112, v112, v120
v_mfma_f32_32x32x16_bf16 v[64:79], a[244:247], v[148:151], v[64:79]
ds_read_b128 a[240:243], v3 offset:12288
buffer_load_dwordx4 a[148:151], v1, s[4:7], s34 offen offset:1024
v_exp_f32 v53, v53
v_mul_f32 v113, v113, v121
v_exp_f32 v54, v54
v_mfma_f32_32x32x16_bf16 v[64:79], a[248:251], v[152:155], v[64:79]
ds_read_b128 a[244:247], v3 offset:13312
v_mul_f32 v114, v114, v122
v_exp_f32 v55, v55
v_mul_f32 v115, v115, v123
v_fma_f32 v52, v52, v50, v50
v_fma_f32 v53, v53, v50, v50
v_mfma_f32_32x32x16_bf16 v[64:79], a[252:255], v[156:159], v[64:79]
ds_read_b128 a[248:251], v3 offset:14336
buffer_load_dwordx4 a[152:155], v1, s[4:7], s34 offen offset:2048
v_fma_f32 v54, v54, v50, v50
v_fma_f32 v55, v55, v50, v50
v_rcp_f32 v52, v52
s_waitcnt lgkmcnt(3)
v_mfma_f32_32x32x16_bf16 v[64:79], a[224:227], v[160:163], v[64:79]
ds_read_b128 a[252:255], v3 offset:15360
buffer_load_dwordx4 v1, s[4:7], s30 offen offset:3072  lds
v_rcp_f32 v53, v53
v_rcp_f32 v54, v54
v_mfma_f32_32x32x16_bf16 v[64:79], a[228:231], v[164:167], v[64:79]
ds_read_b128 a[224:227], v3 offset:16384
v_rcp_f32 v55, v55
v_mul_f32 v112, v112, v52
v_mul_f32 v113, v113, v53
v_mul_f32 v114, v114, v54
v_mul_f32 v115, v115, v55
v_mfma_f32_32x32x16_bf16 v[64:79], a[232:235], v[168:171], v[64:79]
ds_read_b128 a[228:231], v3 offset:17408
buffer_load_dwordx4 a[156:159], v1, s[4:7], s34 offen offset:3072
v_cvt_pk_bf16_f32 v46, v112, v113
v_cvt_pk_bf16_f32 v47, v114, v115
v_mul_f32 v52, v116, v116
v_mul_f32 v53, v117, v117
v_mul_f32 v54, v118, v118
v_mfma_f32_32x32x16_bf16 v[64:79], a[236:239], v[172:175], v[64:79]
ds_read_b128 a[232:235], v3 offset:18432
v_mul_f32 v55, v119, v119
v_fma_f32 v52, v52, v39, v38
v_fma_f32 v53, v53, v39, v38
v_fma_f32 v54, v54, v39, v38
v_fma_f32 v55, v55, v39, v38
v_mul_f32 v52, v52, v116
s_waitcnt lgkmcnt(3)
v_mfma_f32_32x32x16_bf16 v[64:79], a[240:243], v[176:179], v[64:79]
ds_read_b128 a[236:239], v3 offset:19456
s_add_u32 m0, s21, 32768
s_add_u32 s30, s20, 294912
buffer_load_dwordx4 v1, s[4:7], s30 offen offset:0  lds
v_mul_f32 v53, v53, v117
v_mul_f32 v54, v54, v118
v_mfma_f32_32x32x16_bf16 v[64:79], a[244:247], v[180:183], v[64:79]
ds_read_b128 a[240:243], v3 offset:20480
s_add_u32 s34, s35, 40960
buffer_load_dwordx4 a[160:163], v1, s[4:7], s34 offen offset:0
v_mul_f32 v55, v55, v119
v_exp_f32 v52, v52
v_mul_f32 v116, v116, v124
v_mfma_f32_32x32x16_bf16 v[64:79], a[248:251], v[184:187], v[64:79]
ds_read_b128 a[244:247], v3 offset:21504
v_exp_f32 v53, v53
v_mul_f32 v117, v117, v125
v_exp_f32 v54, v54
v_mul_f32 v118, v118, v126
v_mfma_f32_32x32x16_bf16 v[64:79], a[252:255], v[188:191], v[64:79]
ds_read_b128 a[248:251], v3 offset:22528
buffer_load_dwordx4 a[164:167], v1, s[4:7], s34 offen offset:1024
v_exp_f32 v55, v55
v_mul_f32 v119, v119, v127
v_fma_f32 v52, v52, v50, v50
v_fma_f32 v53, v53, v50, v50
s_waitcnt lgkmcnt(3)
v_mfma_f32_32x32x16_bf16 v[64:79], a[224:227], v[192:195], v[64:79]
ds_read_b128 a[252:255], v3 offset:23552
buffer_load_dwordx4 v1, s[4:7], s30 offen offset:1024  lds
v_fma_f32 v54, v54, v50, v50
v_fma_f32 v55, v55, v50, v50
v_rcp_f32 v52, v52
v_mfma_f32_32x32x16_bf16 v[64:79], a[228:231], v[196:199], v[64:79]
ds_read_b128 a[224:227], v3 offset:24576
buffer_load_dwordx4 a[168:171], v1, s[4:7], s34 offen offset:2048
v_rcp_f32 v53, v53
v_rcp_f32 v54, v54
v_mfma_f32_32x32x16_bf16 v[64:79], a[232:235], v[200:203], v[64:79]
ds_read_b128 a[228:231], v3 offset:25600
v_rcp_f32 v55, v55
v_mul_f32 v116, v116, v52
v_mul_f32 v117, v117, v53
v_mul_f32 v118, v118, v54
v_mul_f32 v119, v119, v55
v_mfma_f32_32x32x16_bf16 v[64:79], a[236:239], v[204:207], v[64:79]
ds_read_b128 a[232:235], v3 offset:26624
v_cvt_pk_bf16_f32 v48, v116, v117
v_cvt_pk_bf16_f32 v49, v118, v119
s_add_u32 s37, s36, 6144
buffer_store_dwordx4 v[46:49], v40, s[4:7], s37 offen sc1
s_waitcnt lgkmcnt(3)
v_mfma_f32_32x32x16_bf16 v[64:79], a[240:243], v[208:211], v[64:79]
ds_read_b128 a[236:239], v3 offset:27648
buffer_load_dwordx4 v1, s[4:7], s30 offen offset:2048  lds
v_mfma_f32_32x32x16_bf16 v[64:79], a[244:247], v[212:215], v[64:79]
ds_read_b128 a[240:243], v3 offset:28672
buffer_load_dwordx4 a[172:175], v1, s[4:7], s34 offen offset:3072
v_mfma_f32_32x32x16_bf16 v[64:79], a[248:251], v[216:219], v[64:79]
s_waitcnt vmcnt(9)
s_barrier
ds_read_b128 a[244:247], v3 offset:29696
v_mfma_f32_32x32x16_bf16 v[64:79], a[252:255], v[220:223], v[64:79]
ds_read_b128 a[248:251], v3 offset:30720
s_waitcnt lgkmcnt(3)
v_mfma_f32_32x32x16_bf16 v[64:79], a[224:227], v[224:227], v[64:79]
ds_read_b128 a[252:255], v3 offset:31744
buffer_load_dwordx4 v1, s[4:7], s30 offen offset:3072  lds
v_mfma_f32_32x32x16_bf16 v[64:79], a[228:231], v[228:231], v[64:79]
ds_read_b128 a[224:227], v2 offset:32768
s_add_u32 s34, s35, 16384
buffer_load_dwordx4 a[64:67], v1, s[4:7], s34 offen offset:0
v_mfma_f32_32x32x16_bf16 v[64:79], a[232:235], v[232:235], v[64:79]
ds_read_b128 a[228:231], v2 offset:33792
v_mfma_f32_32x32x16_bf16 v[64:79], a[236:239], v[236:239], v[64:79]
ds_read_b128 a[232:235], v2 offset:34816
s_waitcnt lgkmcnt(3)
v_mfma_f32_32x32x16_bf16 v[64:79], a[240:243], v[240:243], v[64:79]
ds_read_b128 a[236:239], v2 offset:35840
s_add_u32 m0, s21, 36864
s_add_u32 s30, s20, 299008
buffer_load_dwordx4 v1, s[4:7], s30 offen offset:0  lds
v_mfma_f32_32x32x16_bf16 v[64:79], a[244:247], v[244:247], v[64:79]
ds_read_b128 a[240:243], v2 offset:36864
buffer_load_dwordx4 a[68:71], v1, s[4:7], s34 offen offset:1024
v_mfma_f32_32x32x16_bf16 v[64:79], a[248:251], v[248:251], v[64:79]
ds_read_b128 a[244:247], v2 offset:37888
v_mfma_f32_32x32x16_bf16 v[64:79], a[252:255], v[252:255], v[64:79]
ds_read_b128 a[248:251], v2 offset:38912
v_mfma_f32_32x32x16_bf16 v[80:95], v[30:33], v[32:35], 0
s_waitcnt lgkmcnt(3)
v_mfma_f32_32x32x16_bf16 v[80:95], a[224:227], v[128:131], v[80:95]
ds_read_b128 a[252:255], v2 offset:39936
v_mov_b32 v4, 3
s_waitcnt vmcnt(6)
s_mov_b64 exec, 1
buffer_store_dword v4, off, s[4:7], s78 sc1
s_mov_b64 exec, -1
buffer_load_dwordx4 v1, s[4:7], s30 offen offset:1024  lds
v_mfma_f32_32x32x16_bf16 v[80:95], a[228:231], v[132:135], v[80:95]
ds_read_b128 a[224:227], v2 offset:40960
v_mfma_f32_32x32x16_bf16 v[80:95], a[232:235], v[136:139], v[80:95]
ds_read_b128 a[228:231], v2 offset:41984
buffer_load_dwordx4 a[72:75], v1, s[4:7], s34 offen offset:2048
v_mul_f32 v52, v64, v64
v_mul_f32 v53, v65, v65
v_mul_f32 v54, v66, v66
v_mul_f32 v55, v67, v67
v_fma_f32 v52, v52, v39, v38
v_mfma_f32_32x32x16_bf16 v[80:95], a[236:239], v[140:143], v[80:95]
ds_read_b128 a[232:235], v2 offset:43008
v_fma_f32 v53, v53, v39, v38
v_fma_f32 v54, v54, v39, v38
v_fma_f32 v55, v55, v39, v38
v_mul_f32 v52, v52, v64
v_mul_f32 v53, v53, v65
v_mul_f32 v54, v54, v66
s_waitcnt lgkmcnt(3)
v_mfma_f32_32x32x16_bf16 v[80:95], a[240:243], v[144:147], v[80:95]
ds_read_b128 a[236:239], v2 offset:44032
buffer_load_dwordx4 a[76:79], v1, s[4:7], s34 offen offset:3072
v_mul_f32 v55, v55, v67
v_exp_f32 v52, v52
v_mul_f32 v64, v64, v72
v_mfma_f32_32x32x16_bf16 v[80:95], a[244:247], v[148:151], v[80:95]
ds_read_b128 a[240:243], v2 offset:45056
buffer_load_dwordx4 v1, s[4:7], s30 offen offset:2048  lds
v_exp_f32 v53, v53
v_mul_f32 v65, v65, v73
v_exp_f32 v54, v54
v_mfma_f32_32x32x16_bf16 v[80:95], a[248:251], v[152:155], v[80:95]
ds_read_b128 a[244:247], v2 offset:46080
v_mul_f32 v66, v66, v74
v_exp_f32 v55, v55
v_mul_f32 v67, v67, v75
v_fma_f32 v52, v52, v50, v50
v_fma_f32 v53, v53, v50, v50
v_mfma_f32_32x32x16_bf16 v[80:95], a[252:255], v[156:159], v[80:95]
ds_read_b128 a[248:251], v2 offset:47104
s_add_u32 s34, s35, 20480
buffer_load_dwordx4 a[80:83], v1, s[4:7], s34 offen offset:0
v_fma_f32 v54, v54, v50, v50
v_fma_f32 v55, v55, v50, v50
v_rcp_f32 v52, v52
s_waitcnt lgkmcnt(3)
v_mfma_f32_32x32x16_bf16 v[80:95], a[224:227], v[160:163], v[80:95]
ds_read_b128 a[252:255], v2 offset:48128
v_rcp_f32 v53, v53
v_rcp_f32 v54, v54
v_mfma_f32_32x32x16_bf16 v[80:95], a[228:231], v[164:167], v[80:95]
ds_read_b128 a[224:227], v2 offset:49152
buffer_load_dwordx4 v1, s[4:7], s30 offen offset:3072  lds
v_rcp_f32 v55, v55
v_mul_f32 v64, v64, v52
v_mul_f32 v65, v65, v53
v_mul_f32 v66, v66, v54
v_mfma_f32_32x32x16_bf16 v[80:95], a[232:235], v[168:171], v[80:95]
ds_read_b128 a[228:231], v2 offset:50176
buffer_load_dwordx4 a[84:87], v1, s[4:7], s34 offen offset:1024
v_mul_f32 v67, v67, v55
v_cvt_pk_bf16_f32 v42, v64, v65
v_cvt_pk_bf16_f32 v43, v66, v67
v_mul_f32 v52, v68, v68
v_mul_f32 v53, v69, v69
v_mfma_f32_32x32x16_bf16 v[80:95], a[236:239], v[172:175], v[80:95]
ds_read_b128 a[232:235], v2 offset:51200
v_mul_f32 v54, v70, v70
v_mul_f32 v55, v71, v71
v_fma_f32 v52, v52, v39, v38
v_fma_f32 v53, v53, v39, v38
v_fma_f32 v54, v54, v39, v38
v_fma_f32 v55, v55, v39, v38
s_waitcnt lgkmcnt(3)
v_mfma_f32_32x32x16_bf16 v[80:95], a[240:243], v[176:179], v[80:95]
ds_read_b128 a[236:239], v2 offset:52224
buffer_load_dwordx4 a[88:91], v1, s[4:7], s34 offen offset:2048
v_mul_f32 v52, v52, v68
v_mul_f32 v53, v53, v69
v_mul_f32 v54, v54, v70
v_mul_f32 v55, v55, v71
v_mfma_f32_32x32x16_bf16 v[80:95], a[244:247], v[180:183], v[80:95]
ds_read_b128 a[240:243], v2 offset:53248
buffer_load_dword v5, off, s[4:7], s77 sc1
v_exp_f32 v52, v52
v_mul_f32 v68, v68, v76
v_exp_f32 v53, v53
v_mfma_f32_32x32x16_bf16 v[80:95], a[248:251], v[184:187], v[80:95]
ds_read_b128 a[244:247], v2 offset:54272
v_mul_f32 v69, v69, v77
v_exp_f32 v54, v54
v_mul_f32 v70, v70, v78
v_exp_f32 v55, v55
v_mfma_f32_32x32x16_bf16 v[80:95], a[252:255], v[188:191], v[80:95]
ds_read_b128 a[248:251], v2 offset:55296
buffer_load_dwordx4 a[92:95], v1, s[4:7], s34 offen offset:3072
v_mul_f32 v71, v71, v79
v_fma_f32 v52, v52, v50, v50
v_fma_f32 v53, v53, v50, v50
v_fma_f32 v54, v54, v50, v50
v_fma_f32 v55, v55, v50, v50
s_waitcnt lgkmcnt(3)
v_mfma_f32_32x32x16_bf16 v[80:95], a[224:227], v[192:195], v[80:95]
ds_read_b128 a[252:255], v2 offset:56320
v_rcp_f32 v52, v52
v_rcp_f32 v53, v53
v_mfma_f32_32x32x16_bf16 v[80:95], a[228:231], v[196:199], v[80:95]
ds_read_b128 a[224:227], v2 offset:57344
s_add_u32 s34, s35, 45056
buffer_load_dwordx4 a[176:179], v1, s[4:7], s34 offen offset:0
v_rcp_f32 v54, v54
v_rcp_f32 v55, v55
v_mfma_f32_32x32x16_bf16 v[80:95], a[232:235], v[200:203], v[80:95]
ds_read_b128 a[228:231], v2 offset:58368
v_mul_f32 v68, v68, v52
v_mul_f32 v69, v69, v53
v_mul_f32 v70, v70, v54
v_mul_f32 v71, v71, v55
v_cvt_pk_bf16_f32 v44, v68, v69
v_cvt_pk_bf16_f32 v45, v70, v71
v_mfma_f32_32x32x16_bf16 v[80:95], a[236:239], v[204:207], v[80:95]
ds_read_b128 a[232:235], v2 offset:59392
buffer_load_dwordx4 a[180:183], v1, s[4:7], s34 offen offset:1024
s_add_u32 s37, s36, 8192
buffer_store_dwordx4 v[42:45], v40, s[4:7], s37 offen sc1
s_waitcnt lgkmcnt(3)
v_mfma_f32_32x32x16_bf16 v[80:95], a[240:243], v[208:211], v[80:95]
ds_read_b128 a[236:239], v2 offset:60416
v_mfma_f32_32x32x16_bf16 v[80:95], a[244:247], v[212:215], v[80:95]
ds_read_b128 a[240:243], v2 offset:61440
buffer_load_dword v63, v62, s[4:7], s79 offen sc1
v_mfma_f32_32x32x16_bf16 v[80:95], a[248:251], v[216:219], v[80:95]
s_waitcnt vmcnt(8)
s_barrier
ds_read_b128 a[244:247], v2 offset:62464
buffer_load_dwordx4 a[184:187], v1, s[4:7], s34 offen offset:2048
v_mfma_f32_32x32x16_bf16 v[80:95], a[252:255], v[220:223], v[80:95]
ds_read_b128 a[248:251], v2 offset:63488
s_waitcnt lgkmcnt(3)
v_mfma_f32_32x32x16_bf16 v[80:95], a[224:227], v[224:227], v[80:95]
ds_read_b128 a[252:255], v2 offset:64512
v_mfma_f32_32x32x16_bf16 v[80:95], a[228:231], v[228:231], v[80:95]
ds_read_b128 a[224:227], v1 offset:32768
buffer_load_dwordx4 a[188:191], v1, s[4:7], s34 offen offset:3072
v_mfma_f32_32x32x16_bf16 v[80:95], a[232:235], v[232:235], v[80:95]
ds_read_b128 a[228:231], v1 offset:33792
v_mfma_f32_32x32x16_bf16 v[80:95], a[236:239], v[236:239], v[80:95]
ds_read_b128 a[232:235], v1 offset:34816
s_waitcnt lgkmcnt(3)
v_mfma_f32_32x32x16_bf16 v[80:95], a[240:243], v[240:243], v[80:95]
ds_read_b128 a[236:239], v1 offset:35840
s_add_u32 s34, s35, 49152
buffer_load_dwordx4 a[192:195], v1, s[4:7], s34 offen offset:0
v_mfma_f32_32x32x16_bf16 v[80:95], a[244:247], v[244:247], v[80:95]
ds_read_b128 a[240:243], v1 offset:36864
v_mfma_f32_32x32x16_bf16 v[80:95], a[248:251], v[248:251], v[80:95]
ds_read_b128 a[244:247], v1 offset:37888
v_mfma_f32_32x32x16_bf16 v[80:95], a[252:255], v[252:255], v[80:95]
ds_read_b128 a[248:251], v1 offset:38912
s_waitcnt vmcnt(3)
v_cmp_gt_u32 vcc, 3, v63
s_nop 0
s_cbranch_vccnz L_poll_72
L_polled_73:
v_mfma_f32_32x32x16_bf16 v[96:111], v[28:31], v[34:37], 0
s_waitcnt lgkmcnt(3)
v_mfma_f32_32x32x16_bf16 v[96:111], a[224:227], v[128:131], v[96:111]
ds_read_b128 a[252:255], v1 offset:39936
buffer_load_dwordx4 a[196:199], v1, s[4:7], s34 offen offset:1024
v_mfma_f32_32x32x16_bf16 v[96:111], a[228:231], v[132:135], v[96:111]
ds_read_b128 a[224:227], v1 offset:40960
s_add_u32 s23, s87, 25165824
buffer_load_dwordx4 v[128:131], v1, s[4:7], s23 offen offset:0 sc1
v_mfma_f32_32x32x16_bf16 v[96:111], a[232:235], v[136:139], v[96:111]
ds_read_b128 a[228:231], v1 offset:41984
buffer_load_dwordx4 v[132:135], v1, s[4:7], s23 offen offset:1024 sc1
v_mul_f32 v52, v80, v80
v_mul_f32 v53, v81, v81
v_mul_f32 v54, v82, v82
v_mul_f32 v55, v83, v83
v_fma_f32 v52, v52, v39, v38
v_mfma_f32_32x32x16_bf16 v[96:111], a[236:239], v[140:143], v[96:111]
ds_read_b128 a[232:235], v1 offset:43008
buffer_load_dwordx4 v[136:139], v1, s[4:7], s23 offen offset:2048 sc1
v_fma_f32 v53, v53, v39, v38
v_fma_f32 v54, v54, v39, v38
v_fma_f32 v55, v55, v39, v38
v_mul_f32 v52, v52, v80
v_mul_f32 v53, v53, v81
s_waitcnt lgkmcnt(3)
v_mfma_f32_32x32x16_bf16 v[96:111], a[240:243], v[144:147], v[96:111]
ds_read_b128 a[236:239], v1 offset:44032
buffer_load_dwordx4 v[140:143], v1, s[4:7], s23 offen offset:3072 sc1
v_mul_f32 v54, v54, v82
v_mul_f32 v55, v55, v83
v_exp_f32 v52, v52
v_mfma_f32_32x32x16_bf16 v[96:111], a[244:247], v[148:151], v[96:111]
ds_read_b128 a[240:243], v1 offset:45056
buffer_load_dwordx4 a[200:203], v1, s[4:7], s34 offen offset:2048
v_mul_f32 v80, v80, v88
v_exp_f32 v53, v53
v_mul_f32 v81, v81, v89
v_mfma_f32_32x32x16_bf16 v[96:111], a[248:251], v[152:155], v[96:111]
ds_read_b128 a[244:247], v1 offset:46080
s_add_u32 s23, s87, 25169920
buffer_load_dwordx4 v[144:147], v1, s[4:7], s23 offen offset:0 sc1
v_exp_f32 v54, v54
v_mul_f32 v82, v82, v90
v_mfma_f32_32x32x16_bf16 v[96:111], a[252:255], v[156:159], v[96:111]
ds_read_b128 a[248:251], v1 offset:47104
v_exp_f32 v55, v55
v_mul_f32 v83, v83, v91
v_fma_f32 v52, v52, v50, v50
v_fma_f32 v53, v53, v50, v50
v_fma_f32 v54, v54, v50, v50
s_waitcnt lgkmcnt(3)
v_mfma_f32_32x32x16_bf16 v[96:111], a[224:227], v[160:163], v[96:111]
ds_read_b128 a[252:255], v1 offset:48128
buffer_load_dwordx4 v[148:151], v1, s[4:7], s23 offen offset:1024 sc1
v_fma_f32 v55, v55, v50, v50
v_rcp_f32 v52, v52
v_mfma_f32_32x32x16_bf16 v[96:111], a[228:231], v[164:167], v[96:111]
ds_read_b128 a[224:227], v1 offset:49152
buffer_load_dwordx4 a[204:207], v1, s[4:7], s34 offen offset:3072
v_rcp_f32 v53, v53
v_rcp_f32 v54, v54
v_mfma_f32_32x32x16_bf16 v[96:111], a[232:235], v[168:171], v[96:111]
ds_read_b128 a[228:231], v1 offset:50176
buffer_load_dwordx4 v[152:155], v1, s[4:7], s23 offen offset:2048 sc1
v_rcp_f32 v55, v55
v_mul_f32 v80, v80, v52
v_mul_f32 v81, v81, v53
v_mul_f32 v82, v82, v54
v_mfma_f32_32x32x16_bf16 v[96:111], a[236:239], v[172:175], v[96:111]
ds_read_b128 a[232:235], v1 offset:51200
v_mul_f32 v83, v83, v55
v_cvt_pk_bf16_f32 v46, v80, v81
v_cvt_pk_bf16_f32 v47, v82, v83
v_mul_f32 v52, v84, v84
v_mul_f32 v53, v85, v85
v_mul_f32 v54, v86, v86
s_waitcnt lgkmcnt(3)
v_mfma_f32_32x32x16_bf16 v[96:111], a[240:243], v[176:179], v[96:111]
ds_read_b128 a[236:239], v1 offset:52224
buffer_load_dwordx4 v[156:159], v1, s[4:7], s23 offen offset:3072 sc1
v_mul_f32 v55, v87, v87
v_fma_f32 v52, v52, v39, v38
v_fma_f32 v53, v53, v39, v38
v_fma_f32 v54, v54, v39, v38
v_mfma_f32_32x32x16_bf16 v[96:111], a[244:247], v[180:183], v[96:111]
ds_read_b128 a[240:243], v1 offset:53248
s_add_u32 s34, s35, 24576
buffer_load_dwordx4 a[96:99], v1, s[4:7], s34 offen offset:0
v_fma_f32 v55, v55, v39, v38
v_mul_f32 v52, v52, v84
v_mul_f32 v53, v53, v85
v_mul_f32 v54, v54, v86
v_mfma_f32_32x32x16_bf16 v[96:111], a[248:251], v[184:187], v[96:111]
ds_read_b128 a[244:247], v1 offset:54272
s_add_u32 s23, s87, 25180160
buffer_load_dwordx4 v[160:163], v1, s[4:7], s23 offen offset:0 sc1
v_mul_f32 v55, v55, v87
v_exp_f32 v52, v52
v_mul_f32 v84, v84, v92
v_mfma_f32_32x32x16_bf16 v[96:111], a[252:255], v[188:191], v[96:111]
ds_read_b128 a[248:251], v1 offset:55296
buffer_load_dwordx4 a[100:103], v1, s[4:7], s34 offen offset:1024
v_exp_f32 v53, v53
v_mul_f32 v85, v85, v93
v_exp_f32 v54, v54
s_waitcnt lgkmcnt(3)
v_mfma_f32_32x32x16_bf16 v[96:111], a[224:227], v[192:195], v[96:111]
ds_read_b128 a[252:255], v1 offset:56320
buffer_load_dwordx4 v[164:167], v1, s[4:7], s23 offen offset:1024 sc1
v_mul_f32 v86, v86, v94
v_exp_f32 v55, v55
v_mul_f32 v87, v87, v95
v_mfma_f32_32x32x16_bf16 v[96:111], a[228:231], v[196:199], v[96:111]
ds_read_b128 a[224:227], v1 offset:57344
buffer_load_dwordx4 a[104:107], v1, s[4:7], s34 offen offset:2048
v_fma_f32 v52, v52, v50, v50
v_fma_f32 v53, v53, v50, v50
v_fma_f32 v54, v54, v50, v50
v_fma_f32 v55, v55, v50, v50
v_mfma_f32_32x32x16_bf16 v[96:111], a[232:235], v[200:203], v[96:111]
ds_read_b128 a[228:231], v1 offset:58368
buffer_load_dwordx4 v[168:171], v1, s[4:7], s23 offen offset:2048 sc1
v_rcp_f32 v52, v52
v_rcp_f32 v53, v53
v_mfma_f32_32x32x16_bf16 v[96:111], a[236:239], v[204:207], v[96:111]
ds_read_b128 a[232:235], v1 offset:59392
v_rcp_f32 v54, v54
v_rcp_f32 v55, v55
v_mul_f32 v84, v84, v52
v_mul_f32 v85, v85, v53
s_waitcnt lgkmcnt(3)
v_mfma_f32_32x32x16_bf16 v[96:111], a[240:243], v[208:211], v[96:111]
ds_read_b128 a[236:239], v1 offset:60416
buffer_load_dwordx4 v[172:175], v1, s[4:7], s23 offen offset:3072 sc1
v_mul_f32 v86, v86, v54
v_mul_f32 v87, v87, v55
v_cvt_pk_bf16_f32 v48, v84, v85
v_cvt_pk_bf16_f32 v49, v86, v87
v_mfma_f32_32x32x16_bf16 v[96:111], a[244:247], v[212:215], v[96:111]
ds_read_b128 a[240:243], v1 offset:61440
buffer_load_dwordx4 a[108:111], v1, s[4:7], s34 offen offset:3072
buffer_store_dwordx4 v[46:49], v40, s[4:7], s28 offen offset:0 sc1
v_mfma_f32_32x32x16_bf16 v[96:111], a[248:251], v[216:219], v[96:111]
ds_read_b128 a[244:247], v1 offset:62464
s_add_u32 s23, s87, 25184256
buffer_load_dwordx4 v[176:179], v1, s[4:7], s23 offen offset:0 sc1
v_mfma_f32_32x32x16_bf16 v[96:111], a[252:255], v[220:223], v[96:111]
ds_read_b128 a[248:251], v1 offset:63488
s_waitcnt lgkmcnt(3)
v_mfma_f32_32x32x16_bf16 v[96:111], a[224:227], v[224:227], v[96:111]
ds_read_b128 a[252:255], v1 offset:64512
buffer_load_dwordx4 v[180:183], v1, s[4:7], s23 offen offset:1024 sc1
v_mfma_f32_32x32x16_bf16 v[96:111], a[228:231], v[228:231], v[96:111]
s_add_u32 s34, s35, 53248
buffer_load_dwordx4 a[208:211], v1, s[4:7], s34 offen offset:0
v_mfma_f32_32x32x16_bf16 v[96:111], a[232:235], v[232:235], v[96:111]
buffer_load_dwordx4 v[184:187], v1, s[4:7], s23 offen offset:2048 sc1
v_mfma_f32_32x32x16_bf16 v[96:111], a[236:239], v[236:239], v[96:111]
s_waitcnt lgkmcnt(0)
v_mfma_f32_32x32x16_bf16 v[96:111], a[240:243], v[240:243], v[96:111]
buffer_load_dwordx4 v[188:191], v1, s[4:7], s23 offen offset:3072 sc1
v_mfma_f32_32x32x16_bf16 v[96:111], a[244:247], v[244:247], v[96:111]
buffer_load_dwordx4 a[212:215], v1, s[4:7], s34 offen offset:1024
v_mfma_f32_32x32x16_bf16 v[96:111], a[248:251], v[248:251], v[96:111]
s_add_u32 s23, s87, 25280512
buffer_load_dwordx4 v[192:195], v1, s[4:7], s23 offen offset:0 sc1
v_mfma_f32_32x32x16_bf16 v[96:111], a[252:255], v[252:255], v[96:111]
s_waitcnt vmcnt(25)
v_mfma_f32_16x16x32_bf16 v[64:67], a[0:3], v[128:131], 0
buffer_load_dwordx4 v[196:199], v1, s[4:7], s23 offen offset:1024 sc1
v_mfma_f32_16x16x32_bf16 v[68:71], a[4:7], v[128:131], 0
v_mfma_f32_16x16x32_bf16 v[72:75], a[8:11], v[128:131], 0
buffer_load_dwordx4 a[216:219], v1, s[4:7], s34 offen offset:2048
v_mfma_f32_16x16x32_bf16 v[76:79], a[12:15], v[128:131], 0
s_waitcnt vmcnt(26)
v_mfma_f32_16x16x32_bf16 v[92:95], a[12:15], v[132:135], 0
buffer_load_dwordx4 v[200:203], v1, s[4:7], s23 offen offset:2048 sc1
s_nop 1
v_mul_f32 v52, v96, v96
v_mul_f32 v53, v97, v97
v_mul_f32 v54, v98, v98
v_mfma_f32_16x16x32_bf16 v[88:91], a[8:11], v[132:135], 0
v_mul_f32 v55, v99, v99
v_fma_f32 v52, v52, v39, v38
v_fma_f32 v53, v53, v39, v38
v_fma_f32 v54, v54, v39, v38
v_mfma_f32_16x16x32_bf16 v[84:87], a[4:7], v[132:135], 0
buffer_load_dwordx4 a[220:223], v1, s[4:7], s34 offen offset:3072
v_fma_f32 v55, v55, v39, v38
v_mul_f32 v52, v52, v96
v_mul_f32 v53, v53, v97
v_mfma_f32_16x16x32_bf16 v[80:83], a[0:3], v[132:135], 0
v_mul_f32 v54, v54, v98
v_mul_f32 v55, v55, v99
v_exp_f32 v52, v52
s_waitcnt vmcnt(27)
v_mfma_f32_16x16x32_bf16 v[64:67], a[16:19], v[136:139], v[64:67]
buffer_load_dwordx4 v[204:207], v1, s[4:7], s23 offen offset:3072 sc1
v_mul_f32 v96, v96, v104
v_exp_f32 v53, v53
v_mfma_f32_16x16x32_bf16 v[68:71], a[20:23], v[136:139], v[68:71]
v_mul_f32 v97, v97, v105
v_exp_f32 v54, v54
v_mul_f32 v98, v98, v106
v_mfma_f32_16x16x32_bf16 v[72:75], a[24:27], v[136:139], v[72:75]
v_exp_f32 v55, v55
v_mul_f32 v99, v99, v107
v_fma_f32 v52, v52, v50, v50
v_mfma_f32_16x16x32_bf16 v[76:79], a[28:31], v[136:139], v[76:79]
v_fma_f32 v53, v53, v50, v50
v_fma_f32 v54, v54, v50, v50
v_fma_f32 v55, v55, v50, v50
s_barrier
s_waitcnt vmcnt(27)
v_mfma_f32_16x16x32_bf16 v[92:95], a[28:31], v[140:143], v[92:95]
s_add_u32 s23, s87, 25284608
buffer_load_dwordx4 v[208:211], v1, s[4:7], s23 offen offset:0 sc1
v_rcp_f32 v52, v52
v_mfma_f32_16x16x32_bf16 v[88:91], a[24:27], v[140:143], v[88:91]
v_rcp_f32 v53, v53
v_rcp_f32 v54, v54
v_mfma_f32_16x16x32_bf16 v[84:87], a[20:23], v[140:143], v[84:87]
v_rcp_f32 v55, v55
v_mul_f32 v96, v96, v52
v_mul_f32 v97, v97, v53
v_mfma_f32_16x16x32_bf16 v[80:83], a[16:19], v[140:143], v[80:83]
v_mul_f32 v98, v98, v54
v_mul_f32 v99, v99, v55
v_cvt_pk_bf16_f32 v42, v96, v97
v_cvt_pk_bf16_f32 v43, v98, v99
v_mov_b32 v4, 4
s_waitcnt vmcnt(13)
s_mov_b64 exec, 1
buffer_store_dword v4, off, s[4:7], s78 sc1
s_mov_b64 exec, -1
v_mfma_f32_16x16x32_bf16 v[64:67], a[32:35], v[144:147], v[64:67]
buffer_load_dwordx4 v[212:215], v1, s[4:7], s23 offen offset:1024 sc1
v_mul_f32 v52, v100, v100
v_mul_f32 v53, v101, v101
v_mul_f32 v54, v102, v102
v_mfma_f32_16x16x32_bf16 v[68:71], a[36:39], v[144:147], v[68:71]
v_mul_f32 v55, v103, v103
v_fma_f32 v52, v52, v39, v38
v_fma_f32 v53, v53, v39, v38
v_fma_f32 v54, v54, v39, v38
v_mfma_f32_16x16x32_bf16 v[72:75], a[40:43], v[144:147], v[72:75]
v_fma_f32 v55, v55, v39, v38
v_mul_f32 v52, v52, v100
v_mul_f32 v53, v53, v101
v_mul_f32 v54, v54, v102
v_mfma_f32_16x16x32_bf16 v[76:79], a[44:47], v[144:147], v[76:79]
v_mul_f32 v55, v55, v103
v_exp_f32 v52, v52
v_mul_f32 v100, v100, v108
v_mfma_f32_16x16x32_bf16 v[92:95], a[44:47], v[148:151], v[92:95]
buffer_load_dwordx4 v[216:219], v1, s[4:7], s23 offen offset:2048 sc1
v_exp_f32 v53, v53
v_mul_f32 v101, v101, v109
v_mfma_f32_16x16x32_bf16 v[88:91], a[40:43], v[148:151], v[88:91]
v_exp_f32 v54, v54
v_mul_f32 v102, v102, v110
v_mfma_f32_16x16x32_bf16 v[84:87], a[36:39], v[148:151], v[84:87]
v_exp_f32 v55, v55
v_mul_f32 v103, v103, v111
v_fma_f32 v52, v52, v50, v50
v_mfma_f32_16x16x32_bf16 v[80:83], a[32:35], v[148:151], v[80:83]
v_fma_f32 v53, v53, v50, v50
v_fma_f32 v54, v54, v50, v50
v_fma_f32 v55, v55, v50, v50
v_mfma_f32_16x16x32_bf16 v[64:67], a[48:51], v[152:155], v[64:67]
buffer_load_dwordx4 v[220:223], v1, s[4:7], s23 offen offset:3072 sc1
v_rcp_f32 v52, v52
v_mfma_f32_16x16x32_bf16 v[68:71], a[52:55], v[152:155], v[68:71]
v_rcp_f32 v53, v53
v_rcp_f32 v54, v54
v_mfma_f32_16x16x32_bf16 v[72:75], a[56:59], v[152:155], v[72:75]
v_rcp_f32 v55, v55
v_mul_f32 v100, v100, v52
v_mul_f32 v101, v101, v53
v_mfma_f32_16x16x32_bf16 v[76:79], a[60:63], v[152:155], v[76:79]
v_mul_f32 v102, v102, v54
v_mul_f32 v103, v103, v55
v_cvt_pk_bf16_f32 v44, v100, v101
v_cvt_pk_bf16_f32 v45, v102, v103
v_mfma_f32_16x16x32_bf16 v[92:95], a[60:63], v[156:159], v[92:95]
s_add_u32 s23, s87, 25294848
buffer_load_dwordx4 v[224:227], v1, s[4:7], s23 offen offset:0 sc1
buffer_store_dwordx4 v[42:45], v40, s[4:7], s28 offen offset:2048 sc1
v_mfma_f32_16x16x32_bf16 v[88:91], a[56:59], v[156:159], v[88:91]
s_add_u32 s36, s82, 12582912
s_add_u32 s37, s83, 7864320
v_mfma_f32_16x16x32_bf16 v[84:87], a[52:55], v[156:159], v[84:87]
v_permlane16_swap_b32 v6, v8
v_permlane16_swap_b32 v7, v9
v_mfma_f32_16x16x32_bf16 v[80:83], a[48:51], v[156:159], v[80:83]
v_permlane16_swap_b32 v10, v12
v_permlane16_swap_b32 v11, v13
v_mfma_f32_16x16x32_bf16 v[64:67], a[112:115], v[160:163], v[64:67]
buffer_load_dwordx4 v[228:231], v1, s[4:7], s23 offen offset:1024 sc1
s_add_u32 s15, s36, 32768
v_mfma_f32_16x16x32_bf16 v[68:71], a[116:119], v[160:163], v[68:71]
v_lshlrev_b32 v40, 16, v6
v_and_b32 v41, 0xffff0000, v6
v_mfma_f32_16x16x32_bf16 v[72:75], a[120:123], v[160:163], v[72:75]
v_lshlrev_b32 v42, 16, v7
v_and_b32 v43, 0xffff0000, v7
v_mfma_f32_16x16x32_bf16 v[76:79], a[124:127], v[160:163], v[76:79]
v_lshlrev_b32 v44, 16, v8
v_and_b32 v45, 0xffff0000, v8
buffer_load_dword v63, v62, s[4:7], s79 offen sc1
v_mfma_f32_16x16x32_bf16 v[92:95], a[124:127], v[164:167], v[92:95]
buffer_load_dwordx4 v[232:235], v1, s[4:7], s23 offen offset:2048 sc1
v_lshlrev_b32 v46, 16, v9
v_mfma_f32_16x16x32_bf16 v[88:91], a[120:123], v[164:167], v[88:91]
v_and_b32 v47, 0xffff0000, v9
v_lshlrev_b32 v48, 16, v10
v_mfma_f32_16x16x32_bf16 v[84:87], a[116:119], v[164:167], v[84:87]
v_and_b32 v49, 0xffff0000, v10
v_lshlrev_b32 v50, 16, v11
v_mfma_f32_16x16x32_bf16 v[80:83], a[112:115], v[164:167], v[80:83]
v_and_b32 v51, 0xffff0000, v11
v_lshlrev_b32 v52, 16, v12
v_mfma_f32_16x16x32_bf16 v[64:67], a[128:131], v[168:171], v[64:67]
buffer_load_dwordx4 v[236:239], v1, s[4:7], s23 offen offset:3072 sc1
v_and_b32 v53, 0xffff0000, v12
v_mfma_f32_16x16x32_bf16 v[68:71], a[132:135], v[168:171], v[68:71]
v_lshlrev_b32 v54, 16, v13
v_and_b32 v55, 0xffff0000, v13
v_mfma_f32_16x16x32_bf16 v[72:75], a[136:139], v[168:171], v[72:75]
v_and_b32 v38, 1, v0
v_lshlrev_b32 v38, 4, v38
v_mfma_f32_16x16x32_bf16 v[76:79], a[140:143], v[168:171], v[76:79]
v_mov_b32 v39, 0x3f80
v_lshlrev_b32 v38, v38, v39
v_mfma_f32_16x16x32_bf16 v[92:95], a[140:143], v[172:175], v[92:95]
s_add_u32 s23, s87, 25298944
buffer_load_dwordx4 v[240:243], v1, s[4:7], s23 offen offset:0 sc1
v_mfma_f32_16x16x32_bf16 v[88:91], a[136:139], v[172:175], v[88:91]
v_bfe_u32 v39, v0, 1, 3
v_cmp_eq_u32 s[96:97], 0, v39
v_mfma_f32_16x16x32_bf16 v[84:87], a[132:135], v[172:175], v[84:87]
v_cmp_eq_u32 s[26:27], 1, v39
v_cndmask_b32 v60, 0, v38, s[96:97]
v_mfma_f32_16x16x32_bf16 v[80:83], a[128:131], v[172:175], v[80:83]
v_cndmask_b32 v61, 0, v38, s[26:27]
v_cmp_eq_u32 s[96:97], 2, v39
s_waitcnt vmcnt(23)
v_mfma_f32_16x16x32_bf16 v[64:67], a[144:147], v[176:179], v[64:67]
buffer_load_dwordx4 v[244:247], v1, s[4:7], s23 offen offset:1024 sc1
v_cmp_eq_u32 s[26:27], 3, v39
v_mfma_f32_16x16x32_bf16 v[68:71], a[148:151], v[176:179], v[68:71]
v_accvgpr_write_b32 a240, v60
v_accvgpr_write_b32 a241, v61
v_mfma_f32_16x16x32_bf16 v[72:75], a[152:155], v[176:179], v[72:75]
v_cndmask_b32 v60, 0, v38, s[96:97]
v_cndmask_b32 v61, 0, v38, s[26:27]
v_mfma_f32_16x16x32_bf16 v[76:79], a[156:159], v[176:179], v[76:79]
v_cmp_eq_u32 s[96:97], 4, v39
v_cmp_eq_u32 s[26:27], 5, v39
s_waitcnt vmcnt(23)
v_mfma_f32_16x16x32_bf16 v[92:95], a[156:159], v[180:183], v[92:95]
buffer_load_dwordx4 v[248:251], v1, s[4:7], s23 offen offset:2048 sc1
v_accvgpr_write_b32 a242, v60
v_mfma_f32_16x16x32_bf16 v[88:91], a[152:155], v[180:183], v[88:91]
v_accvgpr_write_b32 a243, v61
v_cndmask_b32 v60, 0, v38, s[96:97]
v_mfma_f32_16x16x32_bf16 v[84:87], a[148:151], v[180:183], v[84:87]
v_cndmask_b32 v61, 0, v38, s[26:27]
v_cmp_eq_u32 s[96:97], 6, v39
v_mfma_f32_16x16x32_bf16 v[80:83], a[144:147], v[180:183], v[80:83]
v_cmp_eq_u32 s[26:27], 7, v39
v_accvgpr_write_b32 a244, v60
s_waitcnt vmcnt(22)
v_mfma_f32_16x16x32_bf16 v[64:67], a[160:163], v[184:187], v[64:67]
buffer_load_dwordx4 v[252:255], v1, s[4:7], s23 offen offset:3072 sc1
v_accvgpr_write_b32 a245, v61
v_mfma_f32_16x16x32_bf16 v[68:71], a[164:167], v[184:187], v[68:71]
v_cndmask_b32 v60, 0, v38, s[96:97]
v_cndmask_b32 v61, 0, v38, s[26:27]
v_mfma_f32_16x16x32_bf16 v[72:75], a[168:171], v[184:187], v[72:75]
v_accvgpr_write_b32 a246, v60
v_accvgpr_write_b32 a247, v61
v_mfma_f32_16x16x32_bf16 v[76:79], a[172:175], v[184:187], v[76:79]
s_waitcnt vmcnt(22)
v_mfma_f32_16x16x32_bf16 v[92:95], a[172:175], v[188:191], v[92:95]
v_mfma_f32_16x16x32_bf16 v[88:91], a[168:171], v[188:191], v[88:91]
v_mfma_f32_16x16x32_bf16 v[84:87], a[164:167], v[188:191], v[84:87]
v_mfma_f32_16x16x32_bf16 v[80:83], a[160:163], v[188:191], v[80:83]
s_waitcnt vmcnt(20)
v_mfma_f32_16x16x32_bf16 v[96:99], a[0:3], v[192:195], 0
v_mfma_f32_16x16x32_bf16 v[100:103], a[4:7], v[192:195], 0
v_mfma_f32_16x16x32_bf16 v[104:107], a[8:11], v[192:195], 0
v_mfma_f32_16x16x32_bf16 v[108:111], a[12:15], v[192:195], 0
s_waitcnt vmcnt(19)
v_mfma_f32_16x16x32_bf16 v[124:127], a[12:15], v[196:199], 0
v_mfma_f32_16x16x32_bf16 v[120:123], a[8:11], v[196:199], 0
v_mfma_f32_16x16x32_bf16 v[116:119], a[4:7], v[196:199], 0
v_mfma_f32_16x16x32_bf16 v[112:115], a[0:3], v[196:199], 0
v_mov_b32 v4, 5
s_waitcnt vmcnt(8)
s_mov_b64 exec, 1
buffer_store_dword v4, off, s[4:7], s78 sc1
s_mov_b64 exec, -1
v_mfma_f32_16x16x32_bf16 v[96:99], a[16:19], v[200:203], v[96:99]
v_mfma_f32_16x16x32_bf16 v[100:103], a[20:23], v[200:203], v[100:103]
v_mfma_f32_16x16x32_bf16 v[104:107], a[24:27], v[200:203], v[104:107]
v_mfma_f32_16x16x32_bf16 v[108:111], a[28:31], v[200:203], v[108:111]
s_waitcnt vmcnt(7)
v_cmp_gt_u32 vcc, 4, v63
s_nop 0
s_cbranch_vccnz L_poll_74
L_polled_75:
v_mfma_f32_16x16x32_bf16 v[124:127], a[28:31], v[204:207], v[124:127]
s_add_u32 s23, s87, 25174016
buffer_load_dwordx4 v[128:131], v1, s[4:7], s23 offen offset:0 sc1
v_mfma_f32_16x16x32_bf16 v[120:123], a[24:27], v[204:207], v[120:123]
v_mfma_f32_16x16x32_bf16 v[116:119], a[20:23], v[204:207], v[116:119]
v_mfma_f32_16x16x32_bf16 v[112:115], a[16:19], v[204:207], v[112:115]
v_mfma_f32_16x16x32_bf16 v[96:99], a[32:35], v[208:211], v[96:99]
buffer_load_dwordx4 v[132:135], v1, s[4:7], s23 offen offset:1024 sc1
v_mfma_f32_16x16x32_bf16 v[100:103], a[36:39], v[208:211], v[100:103]
v_mfma_f32_16x16x32_bf16 v[104:107], a[40:43], v[208:211], v[104:107]
v_mfma_f32_16x16x32_bf16 v[108:111], a[44:47], v[208:211], v[108:111]
v_mfma_f32_16x16x32_bf16 v[124:127], a[44:47], v[212:215], v[124:127]
s_add_u32 s23, s39, 20971520
buffer_load_dwordx4 v[136:139], v1, s[4:7], s23 offen offset:0 sc1
v_mfma_f32_16x16x32_bf16 v[120:123], a[40:43], v[212:215], v[120:123]
v_mfma_f32_16x16x32_bf16 v[116:119], a[36:39], v[212:215], v[116:119]
v_mfma_f32_16x16x32_bf16 v[112:115], a[32:35], v[212:215], v[112:115]
v_mfma_f32_16x16x32_bf16 v[96:99], a[48:51], v[216:219], v[96:99]
buffer_load_dwordx4 v[140:143], v1, s[4:7], s23 offen offset:1024 sc1
v_mfma_f32_16x16x32_bf16 v[100:103], a[52:55], v[216:219], v[100:103]
v_mfma_f32_16x16x32_bf16 v[104:107], a[56:59], v[216:219], v[104:107]
v_mfma_f32_16x16x32_bf16 v[108:111], a[60:63], v[216:219], v[108:111]
buffer_load_dword v63, v62, s[4:7], s79 offen sc1
v_mfma_f32_16x16x32_bf16 v[124:127], a[60:63], v[220:223], v[124:127]
s_add_u32 s23, s87, 25188352
buffer_load_dwordx4 v[144:147], v1, s[4:7], s23 offen offset:0 sc1
v_mfma_f32_16x16x32_bf16 v[120:123], a[56:59], v[220:223], v[120:123]
v_mfma_f32_16x16x32_bf16 v[116:119], a[52:55], v[220:223], v[116:119]
v_mfma_f32_16x16x32_bf16 v[112:115], a[48:51], v[220:223], v[112:115]
v_mfma_f32_16x16x32_bf16 v[96:99], a[112:115], v[224:227], v[96:99]
buffer_load_dwordx4 v[148:151], v1, s[4:7], s23 offen offset:1024 sc1
v_mfma_f32_16x16x32_bf16 v[100:103], a[116:119], v[224:227], v[100:103]
v_mfma_f32_16x16x32_bf16 v[104:107], a[120:123], v[224:227], v[104:107]
v_mfma_f32_16x16x32_bf16 v[108:111], a[124:127], v[224:227], v[108:111]
v_mfma_f32_16x16x32_bf16 v[124:127], a[124:127], v[228:231], v[124:127]
s_add_u32 s23, s39, 20975616
buffer_load_dwordx4 v[152:155], v1, s[4:7], s23 offen offset:0 sc1
v_mfma_f32_16x16x32_bf16 v[120:123], a[120:123], v[228:231], v[120:123]
v_mfma_f32_16x16x32_bf16 v[116:119], a[116:119], v[228:231], v[116:119]
v_mfma_f32_16x16x32_bf16 v[112:115], a[112:115], v[228:231], v[112:115]
s_waitcnt vmcnt(14)
v_mfma_f32_16x16x32_bf16 v[96:99], a[128:131], v[232:235], v[96:99]
buffer_load_dwordx4 v[156:159], v1, s[4:7], s23 offen offset:1024 sc1
v_mfma_f32_16x16x32_bf16 v[100:103], a[132:135], v[232:235], v[100:103]
v_mfma_f32_16x16x32_bf16 v[104:107], a[136:139], v[232:235], v[104:107]
v_mfma_f32_16x16x32_bf16 v[108:111], a[140:143], v[232:235], v[108:111]
s_waitcnt vmcnt(14)
v_mfma_f32_16x16x32_bf16 v[124:127], a[140:143], v[236:239], v[124:127]
v_mfma_f32_16x16x32_bf16 v[120:123], a[136:139], v[236:239], v[120:123]
v_mfma_f32_16x16x32_bf16 v[116:119], a[132:135], v[236:239], v[116:119]
v_mfma_f32_16x16x32_bf16 v[112:115], a[128:131], v[236:239], v[112:115]
s_waitcnt vmcnt(13)
v_mfma_f32_16x16x32_bf16 v[96:99], a[144:147], v[240:243], v[96:99]
v_mfma_f32_16x16x32_bf16 v[100:103], a[148:151], v[240:243], v[100:103]
v_mfma_f32_16x16x32_bf16 v[104:107], a[152:155], v[240:243], v[104:107]
v_mfma_f32_16x16x32_bf16 v[108:111], a[156:159], v[240:243], v[108:111]
s_waitcnt vmcnt(12)
v_mfma_f32_16x16x32_bf16 v[124:127], a[156:159], v[244:247], v[124:127]
v_mfma_f32_16x16x32_bf16 v[120:123], a[152:155], v[244:247], v[120:123]
v_mfma_f32_16x16x32_bf16 v[116:119], a[148:151], v[244:247], v[116:119]
v_mfma_f32_16x16x32_bf16 v[112:115], a[144:147], v[244:247], v[112:115]
s_waitcnt vmcnt(11)
v_mfma_f32_16x16x32_bf16 v[96:99], a[160:163], v[248:251], v[96:99]
v_mfma_f32_16x16x32_bf16 v[100:103], a[164:167], v[248:251], v[100:103]
v_mfma_f32_16x16x32_bf16 v[104:107], a[168:171], v[248:251], v[104:107]
v_mfma_f32_16x16x32_bf16 v[108:111], a[172:175], v[248:251], v[108:111]
s_waitcnt vmcnt(4)
v_cmp_gt_u32 vcc, 5, v63
s_nop 0
s_cbranch_vccnz L_poll_76
L_polled_77:
v_mfma_f32_16x16x32_bf16 v[124:127], a[172:175], v[252:255], v[124:127]
s_add_u32 s23, s39, 20973568
buffer_load_dwordx4 v[160:163], v1, s[4:7], s23 offen offset:0 sc1
v_mfma_f32_16x16x32_bf16 v[120:123], a[168:171], v[252:255], v[120:123]
v_mfma_f32_16x16x32_bf16 v[116:119], a[164:167], v[252:255], v[116:119]
s_add_u32 s23, s39, 20977664
buffer_load_dwordx4 v[164:167], v1, s[4:7], s23 offen offset:0 sc1
v_mfma_f32_16x16x32_bf16 v[112:115], a[160:163], v[252:255], v[112:115]
v_mfma_f32_16x16x32_bf16 v[64:67], a[64:67], v[128:131], v[64:67]
s_add_u32 s23, s39, 20974592
buffer_load_dwordx4 v[168:171], v1, s[4:7], s23 offen offset:0 sc1
v_mfma_f32_16x16x32_bf16 v[68:71], a[68:71], v[128:131], v[68:71]
v_mfma_f32_16x16x32_bf16 v[72:75], a[72:75], v[128:131], v[72:75]
s_add_u32 s23, s39, 20978688
buffer_load_dwordx4 v[172:175], v1, s[4:7], s23 offen offset:0 sc1
v_mfma_f32_16x16x32_bf16 v[76:79], a[76:79], v[128:131], v[76:79]
v_mfma_f32_16x16x32_bf16 v[92:95], a[76:79], v[132:135], v[92:95]
s_add_u32 s23, s87, 25288704
buffer_load_dwordx4 v[176:179], v1, s[4:7], s23 offen offset:0 sc1
v_mfma_f32_16x16x32_bf16 v[88:91], a[72:75], v[132:135], v[88:91]
v_mfma_f32_16x16x32_bf16 v[84:87], a[68:71], v[132:135], v[84:87]
s_add_u32 s23, s39, 21004288
buffer_load_dwordx4 v[180:183], v1, s[4:7], s23 offen offset:0 sc1
v_mfma_f32_16x16x32_bf16 v[80:83], a[64:67], v[132:135], v[80:83]
v_mfma_f32_16x16x32_bf16 v[64:67], a[80:83], v[136:139], v[64:67]
s_add_u32 s23, s87, 25303040
buffer_load_dwordx4 v[184:187], v1, s[4:7], s23 offen offset:0 sc1
v_mfma_f32_16x16x32_bf16 v[68:71], a[84:87], v[136:139], v[68:71]
v_mfma_f32_16x16x32_bf16 v[72:75], a[88:91], v[136:139], v[72:75]
s_add_u32 s23, s39, 21008384
buffer_load_dwordx4 v[188:191], v1, s[4:7], s23 offen offset:0 sc1
v_mfma_f32_16x16x32_bf16 v[76:79], a[92:95], v[136:139], v[76:79]
v_mfma_f32_16x16x32_bf16 v[92:95], a[92:95], v[140:143], v[92:95]
s_add_u32 s23, s39, 21006336
buffer_load_dwordx4 v[192:195], v1, s[4:7], s23 offen offset:0 sc1
v_mfma_f32_16x16x32_bf16 v[88:91], a[88:91], v[140:143], v[88:91]
v_mfma_f32_16x16x32_bf16 v[84:87], a[84:87], v[140:143], v[84:87]
v_mfma_f32_16x16x32_bf16 v[80:83], a[80:83], v[140:143], v[80:83]
s_waitcnt vmcnt(12)
v_mfma_f32_16x16x32_bf16 v[64:67], a[176:179], v[144:147], v[64:67]
s_add_u32 s23, s39, 21010432
buffer_load_dwordx4 v[196:199], v1, s[4:7], s23 offen offset:0 sc1
v_mfma_f32_16x16x32_bf16 v[68:71], a[180:183], v[144:147], v[68:71]
v_mfma_f32_16x16x32_bf16 v[72:75], a[184:187], v[144:147], v[72:75]
v_mfma_f32_16x16x32_bf16 v[76:79], a[188:191], v[144:147], v[76:79]
s_waitcnt vmcnt(12)
v_mfma_f32_16x16x32_bf16 v[92:95], a[188:191], v[148:151], v[92:95]
s_add_u32 s23, s87, 25289728
buffer_load_dwordx4 v[200:203], v1, s[4:7], s23 offen offset:0 sc1
v_mfma_f32_16x16x32_bf16 v[88:91], a[184:187], v[148:151], v[88:91]
v_mfma_f32_16x16x32_bf16 v[84:87], a[180:183], v[148:151], v[84:87]
v_mfma_f32_16x16x32_bf16 v[80:83], a[176:179], v[148:151], v[80:83]
s_waitcnt vmcnt(12)
v_mfma_f32_16x16x32_bf16 v[64:67], a[192:195], v[152:155], v[64:67]
s_add_u32 s23, s39, 21005312
buffer_load_dwordx4 v[204:207], v1, s[4:7], s23 offen offset:0 sc1
v_mfma_f32_16x16x32_bf16 v[68:71], a[196:199], v[152:155], v[68:71]
v_mfma_f32_16x16x32_bf16 v[72:75], a[200:203], v[152:155], v[72:75]
v_mfma_f32_16x16x32_bf16 v[76:79], a[204:207], v[152:155], v[76:79]
s_waitcnt vmcnt(12)
v_mfma_f32_16x16x32_bf16 v[92:95], a[204:207], v[156:159], v[92:95]
s_add_u32 s23, s87, 25304064
buffer_load_dwordx4 v[208:211], v1, s[4:7], s23 offen offset:0 sc1
v_mfma_f32_16x16x32_bf16 v[88:91], a[200:203], v[156:159], v[88:91]
v_mfma_f32_16x16x32_bf16 v[84:87], a[196:199], v[156:159], v[84:87]
v_mfma_f32_16x16x32_bf16 v[80:83], a[192:195], v[156:159], v[80:83]
s_waitcnt vmcnt(12)
v_mfma_f32_16x16x32_bf16 v[64:67], a[96:99], v[160:163], v[64:67]
s_add_u32 s23, s39, 21009408
buffer_load_dwordx4 v[212:215], v1, s[4:7], s23 offen offset:0 sc1
v_mfma_f32_16x16x32_bf16 v[68:71], a[100:103], v[160:163], v[68:71]
v_mfma_f32_16x16x32_bf16 v[72:75], a[104:107], v[160:163], v[72:75]
v_mfma_f32_16x16x32_bf16 v[76:79], a[108:111], v[160:163], v[76:79]
s_waitcnt vmcnt(12)
v_mfma_f32_16x16x32_bf16 v[64:67], a[208:211], v[164:167], v[64:67]
s_add_u32 s23, s39, 21007360
buffer_load_dwordx4 v[216:219], v1, s[4:7], s23 offen offset:0 sc1
v_mfma_f32_16x16x32_bf16 v[68:71], a[212:215], v[164:167], v[68:71]
v_mfma_f32_16x16x32_bf16 v[72:75], a[216:219], v[164:167], v[72:75]
v_mfma_f32_16x16x32_bf16 v[76:79], a[220:223], v[164:167], v[76:79]
s_waitcnt vmcnt(12)
v_mfma_f32_16x16x32_bf16 v[92:95], a[108:111], v[168:171], v[92:95]
s_add_u32 s23, s39, 21011456
buffer_load_dwordx4 v[220:223], v1, s[4:7], s23 offen offset:0 sc1
v_mfma_f32_16x16x32_bf16 v[88:91], a[104:107], v[168:171], v[88:91]
v_mfma_f32_16x16x32_bf16 v[84:87], a[100:103], v[168:171], v[84:87]
s_add_u32 m0, s21, 32768
s_add_u32 s30, s20, 0
buffer_load_dwordx4 v1, s[4:7], s30 offen offset:0  lds
v_mfma_f32_16x16x32_bf16 v[80:83], a[96:99], v[168:171], v[80:83]
s_waitcnt vmcnt(13)
v_mfma_f32_16x16x32_bf16 v[92:95], a[220:223], v[172:175], v[92:95]
v_mfma_f32_16x16x32_bf16 v[88:91], a[216:219], v[172:175], v[88:91]
v_cvt_pk_bf16_f32 v64, v64, v65
v_cvt_pk_bf16_f32 v65, v66, v67
v_cvt_pk_bf16_f32 v66, v68, v69
v_cvt_pk_bf16_f32 v67, v70, v71
ds_write_b128 v56, v[64:67] offset:0
v_mfma_f32_16x16x32_bf16 v[84:87], a[212:215], v[172:175], v[84:87]
buffer_load_dwordx4 v1, s[4:7], s30 offen offset:1024  lds
v_mfma_f32_16x16x32_bf16 v[80:83], a[208:211], v[172:175], v[80:83]
s_waitcnt vmcnt(13)
v_mfma_f32_16x16x32_bf16 v[96:99], a[64:67], v[176:179], v[96:99]
v_mfma_f32_16x16x32_bf16 v[100:103], a[68:71], v[176:179], v[100:103]
v_cvt_pk_bf16_f32 v72, v72, v73
v_cvt_pk_bf16_f32 v73, v74, v75
v_cvt_pk_bf16_f32 v74, v76, v77
v_cvt_pk_bf16_f32 v75, v78, v79
ds_write_b128 v56, v[72:75] offset:2048
v_mfma_f32_16x16x32_bf16 v[104:107], a[72:75], v[176:179], v[104:107]
buffer_load_dwordx4 v1, s[4:7], s30 offen offset:2048  lds
v_mfma_f32_16x16x32_bf16 v[108:111], a[76:79], v[176:179], v[108:111]
s_waitcnt vmcnt(13)
v_mfma_f32_16x16x32_bf16 v[96:99], a[80:83], v[180:183], v[96:99]
v_mfma_f32_16x16x32_bf16 v[100:103], a[84:87], v[180:183], v[100:103]
v_cvt_pk_bf16_f32 v80, v80, v81
v_cvt_pk_bf16_f32 v81, v82, v83
v_cvt_pk_bf16_f32 v82, v84, v85
v_cvt_pk_bf16_f32 v83, v86, v87
ds_write_b128 v56, v[80:83] offset:256
v_mfma_f32_16x16x32_bf16 v[104:107], a[88:91], v[180:183], v[104:107]
buffer_load_dwordx4 v1, s[4:7], s30 offen offset:3072  lds
v_mfma_f32_16x16x32_bf16 v[108:111], a[92:95], v[180:183], v[108:111]
s_waitcnt vmcnt(13)
v_mfma_f32_16x16x32_bf16 v[96:99], a[176:179], v[184:187], v[96:99]
v_mfma_f32_16x16x32_bf16 v[100:103], a[180:183], v[184:187], v[100:103]
v_cvt_pk_bf16_f32 v88, v88, v89
v_cvt_pk_bf16_f32 v89, v90, v91
v_cvt_pk_bf16_f32 v90, v92, v93
v_cvt_pk_bf16_f32 v91, v94, v95
ds_write_b128 v56, v[88:91] offset:2304
v_mfma_f32_16x16x32_bf16 v[104:107], a[184:187], v[184:187], v[104:107]
s_add_u32 m0, s21, 36864
s_add_u32 s30, s20, 4096
buffer_load_dwordx4 v1, s[4:7], s30 offen offset:0  lds
v_mfma_f32_16x16x32_bf16 v[108:111], a[188:191], v[184:187], v[108:111]
s_waitcnt vmcnt(13)
v_mfma_f32_16x16x32_bf16 v[96:99], a[192:195], v[188:191], v[96:99]
v_mfma_f32_16x16x32_bf16 v[100:103], a[196:199], v[188:191], v[100:103]
v_mfma_f32_16x16x32_bf16 v[104:107], a[200:203], v[188:191], v[104:107]
buffer_load_dwordx4 v1, s[4:7], s30 offen offset:1024  lds
v_mfma_f32_16x16x32_bf16 v[108:111], a[204:207], v[188:191], v[108:111]
s_waitcnt lgkmcnt(0)
s_barrier
ds_read_b128 v[64:67], v57 offset:0
ds_read_b128 v[68:71], v57 offset:1024
ds_read_b128 v[72:75], v57 offset:2048
ds_read_b128 v[76:79], v57 offset:3072
s_waitcnt vmcnt(13)
v_mfma_f32_16x16x32_bf16 v[96:99], a[96:99], v[192:195], v[96:99]
v_mfma_f32_16x16x32_bf16 v[100:103], a[100:103], v[192:195], v[100:103]
v_mfma_f32_16x16x32_bf16 v[104:107], a[104:107], v[192:195], v[104:107]
buffer_load_dwordx4 v1, s[4:7], s30 offen offset:2048  lds
v_mfma_f32_16x16x32_bf16 v[108:111], a[108:111], v[192:195], v[108:111]
s_waitcnt vmcnt(13)
v_mfma_f32_16x16x32_bf16 v[96:99], a[208:211], v[196:199], v[96:99]
v_mfma_f32_16x16x32_bf16 v[100:103], a[212:215], v[196:199], v[100:103]
v_mfma_f32_16x16x32_bf16 v[104:107], a[216:219], v[196:199], v[104:107]
buffer_load_dwordx4 v1, s[4:7], s30 offen offset:3072  lds
v_mfma_f32_16x16x32_bf16 v[108:111], a[220:223], v[196:199], v[108:111]
s_waitcnt lgkmcnt(3)
v_mfma_f32_16x16x32_bf16 v[40:43], a[240:243], v[64:67], v[40:43]
s_waitcnt lgkmcnt(2)
v_mfma_f32_16x16x32_bf16 v[44:47], a[240:243], v[68:71], v[44:47]
s_waitcnt lgkmcnt(1)
v_mfma_f32_16x16x32_bf16 v[40:43], a[244:247], v[72:75], v[40:43]
s_waitcnt lgkmcnt(0)
v_mfma_f32_16x16x32_bf16 v[44:47], a[244:247], v[76:79], v[44:47]
s_waitcnt vmcnt(13)
v_mfma_f32_16x16x32_bf16 v[124:127], a[76:79], v[200:203], v[124:127]
v_mfma_f32_16x16x32_bf16 v[120:123], a[72:75], v[200:203], v[120:123]
v_mfma_f32_16x16x32_bf16 v[116:119], a[68:71], v[200:203], v[116:119]
v_mfma_f32_16x16x32_bf16 v[112:115], a[64:67], v[200:203], v[112:115]
s_waitcnt vmcnt(12)
v_mfma_f32_16x16x32_bf16 v[124:127], a[92:95], v[204:207], v[124:127]
v_mfma_f32_16x16x32_bf16 v[120:123], a[88:91], v[204:207], v[120:123]
v_cvt_pk_bf16_f32 v6, v40, v41
v_cvt_pk_bf16_f32 v7, v42, v43
v_cvt_pk_bf16_f32 v8, v44, v45
v_cvt_pk_bf16_f32 v9, v46, v47
s_nop 0
v_permlane16_swap_b32 v6, v8
v_permlane16_swap_b32 v7, v9
buffer_store_dwordx4 v[6:9], v58, s[4:7], s36 offen sc1
v_mfma_f32_16x16x32_bf16 v[116:119], a[84:87], v[204:207], v[116:119]
v_mfma_f32_16x16x32_bf16 v[112:115], a[80:83], v[204:207], v[112:115]
v_cvt_pk_bf16_f32 v96, v96, v97
v_cvt_pk_bf16_f32 v97, v98, v99
v_cvt_pk_bf16_f32 v98, v100, v101
v_cvt_pk_bf16_f32 v99, v102, v103
ds_write_b128 v56, v[96:99] offset:16384
s_waitcnt vmcnt(12)
v_mfma_f32_16x16x32_bf16 v[124:127], a[188:191], v[208:211], v[124:127]
v_mfma_f32_16x16x32_bf16 v[120:123], a[184:187], v[208:211], v[120:123]
v_mfma_f32_16x16x32_bf16 v[116:119], a[180:183], v[208:211], v[116:119]
v_mfma_f32_16x16x32_bf16 v[112:115], a[176:179], v[208:211], v[112:115]
v_cvt_pk_bf16_f32 v104, v104, v105
v_cvt_pk_bf16_f32 v105, v106, v107
v_cvt_pk_bf16_f32 v106, v108, v109
v_cvt_pk_bf16_f32 v107, v110, v111
ds_write_b128 v56, v[104:107] offset:18432
s_waitcnt vmcnt(11)
v_mfma_f32_16x16x32_bf16 v[124:127], a[204:207], v[212:215], v[124:127]
v_mfma_f32_16x16x32_bf16 v[120:123], a[200:203], v[212:215], v[120:123]
v_mfma_f32_16x16x32_bf16 v[116:119], a[196:199], v[212:215], v[116:119]
v_mfma_f32_16x16x32_bf16 v[112:115], a[192:195], v[212:215], v[112:115]
s_waitcnt vmcnt(10)
v_mfma_f32_16x16x32_bf16 v[124:127], a[108:111], v[216:219], v[124:127]
v_mfma_f32_16x16x32_bf16 v[120:123], a[104:107], v[216:219], v[120:123]
v_mfma_f32_16x16x32_bf16 v[116:119], a[100:103], v[216:219], v[116:119]
v_mfma_f32_16x16x32_bf16 v[112:115], a[96:99], v[216:219], v[112:115]
s_waitcnt vmcnt(9)
v_mfma_f32_16x16x32_bf16 v[124:127], a[220:223], v[220:223], v[124:127]
v_mfma_f32_16x16x32_bf16 v[120:123], a[216:219], v[220:223], v[120:123]
v_mfma_f32_16x16x32_bf16 v[116:119], a[212:215], v[220:223], v[116:119]
v_mfma_f32_16x16x32_bf16 v[112:115], a[208:211], v[220:223], v[112:115]
s_nop 5
v_cvt_pk_bf16_f32 v120, v120, v121
v_cvt_pk_bf16_f32 v121, v122, v123
v_cvt_pk_bf16_f32 v122, v124, v125
v_cvt_pk_bf16_f32 v123, v126, v127
ds_write_b128 v56, v[120:123] offset:18688
v_cvt_pk_bf16_f32 v112, v112, v113
v_cvt_pk_bf16_f32 v113, v114, v115
v_cvt_pk_bf16_f32 v114, v116, v117
v_cvt_pk_bf16_f32 v115, v118, v119
ds_write_b128 v56, v[112:115] offset:16640
s_waitcnt lgkmcnt(0)
s_barrier
ds_read_b128 v[96:99], v57 offset:16384
ds_read_b128 v[100:103], v57 offset:17408
ds_read_b128 v[104:107], v57 offset:18432
ds_read_b128 v[108:111], v57 offset:19456
v_dot2_f32_bf16 v60, v6, s22, 0
v_dot2_f32_bf16 v61, v6, v6, 0
v_dot2_f32_bf16 v60, v7, s22, v60
v_dot2_f32_bf16 v61, v7, v7, v61
v_dot2_f32_bf16 v60, v8, s22, v60
v_dot2_f32_bf16 v61, v8, v8, v61
v_dot2_f32_bf16 v60, v9, s22, v60
v_dot2_f32_bf16 v61, v9, v9, v61
v_bfe_u32 v62, v0, 4, 1
v_lshl_add_u32 v62, v62, 11, v59
s_nop 0
v_permlane32_swap_b32 v60, v61
v_add_f32 v60, v60, v61
s_waitcnt lgkmcnt(3)
v_mfma_f32_16x16x32_bf16 v[48:51], a[240:243], v[96:99], v[48:51]
s_waitcnt lgkmcnt(2)
v_mfma_f32_16x16x32_bf16 v[52:55], a[240:243], v[100:103], v[52:55]
s_waitcnt lgkmcnt(1)
v_mfma_f32_16x16x32_bf16 v[48:51], a[244:247], v[104:107], v[48:51]
s_waitcnt lgkmcnt(0)
v_mfma_f32_16x16x32_bf16 v[52:55], a[244:247], v[108:111], v[52:55]
s_nop 5
v_cvt_pk_bf16_f32 v10, v48, v49
v_cvt_pk_bf16_f32 v11, v50, v51
v_cvt_pk_bf16_f32 v12, v52, v53
v_cvt_pk_bf16_f32 v13, v54, v55
v_dot2_f32_bf16 v38, v10, s22, 0
v_dot2_f32_bf16 v39, v10, v10, 0
v_dot2_f32_bf16 v38, v11, s22, v38
v_dot2_f32_bf16 v39, v11, v11, v39
v_dot2_f32_bf16 v38, v12, s22, v38
v_dot2_f32_bf16 v39, v12, v12, v39
v_dot2_f32_bf16 v38, v13, s22, v38
v_dot2_f32_bf16 v39, v13, v13, v39
v_permlane16_swap_b32 v10, v12
v_permlane16_swap_b32 v11, v13
buffer_store_dwordx4 v[10:13], v58, s[4:7], s15 offen sc1
v_permlane32_swap_b32 v38, v39
v_add_f32 v38, v38, v39
s_nop 1
v_permlane16_swap_b32 v60, v38
v_add_f32 v60, v60, v38
s_nop 1
v_add_f32_dpp v60, v60, v60 row_ror:8 row_mask:0xf bank_mask:0xf
s_mov_b32 exec_lo, 0x00ff00ff
s_mov_b32 exec_hi, 0x00ff00ff
buffer_store_dword v60, v62, s[4:7], s37 offen sc1
s_mov_b64 exec, -1
v_lshrrev_b32 v40, 5, v0
v_lshlrev_b32 v40, 10, v40
v_and_b32 v41, 31, v0
v_lshl_add_u32 v40, v41, 3, v40
s_add_u32 s23, s81, 7864320
s_add_u32 s15, s80, 12582912
v_and_b32 v62, 31, v0
v_lshlrev_b32 v62, 2, v62
v_mov_b32 v4, 6
s_waitcnt vmcnt(0)
s_mov_b64 exec, 1
buffer_store_dword v4, off, s[4:7], s76 sc1
s_mov_b64 exec, -1
s_barrier
buffer_load_dword v63, v62, s[4:7], s77 offen sc1
ds_read_b128 a[224:227], v1 offset:32768
ds_read_b128 a[228:231], v2 offset:0
ds_read_b128 a[232:235], v1 offset:33792
ds_read_b128 a[236:239], v2 offset:1024
ds_read_b128 a[240:243], v1 offset:34816
ds_read_b128 a[244:247], v2 offset:2048
ds_read_b128 a[248:251], v1 offset:35840
s_waitcnt vmcnt(0)
v_cmp_gt_u32 vcc, 6, v63
s_nop 0
s_cbranch_vccz L_spun_79
L_spin_78:
s_sleep 8
buffer_load_dword v63, v62, s[4:7], s77 offen sc1
s_sub_u32 s29, s29, 1
s_waitcnt vmcnt(0)
v_cmp_gt_u32 vcc, 6, v63
s_cbranch_scc1 L_spinout_80
s_cbranch_vccnz L_spin_78
L_spun_79:
s_add_u32 s27, s15, 0
buffer_load_dwordx4 v[128:131], v1, s[4:7], s27 offen offset:0 sc1
buffer_load_dwordx4 v[132:135], v1, s[4:7], s27 offen offset:1024 sc1
buffer_load_dwordx4 v[136:139], v1, s[4:7], s27 offen offset:2048 sc1
buffer_load_dwordx4 v[140:143], v1, s[4:7], s27 offen offset:3072 sc1
s_add_u32 s27, s15, 4096
buffer_load_dwordx4 v[144:147], v1, s[4:7], s27 offen offset:0 sc1
buffer_load_dwordx4 v[148:151], v1, s[4:7], s27 offen offset:1024 sc1
buffer_load_dwordx2 v[42:43], v40, s[4:7], s23 offen offset:0 sc1
buffer_load_dwordx2 v[44:45], v40, s[4:7], s23 offen offset:256 sc1
buffer_load_dwordx2 v[46:47], v40, s[4:7], s23 offen offset:512 sc1
buffer_load_dwordx2 v[48:49], v40, s[4:7], s23 offen offset:768 sc1
s_waitcnt vmcnt(9) lgkmcnt(5)
v_mfma_f32_32x32x16_bf16 v[64:79], a[224:227], v[128:131], 0
buffer_load_dwordx4 v[152:155], v1, s[4:7], s27 offen offset:2048 sc1
ds_read_b128 a[252:255], v2 offset:3072
v_mfma_f32_32x32x16_bf16 v[80:95], a[228:231], v[128:131], 0
ds_read_b128 a[224:227], v1 offset:36864
s_waitcnt vmcnt(9) lgkmcnt(5)
v_mfma_f32_32x32x16_bf16 v[64:79], a[232:235], v[132:135], v[64:79]
buffer_load_dwordx4 v[156:159], v1, s[4:7], s27 offen offset:3072 sc1
ds_read_b128 a[228:231], v2 offset:4096
v_mfma_f32_32x32x16_bf16 v[80:95], a[236:239], v[132:135], v[80:95]
ds_read_b128 a[232:235], v1 offset:37888
s_waitcnt vmcnt(9) lgkmcnt(5)
v_mfma_f32_32x32x16_bf16 v[64:79], a[240:243], v[136:139], v[64:79]
s_add_u32 s27, s15, 8192
buffer_load_dwordx4 v[160:163], v1, s[4:7], s27 offen offset:0 sc1
ds_read_b128 a[236:239], v2 offset:5120
v_mfma_f32_32x32x16_bf16 v[80:95], a[244:247], v[136:139], v[80:95]
ds_read_b128 a[240:243], v1 offset:38912
s_waitcnt vmcnt(9) lgkmcnt(5)
v_mfma_f32_32x32x16_bf16 v[64:79], a[248:251], v[140:143], v[64:79]
buffer_load_dwordx4 v[164:167], v1, s[4:7], s27 offen offset:1024 sc1
ds_read_b128 a[244:247], v2 offset:6144
v_mfma_f32_32x32x16_bf16 v[80:95], a[252:255], v[140:143], v[80:95]
ds_read_b128 a[248:251], v1 offset:39936
s_waitcnt vmcnt(9) lgkmcnt(5)
v_mfma_f32_32x32x16_bf16 v[64:79], a[224:227], v[144:147], v[64:79]
buffer_load_dwordx4 v[168:171], v1, s[4:7], s27 offen offset:2048 sc1
ds_read_b128 a[252:255], v2 offset:7168
v_mfma_f32_32x32x16_bf16 v[80:95], a[228:231], v[144:147], v[80:95]
ds_read_b128 a[224:227], v1 offset:40960
s_waitcnt vmcnt(9) lgkmcnt(5)
v_mfma_f32_32x32x16_bf16 v[64:79], a[232:235], v[148:151], v[64:79]
buffer_load_dwordx4 v[172:175], v1, s[4:7], s27 offen offset:3072 sc1
ds_read_b128 a[228:231], v2 offset:8192
v_mfma_f32_32x32x16_bf16 v[80:95], a[236:239], v[148:151], v[80:95]
ds_read_b128 a[232:235], v1 offset:41984
s_waitcnt vmcnt(5) lgkmcnt(5)
v_mfma_f32_32x32x16_bf16 v[64:79], a[240:243], v[152:155], v[64:79]
s_add_u32 s27, s15, 12288
buffer_load_dwordx4 v[176:179], v1, s[4:7], s27 offen offset:0 sc1
ds_read_b128 a[236:239], v2 offset:9216
v_add_f32 v42, v42, v44
v_add_f32 v43, v43, v45
v_mfma_f32_32x32x16_bf16 v[80:95], a[244:247], v[152:155], v[80:95]
ds_read_b128 a[240:243], v1 offset:43008
v_add_f32 v46, v46, v48
v_add_f32 v47, v47, v49
v_add_f32 v42, v42, v46
v_add_f32 v43, v43, v47
s_waitcnt vmcnt(5) lgkmcnt(5)
v_mfma_f32_32x32x16_bf16 v[64:79], a[248:251], v[156:159], v[64:79]
buffer_load_dwordx4 v[180:183], v1, s[4:7], s27 offen offset:1024 sc1
ds_read_b128 a[244:247], v2 offset:10240
v_permlane32_swap_b32 v42, v43
v_add_f32 v42, v42, v43
v_mov_b32 v43, v42
v_mfma_f32_32x32x16_bf16 v[80:95], a[252:255], v[156:159], v[80:95]
ds_read_b128 a[248:251], v1 offset:44032
v_permlane32_swap_b32 v42, v43
v_mul_f32 v42, 0xbb000000, v42
v_mul_f32 v43, 0x3b000000, v43
v_cvt_pk_bf16_f32 v44, v42, v42
s_waitcnt vmcnt(5) lgkmcnt(5)
v_mfma_f32_32x32x16_bf16 v[64:79], a[224:227], v[160:163], v[64:79]
buffer_load_dwordx4 v[184:187], v1, s[4:7], s27 offen offset:2048 sc1
ds_read_b128 a[252:255], v2 offset:11264
v_fma_f32 v43, -v42, v42, v43
v_and_b32 v45, 0xffff0000, v44
v_max_f32 v43, 0, v43
v_mfma_f32_32x32x16_bf16 v[80:95], a[228:231], v[160:163], v[80:95]
ds_read_b128 a[224:227], v1 offset:45056
v_sub_f32 v45, v42, v45
v_add_f32 v50, 0x3727c5ac, v43
v_cvt_pk_bf16_f32 v45, v45, v45
v_rsq_f32 v39, v50
s_waitcnt vmcnt(5) lgkmcnt(5)
v_mfma_f32_32x32x16_bf16 v[64:79], a[232:235], v[164:167], v[64:79]
buffer_load_dwordx4 v[188:191], v1, s[4:7], s27 offen offset:3072 sc1
ds_read_b128 a[228:231], v2 offset:12288
v_cndmask_b32 v32, v45, v44, s[24:25]
v_mov_b32 v37, v32
v_mfma_f32_32x32x16_bf16 v[80:95], a[236:239], v[164:167], v[80:95]
ds_read_b128 a[232:235], v1 offset:46080
v_mfma_f32_32x32x16_bf16 v[64:79], v[22:25], v[32:35], v[64:79]
v_mfma_f32_32x32x16_bf16 v[80:95], v[20:23], v[34:37], v[80:95]
s_waitcnt vmcnt(5) lgkmcnt(5)
v_mfma_f32_32x32x16_bf16 v[64:79], a[240:243], v[168:171], v[64:79]
s_add_u32 s27, s15, 16384
buffer_load_dwordx4 v[192:195], v1, s[4:7], s27 offen offset:0 sc1
ds_read_b128 a[236:239], v2 offset:13312
v_mul_f32 v38, 0x3fb8aa3b, v39
v_and_b32 v51, 31, v0
v_mfma_f32_32x32x16_bf16 v[80:95], a[244:247], v[168:171], v[80:95]
ds_read_b128 a[240:243], v1 offset:47104
v_lshl_add_u32 v51, s3, 5, v51
v_lshlrev_b32 v51, 4, v51
v_lshrrev_b32 v52, 5, v0
v_mul_u32_u24 v52, 2112, v52
s_waitcnt vmcnt(5) lgkmcnt(5)
v_mfma_f32_32x32x16_bf16 v[64:79], a[248:251], v[172:175], v[64:79]
buffer_load_dwordx4 v[196:199], v1, s[4:7], s27 offen offset:1024 sc1
ds_read_b128 a[244:247], v2 offset:14336
v_add_u32 v57, v51, v52
v_add_u32 v56, v57, v52
v_lshrrev_b32 v51, 4, v0
v_mfma_f32_32x32x16_bf16 v[80:95], a[252:255], v[172:175], v[80:95]
ds_read_b128 a[248:251], v1 offset:48128
v_bfe_u32 v52, v0, 2, 2
v_lshl_add_u32 v51, v51, 3, v52
v_lshlrev_b32 v51, 4, v51
v_and_b32 v52, 1, v0
s_waitcnt vmcnt(5) lgkmcnt(5)
v_mfma_f32_32x32x16_bf16 v[64:79], a[224:227], v[176:179], v[64:79]
buffer_load_dwordx4 v[200:203], v1, s[4:7], s27 offen offset:2048 sc1
ds_read_b128 a[252:255], v2 offset:15360
v_lshl_add_u32 v51, v52, 3, v51
v_bfe_u32 v52, v0, 1, 1
v_mul_u32_u24 v52, 2112, v52
v_mfma_f32_32x32x16_bf16 v[80:95], a[228:231], v[176:179], v[80:95]
ds_read_b128 a[224:227], v1 offset:49152
v_add_u32 v51, v51, v52
s_and_b32 s26, s3, 1
s_lshr_b32 s28, s3, 1
s_mul_i32 s36, s26, 4224
s_waitcnt vmcnt(5) lgkmcnt(5)
v_mfma_f32_32x32x16_bf16 v[64:79], a[232:235], v[180:183], v[64:79]
buffer_load_dwordx4 v[204:207], v1, s[4:7], s27 offen offset:3072 sc1
ds_read_b128 a[228:231], v2 offset:16384
s_mul_i32 s37, s28, 4224
v_add_u32 v59, s36, v51
s_add_u32 s37, s37, s36
v_mfma_f32_32x32x16_bf16 v[80:95], a[236:239], v[180:183], v[80:95]
ds_read_b128 a[232:235], v1 offset:50176
v_add_u32 v58, s37, v59
s_lshl_b32 s26, s26, 11
s_lshl_b32 s28, s28, 9
s_add_u32 s26, s26, s28
s_waitcnt vmcnt(5) lgkmcnt(5)
v_mfma_f32_32x32x16_bf16 v[64:79], a[240:243], v[184:187], v[64:79]
s_add_u32 s27, s15, 20480
buffer_load_dwordx4 v[208:211], v1, s[4:7], s27 offen offset:0 sc1
ds_read_b128 a[236:239], v2 offset:17408
v_and_b32 v51, 15, v0
v_lshlrev_b32 v51, 4, v51
v_mfma_f32_32x32x16_bf16 v[80:95], a[244:247], v[184:187], v[80:95]
ds_read_b128 a[240:243], v1 offset:51200
v_bfe_u32 v52, v0, 4, 1
v_lshl_add_u32 v51, v52, 3, v51
v_lshrrev_b32 v52, 5, v0
v_lshl_add_u32 v51, v52, 10, v51
s_waitcnt vmcnt(5) lgkmcnt(5)
v_mfma_f32_32x32x16_bf16 v[64:79], a[248:251], v[188:191], v[64:79]
buffer_load_dwordx4 v[212:215], v1, s[4:7], s27 offen offset:1024 sc1
ds_read_b128 a[244:247], v2 offset:18432
v_add_u32 v61, s26, v51
v_and_b32 v51, 1, v0
v_lshl_add_u32 v51, v51, 1, v52
v_mfma_f32_32x32x16_bf16 v[80:95], a[252:255], v[188:191], v[80:95]
ds_read_b128 a[248:251], v1 offset:52224
v_bfe_u32 v52, v0, 1, 1
v_lshl_add_u32 v51, v52, 3, v51
v_bfe_u32 v52, v0, 2, 1
v_lshl_add_u32 v51, v52, 2, v51
s_waitcnt vmcnt(5) lgkmcnt(5)
v_mfma_f32_32x32x16_bf16 v[64:79], a[224:227], v[192:195], v[64:79]
buffer_load_dwordx4 v[216:219], v1, s[4:7], s27 offen offset:2048 sc1
ds_read_b128 a[252:255], v2 offset:19456
v_lshlrev_b32 v51, 4, v51
v_bfe_u32 v52, v0, 3, 1
v_lshl_add_u32 v51, v52, 3, v51
v_mfma_f32_32x32x16_bf16 v[80:95], a[228:231], v[192:195], v[80:95]
ds_read_b128 a[224:227], v1 offset:53248
v_bfe_u32 v52, v0, 4, 1
v_lshl_add_u32 v51, v52, 10, v51
v_add_u32 v60, s26, v51
v_and_b32 v62, 0x30, v0
s_waitcnt vmcnt(5) lgkmcnt(5)
v_mfma_f32_32x32x16_bf16 v[64:79], a[232:235], v[196:199], v[64:79]
buffer_load_dwordx4 v[220:223], v1, s[4:7], s27 offen offset:3072 sc1
ds_read_b128 a[228:231], v2 offset:20480
v_lshlrev_b32 v63, 3, v0
s_add_u32 s36, s86, 9043968
s_add_u32 s37, s31, 9568256
v_mfma_f32_32x32x16_bf16 v[80:95], a[236:239], v[196:199], v[80:95]
ds_read_b128 a[232:235], v1 offset:54272
s_lshl_b32 s26, s16, 9
s_add_u32 s26, s26, s36
s_lshl_b32 s28, s16, 6
s_add_u32 s28, s28, s37
s_waitcnt vmcnt(5) lgkmcnt(5)
v_mfma_f32_32x32x16_bf16 v[64:79], a[240:243], v[200:203], v[64:79]
s_add_u32 s27, s15, 24576
buffer_load_dwordx4 v[224:227], v1, s[4:7], s27 offen offset:0 sc1
ds_read_b128 a[236:239], v2 offset:21504
v_mov_b32 v44, s22
v_mov_b32 v45, s22
v_mfma_f32_32x32x16_bf16 v[80:95], a[244:247], v[200:203], v[80:95]
ds_read_b128 a[240:243], v1 offset:55296
v_mov_b32 v46, s22
v_mov_b32 v47, s22
s_waitcnt vmcnt(5) lgkmcnt(5)
v_mfma_f32_32x32x16_bf16 v[64:79], a[248:251], v[204:207], v[64:79]
buffer_load_dwordx4 v[228:231], v1, s[4:7], s27 offen offset:1024 sc1
ds_read_b128 a[244:247], v2 offset:22528
v_mfma_f32_32x32x16_bf16 v[80:95], a[252:255], v[204:207], v[80:95]
ds_read_b128 a[248:251], v1 offset:56320
s_waitcnt vmcnt(5) lgkmcnt(5)
v_mfma_f32_32x32x16_bf16 v[64:79], a[224:227], v[208:211], v[64:79]
buffer_load_dwordx4 v[232:235], v1, s[4:7], s27 offen offset:2048 sc1
ds_read_b128 a[252:255], v2 offset:23552
v_mfma_f32_32x32x16_bf16 v[80:95], a[228:231], v[208:211], v[80:95]
ds_read_b128 a[224:227], v1 offset:57344
s_waitcnt vmcnt(5) lgkmcnt(5)
v_mfma_f32_32x32x16_bf16 v[64:79], a[232:235], v[212:215], v[64:79]
buffer_load_dwordx4 v[236:239], v1, s[4:7], s27 offen offset:3072 sc1
ds_read_b128 a[228:231], v2 offset:24576
v_mfma_f32_32x32x16_bf16 v[80:95], a[236:239], v[212:215], v[80:95]
ds_read_b128 a[232:235], v1 offset:58368
s_waitcnt vmcnt(5) lgkmcnt(5)
v_mfma_f32_32x32x16_bf16 v[64:79], a[240:243], v[216:219], v[64:79]
s_add_u32 s27, s15, 28672
buffer_load_dwordx4 v[240:243], v1, s[4:7], s27 offen offset:0 sc1
ds_read_b128 a[236:239], v2 offset:25600
v_mfma_f32_32x32x16_bf16 v[80:95], a[244:247], v[216:219], v[80:95]
ds_read_b128 a[240:243], v1 offset:59392
s_waitcnt vmcnt(5) lgkmcnt(5)
v_mfma_f32_32x32x16_bf16 v[64:79], a[248:251], v[220:223], v[64:79]
buffer_load_dwordx4 v[244:247], v1, s[4:7], s27 offen offset:1024 sc1
ds_read_b128 a[244:247], v2 offset:26624
v_mfma_f32_32x32x16_bf16 v[80:95], a[252:255], v[220:223], v[80:95]
ds_read_b128 a[248:251], v1 offset:60416
s_waitcnt vmcnt(5) lgkmcnt(5)
v_mfma_f32_32x32x16_bf16 v[64:79], a[224:227], v[224:227], v[64:79]
buffer_load_dwordx4 v[248:251], v1, s[4:7], s27 offen offset:2048 sc1
ds_read_b128 a[252:255], v2 offset:27648
v_mfma_f32_32x32x16_bf16 v[80:95], a[228:231], v[224:227], v[80:95]
ds_read_b128 a[224:227], v1 offset:61440
s_waitcnt vmcnt(5) lgkmcnt(5)
v_mfma_f32_32x32x16_bf16 v[64:79], a[232:235], v[228:231], v[64:79]
buffer_load_dwordx4 v[252:255], v1, s[4:7], s27 offen offset:3072 sc1
ds_read_b128 a[228:231], v2 offset:28672
v_mfma_f32_32x32x16_bf16 v[80:95], a[236:239], v[228:231], v[80:95]
ds_read_b128 a[232:235], v1 offset:62464
s_waitcnt vmcnt(5) lgkmcnt(5)
v_mfma_f32_32x32x16_bf16 v[64:79], a[240:243], v[232:235], v[64:79]
ds_read_b128 a[236:239], v2 offset:29696
v_mfma_f32_32x32x16_bf16 v[80:95], a[244:247], v[232:235], v[80:95]
ds_read_b128 a[240:243], v1 offset:63488
s_waitcnt vmcnt(4) lgkmcnt(5)
v_mfma_f32_32x32x16_bf16 v[64:79], a[248:251], v[236:239], v[64:79]
ds_read_b128 a[244:247], v2 offset:30720
v_mfma_f32_32x32x16_bf16 v[80:95], a[252:255], v[236:239], v[80:95]
ds_read_b128 a[248:251], v1 offset:64512
s_waitcnt vmcnt(3) lgkmcnt(5)
v_mfma_f32_32x32x16_bf16 v[64:79], a[224:227], v[240:243], v[64:79]
ds_read_b128 a[252:255], v2 offset:31744
v_mfma_f32_32x32x16_bf16 v[80:95], a[228:231], v[240:243], v[80:95]
s_waitcnt vmcnt(2) lgkmcnt(4)
v_mfma_f32_32x32x16_bf16 v[64:79], a[232:235], v[244:247], v[64:79]
v_mfma_f32_32x32x16_bf16 v[80:95], a[236:239], v[244:247], v[80:95]
s_waitcnt vmcnt(1) lgkmcnt(2)
v_mfma_f32_32x32x16_bf16 v[64:79], a[240:243], v[248:251], v[64:79]
v_mfma_f32_32x32x16_bf16 v[80:95], a[244:247], v[248:251], v[80:95]
s_waitcnt vmcnt(0) lgkmcnt(0)
v_mfma_f32_32x32x16_bf16 v[64:79], a[248:251], v[252:255], v[64:79]
v_mfma_f32_32x32x16_bf16 v[80:95], a[252:255], v[252:255], v[80:95]
s_barrier
s_add_u32 m0, s21, 32768
s_add_u32 s30, s20, 65536
buffer_load_dwordx4 v1, s[4:7], s30 offen offset:0  lds
buffer_load_dwordx4 v1, s[4:7], s30 offen offset:1024  lds
s_nop 5
v_cvt_pk_bf16_f32 v48, v64, v65
v_cvt_pk_bf16_f32 v49, v66, v67
v_cvt_pk_bf16_f32 v50, v68, v69
v_cvt_pk_bf16_f32 v51, v70, v71
v_cvt_pk_bf16_f32 v52, v72, v73
v_cvt_pk_bf16_f32 v53, v74, v75
v_cvt_pk_bf16_f32 v54, v76, v77
v_cvt_pk_bf16_f32 v55, v78, v79
v_mfma_f32_32x32x16_bf16 v[96:111], v[14:17], v[48:51], 0
s_nop 0
v_mfma_f32_32x32x16_bf16 v[112:127], v[18:21], v[52:55], 0
v_mul_f32 v80, v39, v80
buffer_load_dwordx4 v1, s[4:7], s30 offen offset:2048  lds
v_mul_f32 v81, v39, v81
v_mul_f32 v82, v39, v82
v_mul_f32 v83, v39, v83
v_mul_f32 v84, v39, v84
v_mul_f32 v85, v39, v85
v_mul_f32 v86, v39, v86
v_mul_f32 v87, v39, v87
v_mul_f32 v88, v39, v88
v_mul_f32 v89, v39, v89
v_mul_f32 v90, v39, v90
v_mul_f32 v91, v39, v91
buffer_load_dwordx4 v1, s[4:7], s30 offen offset:3072  lds
v_mul_f32 v92, v39, v92
v_mul_f32 v93, v39, v93
v_mul_f32 v94, v39, v94
v_mul_f32 v95, v39, v95
v_cvt_pk_bf16_f32 v80, v80, v81
v_cvt_pk_bf16_f32 v81, v82, v83
v_cvt_pk_bf16_f32 v82, v84, v85
v_cvt_pk_bf16_f32 v83, v86, v87
v_cvt_pk_bf16_f32 v84, v88, v89
v_cvt_pk_bf16_f32 v85, v90, v91
v_cvt_pk_bf16_f32 v86, v92, v93
s_add_u32 m0, s21, 36864
s_add_u32 s30, s20, 69632
buffer_load_dwordx4 v1, s[4:7], s30 offen offset:0  lds
v_cvt_pk_bf16_f32 v87, v94, v95
ds_write_b128 v57, v[80:83] offset:16896
ds_write_b128 v57, v[84:87] offset:21120
v_max3_f32 v40, v96, v97, v98
v_max3_f32 v42, v112, v113, v114
v_max3_f32 v40, v40, v99, v100
v_max3_f32 v42, v42, v115, v116
v_max3_f32 v40, v40, v101, v102
v_max3_f32 v42, v42, v117, v118
buffer_load_dwordx4 v1, s[4:7], s30 offen offset:1024  lds
v_max3_f32 v40, v40, v103, v104
v_max3_f32 v42, v42, v119, v120
v_max3_f32 v40, v40, v105, v106
v_max3_f32 v42, v42, v121, v122
v_max3_f32 v40, v40, v107, v108
v_max3_f32 v42, v42, v123, v124
v_max3_f32 v40, v40, v109, v110
v_max3_f32 v42, v42, v125, v126
v_max_f32 v40, v40, v111
v_max_f32 v42, v42, v127
v_mul_f32 v40, -v40, v38
buffer_load_dwordx4 v1, s[4:7], s30 offen offset:2048  lds
v_mul_f32 v42, -v42, v38
v_pk_fma_f32 v[96:97], v[96:97], v[38:39], v[40:41] op_sel_hi:[1,0,0]
v_pk_fma_f32 v[112:113], v[112:113], v[38:39], v[42:43] op_sel_hi:[1,0,0]
v_pk_fma_f32 v[98:99], v[98:99], v[38:39], v[40:41] op_sel_hi:[1,0,0]
v_pk_fma_f32 v[114:115], v[114:115], v[38:39], v[42:43] op_sel_hi:[1,0,0]
v_pk_fma_f32 v[100:101], v[100:101], v[38:39], v[40:41] op_sel_hi:[1,0,0]
v_pk_fma_f32 v[116:117], v[116:117], v[38:39], v[42:43] op_sel_hi:[1,0,0]
v_pk_fma_f32 v[102:103], v[102:103], v[38:39], v[40:41] op_sel_hi:[1,0,0]
v_pk_fma_f32 v[118:119], v[118:119], v[38:39], v[42:43] op_sel_hi:[1,0,0]
v_pk_fma_f32 v[104:105], v[104:105], v[38:39], v[40:41] op_sel_hi:[1,0,0]
v_pk_fma_f32 v[120:121], v[120:121], v[38:39], v[42:43] op_sel_hi:[1,0,0]
buffer_load_dwordx4 v1, s[4:7], s30 offen offset:3072  lds
v_pk_fma_f32 v[106:107], v[106:107], v[38:39], v[40:41] op_sel_hi:[1,0,0]
v_pk_fma_f32 v[122:123], v[122:123], v[38:39], v[42:43] op_sel_hi:[1,0,0]
v_pk_fma_f32 v[108:109], v[108:109], v[38:39], v[40:41] op_sel_hi:[1,0,0]
v_pk_fma_f32 v[124:125], v[124:125], v[38:39], v[42:43] op_sel_hi:[1,0,0]
v_pk_fma_f32 v[110:111], v[110:111], v[38:39], v[40:41] op_sel_hi:[1,0,0]
v_pk_fma_f32 v[126:127], v[126:127], v[38:39], v[42:43] op_sel_hi:[1,0,0]
v_exp_f32 v96, v96
v_exp_f32 v112, v112
v_exp_f32 v97, v97
v_exp_f32 v113, v113
v_exp_f32 v98, v98
v_exp_f32 v114, v114
v_exp_f32 v99, v99
v_exp_f32 v115, v115
v_exp_f32 v100, v100
v_exp_f32 v116, v116
v_exp_f32 v101, v101
v_exp_f32 v117, v117
v_exp_f32 v102, v102
v_exp_f32 v118, v118
v_exp_f32 v103, v103
v_exp_f32 v119, v119
v_exp_f32 v104, v104
v_exp_f32 v120, v120
v_exp_f32 v105, v105
v_exp_f32 v121, v121
v_exp_f32 v106, v106
v_exp_f32 v122, v122
s_lshr_b32 s96, s16, 3
s_lshl_b32 s96, s96, 1
s_add_u32 s96, s96, s18
s_lshl_b32 s96, s96, 12
s_add_u32 s97, s96, s85
buffer_load_dword v5, v1, s[4:7], s97 offen offset:0
v_exp_f32 v107, v107
v_exp_f32 v123, v123
v_exp_f32 v108, v108
buffer_load_dword v5, v1, s[4:7], s97 offen offset:1024
v_exp_f32 v124, v124
v_exp_f32 v109, v109
v_exp_f32 v125, v125
v_exp_f32 v110, v110
v_exp_f32 v126, v126
v_exp_f32 v111, v111
buffer_load_dword v5, v1, s[4:7], s97 offen offset:2048
v_exp_f32 v127, v127
v_pk_add_f32 v[40:41], v[96:97], v[98:99]
v_pk_add_f32 v[42:43], v[112:113], v[114:115]
v_pk_add_f32 v[40:41], v[40:41], v[100:101]
v_pk_add_f32 v[42:43], v[42:43], v[116:117]
v_pk_add_f32 v[40:41], v[40:41], v[102:103]
v_pk_add_f32 v[42:43], v[42:43], v[118:119]
v_pk_add_f32 v[40:41], v[40:41], v[104:105]
v_pk_add_f32 v[42:43], v[42:43], v[120:121]
v_pk_add_f32 v[40:41], v[40:41], v[106:107]
buffer_load_dword v5, v1, s[4:7], s97 offen offset:3072
v_pk_add_f32 v[42:43], v[42:43], v[122:123]
v_pk_add_f32 v[40:41], v[40:41], v[108:109]
v_pk_add_f32 v[42:43], v[42:43], v[124:125]
v_pk_add_f32 v[40:41], v[40:41], v[110:111]
v_pk_add_f32 v[42:43], v[42:43], v[126:127]
v_add_f32 v40, v40, v41
v_add_f32 v42, v42, v43
v_rcp_f32 v40, v40
v_rcp_f32 v42, v42
v_pk_mul_f32 v[96:97], v[96:97], v[40:41] op_sel_hi:[1,0]
v_pk_mul_f32 v[98:99], v[98:99], v[40:41] op_sel_hi:[1,0]
v_pk_mul_f32 v[100:101], v[100:101], v[40:41] op_sel_hi:[1,0]
v_pk_mul_f32 v[102:103], v[102:103], v[40:41] op_sel_hi:[1,0]
v_pk_mul_f32 v[104:105], v[104:105], v[40:41] op_sel_hi:[1,0]
v_pk_mul_f32 v[106:107], v[106:107], v[40:41] op_sel_hi:[1,0]
v_pk_mul_f32 v[108:109], v[108:109], v[40:41] op_sel_hi:[1,0]
v_pk_mul_f32 v[110:111], v[110:111], v[40:41] op_sel_hi:[1,0]
v_cvt_pk_bf16_f32 v64, v96, v97
v_cvt_pk_bf16_f32 v65, v98, v99
v_cvt_pk_bf16_f32 v66, v100, v101
v_cvt_pk_bf16_f32 v67, v102, v103
ds_write_b128 v56, v[64:67] offset:0
v_cvt_pk_bf16_f32 v68, v104, v105
v_cvt_pk_bf16_f32 v69, v106, v107
v_cvt_pk_bf16_f32 v70, v108, v109
v_cvt_pk_bf16_f32 v71, v110, v111
ds_write_b128 v56, v[68:71] offset:2112
v_pk_mul_f32 v[112:113], v[112:113], v[42:43] op_sel_hi:[1,0]
v_pk_mul_f32 v[114:115], v[114:115], v[42:43] op_sel_hi:[1,0]
v_pk_mul_f32 v[116:117], v[116:117], v[42:43] op_sel_hi:[1,0]
v_pk_mul_f32 v[118:119], v[118:119], v[42:43] op_sel_hi:[1,0]
v_pk_mul_f32 v[120:121], v[120:121], v[42:43] op_sel_hi:[1,0]
v_pk_mul_f32 v[122:123], v[122:123], v[42:43] op_sel_hi:[1,0]
v_pk_mul_f32 v[124:125], v[124:125], v[42:43] op_sel_hi:[1,0]
v_pk_mul_f32 v[126:127], v[126:127], v[42:43] op_sel_hi:[1,0]
v_cvt_pk_bf16_f32 v72, v112, v113
v_cvt_pk_bf16_f32 v73, v114, v115
v_cvt_pk_bf16_f32 v74, v116, v117
v_cvt_pk_bf16_f32 v75, v118, v119
ds_write_b128 v56, v[72:75] offset:8448
v_cvt_pk_bf16_f32 v76, v120, v121
v_cvt_pk_bf16_f32 v77, v122, v123
v_cvt_pk_bf16_f32 v78, v124, v125
v_cvt_pk_bf16_f32 v79, v126, v127
ds_write_b128 v56, v[76:79] offset:10560
s_waitcnt vmcnt(4) lgkmcnt(0)
s_barrier
ds_read_b64_tr_b16 v[64:65], v58 offset:0
ds_read_b64_tr_b16 v[66:67], v58 offset:64
ds_read_b64_tr_b16 v[80:81], v59 offset:16896
ds_read_b64_tr_b16 v[82:83], v59 offset:16960
ds_read_b64_tr_b16 v[68:69], v58 offset:512
ds_read_b64_tr_b16 v[70:71], v58 offset:576
ds_read_b64_tr_b16 v[84:85], v59 offset:17408
ds_read_b64_tr_b16 v[86:87], v59 offset:17472
ds_read_b64_tr_b16 v[72:73], v58 offset:1024
ds_read_b64_tr_b16 v[74:75], v58 offset:1088
ds_read_b64_tr_b16 v[88:89], v59 offset:17920
ds_read_b64_tr_b16 v[90:91], v59 offset:17984
ds_read_b64_tr_b16 v[76:77], v58 offset:1536
ds_read_b64_tr_b16 v[78:79], v58 offset:1600
ds_read_b64_tr_b16 v[92:93], v59 offset:18432
ds_read_b64_tr_b16 v[94:95], v59 offset:18496
s_waitcnt lgkmcnt(12)
v_mfma_f32_16x16x32_bf16 v[96:99], v[64:67], v[80:83], 0
v_mfma_f32_16x16x32_bf16 v[100:103], v[64:67], v[44:47], 0
s_waitcnt lgkmcnt(8)
v_mfma_f32_16x16x32_bf16 v[96:99], v[68:71], v[84:87], v[96:99]
v_mfma_f32_16x16x32_bf16 v[100:103], v[68:71], v[44:47], v[100:103]
s_waitcnt lgkmcnt(4)
v_mfma_f32_16x16x32_bf16 v[96:99], v[72:75], v[88:91], v[96:99]
v_mfma_f32_16x16x32_bf16 v[100:103], v[72:75], v[44:47], v[100:103]
s_waitcnt lgkmcnt(0)
v_mfma_f32_16x16x32_bf16 v[96:99], v[76:79], v[92:95], v[96:99]
v_mfma_f32_16x16x32_bf16 v[100:103], v[76:79], v[44:47], v[100:103]
ds_read_b128 a[224:227], v1 offset:32768
ds_read_b128 a[228:231], v1 offset:33792
ds_read_b128 a[232:235], v1 offset:34816
ds_read_b128 a[236:239], v1 offset:35840
ds_read_b128 a[240:243], v1 offset:36864
ds_read_b128 a[244:247], v1 offset:37888
ds_read_b128 a[248:251], v1 offset:38912
v_cvt_pk_bf16_f32 v96, v96, v97
v_cvt_pk_bf16_f32 v97, v98, v99
buffer_store_dwordx2 v[96:97], v63, s[4:7], s26 offen sc1
s_mov_b32 exec_lo, 0x00010001
s_mov_b32 exec_hi, 0x00010001
buffer_store_dwordx4 v[100:103], v62, s[4:7], s28 offen sc1
s_mov_b64 exec, -1
v_mfma_f32_32x32x16_bf16 v[112:127], v[24:27], v[32:35], 0
s_waitcnt lgkmcnt(3)
v_mfma_f32_32x32x16_bf16 v[112:127], a[224:227], v[128:131], v[112:127]
ds_read_b128 a[252:255], v1 offset:39936
s_add_u32 m0, s21, 65536
s_add_u32 s30, s20, 294912
buffer_load_dwordx4 v1, s[4:7], s30 offen offset:0  lds
v_mfma_f32_32x32x16_bf16 v[112:127], a[228:231], v[132:135], v[112:127]
ds_read_b128 a[224:227], v1 offset:40960
v_mfma_f32_32x32x16_bf16 v[112:127], a[232:235], v[136:139], v[112:127]
ds_read_b128 a[228:231], v1 offset:41984
buffer_load_dwordx4 v1, s[4:7], s30 offen offset:1024  lds
v_and_b32 v51, 15, v0
v_lshl_add_u32 v62, v51, 6, v62
v_and_b32 v51, 31, v0
v_mfma_f32_32x32x16_bf16 v[112:127], a[236:239], v[140:143], v[112:127]
ds_read_b128 a[232:235], v1 offset:43008
v_and_b32 v52, 1, v0
v_lshlrev_b32 v52, 4, v52
v_mov_b32 v53, 0x3f80
v_lshlrev_b32 v52, v52, v53
s_waitcnt lgkmcnt(3)
v_mfma_f32_32x32x16_bf16 v[112:127], a[240:243], v[144:147], v[112:127]
ds_read_b128 a[236:239], v1 offset:44032
buffer_load_dwordx4 v1, s[4:7], s30 offen offset:2048  lds
v_lshrrev_b32 v51, 1, v51
s_add_u32 s28, s38, 20971520
v_bfe_u32 v54, v0, 4, 1
v_mfma_f32_32x32x16_bf16 v[112:127], a[244:247], v[148:151], v[112:127]
ds_read_b128 a[240:243], v1 offset:45056
v_lshlrev_b32 v63, 10, v54
v_lshrrev_b32 v54, 5, v0
v_lshl_add_u32 v63, v54, 8, v63
v_and_b32 v54, 15, v0
v_mfma_f32_32x32x16_bf16 v[112:127], a[248:251], v[152:155], v[112:127]
ds_read_b128 a[244:247], v1 offset:46080
buffer_load_dwordx4 v1, s[4:7], s30 offen offset:3072  lds
v_lshl_add_u32 v63, v54, 4, v63
v_cmp_eq_u32 vcc, 0, v51
s_nop 1
v_mfma_f32_32x32x16_bf16 v[112:127], a[252:255], v[156:159], v[112:127]
ds_read_b128 a[248:251], v1 offset:47104
v_cndmask_b32 v44, 0, v52, vcc
v_cmp_eq_u32 vcc, 1, v51
s_nop 1
v_cndmask_b32 v45, 0, v52, vcc
s_waitcnt lgkmcnt(3)
v_mfma_f32_32x32x16_bf16 v[112:127], a[224:227], v[160:163], v[112:127]
ds_read_b128 a[252:255], v1 offset:48128
s_add_u32 m0, s21, 69632
s_add_u32 s30, s20, 299008
buffer_load_dwordx4 v1, s[4:7], s30 offen offset:0  lds
v_cmp_eq_u32 vcc, 2, v51
v_mfma_f32_32x32x16_bf16 v[112:127], a[228:231], v[164:167], v[112:127]
ds_read_b128 a[224:227], v1 offset:49152
s_nop 1
v_cndmask_b32 v46, 0, v52, vcc
v_cmp_eq_u32 vcc, 3, v51
s_nop 1
v_mfma_f32_32x32x16_bf16 v[112:127], a[232:235], v[168:171], v[112:127]
ds_read_b128 a[228:231], v1 offset:50176
buffer_load_dwordx4 v1, s[4:7], s30 offen offset:1024  lds
v_cndmask_b32 v47, 0, v52, vcc
v_mfma_f32_32x32x16_bf16 v[112:127], a[236:239], v[172:175], v[112:127]
ds_read_b128 a[232:235], v1 offset:51200
s_waitcnt lgkmcnt(3)
v_mfma_f32_32x32x16_bf16 v[112:127], a[240:243], v[176:179], v[112:127]
ds_read_b128 a[236:239], v1 offset:52224
buffer_load_dwordx4 v1, s[4:7], s30 offen offset:2048  lds
v_mfma_f32_32x32x16_bf16 v[112:127], a[244:247], v[180:183], v[112:127]
ds_read_b128 a[240:243], v1 offset:53248
v_mfma_f32_32x32x16_bf16 v[112:127], a[248:251], v[184:187], v[112:127]
ds_read_b128 a[244:247], v1 offset:54272
buffer_load_dwordx4 v1, s[4:7], s30 offen offset:3072  lds
v_mfma_f32_32x32x16_bf16 v[112:127], a[252:255], v[188:191], v[112:127]
ds_read_b128 a[248:251], v1 offset:55296
s_waitcnt lgkmcnt(3)
v_mfma_f32_32x32x16_bf16 v[112:127], a[224:227], v[192:195], v[112:127]
ds_read_b128 a[252:255], v1 offset:56320
s_add_u32 s27, s85, 0
buffer_load_dwordx4 v[128:131], v1, s[4:7], s27 offen offset:0
v_mfma_f32_32x32x16_bf16 v[112:127], a[228:231], v[196:199], v[112:127]
ds_read_b128 a[224:227], v1 offset:57344
v_mfma_f32_32x32x16_bf16 v[112:127], a[232:235], v[200:203], v[112:127]
ds_read_b128 a[228:231], v1 offset:58368
buffer_load_dwordx4 v[132:135], v1, s[4:7], s27 offen offset:1024
v_mfma_f32_32x32x16_bf16 v[112:127], a[236:239], v[204:207], v[112:127]
ds_read_b128 a[232:235], v1 offset:59392
s_waitcnt lgkmcnt(3)
v_mfma_f32_32x32x16_bf16 v[112:127], a[240:243], v[208:211], v[112:127]
ds_read_b128 a[236:239], v1 offset:60416
buffer_load_dwordx4 v[136:139], v1, s[4:7], s27 offen offset:2048
v_mfma_f32_32x32x16_bf16 v[112:127], a[244:247], v[212:215], v[112:127]
ds_read_b128 a[240:243], v1 offset:61440
v_mfma_f32_32x32x16_bf16 v[112:127], a[248:251], v[216:219], v[112:127]
ds_read_b128 a[244:247], v1 offset:62464
buffer_load_dwordx4 v[140:143], v1, s[4:7], s27 offen offset:3072
v_mfma_f32_32x32x16_bf16 v[112:127], a[252:255], v[220:223], v[112:127]
ds_read_b128 a[248:251], v1 offset:63488
s_waitcnt lgkmcnt(3)
v_mfma_f32_32x32x16_bf16 v[112:127], a[224:227], v[224:227], v[112:127]
ds_read_b128 a[252:255], v1 offset:64512
s_add_u32 s27, s85, 4096
buffer_load_dwordx4 v[144:147], v1, s[4:7], s27 offen offset:0
v_mfma_f32_32x32x16_bf16 v[112:127], a[228:231], v[228:231], v[112:127]
v_mfma_f32_32x32x16_bf16 v[112:127], a[232:235], v[232:235], v[112:127]
buffer_load_dwordx4 v[148:151], v1, s[4:7], s27 offen offset:1024
v_mfma_f32_32x32x16_bf16 v[112:127], a[236:239], v[236:239], v[112:127]
s_waitcnt lgkmcnt(0)
v_mfma_f32_32x32x16_bf16 v[112:127], a[240:243], v[240:243], v[112:127]
buffer_load_dwordx4 v[152:155], v1, s[4:7], s27 offen offset:2048
v_mfma_f32_32x32x16_bf16 v[112:127], a[244:247], v[244:247], v[112:127]
v_mfma_f32_32x32x16_bf16 v[112:127], a[248:251], v[248:251], v[112:127]
buffer_load_dwordx4 v[156:159], v1, s[4:7], s27 offen offset:3072
v_mfma_f32_32x32x16_bf16 v[112:127], a[252:255], v[252:255], v[112:127]
s_nop 11
v_cvt_pk_bf16_f32 v48, v112, v113
v_cvt_pk_bf16_f32 v49, v114, v115
v_cvt_pk_bf16_f32 v50, v116, v117
v_cvt_pk_bf16_f32 v51, v118, v119
v_cvt_pk_bf16_f32 v52, v120, v121
v_cvt_pk_bf16_f32 v53, v122, v123
v_cvt_pk_bf16_f32 v54, v124, v125
v_cvt_pk_bf16_f32 v55, v126, v127
v_mfma_f32_32x32x16_bf16 v[64:79], v[14:17], v[48:51], 0
s_nop 0
v_mfma_f32_32x32x16_bf16 v[80:95], v[18:21], v[52:55], 0
s_nop 9
v_max3_f32 v40, v64, v65, v66
s_nop 0
v_max3_f32 v42, v80, v81, v82
v_max3_f32 v40, v40, v67, v68
v_max3_f32 v42, v42, v83, v84
v_max3_f32 v40, v40, v69, v70
v_max3_f32 v42, v42, v85, v86
buffer_load_dwordx4 v[224:227], v62, s[4:7], s37 offen sc1
v_max3_f32 v40, v40, v71, v72
v_max3_f32 v42, v42, v87, v88
v_max3_f32 v40, v40, v73, v74
v_max3_f32 v42, v42, v89, v90
v_max3_f32 v40, v40, v75, v76
v_max3_f32 v42, v42, v91, v92
v_max3_f32 v40, v40, v77, v78
v_max3_f32 v42, v42, v93, v94
v_max_f32 v40, v40, v79
v_max_f32 v42, v42, v95
v_mul_f32 v40, -v40, v38
v_mul_f32 v42, -v42, v38
v_pk_fma_f32 v[64:65], v[64:65], v[38:39], v[40:41] op_sel_hi:[1,0,0]
v_pk_fma_f32 v[80:81], v[80:81], v[38:39], v[42:43] op_sel_hi:[1,0,0]
v_pk_fma_f32 v[66:67], v[66:67], v[38:39], v[40:41] op_sel_hi:[1,0,0]
s_add_u32 s23, s36, 0
buffer_load_dwordx4 v[192:195], v1, s[4:7], s23 offen offset:0 sc1
v_pk_fma_f32 v[82:83], v[82:83], v[38:39], v[42:43] op_sel_hi:[1,0,0]
v_pk_fma_f32 v[68:69], v[68:69], v[38:39], v[40:41] op_sel_hi:[1,0,0]
v_pk_fma_f32 v[84:85], v[84:85], v[38:39], v[42:43] op_sel_hi:[1,0,0]
v_pk_fma_f32 v[70:71], v[70:71], v[38:39], v[40:41] op_sel_hi:[1,0,0]
v_pk_fma_f32 v[86:87], v[86:87], v[38:39], v[42:43] op_sel_hi:[1,0,0]
v_pk_fma_f32 v[72:73], v[72:73], v[38:39], v[40:41] op_sel_hi:[1,0,0]
v_pk_fma_f32 v[88:89], v[88:89], v[38:39], v[42:43] op_sel_hi:[1,0,0]
v_pk_fma_f32 v[74:75], v[74:75], v[38:39], v[40:41] op_sel_hi:[1,0,0]
v_pk_fma_f32 v[90:91], v[90:91], v[38:39], v[42:43] op_sel_hi:[1,0,0]
v_pk_fma_f32 v[76:77], v[76:77], v[38:39], v[40:41] op_sel_hi:[1,0,0]
v_pk_fma_f32 v[92:93], v[92:93], v[38:39], v[42:43] op_sel_hi:[1,0,0]
v_pk_fma_f32 v[78:79], v[78:79], v[38:39], v[40:41] op_sel_hi:[1,0,0]
v_pk_fma_f32 v[94:95], v[94:95], v[38:39], v[42:43] op_sel_hi:[1,0,0]
v_exp_f32 v64, v64
buffer_load_dwordx4 v[196:199], v1, s[4:7], s23 offen offset:1024 sc1
v_exp_f32 v80, v80
v_exp_f32 v65, v65
v_exp_f32 v81, v81
v_exp_f32 v66, v66
v_exp_f32 v82, v82
v_exp_f32 v67, v67
v_exp_f32 v83, v83
v_exp_f32 v68, v68
buffer_load_dwordx4 v[200:203], v1, s[4:7], s23 offen offset:2048 sc1
v_exp_f32 v84, v84
v_exp_f32 v69, v69
v_exp_f32 v85, v85
v_exp_f32 v70, v70
v_exp_f32 v86, v86
v_exp_f32 v71, v71
v_exp_f32 v87, v87
v_exp_f32 v72, v72
buffer_load_dwordx4 v[204:207], v1, s[4:7], s23 offen offset:3072 sc1
v_exp_f32 v88, v88
v_exp_f32 v73, v73
v_exp_f32 v89, v89
v_exp_f32 v74, v74
v_exp_f32 v90, v90
v_exp_f32 v75, v75
v_exp_f32 v91, v91
v_exp_f32 v76, v76
s_add_u32 s23, s36, 4096
buffer_load_dwordx4 v[208:211], v1, s[4:7], s23 offen offset:0 sc1
v_exp_f32 v92, v92
v_exp_f32 v77, v77
v_exp_f32 v93, v93
v_exp_f32 v78, v78
v_exp_f32 v94, v94
v_exp_f32 v79, v79
v_exp_f32 v95, v95
buffer_load_dwordx4 v[212:215], v1, s[4:7], s23 offen offset:1024 sc1
v_pk_add_f32 v[40:41], v[64:65], v[66:67]
v_pk_add_f32 v[42:43], v[80:81], v[82:83]
v_pk_add_f32 v[40:41], v[40:41], v[68:69]
v_pk_add_f32 v[42:43], v[42:43], v[84:85]
v_pk_add_f32 v[40:41], v[40:41], v[70:71]
v_pk_add_f32 v[42:43], v[42:43], v[86:87]
v_pk_add_f32 v[40:41], v[40:41], v[72:73]
v_pk_add_f32 v[42:43], v[42:43], v[88:89]
v_pk_add_f32 v[40:41], v[40:41], v[74:75]
v_pk_add_f32 v[42:43], v[42:43], v[90:91]
v_pk_add_f32 v[40:41], v[40:41], v[76:77]
v_pk_add_f32 v[42:43], v[42:43], v[92:93]
v_pk_add_f32 v[40:41], v[40:41], v[78:79]
v_pk_add_f32 v[42:43], v[42:43], v[94:95]
v_add_f32 v40, v40, v41
buffer_load_dwordx4 v[216:219], v1, s[4:7], s23 offen offset:2048 sc1
v_add_f32 v42, v42, v43
v_rcp_f32 v40, v40
v_rcp_f32 v42, v42
v_pk_mul_f32 v[64:65], v[64:65], v[40:41] op_sel_hi:[1,0]
v_pk_mul_f32 v[66:67], v[66:67], v[40:41] op_sel_hi:[1,0]
v_pk_mul_f32 v[68:69], v[68:69], v[40:41] op_sel_hi:[1,0]
v_pk_mul_f32 v[70:71], v[70:71], v[40:41] op_sel_hi:[1,0]
v_pk_mul_f32 v[72:73], v[72:73], v[40:41] op_sel_hi:[1,0]
v_pk_mul_f32 v[74:75], v[74:75], v[40:41] op_sel_hi:[1,0]
v_pk_mul_f32 v[76:77], v[76:77], v[40:41] op_sel_hi:[1,0]
v_pk_mul_f32 v[78:79], v[78:79], v[40:41] op_sel_hi:[1,0]
v_cvt_pk_bf16_f32 v96, v64, v65
v_cvt_pk_bf16_f32 v97, v66, v67
buffer_load_dwordx4 v[220:223], v1, s[4:7], s23 offen offset:3072 sc1
v_cvt_pk_bf16_f32 v98, v68, v69
v_cvt_pk_bf16_f32 v99, v70, v71
v_cvt_pk_bf16_f32 v100, v72, v73
v_cvt_pk_bf16_f32 v101, v74, v75
v_cvt_pk_bf16_f32 v102, v76, v77
v_cvt_pk_bf16_f32 v103, v78, v79
v_pk_mul_f32 v[80:81], v[80:81], v[42:43] op_sel_hi:[1,0]
v_pk_mul_f32 v[82:83], v[82:83], v[42:43] op_sel_hi:[1,0]
v_pk_mul_f32 v[84:85], v[84:85], v[42:43] op_sel_hi:[1,0]
v_pk_mul_f32 v[86:87], v[86:87], v[42:43] op_sel_hi:[1,0]
v_pk_mul_f32 v[88:89], v[88:89], v[42:43] op_sel_hi:[1,0]
v_pk_mul_f32 v[90:91], v[90:91], v[42:43] op_sel_hi:[1,0]
v_pk_mul_f32 v[92:93], v[92:93], v[42:43] op_sel_hi:[1,0]
v_pk_mul_f32 v[94:95], v[94:95], v[42:43] op_sel_hi:[1,0]
v_cvt_pk_bf16_f32 v104, v80, v81
s_add_u32 s27, s85, 8192
buffer_load_dwordx4 v[160:163], v1, s[4:7], s27 offen offset:0
v_cvt_pk_bf16_f32 v105, v82, v83
v_cvt_pk_bf16_f32 v106, v84, v85
v_cvt_pk_bf16_f32 v107, v86, v87
v_cvt_pk_bf16_f32 v108, v88, v89
v_cvt_pk_bf16_f32 v109, v90, v91
v_cvt_pk_bf16_f32 v110, v92, v93
v_cvt_pk_bf16_f32 v111, v94, v95
s_waitcnt vmcnt(9)
s_waitcnt vmcnt(8)
v_mfma_f32_32x32x16_bf16 v[112:127], v[44:47], v[192:195], 0
v_add_f32_dpp v224, v224, v224 row_ror:8 row_mask:0xf bank_mask:0xf
v_add_f32_dpp v225, v225, v225 row_ror:8 row_mask:0xf bank_mask:0xf
v_add_f32_dpp v226, v226, v226 row_ror:8 row_mask:0xf bank_mask:0xf
v_add_f32_dpp v227, v227, v227 row_ror:8 row_mask:0xf bank_mask:0xf
s_waitcnt vmcnt(7)
v_mfma_f32_32x32x16_bf16 v[112:127], v[44:47], v[196:199], v[112:127]
buffer_load_dwordx4 v[164:167], v1, s[4:7], s27 offen offset:1024
v_add_f32_dpp v224, v224, v224 row_ror:4 row_mask:0xf bank_mask:0xf
v_add_f32_dpp v225, v225, v225 row_ror:4 row_mask:0xf bank_mask:0xf
v_add_f32_dpp v226, v226, v226 row_ror:4 row_mask:0xf bank_mask:0xf
v_add_f32_dpp v227, v227, v227 row_ror:4 row_mask:0xf bank_mask:0xf
s_waitcnt vmcnt(7)
v_mfma_f32_32x32x16_bf16 v[112:127], v[44:47], v[200:203], v[112:127]
v_add_f32_dpp v224, v224, v224 row_ror:2 row_mask:0xf bank_mask:0xf
v_add_f32_dpp v225, v225, v225 row_ror:2 row_mask:0xf bank_mask:0xf
v_add_f32_dpp v226, v226, v226 row_ror:2 row_mask:0xf bank_mask:0xf
v_add_f32_dpp v227, v227, v227 row_ror:2 row_mask:0xf bank_mask:0xf
s_waitcnt vmcnt(6)
v_mfma_f32_32x32x16_bf16 v[112:127], v[44:47], v[204:207], v[112:127]
buffer_load_dwordx4 v[168:171], v1, s[4:7], s27 offen offset:2048
v_add_f32_dpp v224, v224, v224 row_ror:1 row_mask:0xf bank_mask:0xf
v_add_f32_dpp v225, v225, v225 row_ror:1 row_mask:0xf bank_mask:0xf
v_add_f32_dpp v226, v226, v226 row_ror:1 row_mask:0xf bank_mask:0xf
v_add_f32_dpp v227, v227, v227 row_ror:1 row_mask:0xf bank_mask:0xf
s_waitcnt vmcnt(6)
v_mfma_f32_32x32x16_bf16 v[112:127], v[44:47], v[208:211], v[112:127]
v_add_f32 v52, v224, v225
v_add_f32 v53, v226, v227
v_cvt_pk_bf16_f32 v54, v224, v225
v_cvt_pk_bf16_f32 v55, v226, v227
s_waitcnt vmcnt(5)
v_mfma_f32_32x32x16_bf16 v[112:127], v[44:47], v[212:215], v[112:127]
buffer_load_dwordx4 v[172:175], v1, s[4:7], s27 offen offset:3072
v_add_f32 v52, v52, v53
s_waitcnt vmcnt(5)
v_mfma_f32_32x32x16_bf16 v[112:127], v[44:47], v[216:219], v[112:127]
s_waitcnt vmcnt(4)
v_mfma_f32_32x32x16_bf16 v[112:127], v[44:47], v[220:223], v[112:127]
s_add_u32 s27, s85, 12288
buffer_load_dwordx4 v[176:179], v1, s[4:7], s27 offen offset:0
s_nop 9
v_cmp_u_f32 vcc, v112, v52
v_cvt_pk_bf16_f32 v50, v112, v113
s_cbranch_vccnz L_kvagain_82
L_kvok_81:
v_cvt_pk_bf16_f32 v51, v114, v115
ds_write_b64 v61, v[54:55] offset:25600
ds_write_b64 v60, v[50:51] offset:25344
s_waitcnt lgkmcnt(0)
s_barrier
ds_read_b128 a[224:227], v1 offset:25344
ds_read_b128 a[232:235], v1 offset:27392
ds_read_b128 a[228:231], v1 offset:26368
ds_read_b128 a[236:239], v1 offset:28416
buffer_load_dwordx4 v[180:183], v1, s[4:7], s27 offen offset:1024
buffer_load_dwordx4 v[184:187], v1, s[4:7], s27 offen offset:2048
buffer_load_dwordx4 v[188:191], v1, s[4:7], s27 offen offset:3072
s_waitcnt lgkmcnt(2)
v_mfma_f32_32x32x16_bf16 v[64:79], a[224:227], v[96:99], 0
v_mfma_f32_32x32x16_bf16 v[80:95], a[232:235], v[104:107], 0
s_waitcnt lgkmcnt(0)
v_mfma_f32_32x32x16_bf16 v[64:79], a[228:231], v[100:103], v[64:79]
v_mfma_f32_32x32x16_bf16 v[80:95], a[236:239], v[108:111], v[80:95]
v_and_b32 v59, 7, v0
v_lshl_add_u32 v59, s3, 3, v59
v_bfe_u32 v61, v0, 4, 1
v_and_b32 v56, 15, v0
v_lshlrev_b32 v60, 3, v61
v_xor_b32 v56, v56, v60
v_lshlrev_b32 v56, 4, v56
v_lshrrev_b32 v60, 4, v0
v_lshl_add_u32 v56, v60, 9, v56
v_lshl_add_u32 v56, s3, 12, v56
s_nop 0
v_add_f32 v72, 0x358637bd, v72
v_rcp_f32 v72, v72
v_add_f32 v88, 0x358637bd, v88
v_rcp_f32 v88, v88
v_pk_mul_f32 v[64:65], v[64:65], v[72:73] op_sel_hi:[1,0]
v_pk_mul_f32 v[66:67], v[66:67], v[72:73] op_sel_hi:[1,0]
v_pk_mul_f32 v[68:69], v[68:69], v[72:73] op_sel_hi:[1,0]
v_pk_mul_f32 v[70:71], v[70:71], v[72:73] op_sel_hi:[1,0]
v_cvt_pk_bf16_f32 v76, v64, v65
v_cvt_pk_bf16_f32 v77, v66, v67
v_cvt_pk_bf16_f32 v78, v68, v69
v_cvt_pk_bf16_f32 v79, v70, v71
buffer_store_dwordx4 v[76:79], v63, s[4:7], s28 offen offset:0 sc1
v_pk_mul_f32 v[80:81], v[80:81], v[88:89] op_sel_hi:[1,0]
v_pk_mul_f32 v[82:83], v[82:83], v[88:89] op_sel_hi:[1,0]
v_pk_mul_f32 v[84:85], v[84:85], v[88:89] op_sel_hi:[1,0]
v_pk_mul_f32 v[86:87], v[86:87], v[88:89] op_sel_hi:[1,0]
v_cvt_pk_bf16_f32 v92, v80, v81
v_cvt_pk_bf16_f32 v93, v82, v83
v_cvt_pk_bf16_f32 v94, v84, v85
v_cvt_pk_bf16_f32 v95, v86, v87
buffer_store_dwordx4 v[92:95], v63, s[4:7], s28 offen offset:512 sc1
v_bfe_u32 v61, v0, 3, 1
v_lshlrev_b32 v57, 3, v61
v_xor_b32 v57, v57, v59
v_lshlrev_b32 v57, 4, v57
v_lshl_add_u32 v57, v61, 9, v57
v_lshl_add_u32 v57, v60, 12, v57
v_lshlrev_b32 v58, 4, v59
v_lshl_add_u32 v58, v61, 9, v58
v_lshl_add_u32 v58, v60, 10, v58
v_lshrrev_b32 v60, 5, v0
v_lshlrev_b32 v59, 3, v59
v_lshl_add_u32 v59, v60, 2, v59
v_and_b32 v62, 7, v0
v_lshlrev_b32 v62, 2, v62
s_add_u32 s36, s82, 12582912
s_add_u32 s37, s83, 7864320
v_permlane16_swap_b32 v6, v8
v_permlane16_swap_b32 v7, v9
v_permlane16_swap_b32 v10, v12
v_permlane16_swap_b32 v11, v13
s_add_u32 s15, s36, 32768
v_lshlrev_b32 v40, 16, v6
v_and_b32 v41, 0xffff0000, v6
v_lshlrev_b32 v42, 16, v7
v_and_b32 v43, 0xffff0000, v7
v_lshlrev_b32 v44, 16, v8
v_and_b32 v45, 0xffff0000, v8
v_lshlrev_b32 v46, 16, v9
v_and_b32 v47, 0xffff0000, v9
v_lshlrev_b32 v48, 16, v10
v_and_b32 v49, 0xffff0000, v10
v_lshlrev_b32 v50, 16, v11
v_and_b32 v51, 0xffff0000, v11
v_lshlrev_b32 v52, 16, v12
v_and_b32 v53, 0xffff0000, v12
v_lshlrev_b32 v54, 16, v13
v_and_b32 v55, 0xffff0000, v13
v_mov_b32 v4, 9
s_waitcnt vmcnt(0)
s_mov_b64 exec, 1
buffer_store_dword v4, off, s[4:7], s78 sc1
s_mov_b64 exec, -1
v_and_b32 v38, 1, v0
v_lshlrev_b32 v38, 4, v38
v_mov_b32 v39, 0x3f80
v_lshlrev_b32 v38, v38, v39
v_bfe_u32 v39, v0, 1, 3
v_cmp_eq_u32 s[96:97], 0, v39
v_cmp_eq_u32 s[26:27], 1, v39
s_nop 0
v_cndmask_b32 v60, 0, v38, s[96:97]
v_cndmask_b32 v61, 0, v38, s[26:27]
v_cmp_eq_u32 s[96:97], 2, v39
v_cmp_eq_u32 s[26:27], 3, v39
v_accvgpr_write_b32 a240, v60
v_accvgpr_write_b32 a241, v61
v_cndmask_b32 v60, 0, v38, s[96:97]
v_cndmask_b32 v61, 0, v38, s[26:27]
v_cmp_eq_u32 s[96:97], 4, v39
v_cmp_eq_u32 s[26:27], 5, v39
v_accvgpr_write_b32 a242, v60
v_accvgpr_write_b32 a243, v61
v_cndmask_b32 v60, 0, v38, s[96:97]
v_cndmask_b32 v61, 0, v38, s[26:27]
v_cmp_eq_u32 s[96:97], 6, v39
v_cmp_eq_u32 s[26:27], 7, v39
v_accvgpr_write_b32 a244, v60
v_accvgpr_write_b32 a245, v61
v_cndmask_b32 v60, 0, v38, s[96:97]
v_cndmask_b32 v61, 0, v38, s[26:27]
v_accvgpr_write_b32 a246, v60
v_accvgpr_write_b32 a247, v61
L_spin_85:
s_sleep 8
buffer_load_dword v63, v62, s[4:7], s79 offen sc1
s_sub_u32 s29, s29, 1
s_waitcnt vmcnt(0)
v_cmp_gt_u32 vcc, 9, v63
s_cbranch_scc1 L_spinout_87
s_cbranch_vccnz L_spin_85
L_spun_86:
s_add_u32 s23, s39, 20971520
buffer_load_dwordx4 v[192:195], v1, s[4:7], s23 offen offset:0 sc1
buffer_load_dwordx4 v[196:199], v1, s[4:7], s23 offen offset:2048 sc1
s_add_u32 s23, s39, 20975616
buffer_load_dwordx4 v[200:203], v1, s[4:7], s23 offen offset:0 sc1
buffer_load_dwordx4 v[204:207], v1, s[4:7], s23 offen offset:2048 sc1
s_add_u32 s23, s39, 20972544
buffer_load_dwordx4 v[208:211], v1, s[4:7], s23 offen offset:0 sc1
buffer_load_dwordx4 v[212:215], v1, s[4:7], s23 offen offset:2048 sc1
s_add_u32 s23, s39, 20976640
buffer_load_dwordx4 v[216:219], v1, s[4:7], s23 offen offset:0 sc1
buffer_load_dwordx4 v[220:223], v1, s[4:7], s23 offen offset:2048 sc1
s_add_u32 s23, s39, 21004288
buffer_load_dwordx4 v[224:227], v1, s[4:7], s23 offen offset:0 sc1
buffer_load_dwordx4 v[228:231], v1, s[4:7], s23 offen offset:2048 sc1
s_waitcnt vmcnt(9)
v_mfma_f32_16x16x32_bf16 v[64:67], v[128:131], v[192:195], 0
s_add_u32 s23, s39, 21008384
buffer_load_dwordx4 v[232:235], v1, s[4:7], s23 offen offset:0 sc1
v_mfma_f32_16x16x32_bf16 v[68:71], v[132:135], v[192:195], 0
v_mfma_f32_16x16x32_bf16 v[72:75], v[136:139], v[192:195], 0
v_mfma_f32_16x16x32_bf16 v[76:79], v[140:143], v[192:195], 0
s_waitcnt vmcnt(9)
v_mfma_f32_16x16x32_bf16 v[64:67], v[144:147], v[196:199], v[64:67]
buffer_load_dwordx4 v[236:239], v1, s[4:7], s23 offen offset:2048 sc1
v_mfma_f32_16x16x32_bf16 v[68:71], v[148:151], v[196:199], v[68:71]
v_mfma_f32_16x16x32_bf16 v[72:75], v[152:155], v[196:199], v[72:75]
v_mfma_f32_16x16x32_bf16 v[76:79], v[156:159], v[196:199], v[76:79]
s_waitcnt vmcnt(9)
v_mfma_f32_16x16x32_bf16 v[64:67], v[160:163], v[200:203], v[64:67]
s_add_u32 s23, s39, 21005312
buffer_load_dwordx4 v[240:243], v1, s[4:7], s23 offen offset:0 sc1
v_mfma_f32_16x16x32_bf16 v[68:71], v[164:167], v[200:203], v[68:71]
v_mfma_f32_16x16x32_bf16 v[72:75], v[168:171], v[200:203], v[72:75]
v_mfma_f32_16x16x32_bf16 v[76:79], v[172:175], v[200:203], v[76:79]
s_waitcnt vmcnt(9)
v_mfma_f32_16x16x32_bf16 v[64:67], v[176:179], v[204:207], v[64:67]
buffer_load_dwordx4 v[244:247], v1, s[4:7], s23 offen offset:2048 sc1
v_mfma_f32_16x16x32_bf16 v[68:71], v[180:183], v[204:207], v[68:71]
v_mfma_f32_16x16x32_bf16 v[72:75], v[184:187], v[204:207], v[72:75]
v_mfma_f32_16x16x32_bf16 v[76:79], v[188:191], v[204:207], v[76:79]
s_waitcnt vmcnt(9)
v_mfma_f32_16x16x32_bf16 v[80:83], v[128:131], v[208:211], 0
s_add_u32 s23, s39, 21009408
buffer_load_dwordx4 v[248:251], v1, s[4:7], s23 offen offset:0 sc1
v_mfma_f32_16x16x32_bf16 v[84:87], v[132:135], v[208:211], 0
v_mfma_f32_16x16x32_bf16 v[88:91], v[136:139], v[208:211], 0
v_mfma_f32_16x16x32_bf16 v[92:95], v[140:143], v[208:211], 0
s_waitcnt vmcnt(9)
v_mfma_f32_16x16x32_bf16 v[80:83], v[144:147], v[212:215], v[80:83]
buffer_load_dwordx4 v[252:255], v1, s[4:7], s23 offen offset:2048 sc1
v_mfma_f32_16x16x32_bf16 v[84:87], v[148:151], v[212:215], v[84:87]
v_cvt_pk_bf16_f32 v64, v64, v65
v_cvt_pk_bf16_f32 v65, v66, v67
v_cvt_pk_bf16_f32 v66, v68, v69
v_cvt_pk_bf16_f32 v67, v70, v71
ds_write_b128 v56, v[64:67] offset:0
v_mfma_f32_16x16x32_bf16 v[88:91], v[152:155], v[212:215], v[88:91]
v_mfma_f32_16x16x32_bf16 v[92:95], v[156:159], v[212:215], v[92:95]
s_waitcnt vmcnt(9)
v_mfma_f32_16x16x32_bf16 v[80:83], v[160:163], v[216:219], v[80:83]
s_add_u32 m0, s21, 32768
s_add_u32 s30, s20, 196608
buffer_load_dwordx4 v1, s[4:7], s30 offen offset:0  lds
v_mfma_f32_16x16x32_bf16 v[84:87], v[164:167], v[216:219], v[84:87]
v_mfma_f32_16x16x32_bf16 v[88:91], v[168:171], v[216:219], v[88:91]
v_mfma_f32_16x16x32_bf16 v[92:95], v[172:175], v[216:219], v[92:95]
v_cvt_pk_bf16_f32 v72, v72, v73
v_cvt_pk_bf16_f32 v73, v74, v75
v_cvt_pk_bf16_f32 v74, v76, v77
v_cvt_pk_bf16_f32 v75, v78, v79
ds_write_b128 v56, v[72:75] offset:2048
s_waitcnt vmcnt(9)
v_mfma_f32_16x16x32_bf16 v[80:83], v[176:179], v[220:223], v[80:83]
buffer_load_dwordx4 v1, s[4:7], s30 offen offset:1024  lds
v_mfma_f32_16x16x32_bf16 v[84:87], v[180:183], v[220:223], v[84:87]
v_mfma_f32_16x16x32_bf16 v[88:91], v[184:187], v[220:223], v[88:91]
v_mfma_f32_16x16x32_bf16 v[92:95], v[188:191], v[220:223], v[92:95]
s_waitcnt vmcnt(9)
v_mfma_f32_16x16x32_bf16 v[96:99], v[128:131], v[224:227], 0
buffer_load_dwordx4 v1, s[4:7], s30 offen offset:2048  lds
v_mfma_f32_16x16x32_bf16 v[100:103], v[132:135], v[224:227], 0
v_mfma_f32_16x16x32_bf16 v[104:107], v[136:139], v[224:227], 0
v_mfma_f32_16x16x32_bf16 v[108:111], v[140:143], v[224:227], 0
v_cvt_pk_bf16_f32 v80, v80, v81
v_cvt_pk_bf16_f32 v81, v82, v83
v_cvt_pk_bf16_f32 v82, v84, v85
v_cvt_pk_bf16_f32 v83, v86, v87
ds_write_b128 v56, v[80:83] offset:256
s_waitcnt vmcnt(9)
v_mfma_f32_16x16x32_bf16 v[96:99], v[144:147], v[228:231], v[96:99]
buffer_load_dwordx4 v1, s[4:7], s30 offen offset:3072  lds
v_mfma_f32_16x16x32_bf16 v[100:103], v[148:151], v[228:231], v[100:103]
v_cvt_pk_bf16_f32 v88, v88, v89
v_cvt_pk_bf16_f32 v89, v90, v91
v_cvt_pk_bf16_f32 v90, v92, v93
v_cvt_pk_bf16_f32 v91, v94, v95
ds_write_b128 v56, v[88:91] offset:2304
v_mfma_f32_16x16x32_bf16 v[104:107], v[152:155], v[228:231], v[104:107]
v_mfma_f32_16x16x32_bf16 v[108:111], v[156:159], v[228:231], v[108:111]
s_waitcnt vmcnt(9)
v_mfma_f32_16x16x32_bf16 v[96:99], v[160:163], v[232:235], v[96:99]
s_add_u32 m0, s21, 36864
s_add_u32 s30, s20, 200704
buffer_load_dwordx4 v1, s[4:7], s30 offen offset:0  lds
v_mfma_f32_16x16x32_bf16 v[100:103], v[164:167], v[232:235], v[100:103]
s_waitcnt lgkmcnt(0)
s_barrier
ds_read_b128 v[64:67], v57 offset:0
ds_read_b128 v[68:71], v57 offset:1024
ds_read_b128 v[72:75], v57 offset:2048
ds_read_b128 v[76:79], v57 offset:3072
v_mfma_f32_16x16x32_bf16 v[104:107], v[168:171], v[232:235], v[104:107]
v_mfma_f32_16x16x32_bf16 v[108:111], v[172:175], v[232:235], v[108:111]
s_waitcnt vmcnt(9)
v_mfma_f32_16x16x32_bf16 v[96:99], v[176:179], v[236:239], v[96:99]
buffer_load_dwordx4 v1, s[4:7], s30 offen offset:1024  lds
v_mfma_f32_16x16x32_bf16 v[100:103], v[180:183], v[236:239], v[100:103]
v_mfma_f32_16x16x32_bf16 v[104:107], v[184:187], v[236:239], v[104:107]
v_mfma_f32_16x16x32_bf16 v[108:111], v[188:191], v[236:239], v[108:111]
s_waitcnt vmcnt(9)
v_mfma_f32_16x16x32_bf16 v[112:115], v[128:131], v[240:243], 0
buffer_load_dwordx4 v1, s[4:7], s30 offen offset:2048  lds
v_mfma_f32_16x16x32_bf16 v[116:119], v[132:135], v[240:243], 0
s_waitcnt lgkmcnt(3)
v_mfma_f32_16x16x32_bf16 v[40:43], a[240:243], v[64:67], v[40:43]
s_waitcnt lgkmcnt(2)
v_mfma_f32_16x16x32_bf16 v[44:47], a[240:243], v[68:71], v[44:47]
s_waitcnt lgkmcnt(1)
v_mfma_f32_16x16x32_bf16 v[40:43], a[244:247], v[72:75], v[40:43]
s_waitcnt lgkmcnt(0)
v_mfma_f32_16x16x32_bf16 v[44:47], a[244:247], v[76:79], v[44:47]
v_mfma_f32_16x16x32_bf16 v[120:123], v[136:139], v[240:243], 0
v_mfma_f32_16x16x32_bf16 v[124:127], v[140:143], v[240:243], 0
s_waitcnt vmcnt(9)
v_mfma_f32_16x16x32_bf16 v[112:115], v[144:147], v[244:247], v[112:115]
buffer_load_dwordx4 v1, s[4:7], s30 offen offset:3072  lds
v_mfma_f32_16x16x32_bf16 v[116:119], v[148:151], v[244:247], v[116:119]
v_cvt_pk_bf16_f32 v96, v96, v97
v_cvt_pk_bf16_f32 v97, v98, v99
v_cvt_pk_bf16_f32 v98, v100, v101
v_cvt_pk_bf16_f32 v99, v102, v103
ds_write_b128 v56, v[96:99] offset:16384
v_mfma_f32_16x16x32_bf16 v[120:123], v[152:155], v[244:247], v[120:123]
v_mfma_f32_16x16x32_bf16 v[124:127], v[156:159], v[244:247], v[124:127]
s_waitcnt vmcnt(9)
v_mfma_f32_16x16x32_bf16 v[112:115], v[160:163], v[248:251], v[112:115]
v_mfma_f32_16x16x32_bf16 v[116:119], v[164:167], v[248:251], v[116:119]
v_cvt_pk_bf16_f32 v104, v104, v105
v_cvt_pk_bf16_f32 v105, v106, v107
v_cvt_pk_bf16_f32 v106, v108, v109
v_cvt_pk_bf16_f32 v107, v110, v111
ds_write_b128 v56, v[104:107] offset:18432
v_mfma_f32_16x16x32_bf16 v[120:123], v[168:171], v[248:251], v[120:123]
v_mfma_f32_16x16x32_bf16 v[124:127], v[172:175], v[248:251], v[124:127]
s_waitcnt vmcnt(8)
v_mfma_f32_16x16x32_bf16 v[112:115], v[176:179], v[252:255], v[112:115]
v_mfma_f32_16x16x32_bf16 v[116:119], v[180:183], v[252:255], v[116:119]
v_cvt_pk_bf16_f32 v6, v40, v41
v_cvt_pk_bf16_f32 v7, v42, v43
v_cvt_pk_bf16_f32 v8, v44, v45
v_cvt_pk_bf16_f32 v9, v46, v47
s_nop 0
v_permlane16_swap_b32 v6, v8
v_permlane16_swap_b32 v7, v9
buffer_store_dwordx4 v[6:9], v58, s[4:7], s36 offen sc1
v_mfma_f32_16x16x32_bf16 v[120:123], v[184:187], v[252:255], v[120:123]
v_mfma_f32_16x16x32_bf16 v[124:127], v[188:191], v[252:255], v[124:127]
v_cvt_pk_bf16_f32 v112, v112, v113
v_cvt_pk_bf16_f32 v113, v114, v115
v_cvt_pk_bf16_f32 v114, v116, v117
v_cvt_pk_bf16_f32 v115, v118, v119
ds_write_b128 v56, v[112:115] offset:16640
s_nop 1
v_cvt_pk_bf16_f32 v120, v120, v121
v_cvt_pk_bf16_f32 v121, v122, v123
v_cvt_pk_bf16_f32 v122, v124, v125
v_cvt_pk_bf16_f32 v123, v126, v127
ds_write_b128 v56, v[120:123] offset:18688
s_waitcnt lgkmcnt(0)
s_barrier
ds_read_b128 v[96:99], v57 offset:16384
ds_read_b128 v[100:103], v57 offset:17408
ds_read_b128 v[104:107], v57 offset:18432
ds_read_b128 v[108:111], v57 offset:19456
v_dot2_f32_bf16 v60, v6, s22, 0
v_dot2_f32_bf16 v61, v6, v6, 0
v_dot2_f32_bf16 v60, v7, s22, v60
v_dot2_f32_bf16 v61, v7, v7, v61
v_dot2_f32_bf16 v60, v8, s22, v60
v_dot2_f32_bf16 v61, v8, v8, v61
v_dot2_f32_bf16 v60, v9, s22, v60
v_dot2_f32_bf16 v61, v9, v9, v61
v_bfe_u32 v62, v0, 4, 1
v_lshl_add_u32 v62, v62, 11, v59
s_nop 0
v_permlane32_swap_b32 v60, v61
v_add_f32 v60, v60, v61
s_waitcnt lgkmcnt(3)
v_mfma_f32_16x16x32_bf16 v[48:51], a[240:243], v[96:99], v[48:51]
s_waitcnt lgkmcnt(2)
v_mfma_f32_16x16x32_bf16 v[52:55], a[240:243], v[100:103], v[52:55]
s_waitcnt lgkmcnt(1)
v_mfma_f32_16x16x32_bf16 v[48:51], a[244:247], v[104:107], v[48:51]
s_waitcnt lgkmcnt(0)
v_mfma_f32_16x16x32_bf16 v[52:55], a[244:247], v[108:111], v[52:55]
s_nop 5
v_cvt_pk_bf16_f32 v10, v48, v49
v_cvt_pk_bf16_f32 v11, v50, v51
v_cvt_pk_bf16_f32 v12, v52, v53
v_cvt_pk_bf16_f32 v13, v54, v55
v_dot2_f32_bf16 v38, v10, s22, 0
v_dot2_f32_bf16 v39, v10, v10, 0
v_dot2_f32_bf16 v38, v11, s22, v38
v_dot2_f32_bf16 v39, v11, v11, v39
v_dot2_f32_bf16 v38, v12, s22, v38
v_dot2_f32_bf16 v39, v12, v12, v39
v_dot2_f32_bf16 v38, v13, s22, v38
v_dot2_f32_bf16 v39, v13, v13, v39
v_permlane16_swap_b32 v10, v12
v_permlane16_swap_b32 v11, v13
buffer_store_dwordx4 v[10:13], v58, s[4:7], s15 offen sc1
v_permlane32_swap_b32 v38, v39
v_add_f32 v38, v38, v39
s_nop 1
v_permlane16_swap_b32 v60, v38
v_add_f32 v60, v60, v38
s_nop 1
v_add_f32_dpp v60, v60, v60 row_ror:8 row_mask:0xf bank_mask:0xf
s_mov_b32 exec_lo, 0x00ff00ff
s_mov_b32 exec_hi, 0x00ff00ff
buffer_store_dword v60, v62, s[4:7], s37 offen sc1
s_mov_b64 exec, -1
v_lshrrev_b32 v40, 5, v0
v_lshlrev_b32 v40, 10, v40
v_and_b32 v41, 31, v0
v_lshl_add_u32 v40, v41, 3, v40
s_add_u32 s23, s81, 7864320
s_add_u32 s15, s80, 12582912
v_and_b32 v62, 31, v0
v_lshlrev_b32 v62, 2, v62
v_mov_b32 v4, 10
s_waitcnt vmcnt(0)
s_mov_b64 exec, 1
buffer_store_dword v4, off, s[4:7], s76 sc1
s_mov_b64 exec, -1
s_barrier
buffer_load_dword v63, v62, s[4:7], s77 offen sc1
ds_read_b128 a[224:227], v3 offset:0
ds_read_b128 a[228:231], v2 offset:32768
ds_read_b128 a[232:235], v3 offset:1024
ds_read_b128 a[236:239], v2 offset:33792
ds_read_b128 a[240:243], v3 offset:2048
ds_read_b128 a[244:247], v2 offset:34816
ds_read_b128 a[248:251], v3 offset:3072
s_waitcnt vmcnt(0)
v_cmp_gt_u32 vcc, 10, v63
s_nop 0
s_cbranch_vccz L_spun_89
L_spin_88:
s_sleep 8
buffer_load_dword v63, v62, s[4:7], s77 offen sc1
s_sub_u32 s29, s29, 1
s_waitcnt vmcnt(0)
v_cmp_gt_u32 vcc, 10, v63
s_cbranch_scc1 L_spinout_90
s_cbranch_vccnz L_spin_88
L_spun_89:
s_add_u32 s27, s15, 0
buffer_load_dwordx4 v[128:131], v1, s[4:7], s27 offen offset:0 sc1
buffer_load_dwordx4 v[132:135], v1, s[4:7], s27 offen offset:1024 sc1
buffer_load_dwordx4 v[136:139], v1, s[4:7], s27 offen offset:2048 sc1
buffer_load_dwordx4 v[140:143], v1, s[4:7], s27 offen offset:3072 sc1
s_add_u32 s27, s15, 4096
buffer_load_dwordx4 v[144:147], v1, s[4:7], s27 offen offset:0 sc1
buffer_load_dwordx4 v[148:151], v1, s[4:7], s27 offen offset:1024 sc1
buffer_load_dwordx4 v[152:155], v1, s[4:7], s27 offen offset:2048 sc1
buffer_load_dwordx4 v[156:159], v1, s[4:7], s27 offen offset:3072 sc1
buffer_load_dwordx2 v[42:43], v40, s[4:7], s23 offen offset:0 sc1
buffer_load_dwordx2 v[44:45], v40, s[4:7], s23 offen offset:256 sc1
buffer_load_dwordx2 v[46:47], v40, s[4:7], s23 offen offset:512 sc1
buffer_load_dwordx2 v[48:49], v40, s[4:7], s23 offen offset:768 sc1
s_waitcnt vmcnt(11) lgkmcnt(5)
v_mfma_f32_32x32x16_bf16 v[64:79], a[224:227], v[128:131], 0
s_add_u32 s27, s15, 8192
buffer_load_dwordx4 v[160:163], v1, s[4:7], s27 offen offset:0 sc1
ds_read_b128 a[252:255], v2 offset:35840
v_mfma_f32_32x32x16_bf16 v[80:95], a[228:231], v[128:131], 0
ds_read_b128 a[224:227], v3 offset:4096
s_waitcnt vmcnt(11) lgkmcnt(5)
v_mfma_f32_32x32x16_bf16 v[64:79], a[232:235], v[132:135], v[64:79]
buffer_load_dwordx4 v[164:167], v1, s[4:7], s27 offen offset:1024 sc1
ds_read_b128 a[228:231], v2 offset:36864
v_mfma_f32_32x32x16_bf16 v[80:95], a[236:239], v[132:135], v[80:95]
ds_read_b128 a[232:235], v3 offset:5120
s_waitcnt vmcnt(11) lgkmcnt(5)
v_mfma_f32_32x32x16_bf16 v[64:79], a[240:243], v[136:139], v[64:79]
buffer_load_dwordx4 v[168:171], v1, s[4:7], s27 offen offset:2048 sc1
ds_read_b128 a[236:239], v2 offset:37888
v_mfma_f32_32x32x16_bf16 v[80:95], a[244:247], v[136:139], v[80:95]
ds_read_b128 a[240:243], v3 offset:6144
s_waitcnt vmcnt(11) lgkmcnt(5)
v_mfma_f32_32x32x16_bf16 v[64:79], a[248:251], v[140:143], v[64:79]
buffer_load_dwordx4 v[172:175], v1, s[4:7], s27 offen offset:3072 sc1
ds_read_b128 a[244:247], v2 offset:38912
v_mfma_f32_32x32x16_bf16 v[80:95], a[252:255], v[140:143], v[80:95]
ds_read_b128 a[248:251], v3 offset:7168
s_waitcnt vmcnt(11) lgkmcnt(5)
v_mfma_f32_32x32x16_bf16 v[64:79], a[224:227], v[144:147], v[64:79]
s_add_u32 s27, s15, 12288
buffer_load_dwordx4 v[176:179], v1, s[4:7], s27 offen offset:0 sc1
ds_read_b128 a[252:255], v2 offset:39936
v_mfma_f32_32x32x16_bf16 v[80:95], a[228:231], v[144:147], v[80:95]
ds_read_b128 a[224:227], v2 offset:0
s_waitcnt vmcnt(11) lgkmcnt(5)
v_mfma_f32_32x32x16_bf16 v[64:79], a[232:235], v[148:151], v[64:79]
buffer_load_dwordx4 v[180:183], v1, s[4:7], s27 offen offset:1024 sc1
ds_read_b128 a[228:231], v3 offset:8192
v_mfma_f32_32x32x16_bf16 v[80:95], a[236:239], v[148:151], v[80:95]
ds_read_b128 a[232:235], v2 offset:40960
s_waitcnt vmcnt(11) lgkmcnt(5)
v_mfma_f32_32x32x16_bf16 v[64:79], a[240:243], v[152:155], v[64:79]
buffer_load_dwordx4 v[184:187], v1, s[4:7], s27 offen offset:2048 sc1
ds_read_b128 a[236:239], v3 offset:9216
v_mfma_f32_32x32x16_bf16 v[80:95], a[244:247], v[152:155], v[80:95]
ds_read_b128 a[240:243], v2 offset:41984
s_waitcnt vmcnt(11) lgkmcnt(4)
v_mfma_f32_32x32x16_bf16 v[64:79], a[248:251], v[156:159], v[64:79]
buffer_load_dwordx4 v[188:191], v1, s[4:7], s27 offen offset:3072 sc1
ds_read_b128 a[244:247], v3 offset:10240
v_mfma_f32_32x32x16_bf16 v[80:95], a[252:255], v[156:159], v[80:95]
ds_read_b128 a[248:251], v2 offset:43008
v_mfma_f32_32x32x16_bf16 v[96:111], a[224:227], v[128:131], 0
ds_read_b128 a[252:255], v3 offset:11264
s_waitcnt vmcnt(7) lgkmcnt(5)
v_mfma_f32_32x32x16_bf16 v[64:79], a[228:231], v[160:163], v[64:79]
s_add_u32 s27, s15, 16384
buffer_load_dwordx4 v[192:195], v1, s[4:7], s27 offen offset:0 sc1
ds_read_b128 a[224:227], v2 offset:44032
v_add_f32 v42, v42, v44
v_add_f32 v43, v43, v45
v_mfma_f32_32x32x16_bf16 v[80:95], a[232:235], v[160:163], v[80:95]
ds_read_b128 a[228:231], v3 offset:12288
v_add_f32 v46, v46, v48
v_add_f32 v47, v47, v49
v_add_f32 v42, v42, v46
v_add_f32 v43, v43, v47
s_waitcnt vmcnt(7) lgkmcnt(5)
v_mfma_f32_32x32x16_bf16 v[64:79], a[236:239], v[164:167], v[64:79]
buffer_load_dwordx4 v[196:199], v1, s[4:7], s27 offen offset:1024 sc1
ds_read_b128 a[232:235], v2 offset:45056
v_permlane32_swap_b32 v42, v43
v_add_f32 v42, v42, v43
v_mov_b32 v43, v42
v_mfma_f32_32x32x16_bf16 v[80:95], a[240:243], v[164:167], v[80:95]
ds_read_b128 a[236:239], v3 offset:13312
v_permlane32_swap_b32 v42, v43
v_mul_f32 v42, 0xbb000000, v42
v_mul_f32 v43, 0x3b000000, v43
v_cvt_pk_bf16_f32 v44, v42, v42
s_waitcnt vmcnt(7) lgkmcnt(5)
v_mfma_f32_32x32x16_bf16 v[64:79], a[244:247], v[168:171], v[64:79]
buffer_load_dwordx4 v[200:203], v1, s[4:7], s27 offen offset:2048 sc1
ds_read_b128 a[240:243], v2 offset:46080
v_fma_f32 v43, -v42, v42, v43
v_and_b32 v45, 0xffff0000, v44
v_max_f32 v43, 0, v43
v_mfma_f32_32x32x16_bf16 v[80:95], a[248:251], v[168:171], v[80:95]
ds_read_b128 a[244:247], v3 offset:14336
v_sub_f32 v45, v42, v45
v_add_f32 v50, 0x3727c5ac, v43
v_cvt_pk_bf16_f32 v45, v45, v45
v_rsq_f32 v51, v50
s_waitcnt vmcnt(7) lgkmcnt(5)
v_mfma_f32_32x32x16_bf16 v[64:79], a[252:255], v[172:175], v[64:79]
buffer_load_dwordx4 v[204:207], v1, s[4:7], s27 offen offset:3072 sc1
ds_read_b128 a[248:251], v2 offset:47104
v_cndmask_b32 v32, v45, v44, s[24:25]
v_mov_b32 v37, v32
v_mfma_f32_32x32x16_bf16 v[80:95], a[224:227], v[172:175], v[80:95]
ds_read_b128 a[252:255], v3 offset:15360
v_mfma_f32_32x32x16_bf16 v[64:79], v[26:29], v[34:37], v[64:79]
v_mfma_f32_32x32x16_bf16 v[80:95], v[30:33], v[32:35], v[80:95]
v_mfma_f32_32x32x16_bf16 v[96:111], v[28:31], v[34:37], v[96:111]
s_waitcnt vmcnt(7) lgkmcnt(5)
v_mfma_f32_32x32x16_bf16 v[64:79], a[228:231], v[176:179], v[64:79]
s_add_u32 s27, s15, 20480
buffer_load_dwordx4 v[208:211], v1, s[4:7], s27 offen offset:0 sc1
ds_read_b128 a[224:227], v2 offset:48128
v_mul_f32 v38, 0xc0135761, v51
v_mul_f32 v39, v51, v51
v_mfma_f32_32x32x16_bf16 v[80:95], a[232:235], v[176:179], v[80:95]
ds_read_b128 a[228:231], v2 offset:1024
v_mul_f32 v39, v39, v38
v_mul_f32 v39, 0x3d372713, v39
s_add_u32 s36, s32, 32505856
s_mul_i32 s28, s18, 1536
s_waitcnt vmcnt(7) lgkmcnt(5)
v_mfma_f32_32x32x16_bf16 v[64:79], a[236:239], v[180:183], v[64:79]
buffer_load_dwordx4 v[212:215], v1, s[4:7], s27 offen offset:1024 sc1
ds_read_b128 a[232:235], v3 offset:16384
s_sub_u32 s28, s38, s28
s_add_u32 s28, s28, 20971520
v_bfe_u32 v41, v0, 4, 1
v_mfma_f32_32x32x16_bf16 v[80:95], a[240:243], v[180:183], v[80:95]
ds_read_b128 a[236:239], v2 offset:49152
v_lshlrev_b32 v40, 10, v41
v_lshrrev_b32 v41, 5, v0
v_lshl_add_u32 v40, v41, 8, v40
v_and_b32 v41, 15, v0
s_waitcnt vmcnt(7) lgkmcnt(5)
v_mfma_f32_32x32x16_bf16 v[64:79], a[244:247], v[184:187], v[64:79]
buffer_load_dwordx4 v[216:219], v1, s[4:7], s27 offen offset:2048 sc1
ds_read_b128 a[240:243], v3 offset:17408
v_lshl_add_u32 v40, v41, 4, v40
v_mov_b32 v41, v58
v_and_b32 v62, 7, v0
v_mfma_f32_32x32x16_bf16 v[80:95], a[248:251], v[184:187], v[80:95]
ds_read_b128 a[244:247], v2 offset:50176
v_lshlrev_b32 v62, 2, v62
v_lshrrev_b32 v60, 4, v0
v_and_b32 v56, 15, v0
v_lshlrev_b32 v61, 1, v60
s_waitcnt vmcnt(7) lgkmcnt(4)
v_mfma_f32_32x32x16_bf16 v[64:79], a[252:255], v[188:191], v[64:79]
buffer_load_dwordx4 v[220:223], v1, s[4:7], s27 offen offset:3072 sc1
ds_read_b128 a[248:251], v3 offset:18432
v_xor_b32 v56, v56, v61
v_lshlrev_b32 v56, 4, v56
v_lshl_add_u32 v56, v60, 9, v56
v_mfma_f32_32x32x16_bf16 v[80:95], a[224:227], v[188:191], v[80:95]
ds_read_b128 a[252:255], v2 offset:51200
v_lshl_add_u32 v56, s3, 12, v56
v_bfe_u32 v57, v0, 3, 1
v_lshl_add_u32 v57, s3, 3, v57
v_and_b32 v61, 7, v0
v_mfma_f32_32x32x16_bf16 v[96:111], a[228:231], v[132:135], v[96:111]
ds_read_b128 a[224:227], v3 offset:19456
v_lshlrev_b32 v59, 1, v61
v_xor_b32 v57, v57, v59
v_lshlrev_b32 v57, 4, v57
v_lshl_add_u32 v57, v61, 9, v57
s_waitcnt vmcnt(7) lgkmcnt(5)
v_mfma_f32_32x32x16_bf16 v[64:79], a[232:235], v[192:195], v[64:79]
s_add_u32 s27, s15, 24576
buffer_load_dwordx4 v[224:227], v1, s[4:7], s27 offen offset:0 sc1
ds_read_b128 a[228:231], v2 offset:52224
v_lshl_add_u32 v57, v60, 12, v57
v_lshrrev_b32 v60, 3, v0
v_mfma_f32_32x32x16_bf16 v[80:95], a[236:239], v[192:195], v[80:95]
ds_read_b128 a[232:235], v3 offset:20480
v_lshl_add_u32 v58, s3, 3, v60
v_lshlrev_b32 v58, 10, v58
v_lshl_add_u32 v58, v61, 4, v58
v_lshl_add_u32 v60, v61, 3, v60
s_waitcnt vmcnt(7) lgkmcnt(5)
v_mfma_f32_32x32x16_bf16 v[64:79], a[240:243], v[196:199], v[64:79]
buffer_load_dwordx4 v[228:231], v1, s[4:7], s27 offen offset:1024 sc1
ds_read_b128 a[236:239], v2 offset:53248
v_lshlrev_b32 v60, 2, v60
v_xor_b32 v59, 0x80, v56
v_mfma_f32_32x32x16_bf16 v[80:95], a[244:247], v[196:199], v[80:95]
ds_read_b128 a[240:243], v3 offset:21504
s_waitcnt vmcnt(7) lgkmcnt(5)
v_mfma_f32_32x32x16_bf16 v[64:79], a[248:251], v[200:203], v[64:79]
buffer_load_dwordx4 v[232:235], v1, s[4:7], s27 offen offset:2048 sc1
ds_read_b128 a[244:247], v2 offset:54272
v_mfma_f32_32x32x16_bf16 v[80:95], a[252:255], v[200:203], v[80:95]
ds_read_b128 a[248:251], v3 offset:22528
s_waitcnt vmcnt(7) lgkmcnt(5)
v_mfma_f32_32x32x16_bf16 v[64:79], a[224:227], v[204:207], v[64:79]
buffer_load_dwordx4 v[236:239], v1, s[4:7], s27 offen offset:3072 sc1
ds_read_b128 a[252:255], v2 offset:55296
v_mfma_f32_32x32x16_bf16 v[80:95], a[228:231], v[204:207], v[80:95]
ds_read_b128 a[224:227], v3 offset:23552
s_waitcnt vmcnt(7) lgkmcnt(5)
v_mfma_f32_32x32x16_bf16 v[64:79], a[232:235], v[208:211], v[64:79]
s_add_u32 s27, s15, 28672
buffer_load_dwordx4 v[240:243], v1, s[4:7], s27 offen offset:0 sc1
ds_read_b128 a[228:231], v2 offset:56320
v_mfma_f32_32x32x16_bf16 v[80:95], a[236:239], v[208:211], v[80:95]
ds_read_b128 a[232:235], v2 offset:2048
s_waitcnt vmcnt(7) lgkmcnt(5)
v_mfma_f32_32x32x16_bf16 v[64:79], a[240:243], v[212:215], v[64:79]
buffer_load_dwordx4 v[244:247], v1, s[4:7], s27 offen offset:1024 sc1
ds_read_b128 a[236:239], v3 offset:24576
v_mfma_f32_32x32x16_bf16 v[80:95], a[244:247], v[212:215], v[80:95]
ds_read_b128 a[240:243], v2 offset:57344
s_waitcnt vmcnt(7) lgkmcnt(5)
v_mfma_f32_32x32x16_bf16 v[64:79], a[248:251], v[216:219], v[64:79]
buffer_load_dwordx4 v[248:251], v1, s[4:7], s27 offen offset:2048 sc1
ds_read_b128 a[244:247], v3 offset:25600
v_mfma_f32_32x32x16_bf16 v[80:95], a[252:255], v[216:219], v[80:95]
ds_read_b128 a[248:251], v2 offset:58368
s_waitcnt vmcnt(7) lgkmcnt(4)
v_mfma_f32_32x32x16_bf16 v[64:79], a[224:227], v[220:223], v[64:79]
buffer_load_dwordx4 v[252:255], v1, s[4:7], s27 offen offset:3072 sc1
ds_read_b128 a[252:255], v3 offset:26624
v_mfma_f32_32x32x16_bf16 v[80:95], a[228:231], v[220:223], v[80:95]
ds_read_b128 a[224:227], v2 offset:59392
v_mfma_f32_32x32x16_bf16 v[96:111], a[232:235], v[136:139], v[96:111]
ds_read_b128 a[228:231], v3 offset:27648
s_waitcnt vmcnt(7) lgkmcnt(5)
v_mfma_f32_32x32x16_bf16 v[64:79], a[236:239], v[224:227], v[64:79]
ds_read_b128 a[232:235], v2 offset:60416
v_mfma_f32_32x32x16_bf16 v[80:95], a[240:243], v[224:227], v[80:95]
ds_read_b128 a[236:239], v3 offset:28672
s_waitcnt vmcnt(6) lgkmcnt(5)
v_mfma_f32_32x32x16_bf16 v[64:79], a[244:247], v[228:231], v[64:79]
ds_read_b128 a[240:243], v2 offset:61440
v_mfma_f32_32x32x16_bf16 v[80:95], a[248:251], v[228:231], v[80:95]
ds_read_b128 a[244:247], v3 offset:29696
s_waitcnt vmcnt(5) lgkmcnt(5)
v_mfma_f32_32x32x16_bf16 v[64:79], a[252:255], v[232:235], v[64:79]
ds_read_b128 a[248:251], v2 offset:62464
v_mfma_f32_32x32x16_bf16 v[80:95], a[224:227], v[232:235], v[80:95]
ds_read_b128 a[252:255], v3 offset:30720
s_waitcnt vmcnt(4) lgkmcnt(5)
v_mfma_f32_32x32x16_bf16 v[64:79], a[228:231], v[236:239], v[64:79]
ds_read_b128 a[224:227], v2 offset:63488
v_mfma_f32_32x32x16_bf16 v[80:95], a[232:235], v[236:239], v[80:95]
ds_read_b128 a[228:231], v3 offset:31744
s_waitcnt vmcnt(3) lgkmcnt(5)
v_mfma_f32_32x32x16_bf16 v[64:79], a[236:239], v[240:243], v[64:79]
ds_read_b128 a[232:235], v2 offset:64512
v_mfma_f32_32x32x16_bf16 v[80:95], a[240:243], v[240:243], v[80:95]
ds_read_b128 a[236:239], v2 offset:3072
s_waitcnt vmcnt(2) lgkmcnt(5)
v_mfma_f32_32x32x16_bf16 v[64:79], a[244:247], v[244:247], v[64:79]
ds_read_b128 a[240:243], v2 offset:4096
v_mfma_f32_32x32x16_bf16 v[80:95], a[248:251], v[244:247], v[80:95]
ds_read_b128 a[244:247], v2 offset:5120
s_waitcnt vmcnt(1) lgkmcnt(5)
v_mfma_f32_32x32x16_bf16 v[64:79], a[252:255], v[248:251], v[64:79]
ds_read_b128 a[248:251], v2 offset:6144
v_mfma_f32_32x32x16_bf16 v[80:95], a[224:227], v[248:251], v[80:95]
ds_read_b128 a[252:255], v2 offset:7168
s_waitcnt vmcnt(0) lgkmcnt(4)
v_mfma_f32_32x32x16_bf16 v[64:79], a[228:231], v[252:255], v[64:79]
ds_read_b128 a[224:227], v2 offset:8192
v_mfma_f32_32x32x16_bf16 v[80:95], a[232:235], v[252:255], v[80:95]
ds_read_b128 a[228:231], v2 offset:9216
v_mfma_f32_32x32x16_bf16 v[96:111], a[236:239], v[140:143], v[96:111]
ds_read_b128 a[232:235], v2 offset:10240
s_waitcnt lgkmcnt(3)
v_mfma_f32_32x32x16_bf16 v[96:111], a[240:243], v[144:147], v[96:111]
s_barrier
ds_read_b128 a[236:239], v2 offset:11264
v_mfma_f32_32x32x16_bf16 v[96:111], a[244:247], v[148:151], v[96:111]
ds_read_b128 a[240:243], v2 offset:12288
v_mfma_f32_32x32x16_bf16 v[96:111], a[248:251], v[152:155], v[96:111]
ds_read_b128 a[244:247], v2 offset:13312
v_mul_f32 v52, v64, v64
v_mul_f32 v53, v65, v65
v_mul_f32 v54, v66, v66
v_mul_f32 v55, v67, v67
v_fma_f32 v52, v52, v39, v38
v_mfma_f32_32x32x16_bf16 v[96:111], a[252:255], v[156:159], v[96:111]
ds_read_b128 a[248:251], v2 offset:14336
s_add_u32 m0, s21, 131072
s_add_u32 s30, s20, 163840
buffer_load_dwordx4 v1, s[4:7], s30 offen offset:0  lds
v_fma_f32 v53, v53, v39, v38
v_fma_f32 v54, v54, v39, v38
s_waitcnt lgkmcnt(3)
v_mfma_f32_32x32x16_bf16 v[96:111], a[224:227], v[160:163], v[96:111]
ds_read_b128 a[252:255], v2 offset:15360
v_fma_f32 v55, v55, v39, v38
v_mul_f32 v52, v52, v64
v_mul_f32 v53, v53, v65
v_mul_f32 v54, v54, v66
v_mfma_f32_32x32x16_bf16 v[96:111], a[228:231], v[164:167], v[96:111]
ds_read_b128 a[224:227], v2 offset:16384
buffer_load_dwordx4 v1, s[4:7], s30 offen offset:1024  lds
v_mul_f32 v55, v55, v67
v_exp_f32 v52, v52
v_mul_f32 v64, v64, v72
v_mfma_f32_32x32x16_bf16 v[96:111], a[232:235], v[168:171], v[96:111]
ds_read_b128 a[228:231], v2 offset:17408
v_exp_f32 v53, v53
v_mul_f32 v65, v65, v73
v_exp_f32 v54, v54
v_mfma_f32_32x32x16_bf16 v[96:111], a[236:239], v[172:175], v[96:111]
ds_read_b128 a[232:235], v2 offset:18432
buffer_load_dwordx4 v1, s[4:7], s30 offen offset:2048  lds
v_mul_f32 v66, v66, v74
v_exp_f32 v55, v55
v_mul_f32 v67, v67, v75
s_waitcnt lgkmcnt(3)
v_mfma_f32_32x32x16_bf16 v[96:111], a[240:243], v[176:179], v[96:111]
ds_read_b128 a[236:239], v2 offset:19456
v_fma_f32 v52, v52, v50, v50
v_fma_f32 v53, v53, v50, v50
v_fma_f32 v54, v54, v50, v50
v_fma_f32 v55, v55, v50, v50
v_mfma_f32_32x32x16_bf16 v[96:111], a[244:247], v[180:183], v[96:111]
ds_read_b128 a[240:243], v2 offset:20480
buffer_load_dwordx4 v1, s[4:7], s30 offen offset:3072  lds
v_rcp_f32 v52, v52
v_rcp_f32 v53, v53
v_mfma_f32_32x32x16_bf16 v[96:111], a[248:251], v[184:187], v[96:111]
ds_read_b128 a[244:247], v2 offset:21504
v_rcp_f32 v54, v54
v_rcp_f32 v55, v55
v_mul_f32 v64, v64, v52
v_mfma_f32_32x32x16_bf16 v[96:111], a[252:255], v[188:191], v[96:111]
ds_read_b128 a[248:251], v2 offset:22528
s_add_u32 m0, s21, 135168
s_add_u32 s30, s20, 167936
buffer_load_dwordx4 v1, s[4:7], s30 offen offset:0  lds
v_mul_f32 v65, v65, v53
v_mul_f32 v66, v66, v54
s_waitcnt lgkmcnt(3)
v_mfma_f32_32x32x16_bf16 v[96:111], a[224:227], v[192:195], v[96:111]
ds_read_b128 a[252:255], v2 offset:23552
v_mul_f32 v67, v67, v55
v_cvt_pk_bf16_f32 v42, v64, v65
v_cvt_pk_bf16_f32 v43, v66, v67
v_mul_f32 v52, v68, v68
v_mfma_f32_32x32x16_bf16 v[96:111], a[228:231], v[196:199], v[96:111]
ds_read_b128 a[224:227], v2 offset:24576
buffer_load_dwordx4 v1, s[4:7], s30 offen offset:1024  lds
v_mul_f32 v53, v69, v69
v_mul_f32 v54, v70, v70
v_mul_f32 v55, v71, v71
v_fma_f32 v52, v52, v39, v38
v_mfma_f32_32x32x16_bf16 v[96:111], a[232:235], v[200:203], v[96:111]
ds_read_b128 a[228:231], v2 offset:25600
v_fma_f32 v53, v53, v39, v38
v_fma_f32 v54, v54, v39, v38
v_fma_f32 v55, v55, v39, v38
v_mul_f32 v52, v52, v68
v_mul_f32 v53, v53, v69
v_mfma_f32_32x32x16_bf16 v[96:111], a[236:239], v[204:207], v[96:111]
ds_read_b128 a[232:235], v2 offset:26624
buffer_load_dwordx4 v1, s[4:7], s30 offen offset:2048  lds
v_mul_f32 v54, v54, v70
v_mul_f32 v55, v55, v71
v_exp_f32 v52, v52
s_waitcnt lgkmcnt(3)
v_mfma_f32_32x32x16_bf16 v[96:111], a[240:243], v[208:211], v[96:111]
ds_read_b128 a[236:239], v2 offset:27648
v_mul_f32 v68, v68, v76
v_exp_f32 v53, v53
v_mul_f32 v69, v69, v77
v_mfma_f32_32x32x16_bf16 v[96:111], a[244:247], v[212:215], v[96:111]
ds_read_b128 a[240:243], v2 offset:28672
buffer_load_dwordx4 v1, s[4:7], s30 offen offset:3072  lds
v_exp_f32 v54, v54
v_mul_f32 v70, v70, v78
v_mfma_f32_32x32x16_bf16 v[96:111], a[248:251], v[216:219], v[96:111]
s_barrier
ds_read_b128 a[244:247], v2 offset:29696
v_exp_f32 v55, v55
v_mul_f32 v71, v71, v79
v_fma_f32 v52, v52, v50, v50
v_mfma_f32_32x32x16_bf16 v[96:111], a[252:255], v[220:223], v[96:111]
ds_read_b128 a[248:251], v2 offset:30720
s_add_u32 m0, s21, 98304
s_add_u32 s30, s20, 131072
buffer_load_dwordx4 v1, s[4:7], s30 offen offset:0  lds
v_fma_f32 v53, v53, v50, v50
v_fma_f32 v54, v54, v50, v50
s_waitcnt lgkmcnt(3)
v_mfma_f32_32x32x16_bf16 v[96:111], a[224:227], v[224:227], v[96:111]
ds_read_b128 a[252:255], v2 offset:31744
v_fma_f32 v55, v55, v50, v50
v_rcp_f32 v52, v52
v_mfma_f32_32x32x16_bf16 v[96:111], a[228:231], v[228:231], v[96:111]
ds_read_b128 a[224:227], v1 offset:32768
buffer_load_dwordx4 v1, s[4:7], s30 offen offset:1024  lds
v_rcp_f32 v53, v53
v_rcp_f32 v54, v54
v_mfma_f32_32x32x16_bf16 v[96:111], a[232:235], v[232:235], v[96:111]
ds_read_b128 a[228:231], v1 offset:33792
v_rcp_f32 v55, v55
v_mul_f32 v68, v68, v52
v_mul_f32 v69, v69, v53
v_mul_f32 v70, v70, v54
v_mfma_f32_32x32x16_bf16 v[96:111], a[236:239], v[236:239], v[96:111]
ds_read_b128 a[232:235], v1 offset:34816
buffer_load_dwordx4 v1, s[4:7], s30 offen offset:2048  lds
v_mul_f32 v71, v71, v55
v_cvt_pk_bf16_f32 v44, v68, v69
v_cvt_pk_bf16_f32 v45, v70, v71
s_add_u32 s37, s36, 8192
buffer_store_dwordx4 v[42:45], v40, s[4:7], s37 offen sc1
s_waitcnt lgkmcnt(3)
v_mfma_f32_32x32x16_bf16 v[96:111], a[240:243], v[240:243], v[96:111]
ds_read_b128 a[236:239], v1 offset:35840
v_mul_f32 v52, v80, v80
v_mul_f32 v53, v81, v81
v_mul_f32 v54, v82, v82
v_mul_f32 v55, v83, v83
v_mfma_f32_32x32x16_bf16 v[96:111], a[244:247], v[244:247], v[96:111]
ds_read_b128 a[240:243], v1 offset:36864
buffer_load_dwordx4 v1, s[4:7], s30 offen offset:3072  lds
v_fma_f32 v52, v52, v39, v38
v_fma_f32 v53, v53, v39, v38
v_fma_f32 v54, v54, v39, v38
v_fma_f32 v55, v55, v39, v38
v_mfma_f32_32x32x16_bf16 v[96:111], a[248:251], v[248:251], v[96:111]
ds_read_b128 a[244:247], v1 offset:37888
v_mul_f32 v52, v52, v80
v_mul_f32 v53, v53, v81
v_mul_f32 v54, v54, v82
v_mul_f32 v55, v55, v83
v_mfma_f32_32x32x16_bf16 v[96:111], a[252:255], v[252:255], v[96:111]
ds_read_b128 a[248:251], v1 offset:38912
s_add_u32 m0, s21, 102400
s_add_u32 s30, s20, 135168
buffer_load_dwordx4 v1, s[4:7], s30 offen offset:0  lds
v_exp_f32 v52, v52
v_mfma_f32_32x32x16_bf16 v[112:127], v[28:31], v[32:35], 0
s_waitcnt lgkmcnt(3)
v_mfma_f32_32x32x16_bf16 v[112:127], a[224:227], v[128:131], v[112:127]
ds_read_b128 a[252:255], v1 offset:39936
buffer_load_dwordx4 v1, s[4:7], s30 offen offset:1024  lds
v_mfma_f32_32x32x16_bf16 v[112:127], a[228:231], v[132:135], v[112:127]
ds_read_b128 a[224:227], v1 offset:40960
v_mfma_f32_32x32x16_bf16 v[112:127], a[232:235], v[136:139], v[112:127]
ds_read_b128 a[228:231], v1 offset:41984
buffer_load_dwordx4 v1, s[4:7], s30 offen offset:2048  lds
v_mul_f32 v80, v80, v88
v_exp_f32 v53, v53
v_mul_f32 v81, v81, v89
v_mfma_f32_32x32x16_bf16 v[112:127], a[236:239], v[140:143], v[112:127]
ds_read_b128 a[232:235], v1 offset:43008
v_exp_f32 v54, v54
v_mul_f32 v82, v82, v90
v_exp_f32 v55, v55
s_waitcnt lgkmcnt(3)
v_mfma_f32_32x32x16_bf16 v[112:127], a[240:243], v[144:147], v[112:127]
ds_read_b128 a[236:239], v1 offset:44032
buffer_load_dwordx4 v1, s[4:7], s30 offen offset:3072  lds
v_mul_f32 v83, v83, v91
v_fma_f32 v52, v52, v50, v50
v_fma_f32 v53, v53, v50, v50
v_mfma_f32_32x32x16_bf16 v[112:127], a[244:247], v[148:151], v[112:127]
ds_read_b128 a[240:243], v1 offset:45056
v_fma_f32 v54, v54, v50, v50
v_fma_f32 v55, v55, v50, v50
v_rcp_f32 v52, v52
v_mfma_f32_32x32x16_bf16 v[112:127], a[248:251], v[152:155], v[112:127]
ds_read_b128 a[244:247], v1 offset:46080
v_rcp_f32 v53, v53
v_rcp_f32 v54, v54
v_mfma_f32_32x32x16_bf16 v[112:127], a[252:255], v[156:159], v[112:127]
ds_read_b128 a[248:251], v1 offset:47104
v_rcp_f32 v55, v55
v_mul_f32 v80, v80, v52
v_mul_f32 v81, v81, v53
v_mul_f32 v82, v82, v54
s_waitcnt lgkmcnt(3)
v_mfma_f32_32x32x16_bf16 v[112:127], a[224:227], v[160:163], v[112:127]
ds_read_b128 a[252:255], v1 offset:48128
v_mul_f32 v83, v83, v55
v_cvt_pk_bf16_f32 v46, v80, v81
v_cvt_pk_bf16_f32 v47, v82, v83
v_mul_f32 v52, v84, v84
v_mfma_f32_32x32x16_bf16 v[112:127], a[228:231], v[164:167], v[112:127]
ds_read_b128 a[224:227], v1 offset:49152
v_mul_f32 v53, v85, v85
v_mul_f32 v54, v86, v86
v_mul_f32 v55, v87, v87
v_fma_f32 v52, v52, v39, v38
v_fma_f32 v53, v53, v39, v38
v_mfma_f32_32x32x16_bf16 v[112:127], a[232:235], v[168:171], v[112:127]
ds_read_b128 a[228:231], v1 offset:50176
v_fma_f32 v54, v54, v39, v38
v_fma_f32 v55, v55, v39, v38
v_mul_f32 v52, v52, v84
v_mul_f32 v53, v53, v85
v_mul_f32 v54, v54, v86
v_mfma_f32_32x32x16_bf16 v[112:127], a[236:239], v[172:175], v[112:127]
ds_read_b128 a[232:235], v1 offset:51200
v_mul_f32 v55, v55, v87
v_exp_f32 v52, v52
v_mul_f32 v84, v84, v92
s_waitcnt lgkmcnt(3)
v_mfma_f32_32x32x16_bf16 v[112:127], a[240:243], v[176:179], v[112:127]
ds_read_b128 a[236:239], v1 offset:52224
v_exp_f32 v53, v53
v_mul_f32 v85, v85, v93
v_mfma_f32_32x32x16_bf16 v[112:127], a[244:247], v[180:183], v[112:127]
ds_read_b128 a[240:243], v1 offset:53248
v_exp_f32 v54, v54
v_mul_f32 v86, v86, v94
v_exp_f32 v55, v55
v_mfma_f32_32x32x16_bf16 v[112:127], a[248:251], v[184:187], v[112:127]
ds_read_b128 a[244:247], v1 offset:54272
v_mul_f32 v87, v87, v95
v_fma_f32 v52, v52, v50, v50
v_fma_f32 v53, v53, v50, v50
v_fma_f32 v54, v54, v50, v50
v_fma_f32 v55, v55, v50, v50
v_mfma_f32_32x32x16_bf16 v[112:127], a[252:255], v[188:191], v[112:127]
ds_read_b128 a[248:251], v1 offset:55296
v_rcp_f32 v52, v52
v_rcp_f32 v53, v53
s_waitcnt lgkmcnt(3)
v_mfma_f32_32x32x16_bf16 v[112:127], a[224:227], v[192:195], v[112:127]
ds_read_b128 a[252:255], v1 offset:56320
v_rcp_f32 v54, v54
v_rcp_f32 v55, v55
v_mfma_f32_32x32x16_bf16 v[112:127], a[228:231], v[196:199], v[112:127]
ds_read_b128 a[224:227], v1 offset:57344
v_mul_f32 v84, v84, v52
v_mul_f32 v85, v85, v53
v_mul_f32 v86, v86, v54
v_mul_f32 v87, v87, v55
v_cvt_pk_bf16_f32 v48, v84, v85
v_mfma_f32_32x32x16_bf16 v[112:127], a[232:235], v[200:203], v[112:127]
ds_read_b128 a[228:231], v1 offset:58368
v_cvt_pk_bf16_f32 v49, v86, v87
s_add_u32 s37, s36, 10240
buffer_store_dwordx4 v[46:49], v40, s[4:7], s37 offen sc1
v_mul_f32 v52, v96, v96
v_mul_f32 v53, v97, v97
v_mul_f32 v54, v98, v98
v_mfma_f32_32x32x16_bf16 v[112:127], a[236:239], v[204:207], v[112:127]
ds_read_b128 a[232:235], v1 offset:59392
v_mul_f32 v55, v99, v99
v_fma_f32 v52, v52, v39, v38
v_fma_f32 v53, v53, v39, v38
v_fma_f32 v54, v54, v39, v38
v_fma_f32 v55, v55, v39, v38
s_waitcnt lgkmcnt(3)
v_mfma_f32_32x32x16_bf16 v[112:127], a[240:243], v[208:211], v[112:127]
ds_read_b128 a[236:239], v1 offset:60416
v_mul_f32 v52, v52, v96
v_mul_f32 v53, v53, v97
v_mul_f32 v54, v54, v98
v_mul_f32 v55, v55, v99
v_mfma_f32_32x32x16_bf16 v[112:127], a[244:247], v[212:215], v[112:127]
ds_read_b128 a[240:243], v1 offset:61440
v_exp_f32 v52, v52
v_mul_f32 v96, v96, v104
v_exp_f32 v53, v53
v_mfma_f32_32x32x16_bf16 v[112:127], a[248:251], v[216:219], v[112:127]
s_waitcnt vmcnt(10)
s_barrier
ds_read_b128 a[244:247], v1 offset:62464
s_add_u32 m0, s21, 65536
s_add_u32 s30, s20, 98304
buffer_load_dwordx4 v1, s[4:7], s30 offen offset:0  lds
v_mfma_f32_32x32x16_bf16 v[112:127], a[252:255], v[220:223], v[112:127]
ds_read_b128 a[248:251], v1 offset:63488
v_mul_f32 v97, v97, v105
v_exp_f32 v54, v54
v_mul_f32 v98, v98, v106
s_waitcnt lgkmcnt(3)
v_mfma_f32_32x32x16_bf16 v[112:127], a[224:227], v[224:227], v[112:127]
ds_read_b128 a[252:255], v1 offset:64512
v_exp_f32 v55, v55
v_mul_f32 v99, v99, v107
v_fma_f32 v52, v52, v50, v50
v_mfma_f32_32x32x16_bf16 v[112:127], a[228:231], v[228:231], v[112:127]
ds_read_b128 a[224:227], v3 offset:0
buffer_load_dwordx4 v1, s[4:7], s30 offen offset:1024  lds
v_fma_f32 v53, v53, v50, v50
v_fma_f32 v54, v54, v50, v50
v_fma_f32 v55, v55, v50, v50
v_mfma_f32_32x32x16_bf16 v[112:127], a[232:235], v[232:235], v[112:127]
ds_read_b128 a[228:231], v3 offset:1024
v_rcp_f32 v52, v52
v_rcp_f32 v53, v53
v_mfma_f32_32x32x16_bf16 v[112:127], a[236:239], v[236:239], v[112:127]
ds_read_b128 a[232:235], v3 offset:2048
buffer_load_dwordx4 v1, s[4:7], s30 offen offset:2048  lds
v_rcp_f32 v54, v54
v_rcp_f32 v55, v55
s_waitcnt lgkmcnt(3)
v_mfma_f32_32x32x16_bf16 v[112:127], a[240:243], v[240:243], v[112:127]
ds_read_b128 a[236:239], v3 offset:3072
v_mul_f32 v96, v96, v52
v_mul_f32 v97, v97, v53
v_mul_f32 v98, v98, v54
v_mul_f32 v99, v99, v55
v_mfma_f32_32x32x16_bf16 v[112:127], a[244:247], v[244:247], v[112:127]
ds_read_b128 a[240:243], v3 offset:4096
buffer_load_dwordx4 v1, s[4:7], s30 offen offset:3072  lds
v_cvt_pk_bf16_f32 v42, v96, v97
v_cvt_pk_bf16_f32 v43, v98, v99
v_mul_f32 v52, v100, v100
v_mul_f32 v53, v101, v101
v_mfma_f32_32x32x16_bf16 v[112:127], a[248:251], v[248:251], v[112:127]
ds_read_b128 a[244:247], v3 offset:5120
v_mul_f32 v54, v102, v102
v_mul_f32 v55, v103, v103
v_fma_f32 v52, v52, v39, v38
v_fma_f32 v53, v53, v39, v38
v_fma_f32 v54, v54, v39, v38
v_mfma_f32_32x32x16_bf16 v[112:127], a[252:255], v[252:255], v[112:127]
ds_read_b128 a[248:251], v3 offset:6144
s_add_u32 m0, s21, 69632
s_add_u32 s30, s20, 102400
buffer_load_dwordx4 v1, s[4:7], s30 offen offset:0  lds
v_fma_f32 v55, v55, v39, v38
v_mul_f32 v52, v52, v100
v_mfma_f32_32x32x16_bf16 v[64:79], v[24:27], v[34:37], 0
s_waitcnt lgkmcnt(3)
v_mfma_f32_32x32x16_bf16 v[64:79], a[224:227], v[128:131], v[64:79]
ds_read_b128 a[252:255], v3 offset:7168
buffer_load_dwordx4 v1, s[4:7], s30 offen offset:1024  lds
v_mfma_f32_32x32x16_bf16 v[64:79], a[228:231], v[132:135], v[64:79]
ds_read_b128 a[224:227], v3 offset:8192
v_mfma_f32_32x32x16_bf16 v[64:79], a[232:235], v[136:139], v[64:79]
ds_read_b128 a[228:231], v3 offset:9216
buffer_load_dwordx4 v1, s[4:7], s30 offen offset:2048  lds
v_mul_f32 v53, v53, v101
v_mul_f32 v54, v54, v102
v_mul_f32 v55, v55, v103
v_mfma_f32_32x32x16_bf16 v[64:79], a[236:239], v[140:143], v[64:79]
ds_read_b128 a[232:235], v3 offset:10240
v_exp_f32 v52, v52
v_mul_f32 v100, v100, v108
v_exp_f32 v53, v53
s_waitcnt lgkmcnt(3)
v_mfma_f32_32x32x16_bf16 v[64:79], a[240:243], v[144:147], v[64:79]
ds_read_b128 a[236:239], v3 offset:11264
buffer_load_dwordx4 v1, s[4:7], s30 offen offset:3072  lds
v_mul_f32 v101, v101, v109
v_exp_f32 v54, v54
v_mfma_f32_32x32x16_bf16 v[64:79], a[244:247], v[148:151], v[64:79]
ds_read_b128 a[240:243], v3 offset:12288
v_mul_f32 v102, v102, v110
v_exp_f32 v55, v55
v_mul_f32 v103, v103, v111
v_fma_f32 v52, v52, v50, v50
v_mfma_f32_32x32x16_bf16 v[64:79], a[248:251], v[152:155], v[64:79]
ds_read_b128 a[244:247], v3 offset:13312
v_fma_f32 v53, v53, v50, v50
v_fma_f32 v54, v54, v50, v50
v_fma_f32 v55, v55, v50, v50
v_rcp_f32 v52, v52
v_mfma_f32_32x32x16_bf16 v[64:79], a[252:255], v[156:159], v[64:79]
ds_read_b128 a[248:251], v3 offset:14336
v_rcp_f32 v53, v53
v_rcp_f32 v54, v54
s_waitcnt lgkmcnt(3)
v_mfma_f32_32x32x16_bf16 v[64:79], a[224:227], v[160:163], v[64:79]
ds_read_b128 a[252:255], v3 offset:15360
v_rcp_f32 v55, v55
v_mul_f32 v100, v100, v52
v_mul_f32 v101, v101, v53
v_mfma_f32_32x32x16_bf16 v[64:79], a[228:231], v[164:167], v[64:79]
ds_read_b128 a[224:227], v3 offset:16384
v_mul_f32 v102, v102, v54
v_mul_f32 v103, v103, v55
v_cvt_pk_bf16_f32 v44, v100, v101
v_cvt_pk_bf16_f32 v45, v102, v103
s_add_u32 s37, s36, 12288
buffer_store_dwordx4 v[42:45], v40, s[4:7], s37 offen sc1
v_mfma_f32_32x32x16_bf16 v[64:79], a[232:235], v[168:171], v[64:79]
ds_read_b128 a[228:231], v3 offset:17408
v_mul_f32 v52, v112, v112
v_mul_f32 v53, v113, v113
v_mul_f32 v54, v114, v114
v_mul_f32 v55, v115, v115
v_fma_f32 v52, v52, v39, v38
v_mfma_f32_32x32x16_bf16 v[64:79], a[236:239], v[172:175], v[64:79]
ds_read_b128 a[232:235], v3 offset:18432
v_fma_f32 v53, v53, v39, v38
v_fma_f32 v54, v54, v39, v38
v_fma_f32 v55, v55, v39, v38
v_mul_f32 v52, v52, v112
v_mul_f32 v53, v53, v113
s_waitcnt lgkmcnt(3)
v_mfma_f32_32x32x16_bf16 v[64:79], a[240:243], v[176:179], v[64:79]
ds_read_b128 a[236:239], v3 offset:19456
v_mul_f32 v54, v54, v114
v_mul_f32 v55, v55, v115
v_exp_f32 v52, v52
v_mfma_f32_32x32x16_bf16 v[64:79], a[244:247], v[180:183], v[64:79]
ds_read_b128 a[240:243], v3 offset:20480
v_mul_f32 v112, v112, v120
v_exp_f32 v53, v53
v_mul_f32 v113, v113, v121
v_mfma_f32_32x32x16_bf16 v[64:79], a[248:251], v[184:187], v[64:79]
ds_read_b128 a[244:247], v3 offset:21504
v_exp_f32 v54, v54
v_mul_f32 v114, v114, v122
v_exp_f32 v55, v55
v_mfma_f32_32x32x16_bf16 v[64:79], a[252:255], v[188:191], v[64:79]
ds_read_b128 a[248:251], v3 offset:22528
v_mul_f32 v115, v115, v123
v_fma_f32 v52, v52, v50, v50
v_fma_f32 v53, v53, v50, v50
v_fma_f32 v54, v54, v50, v50
v_fma_f32 v55, v55, v50, v50
s_waitcnt lgkmcnt(3)
v_mfma_f32_32x32x16_bf16 v[64:79], a[224:227], v[192:195], v[64:79]
ds_read_b128 a[252:255], v3 offset:23552
v_rcp_f32 v52, v52
v_rcp_f32 v53, v53
v_mfma_f32_32x32x16_bf16 v[64:79], a[228:231], v[196:199], v[64:79]
ds_read_b128 a[224:227], v3 offset:24576
v_rcp_f32 v54, v54
v_rcp_f32 v55, v55
v_mul_f32 v112, v112, v52
v_mfma_f32_32x32x16_bf16 v[64:79], a[232:235], v[200:203], v[64:79]
ds_read_b128 a[228:231], v3 offset:25600
v_mul_f32 v113, v113, v53
v_mul_f32 v114, v114, v54
v_mul_f32 v115, v115, v55
v_cvt_pk_bf16_f32 v46, v112, v113
v_cvt_pk_bf16_f32 v47, v114, v115
v_mfma_f32_32x32x16_bf16 v[64:79], a[236:239], v[204:207], v[64:79]
ds_read_b128 a[232:235], v3 offset:26624
v_mul_f32 v52, v116, v116
v_mul_f32 v53, v117, v117
v_mul_f32 v54, v118, v118
v_mul_f32 v55, v119, v119
v_fma_f32 v52, v52, v39, v38
s_waitcnt lgkmcnt(3)
v_mfma_f32_32x32x16_bf16 v[64:79], a[240:243], v[208:211], v[64:79]
ds_read_b128 a[236:239], v3 offset:27648
v_fma_f32 v53, v53, v39, v38
v_fma_f32 v54, v54, v39, v38
v_fma_f32 v55, v55, v39, v38
v_mul_f32 v52, v52, v116
v_mfma_f32_32x32x16_bf16 v[64:79], a[244:247], v[212:215], v[64:79]
ds_read_b128 a[240:243], v3 offset:28672
v_mul_f32 v53, v53, v117
v_mul_f32 v54, v54, v118
v_mul_f32 v55, v55, v119
v_exp_f32 v52, v52
v_mfma_f32_32x32x16_bf16 v[64:79], a[248:251], v[216:219], v[64:79]
s_waitcnt vmcnt(10)
s_barrier
ds_read_b128 a[244:247], v3 offset:29696
v_mul_f32 v116, v116, v124
v_exp_f32 v53, v53
v_mfma_f32_32x32x16_bf16 v[64:79], a[252:255], v[220:223], v[64:79]
ds_read_b128 a[248:251], v3 offset:30720
v_mul_f32 v117, v117, v125
v_exp_f32 v54, v54
v_mul_f32 v118, v118, v126
s_waitcnt lgkmcnt(3)
v_mfma_f32_32x32x16_bf16 v[64:79], a[224:227], v[224:227], v[64:79]
ds_read_b128 a[252:255], v3 offset:31744
v_exp_f32 v55, v55
v_mul_f32 v119, v119, v127
v_fma_f32 v52, v52, v50, v50
v_mfma_f32_32x32x16_bf16 v[64:79], a[228:231], v[228:231], v[64:79]
ds_read_b128 a[224:227], v2 offset:32768
v_fma_f32 v53, v53, v50, v50
v_fma_f32 v54, v54, v50, v50
v_fma_f32 v55, v55, v50, v50
v_rcp_f32 v52, v52
v_mfma_f32_32x32x16_bf16 v[64:79], a[232:235], v[232:235], v[64:79]
ds_read_b128 a[228:231], v2 offset:33792
v_rcp_f32 v53, v53
v_rcp_f32 v54, v54
v_mfma_f32_32x32x16_bf16 v[64:79], a[236:239], v[236:239], v[64:79]
ds_read_b128 a[232:235], v2 offset:34816
v_rcp_f32 v55, v55
v_mul_f32 v116, v116, v52
v_mul_f32 v117, v117, v53
v_mul_f32 v118, v118, v54
s_waitcnt lgkmcnt(3)
v_mfma_f32_32x32x16_bf16 v[64:79], a[240:243], v[240:243], v[64:79]
ds_read_b128 a[236:239], v2 offset:35840
v_mul_f32 v119, v119, v55
v_cvt_pk_bf16_f32 v48, v116, v117
v_cvt_pk_bf16_f32 v49, v118, v119
s_add_u32 s37, s36, 6144
buffer_store_dwordx4 v[46:49], v40, s[4:7], s37 offen sc1
v_mfma_f32_32x32x16_bf16 v[64:79], a[244:247], v[244:247], v[64:79]
ds_read_b128 a[240:243], v2 offset:36864
v_mfma_f32_32x32x16_bf16 v[64:79], a[248:251], v[248:251], v[64:79]
ds_read_b128 a[244:247], v2 offset:37888
v_mfma_f32_32x32x16_bf16 v[64:79], a[252:255], v[252:255], v[64:79]
ds_read_b128 a[248:251], v2 offset:38912
v_mfma_f32_32x32x16_bf16 v[80:95], v[26:29], v[32:35], 0
s_waitcnt lgkmcnt(3)
v_mfma_f32_32x32x16_bf16 v[80:95], a[224:227], v[128:131], v[80:95]
ds_read_b128 a[252:255], v2 offset:39936
v_mfma_f32_32x32x16_bf16 v[80:95], a[228:231], v[132:135], v[80:95]
ds_read_b128 a[224:227], v2 offset:40960
v_mfma_f32_32x32x16_bf16 v[80:95], a[232:235], v[136:139], v[80:95]
ds_read_b128 a[228:231], v2 offset:41984
s_nop 2
v_mul_f32 v52, v64, v64
v_mul_f32 v53, v65, v65
v_mul_f32 v54, v66, v66
v_mul_f32 v55, v67, v67
v_fma_f32 v52, v52, v39, v38
v_mfma_f32_32x32x16_bf16 v[80:95], a[236:239], v[140:143], v[80:95]
ds_read_b128 a[232:235], v2 offset:43008
v_fma_f32 v53, v53, v39, v38
v_fma_f32 v54, v54, v39, v38
v_fma_f32 v55, v55, v39, v38
v_mul_f32 v52, v52, v64
v_mul_f32 v53, v53, v65
s_waitcnt lgkmcnt(3)
v_mfma_f32_32x32x16_bf16 v[80:95], a[240:243], v[144:147], v[80:95]
ds_read_b128 a[236:239], v2 offset:44032
v_mul_f32 v54, v54, v66
v_mul_f32 v55, v55, v67
v_exp_f32 v52, v52
v_mfma_f32_32x32x16_bf16 v[80:95], a[244:247], v[148:151], v[80:95]
ds_read_b128 a[240:243], v2 offset:45056
v_mul_f32 v64, v64, v72
v_exp_f32 v53, v53
v_mul_f32 v65, v65, v73
v_mfma_f32_32x32x16_bf16 v[80:95], a[248:251], v[152:155], v[80:95]
ds_read_b128 a[244:247], v2 offset:46080
v_exp_f32 v54, v54
v_mul_f32 v66, v66, v74
v_exp_f32 v55, v55
v_mfma_f32_32x32x16_bf16 v[80:95], a[252:255], v[156:159], v[80:95]
ds_read_b128 a[248:251], v2 offset:47104
v_mul_f32 v67, v67, v75
v_fma_f32 v52, v52, v50, v50
v_fma_f32 v53, v53, v50, v50
v_fma_f32 v54, v54, v50, v50
v_fma_f32 v55, v55, v50, v50
s_waitcnt lgkmcnt(3)
v_mfma_f32_32x32x16_bf16 v[80:95], a[224:227], v[160:163], v[80:95]
ds_read_b128 a[252:255], v2 offset:48128
v_rcp_f32 v52, v52
v_rcp_f32 v53, v53
v_mfma_f32_32x32x16_bf16 v[80:95], a[228:231], v[164:167], v[80:95]
ds_read_b128 a[224:227], v2 offset:49152
v_mov_b32 v4, 11
s_waitcnt vmcnt(0)
s_mov_b64 exec, 1
buffer_store_dword v4, off, s[4:7], s78 sc1
s_mov_b64 exec, -1
v_mfma_f32_32x32x16_bf16 v[80:95], a[232:235], v[168:171], v[80:95]
ds_read_b128 a[228:231], v2 offset:50176
v_rcp_f32 v54, v54
v_rcp_f32 v55, v55
v_mul_f32 v64, v64, v52
v_mfma_f32_32x32x16_bf16 v[80:95], a[236:239], v[172:175], v[80:95]
ds_read_b128 a[232:235], v2 offset:51200
v_mul_f32 v65, v65, v53
v_mul_f32 v66, v66, v54
v_mul_f32 v67, v67, v55
v_cvt_pk_bf16_f32 v42, v64, v65
v_cvt_pk_bf16_f32 v43, v66, v67
s_waitcnt lgkmcnt(3)
v_mfma_f32_32x32x16_bf16 v[80:95], a[240:243], v[176:179], v[80:95]
ds_read_b128 a[236:239], v2 offset:52224
v_mul_f32 v52, v68, v68
v_mul_f32 v53, v69, v69
v_mul_f32 v54, v70, v70
v_mul_f32 v55, v71, v71
v_mfma_f32_32x32x16_bf16 v[80:95], a[244:247], v[180:183], v[80:95]
ds_read_b128 a[240:243], v2 offset:53248
v_fma_f32 v52, v52, v39, v38
v_fma_f32 v53, v53, v39, v38
v_fma_f32 v54, v54, v39, v38
v_fma_f32 v55, v55, v39, v38
v_mul_f32 v52, v52, v68
v_mfma_f32_32x32x16_bf16 v[80:95], a[248:251], v[184:187], v[80:95]
ds_read_b128 a[244:247], v2 offset:54272
v_mul_f32 v53, v53, v69
v_mul_f32 v54, v54, v70
v_mul_f32 v55, v55, v71
v_exp_f32 v52, v52
v_mfma_f32_32x32x16_bf16 v[80:95], a[252:255], v[188:191], v[80:95]
ds_read_b128 a[248:251], v2 offset:55296
v_mul_f32 v68, v68, v76
v_exp_f32 v53, v53
v_mul_f32 v69, v69, v77
s_waitcnt lgkmcnt(3)
v_mfma_f32_32x32x16_bf16 v[80:95], a[224:227], v[192:195], v[80:95]
ds_read_b128 a[252:255], v2 offset:56320
v_exp_f32 v54, v54
v_mul_f32 v70, v70, v78
v_mfma_f32_32x32x16_bf16 v[80:95], a[228:231], v[196:199], v[80:95]
ds_read_b128 a[224:227], v2 offset:57344
v_exp_f32 v55, v55
v_mul_f32 v71, v71, v79
v_fma_f32 v52, v52, v50, v50
v_fma_f32 v53, v53, v50, v50
v_mfma_f32_32x32x16_bf16 v[80:95], a[232:235], v[200:203], v[80:95]
ds_read_b128 a[228:231], v2 offset:58368
v_fma_f32 v54, v54, v50, v50
v_fma_f32 v55, v55, v50, v50
v_rcp_f32 v52, v52
v_mfma_f32_32x32x16_bf16 v[80:95], a[236:239], v[204:207], v[80:95]
ds_read_b128 a[232:235], v2 offset:59392
v_rcp_f32 v53, v53
v_rcp_f32 v54, v54
s_waitcnt lgkmcnt(3)
v_mfma_f32_32x32x16_bf16 v[80:95], a[240:243], v[208:211], v[80:95]
ds_read_b128 a[236:239], v2 offset:60416
v_rcp_f32 v55, v55
v_mul_f32 v68, v68, v52
v_mul_f32 v69, v69, v53
v_mfma_f32_32x32x16_bf16 v[80:95], a[244:247], v[212:215], v[80:95]
ds_read_b128 a[240:243], v2 offset:61440
buffer_load_dword v63, v62, s[4:7], s79 offen sc1
v_mul_f32 v70, v70, v54
v_mul_f32 v71, v71, v55
v_cvt_pk_bf16_f32 v44, v68, v69
v_cvt_pk_bf16_f32 v45, v70, v71
v_mfma_f32_32x32x16_bf16 v[80:95], a[248:251], v[216:219], v[80:95]
s_barrier
ds_read_b128 a[244:247], v2 offset:62464
s_add_u32 s37, s36, 4096
buffer_store_dwordx4 v[42:45], v40, s[4:7], s37 offen sc1
v_mfma_f32_32x32x16_bf16 v[80:95], a[252:255], v[220:223], v[80:95]
ds_read_b128 a[248:251], v2 offset:63488
s_waitcnt lgkmcnt(3)
v_mfma_f32_32x32x16_bf16 v[80:95], a[224:227], v[224:227], v[80:95]
ds_read_b128 a[252:255], v2 offset:64512
v_mfma_f32_32x32x16_bf16 v[80:95], a[228:231], v[228:231], v[80:95]
ds_read_b128 a[224:227], v2 offset:0
v_mfma_f32_32x32x16_bf16 v[80:95], a[232:235], v[232:235], v[80:95]
ds_read_b128 a[228:231], v2 offset:1024
v_mfma_f32_32x32x16_bf16 v[80:95], a[236:239], v[236:239], v[80:95]
ds_read_b128 a[232:235], v2 offset:2048
s_waitcnt lgkmcnt(3)
v_mfma_f32_32x32x16_bf16 v[80:95], a[240:243], v[240:243], v[80:95]
ds_read_b128 a[236:239], v2 offset:3072
v_mfma_f32_32x32x16_bf16 v[80:95], a[244:247], v[244:247], v[80:95]
ds_read_b128 a[240:243], v2 offset:4096
v_mfma_f32_32x32x16_bf16 v[80:95], a[248:251], v[248:251], v[80:95]
ds_read_b128 a[244:247], v2 offset:5120
v_mfma_f32_32x32x16_bf16 v[80:95], a[252:255], v[252:255], v[80:95]
ds_read_b128 a[248:251], v2 offset:6144
s_waitcnt vmcnt(1)
v_cmp_gt_u32 vcc, 11, v63
s_nop 0
s_cbranch_vccnz L_poll_91
L_polled_92:
v_mfma_f32_32x32x16_bf16 v[96:111], v[22:25], v[34:37], 0
s_waitcnt lgkmcnt(3)
v_mfma_f32_32x32x16_bf16 v[96:111], a[224:227], v[128:131], v[96:111]
ds_read_b128 a[252:255], v2 offset:7168
v_mfma_f32_32x32x16_bf16 v[96:111], a[228:231], v[132:135], v[96:111]
ds_read_b128 a[224:227], v2 offset:8192
s_add_u32 s23, s87, 32512000
buffer_load_dwordx4 v[128:131], v1, s[4:7], s23 offen offset:0 sc1
v_mfma_f32_32x32x16_bf16 v[96:111], a[232:235], v[136:139], v[96:111]
ds_read_b128 a[228:231], v2 offset:9216
buffer_load_dwordx4 v[132:135], v1, s[4:7], s23 offen offset:1024 sc1
v_mul_f32 v52, v80, v80
v_mul_f32 v53, v81, v81
v_mul_f32 v54, v82, v82
v_mul_f32 v55, v83, v83
v_mfma_f32_32x32x16_bf16 v[96:111], a[236:239], v[140:143], v[96:111]
ds_read_b128 a[232:235], v2 offset:10240
buffer_load_dwordx4 v[136:139], v1, s[4:7], s23 offen offset:2048 sc1
v_fma_f32 v52, v52, v39, v38
v_fma_f32 v53, v53, v39, v38
v_fma_f32 v54, v54, v39, v38
v_fma_f32 v55, v55, v39, v38
s_waitcnt lgkmcnt(3)
v_mfma_f32_32x32x16_bf16 v[96:111], a[240:243], v[144:147], v[96:111]
ds_read_b128 a[236:239], v2 offset:11264
buffer_load_dwordx4 v[140:143], v1, s[4:7], s23 offen offset:3072 sc1
v_mul_f32 v52, v52, v80
v_mul_f32 v53, v53, v81
v_mul_f32 v54, v54, v82
v_mfma_f32_32x32x16_bf16 v[96:111], a[244:247], v[148:151], v[96:111]
ds_read_b128 a[240:243], v2 offset:12288
v_mul_f32 v55, v55, v83
v_exp_f32 v52, v52
v_mul_f32 v80, v80, v88
v_mfma_f32_32x32x16_bf16 v[96:111], a[248:251], v[152:155], v[96:111]
ds_read_b128 a[244:247], v2 offset:13312
s_add_u32 s23, s87, 32516096
buffer_load_dwordx4 v[144:147], v1, s[4:7], s23 offen offset:0 sc1
v_exp_f32 v53, v53
v_mul_f32 v81, v81, v89
v_mfma_f32_32x32x16_bf16 v[96:111], a[252:255], v[156:159], v[96:111]
ds_read_b128 a[248:251], v2 offset:14336
v_exp_f32 v54, v54
v_mul_f32 v82, v82, v90
v_exp_f32 v55, v55
s_waitcnt lgkmcnt(3)
v_mfma_f32_32x32x16_bf16 v[96:111], a[224:227], v[160:163], v[96:111]
ds_read_b128 a[252:255], v2 offset:15360
buffer_load_dwordx4 v[148:151], v1, s[4:7], s23 offen offset:1024 sc1
v_mul_f32 v83, v83, v91
v_fma_f32 v52, v52, v50, v50
v_fma_f32 v53, v53, v50, v50
v_mfma_f32_32x32x16_bf16 v[96:111], a[228:231], v[164:167], v[96:111]
ds_read_b128 a[224:227], v2 offset:16384
v_fma_f32 v54, v54, v50, v50
v_fma_f32 v55, v55, v50, v50
v_rcp_f32 v52, v52
v_mfma_f32_32x32x16_bf16 v[96:111], a[232:235], v[168:171], v[96:111]
ds_read_b128 a[228:231], v2 offset:17408
buffer_load_dwordx4 v[152:155], v1, s[4:7], s23 offen offset:2048 sc1
v_rcp_f32 v53, v53
v_rcp_f32 v54, v54
v_mfma_f32_32x32x16_bf16 v[96:111], a[236:239], v[172:175], v[96:111]
ds_read_b128 a[232:235], v2 offset:18432
v_rcp_f32 v55, v55
v_mul_f32 v80, v80, v52
v_mul_f32 v81, v81, v53
v_mul_f32 v82, v82, v54
s_waitcnt lgkmcnt(3)
v_mfma_f32_32x32x16_bf16 v[96:111], a[240:243], v[176:179], v[96:111]
ds_read_b128 a[236:239], v2 offset:19456
buffer_load_dwordx4 v[156:159], v1, s[4:7], s23 offen offset:3072 sc1
v_mul_f32 v83, v83, v55
v_cvt_pk_bf16_f32 v46, v80, v81
v_cvt_pk_bf16_f32 v47, v82, v83
v_mfma_f32_32x32x16_bf16 v[96:111], a[244:247], v[180:183], v[96:111]
ds_read_b128 a[240:243], v2 offset:20480
v_mul_f32 v52, v84, v84
v_mul_f32 v53, v85, v85
v_mul_f32 v54, v86, v86
v_mul_f32 v55, v87, v87
v_fma_f32 v52, v52, v39, v38
v_mfma_f32_32x32x16_bf16 v[96:111], a[248:251], v[184:187], v[96:111]
ds_read_b128 a[244:247], v2 offset:21504
s_add_u32 s23, s87, 32526336
buffer_load_dwordx4 v[160:163], v1, s[4:7], s23 offen offset:0 sc1
v_fma_f32 v53, v53, v39, v38
v_fma_f32 v54, v54, v39, v38
v_fma_f32 v55, v55, v39, v38
v_mfma_f32_32x32x16_bf16 v[96:111], a[252:255], v[188:191], v[96:111]
ds_read_b128 a[248:251], v2 offset:22528
v_mul_f32 v52, v52, v84
v_mul_f32 v53, v53, v85
v_mul_f32 v54, v54, v86
v_mul_f32 v55, v55, v87
s_waitcnt lgkmcnt(3)
v_mfma_f32_32x32x16_bf16 v[96:111], a[224:227], v[192:195], v[96:111]
ds_read_b128 a[252:255], v2 offset:23552
buffer_load_dwordx4 v[164:167], v1, s[4:7], s23 offen offset:1024 sc1
v_exp_f32 v52, v52
v_mul_f32 v84, v84, v92
v_mfma_f32_32x32x16_bf16 v[96:111], a[228:231], v[196:199], v[96:111]
ds_read_b128 a[224:227], v2 offset:24576
v_exp_f32 v53, v53
v_mul_f32 v85, v85, v93
v_exp_f32 v54, v54
v_mfma_f32_32x32x16_bf16 v[96:111], a[232:235], v[200:203], v[96:111]
ds_read_b128 a[228:231], v2 offset:25600
buffer_load_dwordx4 v[168:171], v1, s[4:7], s23 offen offset:2048 sc1
v_mul_f32 v86, v86, v94
v_exp_f32 v55, v55
v_mul_f32 v87, v87, v95
v_mfma_f32_32x32x16_bf16 v[96:111], a[236:239], v[204:207], v[96:111]
ds_read_b128 a[232:235], v2 offset:26624
v_fma_f32 v52, v52, v50, v50
v_fma_f32 v53, v53, v50, v50
v_fma_f32 v54, v54, v50, v50
v_fma_f32 v55, v55, v50, v50
s_waitcnt lgkmcnt(3)
v_mfma_f32_32x32x16_bf16 v[96:111], a[240:243], v[208:211], v[96:111]
ds_read_b128 a[236:239], v2 offset:27648
buffer_load_dwordx4 v[172:175], v1, s[4:7], s23 offen offset:3072 sc1
v_rcp_f32 v52, v52
v_mfma_f32_32x32x16_bf16 v[96:111], a[244:247], v[212:215], v[96:111]
ds_read_b128 a[240:243], v2 offset:28672
v_rcp_f32 v53, v53
v_rcp_f32 v54, v54
v_mfma_f32_32x32x16_bf16 v[96:111], a[248:251], v[216:219], v[96:111]
ds_read_b128 a[244:247], v2 offset:29696
s_add_u32 s23, s87, 32530432
buffer_load_dwordx4 v[176:179], v1, s[4:7], s23 offen offset:0 sc1
v_rcp_f32 v55, v55
v_mul_f32 v84, v84, v52
v_mfma_f32_32x32x16_bf16 v[96:111], a[252:255], v[220:223], v[96:111]
ds_read_b128 a[248:251], v2 offset:30720
v_mul_f32 v85, v85, v53
v_mul_f32 v86, v86, v54
v_mul_f32 v87, v87, v55
v_cvt_pk_bf16_f32 v48, v84, v85
v_cvt_pk_bf16_f32 v49, v86, v87
s_waitcnt lgkmcnt(3)
v_mfma_f32_32x32x16_bf16 v[96:111], a[224:227], v[224:227], v[96:111]
ds_read_b128 a[252:255], v2 offset:31744
buffer_load_dwordx4 v[180:183], v1, s[4:7], s23 offen offset:1024 sc1
buffer_store_dwordx4 v[46:49], v40, s[4:7], s28 offen offset:0 sc1
v_mfma_f32_32x32x16_bf16 v[96:111], a[228:231], v[228:231], v[96:111]
v_mfma_f32_32x32x16_bf16 v[96:111], a[232:235], v[232:235], v[96:111]
buffer_load_dwordx4 v[184:187], v1, s[4:7], s23 offen offset:2048 sc1
v_mfma_f32_32x32x16_bf16 v[96:111], a[236:239], v[236:239], v[96:111]
s_waitcnt lgkmcnt(0)
v_mfma_f32_32x32x16_bf16 v[96:111], a[240:243], v[240:243], v[96:111]
buffer_load_dwordx4 v[188:191], v1, s[4:7], s23 offen offset:3072 sc1
v_mfma_f32_32x32x16_bf16 v[96:111], a[244:247], v[244:247], v[96:111]
v_mfma_f32_32x32x16_bf16 v[96:111], a[248:251], v[248:251], v[96:111]
s_add_u32 s23, s87, 32626688
buffer_load_dwordx4 v[192:195], v1, s[4:7], s23 offen offset:0 sc1
v_mfma_f32_32x32x16_bf16 v[96:111], a[252:255], v[252:255], v[96:111]
ds_bpermute_b32 v6, v60, v6
ds_bpermute_b32 v7, v60, v7
ds_bpermute_b32 v8, v60, v8
ds_bpermute_b32 v9, v60, v9
ds_bpermute_b32 v10, v60, v10
ds_bpermute_b32 v11, v60, v11
ds_bpermute_b32 v12, v60, v12
ds_bpermute_b32 v13, v60, v13
s_waitcnt vmcnt(17)
v_mfma_f32_16x16x32_bf16 v[64:67], a[48:51], v[128:131], 0
buffer_load_dwordx4 v[196:199], v1, s[4:7], s23 offen offset:1024 sc1
v_mfma_f32_16x16x32_bf16 v[68:71], a[52:55], v[128:131], 0
v_mfma_f32_16x16x32_bf16 v[72:75], a[56:59], v[128:131], 0
v_mfma_f32_16x16x32_bf16 v[76:79], a[60:63], v[128:131], 0
s_waitcnt vmcnt(17)
v_mfma_f32_16x16x32_bf16 v[92:95], a[60:63], v[132:135], 0
buffer_load_dwordx4 v[200:203], v1, s[4:7], s23 offen offset:2048 sc1
v_mul_f32 v52, v96, v96
v_mul_f32 v53, v97, v97
v_mul_f32 v54, v98, v98
v_mfma_f32_16x16x32_bf16 v[88:91], a[56:59], v[132:135], 0
v_mul_f32 v55, v99, v99
v_fma_f32 v52, v52, v39, v38
v_fma_f32 v53, v53, v39, v38
v_fma_f32 v54, v54, v39, v38
v_mfma_f32_16x16x32_bf16 v[84:87], a[52:55], v[132:135], 0
v_fma_f32 v55, v55, v39, v38
v_mul_f32 v52, v52, v96
v_mul_f32 v53, v53, v97
v_mul_f32 v54, v54, v98
v_mfma_f32_16x16x32_bf16 v[80:83], a[48:51], v[132:135], 0
v_mul_f32 v55, v55, v99
v_exp_f32 v52, v52
v_mul_f32 v96, v96, v104
s_waitcnt vmcnt(17)
v_mfma_f32_16x16x32_bf16 v[64:67], a[64:67], v[136:139], v[64:67]
buffer_load_dwordx4 v[204:207], v1, s[4:7], s23 offen offset:3072 sc1
v_exp_f32 v53, v53
v_mul_f32 v97, v97, v105
v_mfma_f32_16x16x32_bf16 v[68:71], a[68:71], v[136:139], v[68:71]
v_exp_f32 v54, v54
v_mul_f32 v98, v98, v106
v_mfma_f32_16x16x32_bf16 v[72:75], a[72:75], v[136:139], v[72:75]
v_exp_f32 v55, v55
v_mul_f32 v99, v99, v107
v_fma_f32 v52, v52, v50, v50
v_mfma_f32_16x16x32_bf16 v[76:79], a[76:79], v[136:139], v[76:79]
v_fma_f32 v53, v53, v50, v50
v_fma_f32 v54, v54, v50, v50
v_fma_f32 v55, v55, v50, v50
s_waitcnt vmcnt(17)
v_mfma_f32_16x16x32_bf16 v[92:95], a[76:79], v[140:143], v[92:95]
s_add_u32 s23, s87, 32630784
buffer_load_dwordx4 v[208:211], v1, s[4:7], s23 offen offset:0 sc1
v_rcp_f32 v52, v52
v_mfma_f32_16x16x32_bf16 v[88:91], a[72:75], v[140:143], v[88:91]
v_rcp_f32 v53, v53
v_rcp_f32 v54, v54
v_mfma_f32_16x16x32_bf16 v[84:87], a[68:71], v[140:143], v[84:87]
v_rcp_f32 v55, v55
v_mul_f32 v96, v96, v52
v_mul_f32 v97, v97, v53
v_mfma_f32_16x16x32_bf16 v[80:83], a[64:67], v[140:143], v[80:83]
v_mul_f32 v98, v98, v54
v_mul_f32 v99, v99, v55
v_cvt_pk_bf16_f32 v42, v96, v97
v_cvt_pk_bf16_f32 v43, v98, v99
v_mov_b32 v4, 12
s_waitcnt vmcnt(7)
s_mov_b64 exec, 1
buffer_store_dword v4, off, s[4:7], s78 sc1
s_mov_b64 exec, -1
v_mfma_f32_16x16x32_bf16 v[64:67], a[80:83], v[144:147], v[64:67]
buffer_load_dwordx4 v[212:215], v1, s[4:7], s23 offen offset:1024 sc1
v_mul_f32 v52, v100, v100
v_mul_f32 v53, v101, v101
v_mul_f32 v54, v102, v102
v_mfma_f32_16x16x32_bf16 v[68:71], a[84:87], v[144:147], v[68:71]
v_mul_f32 v55, v103, v103
v_fma_f32 v52, v52, v39, v38
v_fma_f32 v53, v53, v39, v38
v_fma_f32 v54, v54, v39, v38
v_mfma_f32_16x16x32_bf16 v[72:75], a[88:91], v[144:147], v[72:75]
v_fma_f32 v55, v55, v39, v38
v_mul_f32 v52, v52, v100
v_mul_f32 v53, v53, v101
v_mul_f32 v54, v54, v102
v_mfma_f32_16x16x32_bf16 v[76:79], a[92:95], v[144:147], v[76:79]
v_mul_f32 v55, v55, v103
v_exp_f32 v52, v52
v_mul_f32 v100, v100, v108
v_mfma_f32_16x16x32_bf16 v[92:95], a[92:95], v[148:151], v[92:95]
buffer_load_dwordx4 v[216:219], v1, s[4:7], s23 offen offset:2048 sc1
v_exp_f32 v53, v53
v_mul_f32 v101, v101, v109
v_mfma_f32_16x16x32_bf16 v[88:91], a[88:91], v[148:151], v[88:91]
v_exp_f32 v54, v54
v_mul_f32 v102, v102, v110
v_mfma_f32_16x16x32_bf16 v[84:87], a[84:87], v[148:151], v[84:87]
v_exp_f32 v55, v55
v_mul_f32 v103, v103, v111
v_fma_f32 v52, v52, v50, v50
v_mfma_f32_16x16x32_bf16 v[80:83], a[80:83], v[148:151], v[80:83]
v_fma_f32 v53, v53, v50, v50
v_fma_f32 v54, v54, v50, v50
v_fma_f32 v55, v55, v50, v50
v_mfma_f32_16x16x32_bf16 v[64:67], a[96:99], v[152:155], v[64:67]
buffer_load_dwordx4 v[220:223], v1, s[4:7], s23 offen offset:3072 sc1
v_rcp_f32 v52, v52
v_mfma_f32_16x16x32_bf16 v[68:71], a[100:103], v[152:155], v[68:71]
v_rcp_f32 v53, v53
v_rcp_f32 v54, v54
v_mfma_f32_16x16x32_bf16 v[72:75], a[104:107], v[152:155], v[72:75]
v_rcp_f32 v55, v55
v_mul_f32 v100, v100, v52
v_mul_f32 v101, v101, v53
v_mfma_f32_16x16x32_bf16 v[76:79], a[108:111], v[152:155], v[76:79]
v_mul_f32 v102, v102, v54
v_mul_f32 v103, v103, v55
v_cvt_pk_bf16_f32 v44, v100, v101
v_cvt_pk_bf16_f32 v45, v102, v103
v_mfma_f32_16x16x32_bf16 v[92:95], a[108:111], v[156:159], v[92:95]
s_add_u32 s23, s87, 32641024
buffer_load_dwordx4 v[224:227], v1, s[4:7], s23 offen offset:0 sc1
buffer_store_dwordx4 v[42:45], v40, s[4:7], s28 offen offset:2048 sc1
s_waitcnt lgkmcnt(0)
v_mfma_f32_16x16x32_bf16 v[88:91], a[104:107], v[156:159], v[88:91]
s_mov_b32 s36, s88
v_permlane16_swap_b32 v6, v8
v_mfma_f32_16x16x32_bf16 v[84:87], a[100:103], v[156:159], v[84:87]
v_permlane16_swap_b32 v7, v9
v_permlane16_swap_b32 v10, v12
v_mfma_f32_16x16x32_bf16 v[80:83], a[96:99], v[156:159], v[80:83]
v_permlane16_swap_b32 v11, v13
s_add_u32 s15, s36, 32768
v_mfma_f32_16x16x32_bf16 v[64:67], a[160:163], v[160:163], v[64:67]
buffer_load_dwordx4 v[228:231], v1, s[4:7], s23 offen offset:1024 sc1
v_lshlrev_b32 v40, 16, v6
v_mfma_f32_16x16x32_bf16 v[68:71], a[164:167], v[160:163], v[68:71]
v_and_b32 v41, 0xffff0000, v6
v_lshlrev_b32 v42, 16, v7
v_mfma_f32_16x16x32_bf16 v[72:75], a[168:171], v[160:163], v[72:75]
v_and_b32 v43, 0xffff0000, v7
v_lshlrev_b32 v44, 16, v8
v_mfma_f32_16x16x32_bf16 v[76:79], a[172:175], v[160:163], v[76:79]
v_and_b32 v45, 0xffff0000, v8
v_lshlrev_b32 v46, 16, v9
buffer_load_dword v63, v62, s[4:7], s79 offen sc1
v_mfma_f32_16x16x32_bf16 v[92:95], a[172:175], v[164:167], v[92:95]
buffer_load_dwordx4 v[232:235], v1, s[4:7], s23 offen offset:2048 sc1
v_and_b32 v47, 0xffff0000, v9
v_mfma_f32_16x16x32_bf16 v[88:91], a[168:171], v[164:167], v[88:91]
v_lshlrev_b32 v48, 16, v10
v_and_b32 v49, 0xffff0000, v10
v_mfma_f32_16x16x32_bf16 v[84:87], a[164:167], v[164:167], v[84:87]
v_lshlrev_b32 v50, 16, v11
v_and_b32 v51, 0xffff0000, v11
v_mfma_f32_16x16x32_bf16 v[80:83], a[160:163], v[164:167], v[80:83]
v_lshlrev_b32 v52, 16, v12
v_and_b32 v53, 0xffff0000, v12
v_mfma_f32_16x16x32_bf16 v[64:67], a[176:179], v[168:171], v[64:67]
buffer_load_dwordx4 v[236:239], v1, s[4:7], s23 offen offset:3072 sc1
v_lshlrev_b32 v54, 16, v13
v_mfma_f32_16x16x32_bf16 v[68:71], a[180:183], v[168:171], v[68:71]
v_and_b32 v55, 0xffff0000, v13
v_and_b32 v38, 1, v0
v_mfma_f32_16x16x32_bf16 v[72:75], a[184:187], v[168:171], v[72:75]
v_lshlrev_b32 v38, 4, v38
v_mov_b32 v39, 0x3f80
v_mfma_f32_16x16x32_bf16 v[76:79], a[188:191], v[168:171], v[76:79]
v_lshlrev_b32 v38, v38, v39
v_bfe_u32 v39, v0, 1, 3
v_mfma_f32_16x16x32_bf16 v[92:95], a[188:191], v[172:175], v[92:95]
s_add_u32 s23, s87, 32645120
buffer_load_dwordx4 v[240:243], v1, s[4:7], s23 offen offset:0 sc1
v_mfma_f32_16x16x32_bf16 v[88:91], a[184:187], v[172:175], v[88:91]
v_cmp_eq_u32 s[96:97], 0, v39
v_cmp_eq_u32 s[26:27], 1, v39
v_mfma_f32_16x16x32_bf16 v[84:87], a[180:183], v[172:175], v[84:87]
v_cndmask_b32 v60, 0, v38, s[96:97]
v_cndmask_b32 v61, 0, v38, s[26:27]
v_mfma_f32_16x16x32_bf16 v[80:83], a[176:179], v[172:175], v[80:83]
v_cmp_eq_u32 s[96:97], 2, v39
v_cmp_eq_u32 s[26:27], 3, v39
v_mfma_f32_16x16x32_bf16 v[64:67], a[192:195], v[176:179], v[64:67]
buffer_load_dwordx4 v[244:247], v1, s[4:7], s23 offen offset:1024 sc1
v_accvgpr_write_b32 a240, v60
v_mfma_f32_16x16x32_bf16 v[68:71], a[196:199], v[176:179], v[68:71]
v_accvgpr_write_b32 a241, v61
v_cndmask_b32 v60, 0, v38, s[96:97]
v_mfma_f32_16x16x32_bf16 v[72:75], a[200:203], v[176:179], v[72:75]
v_cndmask_b32 v61, 0, v38, s[26:27]
v_cmp_eq_u32 s[96:97], 4, v39
v_mfma_f32_16x16x32_bf16 v[76:79], a[204:207], v[176:179], v[76:79]
v_cmp_eq_u32 s[26:27], 5, v39
v_accvgpr_write_b32 a242, v60
v_mfma_f32_16x16x32_bf16 v[92:95], a[204:207], v[180:183], v[92:95]
buffer_load_dwordx4 v[248:251], v1, s[4:7], s23 offen offset:2048 sc1
v_accvgpr_write_b32 a243, v61
v_mfma_f32_16x16x32_bf16 v[88:91], a[200:203], v[180:183], v[88:91]
v_cndmask_b32 v60, 0, v38, s[96:97]
v_cndmask_b32 v61, 0, v38, s[26:27]
v_mfma_f32_16x16x32_bf16 v[84:87], a[196:199], v[180:183], v[84:87]
v_cmp_eq_u32 s[96:97], 6, v39
v_cmp_eq_u32 s[26:27], 7, v39
v_mfma_f32_16x16x32_bf16 v[80:83], a[192:195], v[180:183], v[80:83]
v_accvgpr_write_b32 a244, v60
v_accvgpr_write_b32 a245, v61
s_waitcnt vmcnt(19)
v_mfma_f32_16x16x32_bf16 v[64:67], a[208:211], v[184:187], v[64:67]
buffer_load_dwordx4 v[252:255], v1, s[4:7], s23 offen offset:3072 sc1
v_cndmask_b32 v60, 0, v38, s[96:97]
v_mfma_f32_16x16x32_bf16 v[68:71], a[212:215], v[184:187], v[68:71]
v_cndmask_b32 v61, 0, v38, s[26:27]
v_accvgpr_write_b32 a246, v60
v_mfma_f32_16x16x32_bf16 v[72:75], a[216:219], v[184:187], v[72:75]
v_accvgpr_write_b32 a247, v61
v_xor_b32 v38, 32, v57
v_mfma_f32_16x16x32_bf16 v[76:79], a[220:223], v[184:187], v[76:79]
v_xor_b32 v39, 64, v57
v_xor_b32 v60, 96, v57
s_waitcnt vmcnt(19)
v_mfma_f32_16x16x32_bf16 v[92:95], a[220:223], v[188:191], v[92:95]
v_mfma_f32_16x16x32_bf16 v[88:91], a[216:219], v[188:191], v[88:91]
v_mfma_f32_16x16x32_bf16 v[84:87], a[212:215], v[188:191], v[84:87]
v_mfma_f32_16x16x32_bf16 v[80:83], a[208:211], v[188:191], v[80:83]
s_waitcnt vmcnt(18)
v_mfma_f32_16x16x32_bf16 v[96:99], a[48:51], v[192:195], 0
v_mfma_f32_16x16x32_bf16 v[100:103], a[52:55], v[192:195], 0
v_mfma_f32_16x16x32_bf16 v[104:107], a[56:59], v[192:195], 0
v_mfma_f32_16x16x32_bf16 v[108:111], a[60:63], v[192:195], 0
s_waitcnt vmcnt(17)
v_mfma_f32_16x16x32_bf16 v[124:127], a[60:63], v[196:199], 0
v_mfma_f32_16x16x32_bf16 v[120:123], a[56:59], v[196:199], 0
v_mfma_f32_16x16x32_bf16 v[116:119], a[52:55], v[196:199], 0
v_mfma_f32_16x16x32_bf16 v[112:115], a[48:51], v[196:199], 0
v_mov_b32 v4, 13
s_waitcnt vmcnt(8)
s_mov_b64 exec, 1
buffer_store_dword v4, off, s[4:7], s78 sc1
s_mov_b64 exec, -1
v_mfma_f32_16x16x32_bf16 v[96:99], a[64:67], v[200:203], v[96:99]
v_mfma_f32_16x16x32_bf16 v[100:103], a[68:71], v[200:203], v[100:103]
v_mfma_f32_16x16x32_bf16 v[104:107], a[72:75], v[200:203], v[104:107]
v_mfma_f32_16x16x32_bf16 v[108:111], a[76:79], v[200:203], v[108:111]
s_waitcnt vmcnt(7)
v_cmp_gt_u32 vcc, 12, v63
s_nop 0
s_cbranch_vccnz L_poll_93
L_polled_94:
v_mfma_f32_16x16x32_bf16 v[124:127], a[76:79], v[204:207], v[124:127]
s_add_u32 s23, s39, 20971520
buffer_load_dwordx4 v[128:131], v1, s[4:7], s23 offen offset:0 sc1
v_mfma_f32_16x16x32_bf16 v[120:123], a[72:75], v[204:207], v[120:123]
v_mfma_f32_16x16x32_bf16 v[116:119], a[68:71], v[204:207], v[116:119]
v_mfma_f32_16x16x32_bf16 v[112:115], a[64:67], v[204:207], v[112:115]
v_mfma_f32_16x16x32_bf16 v[96:99], a[80:83], v[208:211], v[96:99]
buffer_load_dwordx4 v[132:135], v1, s[4:7], s23 offen offset:1024 sc1
v_mfma_f32_16x16x32_bf16 v[100:103], a[84:87], v[208:211], v[100:103]
v_mfma_f32_16x16x32_bf16 v[104:107], a[88:91], v[208:211], v[104:107]
v_mfma_f32_16x16x32_bf16 v[108:111], a[92:95], v[208:211], v[108:111]
v_mfma_f32_16x16x32_bf16 v[124:127], a[92:95], v[212:215], v[124:127]
s_add_u32 s23, s87, 32509952
buffer_load_dwordx4 v[136:139], v1, s[4:7], s23 offen offset:0 sc1
v_mfma_f32_16x16x32_bf16 v[120:123], a[88:91], v[212:215], v[120:123]
v_mfma_f32_16x16x32_bf16 v[116:119], a[84:87], v[212:215], v[116:119]
v_mfma_f32_16x16x32_bf16 v[112:115], a[80:83], v[212:215], v[112:115]
v_mfma_f32_16x16x32_bf16 v[96:99], a[96:99], v[216:219], v[96:99]
buffer_load_dwordx4 v[140:143], v1, s[4:7], s23 offen offset:1024 sc1
v_mfma_f32_16x16x32_bf16 v[100:103], a[100:103], v[216:219], v[100:103]
v_mfma_f32_16x16x32_bf16 v[104:107], a[104:107], v[216:219], v[104:107]
v_mfma_f32_16x16x32_bf16 v[108:111], a[108:111], v[216:219], v[108:111]
buffer_load_dword v63, v62, s[4:7], s79 offen sc1
v_mfma_f32_16x16x32_bf16 v[124:127], a[108:111], v[220:223], v[124:127]
s_add_u32 s23, s39, 20975616
buffer_load_dwordx4 v[144:147], v1, s[4:7], s23 offen offset:0 sc1
v_mfma_f32_16x16x32_bf16 v[120:123], a[104:107], v[220:223], v[120:123]
v_mfma_f32_16x16x32_bf16 v[116:119], a[100:103], v[220:223], v[116:119]
v_mfma_f32_16x16x32_bf16 v[112:115], a[96:99], v[220:223], v[112:115]
v_mfma_f32_16x16x32_bf16 v[96:99], a[160:163], v[224:227], v[96:99]
buffer_load_dwordx4 v[148:151], v1, s[4:7], s23 offen offset:1024 sc1
v_mfma_f32_16x16x32_bf16 v[100:103], a[164:167], v[224:227], v[100:103]
v_mfma_f32_16x16x32_bf16 v[104:107], a[168:171], v[224:227], v[104:107]
v_mfma_f32_16x16x32_bf16 v[108:111], a[172:175], v[224:227], v[108:111]
v_mfma_f32_16x16x32_bf16 v[124:127], a[172:175], v[228:231], v[124:127]
s_add_u32 s23, s87, 32524288
buffer_load_dwordx4 v[152:155], v1, s[4:7], s23 offen offset:0 sc1
v_mfma_f32_16x16x32_bf16 v[120:123], a[168:171], v[228:231], v[120:123]
v_mfma_f32_16x16x32_bf16 v[116:119], a[164:167], v[228:231], v[116:119]
v_mfma_f32_16x16x32_bf16 v[112:115], a[160:163], v[228:231], v[112:115]
s_waitcnt vmcnt(14)
v_mfma_f32_16x16x32_bf16 v[96:99], a[176:179], v[232:235], v[96:99]
buffer_load_dwordx4 v[156:159], v1, s[4:7], s23 offen offset:1024 sc1
v_mfma_f32_16x16x32_bf16 v[100:103], a[180:183], v[232:235], v[100:103]
v_mfma_f32_16x16x32_bf16 v[104:107], a[184:187], v[232:235], v[104:107]
v_mfma_f32_16x16x32_bf16 v[108:111], a[188:191], v[232:235], v[108:111]
s_waitcnt vmcnt(14)
v_mfma_f32_16x16x32_bf16 v[124:127], a[188:191], v[236:239], v[124:127]
v_mfma_f32_16x16x32_bf16 v[120:123], a[184:187], v[236:239], v[120:123]
v_mfma_f32_16x16x32_bf16 v[116:119], a[180:183], v[236:239], v[116:119]
v_mfma_f32_16x16x32_bf16 v[112:115], a[176:179], v[236:239], v[112:115]
s_waitcnt vmcnt(13)
v_mfma_f32_16x16x32_bf16 v[96:99], a[192:195], v[240:243], v[96:99]
v_mfma_f32_16x16x32_bf16 v[100:103], a[196:199], v[240:243], v[100:103]
v_mfma_f32_16x16x32_bf16 v[104:107], a[200:203], v[240:243], v[104:107]
v_mfma_f32_16x16x32_bf16 v[108:111], a[204:207], v[240:243], v[108:111]
s_waitcnt vmcnt(12)
v_mfma_f32_16x16x32_bf16 v[124:127], a[204:207], v[244:247], v[124:127]
v_mfma_f32_16x16x32_bf16 v[120:123], a[200:203], v[244:247], v[120:123]
v_mfma_f32_16x16x32_bf16 v[116:119], a[196:199], v[244:247], v[116:119]
v_mfma_f32_16x16x32_bf16 v[112:115], a[192:195], v[244:247], v[112:115]
s_waitcnt vmcnt(11)
v_mfma_f32_16x16x32_bf16 v[96:99], a[208:211], v[248:251], v[96:99]
v_mfma_f32_16x16x32_bf16 v[100:103], a[212:215], v[248:251], v[100:103]
v_mfma_f32_16x16x32_bf16 v[104:107], a[216:219], v[248:251], v[104:107]
v_mfma_f32_16x16x32_bf16 v[108:111], a[220:223], v[248:251], v[108:111]
s_waitcnt vmcnt(4)
v_cmp_gt_u32 vcc, 13, v63
s_nop 0
s_cbranch_vccnz L_poll_95
L_polled_96:
v_mfma_f32_16x16x32_bf16 v[124:127], a[220:223], v[252:255], v[124:127]
s_add_u32 s23, s39, 20973568
buffer_load_dwordx4 v[160:163], v1, s[4:7], s23 offen offset:0 sc1
v_mfma_f32_16x16x32_bf16 v[120:123], a[216:219], v[252:255], v[120:123]
v_mfma_f32_16x16x32_bf16 v[116:119], a[212:215], v[252:255], v[116:119]
s_add_u32 s23, s39, 20977664
buffer_load_dwordx4 v[164:167], v1, s[4:7], s23 offen offset:0 sc1
v_mfma_f32_16x16x32_bf16 v[112:115], a[208:211], v[252:255], v[112:115]
v_mfma_f32_16x16x32_bf16 v[64:67], a[16:19], v[128:131], v[64:67]
s_add_u32 s23, s39, 20974592
buffer_load_dwordx4 v[168:171], v1, s[4:7], s23 offen offset:0 sc1
v_mfma_f32_16x16x32_bf16 v[68:71], a[20:23], v[128:131], v[68:71]
v_mfma_f32_16x16x32_bf16 v[72:75], a[24:27], v[128:131], v[72:75]
s_add_u32 s23, s39, 20978688
buffer_load_dwordx4 v[172:175], v1, s[4:7], s23 offen offset:0 sc1
v_mfma_f32_16x16x32_bf16 v[76:79], a[28:31], v[128:131], v[76:79]
v_mfma_f32_16x16x32_bf16 v[92:95], a[28:31], v[132:135], v[92:95]
s_add_u32 s23, s39, 21004288
buffer_load_dwordx4 v[176:179], v1, s[4:7], s23 offen offset:0 sc1
v_mfma_f32_16x16x32_bf16 v[88:91], a[24:27], v[132:135], v[88:91]
v_mfma_f32_16x16x32_bf16 v[84:87], a[20:23], v[132:135], v[84:87]
s_add_u32 s23, s87, 32624640
buffer_load_dwordx4 v[180:183], v1, s[4:7], s23 offen offset:0 sc1
v_mfma_f32_16x16x32_bf16 v[80:83], a[16:19], v[132:135], v[80:83]
v_mfma_f32_16x16x32_bf16 v[64:67], a[32:35], v[136:139], v[64:67]
s_add_u32 s23, s39, 21008384
buffer_load_dwordx4 v[184:187], v1, s[4:7], s23 offen offset:0 sc1
v_mfma_f32_16x16x32_bf16 v[68:71], a[36:39], v[136:139], v[68:71]
v_mfma_f32_16x16x32_bf16 v[72:75], a[40:43], v[136:139], v[72:75]
s_add_u32 s23, s87, 32638976
buffer_load_dwordx4 v[188:191], v1, s[4:7], s23 offen offset:0 sc1
v_mfma_f32_16x16x32_bf16 v[76:79], a[44:47], v[136:139], v[76:79]
v_mfma_f32_16x16x32_bf16 v[92:95], a[44:47], v[140:143], v[92:95]
s_add_u32 s23, s39, 21006336
buffer_load_dwordx4 v[192:195], v1, s[4:7], s23 offen offset:0 sc1
v_mfma_f32_16x16x32_bf16 v[88:91], a[40:43], v[140:143], v[88:91]
v_mfma_f32_16x16x32_bf16 v[84:87], a[36:39], v[140:143], v[84:87]
v_mfma_f32_16x16x32_bf16 v[80:83], a[32:35], v[140:143], v[80:83]
s_waitcnt vmcnt(12)
v_mfma_f32_16x16x32_bf16 v[64:67], a[128:131], v[144:147], v[64:67]
s_add_u32 s23, s39, 21010432
buffer_load_dwordx4 v[196:199], v1, s[4:7], s23 offen offset:0 sc1
v_mfma_f32_16x16x32_bf16 v[68:71], a[132:135], v[144:147], v[68:71]
v_mfma_f32_16x16x32_bf16 v[72:75], a[136:139], v[144:147], v[72:75]
v_mfma_f32_16x16x32_bf16 v[76:79], a[140:143], v[144:147], v[76:79]
s_waitcnt vmcnt(12)
v_mfma_f32_16x16x32_bf16 v[92:95], a[140:143], v[148:151], v[92:95]
s_add_u32 s23, s39, 21005312
buffer_load_dwordx4 v[200:203], v1, s[4:7], s23 offen offset:0 sc1
v_mfma_f32_16x16x32_bf16 v[88:91], a[136:139], v[148:151], v[88:91]
v_mfma_f32_16x16x32_bf16 v[84:87], a[132:135], v[148:151], v[84:87]
v_mfma_f32_16x16x32_bf16 v[80:83], a[128:131], v[148:151], v[80:83]
s_waitcnt vmcnt(12)
v_mfma_f32_16x16x32_bf16 v[64:67], a[144:147], v[152:155], v[64:67]
s_add_u32 s23, s87, 32625664
buffer_load_dwordx4 v[204:207], v1, s[4:7], s23 offen offset:0 sc1
v_mfma_f32_16x16x32_bf16 v[68:71], a[148:151], v[152:155], v[68:71]
v_mfma_f32_16x16x32_bf16 v[72:75], a[152:155], v[152:155], v[72:75]
v_mfma_f32_16x16x32_bf16 v[76:79], a[156:159], v[152:155], v[76:79]
s_waitcnt vmcnt(12)
v_mfma_f32_16x16x32_bf16 v[92:95], a[156:159], v[156:159], v[92:95]
s_add_u32 s23, s39, 21009408
buffer_load_dwordx4 v[208:211], v1, s[4:7], s23 offen offset:0 sc1
v_mfma_f32_16x16x32_bf16 v[88:91], a[152:155], v[156:159], v[88:91]
v_mfma_f32_16x16x32_bf16 v[84:87], a[148:151], v[156:159], v[84:87]
v_mfma_f32_16x16x32_bf16 v[80:83], a[144:147], v[156:159], v[80:83]
s_waitcnt vmcnt(12)
v_mfma_f32_16x16x32_bf16 v[64:67], a[0:3], v[160:163], v[64:67]
s_add_u32 s23, s87, 32640000
buffer_load_dwordx4 v[212:215], v1, s[4:7], s23 offen offset:0 sc1
v_mfma_f32_16x16x32_bf16 v[68:71], a[4:7], v[160:163], v[68:71]
v_mfma_f32_16x16x32_bf16 v[72:75], a[8:11], v[160:163], v[72:75]
v_mfma_f32_16x16x32_bf16 v[76:79], a[12:15], v[160:163], v[76:79]
s_waitcnt vmcnt(12)
v_mfma_f32_16x16x32_bf16 v[64:67], a[112:115], v[164:167], v[64:67]
s_add_u32 s23, s39, 21007360
buffer_load_dwordx4 v[216:219], v1, s[4:7], s23 offen offset:0 sc1
v_mfma_f32_16x16x32_bf16 v[68:71], a[116:119], v[164:167], v[68:71]
v_mfma_f32_16x16x32_bf16 v[72:75], a[120:123], v[164:167], v[72:75]
v_mfma_f32_16x16x32_bf16 v[76:79], a[124:127], v[164:167], v[76:79]
s_waitcnt vmcnt(12)
v_mfma_f32_16x16x32_bf16 v[92:95], a[12:15], v[168:171], v[92:95]
s_add_u32 s23, s39, 21011456
buffer_load_dwordx4 v[220:223], v1, s[4:7], s23 offen offset:0 sc1
v_mfma_f32_16x16x32_bf16 v[88:91], a[8:11], v[168:171], v[88:91]
v_mfma_f32_16x16x32_bf16 v[84:87], a[4:7], v[168:171], v[84:87]
v_mfma_f32_16x16x32_bf16 v[80:83], a[0:3], v[168:171], v[80:83]
s_waitcnt vmcnt(12)
v_mfma_f32_16x16x32_bf16 v[92:95], a[124:127], v[172:175], v[92:95]
v_mfma_f32_16x16x32_bf16 v[88:91], a[120:123], v[172:175], v[88:91]
v_cvt_pk_bf16_f32 v64, v64, v65
v_cvt_pk_bf16_f32 v65, v66, v67
v_cvt_pk_bf16_f32 v66, v68, v69
v_cvt_pk_bf16_f32 v67, v70, v71
ds_write_b128 v56, v[64:67] offset:0
v_mfma_f32_16x16x32_bf16 v[84:87], a[116:119], v[172:175], v[84:87]
v_mfma_f32_16x16x32_bf16 v[80:83], a[112:115], v[172:175], v[80:83]
s_waitcnt vmcnt(11)
v_mfma_f32_16x16x32_bf16 v[96:99], a[16:19], v[176:179], v[96:99]
v_mfma_f32_16x16x32_bf16 v[100:103], a[20:23], v[176:179], v[100:103]
v_cvt_pk_bf16_f32 v72, v72, v73
v_cvt_pk_bf16_f32 v73, v74, v75
v_cvt_pk_bf16_f32 v74, v76, v77
v_cvt_pk_bf16_f32 v75, v78, v79
ds_write_b128 v59, v[72:75] offset:2048
v_mfma_f32_16x16x32_bf16 v[104:107], a[24:27], v[176:179], v[104:107]
v_mfma_f32_16x16x32_bf16 v[108:111], a[28:31], v[176:179], v[108:111]
s_waitcnt vmcnt(10)
v_mfma_f32_16x16x32_bf16 v[96:99], a[32:35], v[180:183], v[96:99]
v_mfma_f32_16x16x32_bf16 v[100:103], a[36:39], v[180:183], v[100:103]
v_cvt_pk_bf16_f32 v80, v80, v81
v_cvt_pk_bf16_f32 v81, v82, v83
v_cvt_pk_bf16_f32 v82, v84, v85
v_cvt_pk_bf16_f32 v83, v86, v87
ds_write_b128 v56, v[80:83] offset:256
v_mfma_f32_16x16x32_bf16 v[104:107], a[40:43], v[180:183], v[104:107]
v_mfma_f32_16x16x32_bf16 v[108:111], a[44:47], v[180:183], v[108:111]
s_waitcnt vmcnt(9)
v_mfma_f32_16x16x32_bf16 v[96:99], a[128:131], v[184:187], v[96:99]
v_mfma_f32_16x16x32_bf16 v[100:103], a[132:135], v[184:187], v[100:103]
v_cvt_pk_bf16_f32 v88, v88, v89
v_cvt_pk_bf16_f32 v89, v90, v91
v_cvt_pk_bf16_f32 v90, v92, v93
v_cvt_pk_bf16_f32 v91, v94, v95
ds_write_b128 v59, v[88:91] offset:2304
v_mfma_f32_16x16x32_bf16 v[104:107], a[136:139], v[184:187], v[104:107]
v_mfma_f32_16x16x32_bf16 v[108:111], a[140:143], v[184:187], v[108:111]
s_waitcnt vmcnt(8)
v_mfma_f32_16x16x32_bf16 v[96:99], a[144:147], v[188:191], v[96:99]
v_mfma_f32_16x16x32_bf16 v[100:103], a[148:151], v[188:191], v[100:103]
v_mfma_f32_16x16x32_bf16 v[104:107], a[152:155], v[188:191], v[104:107]
v_mfma_f32_16x16x32_bf16 v[108:111], a[156:159], v[188:191], v[108:111]
s_waitcnt lgkmcnt(0)
s_barrier
ds_read_b128 v[64:67], v57 offset:0
ds_read_b128 v[68:71], v38 offset:0
ds_read_b128 v[72:75], v39 offset:0
ds_read_b128 v[76:79], v60 offset:0
s_waitcnt vmcnt(7)
v_mfma_f32_16x16x32_bf16 v[96:99], a[0:3], v[192:195], v[96:99]
v_mfma_f32_16x16x32_bf16 v[100:103], a[4:7], v[192:195], v[100:103]
v_mfma_f32_16x16x32_bf16 v[104:107], a[8:11], v[192:195], v[104:107]
v_mfma_f32_16x16x32_bf16 v[108:111], a[12:15], v[192:195], v[108:111]
s_waitcnt vmcnt(6)
v_mfma_f32_16x16x32_bf16 v[96:99], a[112:115], v[196:199], v[96:99]
v_mfma_f32_16x16x32_bf16 v[100:103], a[116:119], v[196:199], v[100:103]
v_mfma_f32_16x16x32_bf16 v[104:107], a[120:123], v[196:199], v[104:107]
v_mfma_f32_16x16x32_bf16 v[108:111], a[124:127], v[196:199], v[108:111]
s_waitcnt lgkmcnt(3)
v_mfma_f32_16x16x32_bf16 v[40:43], a[240:243], v[64:67], v[40:43]
s_waitcnt lgkmcnt(2)
v_mfma_f32_16x16x32_bf16 v[44:47], a[240:243], v[68:71], v[44:47]
s_waitcnt lgkmcnt(1)
v_mfma_f32_16x16x32_bf16 v[40:43], a[244:247], v[72:75], v[40:43]
s_waitcnt lgkmcnt(0)
v_mfma_f32_16x16x32_bf16 v[44:47], a[244:247], v[76:79], v[44:47]
s_waitcnt vmcnt(5)
v_mfma_f32_16x16x32_bf16 v[124:127], a[28:31], v[200:203], v[124:127]
v_mfma_f32_16x16x32_bf16 v[120:123], a[24:27], v[200:203], v[120:123]
v_mfma_f32_16x16x32_bf16 v[116:119], a[20:23], v[200:203], v[116:119]
v_mfma_f32_16x16x32_bf16 v[112:115], a[16:19], v[200:203], v[112:115]
s_waitcnt vmcnt(4)
v_mfma_f32_16x16x32_bf16 v[124:127], a[44:47], v[204:207], v[124:127]
v_mfma_f32_16x16x32_bf16 v[120:123], a[40:43], v[204:207], v[120:123]
v_cvt_pk_bf16_f32 v6, v40, v41
v_cvt_pk_bf16_f32 v7, v42, v43
v_cvt_pk_bf16_f32 v8, v44, v45
v_cvt_pk_bf16_f32 v9, v46, v47
s_nop 0
v_permlane16_swap_b32 v6, v8
v_permlane16_swap_b32 v7, v9
buffer_store_dwordx4 v[6:9], v58, s[8:11], s36 offen sc1
v_mfma_f32_16x16x32_bf16 v[116:119], a[36:39], v[204:207], v[116:119]
v_mfma_f32_16x16x32_bf16 v[112:115], a[32:35], v[204:207], v[112:115]
v_cvt_pk_bf16_f32 v96, v96, v97
v_cvt_pk_bf16_f32 v97, v98, v99
v_cvt_pk_bf16_f32 v98, v100, v101
v_cvt_pk_bf16_f32 v99, v102, v103
ds_write_b128 v56, v[96:99] offset:16384
s_waitcnt vmcnt(4)
v_mfma_f32_16x16x32_bf16 v[124:127], a[140:143], v[208:211], v[124:127]
v_mfma_f32_16x16x32_bf16 v[120:123], a[136:139], v[208:211], v[120:123]
v_mfma_f32_16x16x32_bf16 v[116:119], a[132:135], v[208:211], v[116:119]
v_mfma_f32_16x16x32_bf16 v[112:115], a[128:131], v[208:211], v[112:115]
v_cvt_pk_bf16_f32 v104, v104, v105
v_cvt_pk_bf16_f32 v105, v106, v107
v_cvt_pk_bf16_f32 v106, v108, v109
v_cvt_pk_bf16_f32 v107, v110, v111
ds_write_b128 v59, v[104:107] offset:18432
s_waitcnt vmcnt(3)
v_mfma_f32_16x16x32_bf16 v[124:127], a[156:159], v[212:215], v[124:127]
v_mfma_f32_16x16x32_bf16 v[120:123], a[152:155], v[212:215], v[120:123]
v_mfma_f32_16x16x32_bf16 v[116:119], a[148:151], v[212:215], v[116:119]
v_mfma_f32_16x16x32_bf16 v[112:115], a[144:147], v[212:215], v[112:115]
s_waitcnt vmcnt(2)
v_mfma_f32_16x16x32_bf16 v[124:127], a[12:15], v[216:219], v[124:127]
v_mfma_f32_16x16x32_bf16 v[120:123], a[8:11], v[216:219], v[120:123]
v_mfma_f32_16x16x32_bf16 v[116:119], a[4:7], v[216:219], v[116:119]
v_mfma_f32_16x16x32_bf16 v[112:115], a[0:3], v[216:219], v[112:115]
s_waitcnt vmcnt(1)
v_mfma_f32_16x16x32_bf16 v[124:127], a[124:127], v[220:223], v[124:127]
v_mfma_f32_16x16x32_bf16 v[120:123], a[120:123], v[220:223], v[120:123]
v_mfma_f32_16x16x32_bf16 v[116:119], a[116:119], v[220:223], v[116:119]
v_mfma_f32_16x16x32_bf16 v[112:115], a[112:115], v[220:223], v[112:115]
s_nop 5
v_cvt_pk_bf16_f32 v120, v120, v121
v_cvt_pk_bf16_f32 v121, v122, v123
v_cvt_pk_bf16_f32 v122, v124, v125
v_cvt_pk_bf16_f32 v123, v126, v127
ds_write_b128 v59, v[120:123] offset:18688
v_cvt_pk_bf16_f32 v112, v112, v113
v_cvt_pk_bf16_f32 v113, v114, v115
v_cvt_pk_bf16_f32 v114, v116, v117
v_cvt_pk_bf16_f32 v115, v118, v119
ds_write_b128 v56, v[112:115] offset:16640
s_waitcnt lgkmcnt(0)
s_barrier
ds_read_b128 v[96:99], v57 offset:16384
ds_read_b128 v[100:103], v38 offset:16384
ds_read_b128 v[104:107], v39 offset:16384
ds_read_b128 v[108:111], v60 offset:16384
s_waitcnt lgkmcnt(3)
v_mfma_f32_16x16x32_bf16 v[48:51], a[240:243], v[96:99], v[48:51]
s_waitcnt lgkmcnt(2)
v_mfma_f32_16x16x32_bf16 v[52:55], a[240:243], v[100:103], v[52:55]
s_waitcnt lgkmcnt(1)
v_mfma_f32_16x16x32_bf16 v[48:51], a[244:247], v[104:107], v[48:51]
s_waitcnt lgkmcnt(0)
v_mfma_f32_16x16x32_bf16 v[52:55], a[244:247], v[108:111], v[52:55]
s_nop 5
v_cvt_pk_bf16_f32 v10, v48, v49
v_cvt_pk_bf16_f32 v11, v50, v51
v_cvt_pk_bf16_f32 v12, v52, v53
v_cvt_pk_bf16_f32 v13, v54, v55
s_nop 0
v_permlane16_swap_b32 v10, v12
v_permlane16_swap_b32 v11, v13
buffer_store_dwordx4 v[10:13], v58, s[8:11], s15 offen sc1
s_endpgm
L_spinout_68:
s_mov_b32 s29, 0
s_branch L_spun_67
L_spinout_71:
s_mov_b32 s29, 0
s_branch L_spun_70
L_poll_72:
s_sleep 8
buffer_load_dword v63, v62, s[4:7], s79 offen sc1
s_waitcnt vmcnt(0)
v_cmp_gt_u32 vcc, 3, v63
s_nop 0
s_cbranch_vccz L_polled_73
s_sub_u32 s29, s29, 1
s_cbranch_scc0 L_poll_72
s_mov_b32 s29, 0
s_branch L_polled_73
L_poll_74:
s_sleep 8
buffer_load_dword v63, v62, s[4:7], s79 offen sc1
s_waitcnt vmcnt(0)
v_cmp_gt_u32 vcc, 4, v63
s_nop 0
s_cbranch_vccz L_polled_75
s_sub_u32 s29, s29, 1
s_cbranch_scc0 L_poll_74
s_mov_b32 s29, 0
s_branch L_polled_75
L_poll_76:
s_sleep 8
buffer_load_dword v63, v62, s[4:7], s79 offen sc1
s_waitcnt vmcnt(0)
v_cmp_gt_u32 vcc, 5, v63
s_nop 0
s_cbranch_vccz L_polled_77
s_sub_u32 s29, s29, 1
s_cbranch_scc0 L_poll_76
s_mov_b32 s29, 0
s_branch L_polled_77
L_spinout_80:
s_mov_b32 s29, 0
s_branch L_spun_79
L_kvagain_82:
s_mov_b32 s98, 4096
L_kvmore_84:
s_sub_u32 s98, s98, 1
s_cbranch_scc1 L_kvok_81
s_sleep 2
buffer_load_dwordx4 v[224:227], v62, s[4:7], s37 offen sc1
s_add_u32 s23, s36, 0
buffer_load_dwordx4 v[192:195], v1, s[4:7], s23 offen offset:0 sc1
buffer_load_dwordx4 v[196:199], v1, s[4:7], s23 offen offset:1024 sc1
buffer_load_dwordx4 v[200:203], v1, s[4:7], s23 offen offset:2048 sc1
buffer_load_dwordx4 v[204:207], v1, s[4:7], s23 offen offset:3072 sc1
s_add_u32 s23, s36, 4096
buffer_load_dwordx4 v[208:211], v1, s[4:7], s23 offen offset:0 sc1
buffer_load_dwordx4 v[212:215], v1, s[4:7], s23 offen offset:1024 sc1
buffer_load_dwordx4 v[216:219], v1, s[4:7], s23 offen offset:2048 sc1
buffer_load_dwordx4 v[220:223], v1, s[4:7], s23 offen offset:3072 sc1
s_waitcnt vmcnt(8)
s_waitcnt vmcnt(7)
v_mfma_f32_32x32x16_bf16 v[112:127], v[44:47], v[192:195], 0
v_add_f32_dpp v224, v224, v224 row_ror:8 row_mask:0xf bank_mask:0xf
v_add_f32_dpp v225, v225, v225 row_ror:8 row_mask:0xf bank_mask:0xf
v_add_f32_dpp v226, v226, v226 row_ror:8 row_mask:0xf bank_mask:0xf
v_add_f32_dpp v227, v227, v227 row_ror:8 row_mask:0xf bank_mask:0xf
s_waitcnt vmcnt(6)
v_mfma_f32_32x32x16_bf16 v[112:127], v[44:47], v[196:199], v[112:127]
v_add_f32_dpp v224, v224, v224 row_ror:4 row_mask:0xf bank_mask:0xf
v_add_f32_dpp v225, v225, v225 row_ror:4 row_mask:0xf bank_mask:0xf
v_add_f32_dpp v226, v226, v226 row_ror:4 row_mask:0xf bank_mask:0xf
v_add_f32_dpp v227, v227, v227 row_ror:4 row_mask:0xf bank_mask:0xf
s_waitcnt vmcnt(5)
v_mfma_f32_32x32x16_bf16 v[112:127], v[44:47], v[200:203], v[112:127]
v_add_f32_dpp v224, v224, v224 row_ror:2 row_mask:0xf bank_mask:0xf
v_add_f32_dpp v225, v225, v225 row_ror:2 row_mask:0xf bank_mask:0xf
v_add_f32_dpp v226, v226, v226 row_ror:2 row_mask:0xf bank_mask:0xf
v_add_f32_dpp v227, v227, v227 row_ror:2 row_mask:0xf bank_mask:0xf
s_waitcnt vmcnt(4)
v_mfma_f32_32x32x16_bf16 v[112:127], v[44:47], v[204:207], v[112:127]
v_add_f32_dpp v224, v224, v224 row_ror:1 row_mask:0xf bank_mask:0xf
v_add_f32_dpp v225, v225, v225 row_ror:1 row_mask:0xf bank_mask:0xf
v_add_f32_dpp v226, v226, v226 row_ror:1 row_mask:0xf bank_mask:0xf
v_add_f32_dpp v227, v227, v227 row_ror:1 row_mask:0xf bank_mask:0xf
s_waitcnt vmcnt(3)
v_mfma_f32_32x32x16_bf16 v[112:127], v[44:47], v[208:211], v[112:127]
v_add_f32 v52, v224, v225
v_add_f32 v53, v226, v227
v_cvt_pk_bf16_f32 v54, v224, v225
v_cvt_pk_bf16_f32 v55, v226, v227
s_waitcnt vmcnt(2)
v_mfma_f32_32x32x16_bf16 v[112:127], v[44:47], v[212:215], v[112:127]
v_add_f32 v52, v52, v53
s_waitcnt vmcnt(1)
v_mfma_f32_32x32x16_bf16 v[112:127], v[44:47], v[216:219], v[112:127]
s_waitcnt vmcnt(0)
v_mfma_f32_32x32x16_bf16 v[112:127], v[44:47], v[220:223], v[112:127]
s_nop 11
v_cmp_u_f32 vcc, v112, v52
v_cvt_pk_bf16_f32 v50, v112, v113
s_cbranch_vccnz L_kvmore_84
s_branch L_kvok_81
L_spinout_87:
s_mov_b32 s29, 0
s_branch L_spun_86
L_spinout_90:
s_mov_b32 s29, 0
s_branch L_spun_89
L_poll_91:
s_sleep 8
buffer_load_dword v63, v62, s[4:7], s79 offen sc1
s_waitcnt vmcnt(0)
v_cmp_gt_u32 vcc, 11, v63
s_nop 0
s_cbranch_vccz L_polled_92
s_sub_u32 s29, s29, 1
s_cbranch_scc0 L_poll_91
s_mov_b32 s29, 0
s_branch L_polled_92
L_poll_93:
s_sleep 8
buffer_load_dword v63, v62, s[4:7], s79 offen sc1
s_waitcnt vmcnt(0)
v_cmp_gt_u32 vcc, 12, v63
s_nop 0
s_cbranch_vccz L_polled_94
s_sub_u32 s29, s29, 1
s_cbranch_scc0 L_poll_93
s_mov_b32 s29, 0
s_branch L_polled_94
L_poll_95:
s_sleep 8
buffer_load_dword v63, v62, s[4:7], s79 offen sc1
s_waitcnt vmcnt(0)
v_cmp_gt_u32 vcc, 13, v63
s_nop 0
s_cbranch_vccz L_polled_96
s_sub_u32 s29, s29, 1
s_cbranch_scc0 L_poll_95
s_mov_b32 s29, 0
s_branch L_polled_96
.section .rodata,"a"
.p2align 6
.amdhsa_kernel interleave_layers__linear_kernel_hedgehog__glu_gated_geglu__prompt_kernel
  .amdhsa_next_free_vgpr 512
  .amdhsa_next_free_sgpr 102
  .amdhsa_accum_offset 256
  .amdhsa_group_segment_fixed_size 0
  .amdhsa_kernarg_size 88
  .amdhsa_user_sgpr_count 2
  .amdhsa_user_sgpr_kernarg_segment_ptr 1
  .amdhsa_system_sgpr_workgroup_id_x 1
  .amdhsa_float_denorm_mode_32 3
  .amdhsa_float_denorm_mode_16_64 3
.end_amdhsa_kernel
```
